```python
import torch

def _softmax(x, axis=-1):
    return torch.softmax(x, dim=axis)

def _gelu(x):
    return torch.nn.functional.gelu(x, approximate='tanh')

def _silu(x):
    return torch.nn.functional.silu(x)

def _sigmoid(x):
    return torch.sigmoid(x)

def _layernorm(x, axis=-1, eps=1e-05):
    m = x.mean(dim=axis, keepdim=True)
    v = x.var(dim=axis, keepdim=True, unbiased=False)
    return (x - m) / torch.sqrt(v + eps)

def _scatter_add(tgt, idx, src, axis=0):
    return tgt.clone().index_add_(axis, idx, src)

def _segment_sum(src, seg, n):
    out = torch.zeros((n,) + src.shape[1:], dtype=src.dtype)
    return out.index_add_(0, seg, src)

def _pad(x, pw):
    flat = tuple((v for pair in reversed(pw) for v in pair))
    return torch.nn.functional.pad(x, flat)
kernel_name = 'adaLN_cond__memory_aug_recurrent_mem_tr__glu_gated_reglu__prompt'

def setup_inputs():

    _w = lambda a: (lambda t: t.to(torch.bfloat16) if t.is_floating_point() else t)(torch.as_tensor(a))

    def _A_setup():
        B, S, Dm = (1, 2048, 640)
        H, Dh = (32, 128)
        M, seg = (8, 32)
        seg = min(seg, S)
        S = S // seg * seg
        return {'x': _w((lambda *s: torch.randn(*s, dtype=torch.bfloat16) * 0.05)(B, S, Dm)), 'mem0': _w((lambda *s: torch.randn(*s, dtype=torch.bfloat16) * 0.8)(B, M, Dm)), 'Wq': _w((lambda *s: torch.randn(*s, dtype=torch.bfloat16) * 0.8)(Dm, H, Dh) * Dm ** (-0.5)), 'Wk': _w((lambda *s: torch.randn(*s, dtype=torch.bfloat16) * 0.8)(Dm, H, Dh) * Dm ** (-0.5)), 'Wv': _w((lambda *s: torch.randn(*s, dtype=torch.bfloat16) * 0.8)(Dm, H, Dh) * Dm ** (-0.5)), 'Wo': _w((lambda *s: torch.randn(*s, dtype=torch.bfloat16) * 0.8)(H, Dh, Dm) * (H * Dh) ** (-0.5)), 'seg_len': seg}
    _A_in = _A_setup()

    def _B_setup():
        B, S, D, F = (1, 2048, 640, 1728)
        return {'x': _w((lambda *s: torch.randn(*s, dtype=torch.bfloat16) * 0.05)(B, S, D)), 'W_gate': _w((lambda *s: torch.randn(*s, dtype=torch.bfloat16) * 0.4)(D, F) * (2.0 / D) ** 0.5), 'W_up': _w((lambda *s: torch.randn(*s, dtype=torch.bfloat16) * 0.4)(D, F) * (2.0 / D) ** 0.5), 'W_down': _w((lambda *s: torch.randn(*s, dtype=torch.bfloat16) * 0.4)(F, D) * (1.0 / F) ** 0.5)}
    _B_in = _B_setup()
    return {'A_x': _A_in['x'], 'A_mem0': _A_in['mem0'], 'A_Wq': _A_in['Wq'], 'A_Wk': _A_in['Wk'], 'A_Wv': _A_in['Wv'], 'A_Wo': _A_in['Wo'], 'A_seg_len': _A_in['seg_len'], 'B_x': _B_in['x'], 'B_W_gate': _B_in['W_gate'], 'B_W_up': _B_in['W_up'], 'B_W_down': _B_in['W_down'], 'c': _w((lambda *s: torch.randn(*s, dtype=torch.bfloat16) * 0.1)(1, 640) * 8.0), 'w_mod': _w((lambda *s: torch.randn(*s, dtype=torch.bfloat16) * 0.1)(640, 6 * 640) * 640 ** (-0.5) * 8.0)}

def reference(A_x, A_mem0, A_Wq, A_Wk, A_Wv, A_Wo, A_seg_len, B_x, B_W_gate, B_W_up, B_W_down, c, w_mod):

    def _A_ref(x, mem0, Wq, Wk, Wv, Wo, seg_len):
        B, S, Dm = x.shape
        H, Dh = (Wq.shape[1], Wq.shape[2])
        M = mem0.shape[1]
        scale = Dh ** (-0.5)
        n_seg = S // seg_len
        L = M + seg_len
        idx = torch.arange(L)
        mask = (idx[:, None] < M) | (idx[:, None] >= idx[None, :])
        mem = mem0
        outs = []
        for s in range(n_seg):
            xs = x[:, s * seg_len:(s + 1) * seg_len, :].clone()
            h = torch.concatenate([mem, xs], axis=1)
            q = torch.einsum('btd,dhe->bhte', h, Wq)
            k = torch.einsum('btd,dhe->bhte', h, Wk)
            v = torch.einsum('btd,dhe->bhte', h, Wv)
            scores = torch.einsum('bhqe,bhke->bhqk', q, k) * scale
            scores = torch.where(mask[None, None], scores, -1000000000.0)
            p = _softmax(scores, axis=-1)
            o = torch.einsum('bhqk,bhke->bhqe', p, v)
            o = torch.einsum('bhte,hed->btd', o, Wo)
            mem = o[:, :M, :].clone()
            outs.append(o[:, M:, :])
        return torch.concatenate(outs, axis=1)

    def _B_ref(x, W_gate, W_up, W_down):
        gate = torch.einsum('bsd,df->bsf', x, W_gate)
        up = torch.einsum('bsd,df->bsf', x, W_up)
        gate = gate * (lambda x, dt: x.to(dt))(gate > 0, gate.dtype)
        h = gate * up
        return torch.einsum('bsf,fd->bsd', h, W_down)
    x = A_x
    mod = (_silu(c) @ w_mod).reshape(c.shape[0], 6, 1, -1)
    sa, ca, ga, sb, cb, gb = (mod[:, 0].clone(), mod[:, 1].clone(), mod[:, 2].clone(), mod[:, 3].clone(), mod[:, 4].clone(), mod[:, 5].clone())
    h = _layernorm(x, axis=-1) * (1 + ca) + sa
    x = x + ga * _A_ref(h, A_mem0, A_Wq, A_Wk, A_Wv, A_Wo, A_seg_len)
    h = _layernorm(x, axis=-1) * (1 + cb) + sb
    x = x + gb * _B_ref(h, B_W_gate, B_W_up, B_W_down)
    return x
```

```asm
; @launch grid=(256,1,1) block=(256,1,1) lds=163840
.amdgcn_target "amdgcn-amd-amdhsa--gfx950"
.text
.globl adaLN_cond__memory_aug_recurrent_mem_tr__glu_gated_reglu__prompt_kernel
.p2align 8
.type adaLN_cond__memory_aug_recurrent_mem_tr__glu_gated_reglu__prompt_kernel,@function
adaLN_cond__memory_aug_recurrent_mem_tr__glu_gated_reglu__prompt_kernel:
s_cmp_ge_u32 s2, 256
s_cbranch_scc1 L_exit
v_lshrrev_b32 v1, 6, v0
s_nop 0
v_readfirstlane_b32 s26, v1
s_mov_b32 s27, 0
s_mov_b32 s3, 0
L_start:
s_load_dwordx16 s[64:79], s[0:1], 0
s_load_dwordx16 s[80:95], s[0:1], 64
s_getreg_b32 s30, hwreg(HW_REG_XCC_ID)
s_mul_i32 s31, s3, 2097152
s_waitcnt lgkmcnt(0)
s_mov_b32 s28, s92
s_mov_b32 s29, s93
s_add_u32 s4, s94, s31
s_addc_u32 s5, s95, 0
s_mov_b32 s6, 134217728
s_mov_b32 s7, 0x20000
s_mov_b32 s77, s3
s_and_b32 s78, s30, 8
s_and_b32 s30, s30, 7
s_lshl_b32 s30, s30, 2
s_lshr_b32 s24, 1412568838, s30
s_and_b32 s24, s24, 7
s_lshr_b32 s25, s2, 3
s_mov_b32 s76, 0
s_cmp_lg_u32 s3, 0
s_cbranch_scc1 L_again
L_roles_f:
s_cmp_ge_u32 s24, 4
s_cbranch_scc1 L_role_p_f
s_cmp_ge_u32 s24, 2
s_cbranch_scc1 L_role_k_f
L_role_r_f:
s_cmp_lg_u32 s26, 0
s_cbranch_scc1 L_arrr_f
s_mul_i32 s3, s24, 66
s_and_b32 s3, s3, 0xc8
s_add_u32 s3, s3, s76
v_mov_b32 v18, s3
s_lshl_b32 s3, 1, s25
v_mov_b32 v16, s3
s_add_u32 s3, s78, 0x10000
v_mov_b32 v17, s3
s_mov_b64 exec, 1
global_atomic_add_x2 v18, v[16:17], s[28:29] sc1
s_mov_b64 exec, -1
L_arrr_f:
s_mov_b32 s8, s68
s_mov_b32 s9, s69
s_mov_b32 s10, 5242880
s_mov_b32 s11, 0x20000
s_mov_b32 s12, s70
s_mov_b32 s13, s71
s_mov_b32 s14, 5242880
s_mov_b32 s15, 0x20000
s_mov_b32 s16, s72
s_mov_b32 s17, s73
s_mov_b32 s18, 5242880
s_mov_b32 s19, 0x20000
s_mov_b32 s20, s74
s_mov_b32 s21, s75
s_mov_b32 s22, 5242880
s_mov_b32 s23, 0x20000
v_mbcnt_lo_u32_b32 v6, -1, 0
v_mbcnt_hi_u32_b32 v6, -1, v6
s_lshl_b32 s32, s26, 6
s_lshl_b32 s3, s25, 8
s_add_u32 s3, s3, s32
s_mul_i32 s33, s24, 2621440
s_sub_u32 s34, 2621440, s33
s_lshl_b32 s35, s26, 10
v_lshrrev_b32 v7, 2, v6
v_and_b32 v4, 3, v6
v_lshlrev_b32 v0, 13, v7
v_lshl_add_u32 v0, v4, 4, v0
v_add_u32 v0, s3, v0
s_mul_i32 s3, s25, 163840
s_mul_i32 s30, s24, 640
s_add_u32 s3, s3, s30
v_mul_u32_u24 v1, 1280, v7
v_lshl_add_u32 v1, v4, 4, v1
v_add_u32 v1, s3, v1
s_and_b32 s37, s32, 64
s_lshr_b32 s30, s26, 1
s_mul_i32 s30, s30, 81920
s_add_u32 s37, s37, s30
s_add_u32 s37, s37, 512
s_add_u32 m0, s35, 40960
s_add_u32 s36, s33, 0
buffer_load_dwordx4 v0, s[16:19], s36 offen lds
s_add_u32 m0, s35, 45056
s_add_u32 s36, s33, 131072
buffer_load_dwordx4 v0, s[16:19], s36 offen lds
s_add_u32 m0, s35, 49152
s_add_u32 s36, s33, 262144
buffer_load_dwordx4 v0, s[16:19], s36 offen lds
s_add_u32 m0, s35, 53248
s_add_u32 s36, s33, 393216
buffer_load_dwordx4 v0, s[16:19], s36 offen lds
s_barrier
s_add_u32 m0, s35, 57344
s_add_u32 s36, s33, 524288
buffer_load_dwordx4 v0, s[12:15], s36 offen lds
s_add_u32 m0, s35, 61440
s_add_u32 s36, s33, 655360
buffer_load_dwordx4 v0, s[12:15], s36 offen lds
s_add_u32 m0, s35, 65536
s_add_u32 s36, s33, 786432
buffer_load_dwordx4 v0, s[12:15], s36 offen lds
s_add_u32 m0, s35, 69632
s_add_u32 s36, s33, 917504
buffer_load_dwordx4 v0, s[12:15], s36 offen lds
s_barrier
s_add_u32 m0, s35, 73728
s_add_u32 s36, s33, 524288
buffer_load_dwordx4 v0, s[16:19], s36 offen lds
s_add_u32 m0, s35, 77824
s_add_u32 s36, s33, 655360
buffer_load_dwordx4 v0, s[16:19], s36 offen lds
s_add_u32 m0, s35, 81920
s_add_u32 s36, s33, 786432
buffer_load_dwordx4 v0, s[16:19], s36 offen lds
s_add_u32 m0, s35, 86016
s_add_u32 s36, s33, 917504
buffer_load_dwordx4 v0, s[16:19], s36 offen lds
s_barrier
s_add_u32 m0, s35, 90112
s_add_u32 s36, s33, 1048576
buffer_load_dwordx4 v0, s[16:19], s36 offen lds
s_add_u32 m0, s35, 94208
s_add_u32 s36, s33, 1179648
buffer_load_dwordx4 v0, s[16:19], s36 offen lds
s_add_u32 m0, s35, 98304
s_add_u32 s36, s33, 1310720
buffer_load_dwordx4 v0, s[16:19], s36 offen lds
s_add_u32 m0, s35, 102400
s_add_u32 s36, s33, 1441792
buffer_load_dwordx4 v0, s[16:19], s36 offen lds
s_barrier
v_bfe_u32 v8, v6, 5, 1
v_bfe_u32 v9, v6, 4, 1
v_bfe_u32 v10, v6, 3, 1
v_bfe_u32 v11, v6, 2, 1
s_min_u32 s41, s26, 1
s_lshr_b32 s38, s25, s41
s_lshl_b32 s3, s26, 5
s_add_u32 s38, s38, s3
s_and_b32 s42, s25, s41
s_mul_i32 s30, s24, 262144
s_add_u32 s30, s30, 1048576
s_lshl_b32 s46, s38, 12
s_add_u32 s46, s46, s30
s_lshl_b32 s3, s42, 6
s_add_u32 s46, s46, s3
s_add_u32 s47, s46, 32768
s_lshr_b32 s39, s38, 2
s_lshl_b32 s53, s39, 9
s_and_b32 s40, s38, 3
s_lshl_b32 s3, s40, 6
s_add_u32 s53, s53, s3
s_lshl_b32 s3, s26, 14
s_lshl_b32 s55, s25, 7
s_add_u32 s43, s3, s55
s_add_u32 s43, s43, s30
s_add_u32 s44, s43, 65536
s_add_u32 s45, s43, 131072
s_add_u32 s54, s55, 0
s_lshl_b32 s3, s24, 2
s_add_u32 s55, s55, s3
s_add_u32 s55, s55, 524288
s_lshl_b32 s60, s24, 15
s_add_u32 s60, s60, 65536
s_mul_i32 s61, s24, 131072
s_sub_u32 s62, 393216, s61
s_add_u32 s61, s61, 262144
v_lshrrev_b32 v12, 4, v6
v_and_b32 v13, 15, v6
v_lshlrev_b32 v14, 12, v12
v_lshl_add_u32 v14, v13, 3, v14
v_mov_b32 v16, 1
v_mov_b32 v17, 1
v_mov_b32 v18, 0
buffer_store_dwordx2 v[16:17], v14, s[4:7], s43 offen
buffer_store_dwordx2 v[16:17], v14, s[4:7], s44 offen
buffer_store_dwordx2 v[16:17], v14, s[4:7], s45 offen
s_mov_b32 s96, s66
s_mov_b32 s97, s67
s_mov_b32 s98, 10240
s_mov_b32 s99, 0x20000
s_mul_i32 s40, s40, 2560
s_lshl_b32 s39, s39, 6
s_add_u32 s39, s39, s40
s_mul_i32 s3, s24, 640
s_add_u32 s101, s39, s3
v_and_b32 v15, 1, v6
v_bfe_u32 v20, v6, 1, 1
v_lshlrev_b32 v23, 8, v20
v_lshl_add_u32 v23, v11, 5, v23
v_lshl_add_u32 v23, v15, 4, v23
s_xor_b32 s3, s41, 1
v_and_b32 v25, s3, v12
v_add_u32 v25, s42, v25
v_lshl_add_u32 v25, v25, 1, v8
v_lshl_add_u32 v23, v25, 2, v23
v_add_u32 v23, s53, v23
v_mov_b32 v24, -1
v_mul_u32_u24 v19, 1280, v15
v_lshl_add_u32 v19, v20, 5, v19
v_lshl_add_u32 v19, v25, 3, v19
v_lshl_add_u32 v19, v11, 1, v19
buffer_load_ushort v200, v19, s[96:99], s101 offen
buffer_load_ushort v201, v19, s[96:99], s101 offen offset:4
v_mov_b32 v26, 2147483632
s_cmp_lt_u32 s38, 40
s_cselect_b64 vcc, -1, 0
v_cndmask_b32 v202, v26, v23, vcc
s_cbranch_scc0 L_rinit_f
s_add_u32 s3, s60, 5120
buffer_store_dword v24, v202, s[4:7], s3 offen
s_add_u32 s3, s61, 32768
buffer_store_dword v24, v202, s[4:7], s3 offen sc1
s_add_u32 s3, s61, 40960
buffer_store_dword v24, v202, s[4:7], s3 offen sc1
s_add_u32 s3, s61, 49152
buffer_store_dword v24, v202, s[4:7], s3 offen sc1
s_add_u32 s3, s61, 57344
buffer_store_dword v24, v202, s[4:7], s3 offen sc1
s_add_u32 s3, s60, 10240
buffer_store_dword v24, v202, s[4:7], s3 offen
s_add_u32 s3, s61, 65536
buffer_store_dword v24, v202, s[4:7], s3 offen sc1
s_add_u32 s3, s61, 73728
buffer_store_dword v24, v202, s[4:7], s3 offen sc1
s_add_u32 s3, s61, 81920
buffer_store_dword v24, v202, s[4:7], s3 offen sc1
s_add_u32 s3, s61, 90112
buffer_store_dword v24, v202, s[4:7], s3 offen sc1
s_add_u32 s3, s60, 15360
buffer_store_dword v24, v202, s[4:7], s3 offen
s_add_u32 s3, s61, 98304
buffer_store_dword v24, v202, s[4:7], s3 offen sc1
s_add_u32 s3, s61, 106496
buffer_store_dword v24, v202, s[4:7], s3 offen sc1
s_add_u32 s3, s61, 114688
buffer_store_dword v24, v202, s[4:7], s3 offen sc1
s_add_u32 s3, s61, 122880
buffer_store_dword v24, v202, s[4:7], s3 offen sc1
L_rinit_f:
v_lshlrev_b32 v19, 13, v6
v_mov_b32 v20, 2147483632
s_cmp_eq_u32 s26, 3
s_cselect_b32 s3, 4, 0
v_cmp_gt_u32 vcc, s3, v6
s_nop 1
v_cndmask_b32 v19, v20, v19, vcc
buffer_store_dword v18, v19, s[4:7], s55 offen sc1
v_and_b32 v19, 7, v6
v_lshlrev_b32 v19, 7, v19
s_lshl_b32 s3, s24, 10
s_lshl_b32 s30, s25, 2
s_add_u32 s3, s3, s30
s_add_u32 s3, s3, 49152
buffer_store_dword v18, v19, s[4:7], s3 offen
v_lshlrev_b32 v5, 4, v6
v_add_u32 v5, s35, v5
v_lshlrev_b32 v4, 3, v4
v_add_u32 v4, s35, v4
v_lshl_add_u32 v2, v8, 12, v4
v_lshl_add_u32 v2, v9, 9, v2
v_lshl_add_u32 v2, v11, 7, v2
v_lshl_add_u32 v2, v10, 6, v2
v_lshl_add_u32 v3, v9, 12, v4
v_lshl_add_u32 v3, v10, 5, v3
v_lshl_add_u32 v3, v8, 8, v3
v_lshl_add_u32 v3, v11, 6, v3
s_waitcnt vmcnt(19)
v_add_u32 v4, 40960, v2
ds_read_b64_tr_b16 a[64:65], v4 offset:0
ds_read_b64_tr_b16 a[66:67], v4 offset:256
ds_read_b64_tr_b16 a[68:69], v4 offset:8192
ds_read_b64_tr_b16 a[70:71], v4 offset:8448
ds_read_b64_tr_b16 a[72:73], v4 offset:32
ds_read_b64_tr_b16 a[74:75], v4 offset:288
ds_read_b64_tr_b16 a[76:77], v4 offset:8224
ds_read_b64_tr_b16 a[78:79], v4 offset:8480
s_waitcnt lgkmcnt(0)
s_barrier
s_add_u32 m0, s35, 106496
s_add_u32 s36, s33, 1572864
buffer_load_dwordx4 v0, s[12:15], s36 offen lds
s_add_u32 m0, s35, 110592
s_add_u32 s36, s33, 1703936
buffer_load_dwordx4 v0, s[12:15], s36 offen lds
s_add_u32 m0, s35, 114688
s_add_u32 s36, s33, 1835008
buffer_load_dwordx4 v0, s[12:15], s36 offen lds
s_add_u32 m0, s35, 118784
s_add_u32 s36, s33, 1966080
buffer_load_dwordx4 v0, s[12:15], s36 offen lds
s_waitcnt vmcnt(19)
v_add_u32 v4, 57344, v2
ds_read_b64_tr_b16 v[208:209], v4 offset:0
ds_read_b64_tr_b16 v[210:211], v4 offset:256
ds_read_b64_tr_b16 v[212:213], v4 offset:8192
ds_read_b64_tr_b16 v[214:215], v4 offset:8448
ds_read_b64_tr_b16 v[216:217], v4 offset:32
ds_read_b64_tr_b16 v[218:219], v4 offset:288
ds_read_b64_tr_b16 v[220:221], v4 offset:8224
ds_read_b64_tr_b16 v[222:223], v4 offset:8480
s_waitcnt lgkmcnt(0)
s_barrier
s_add_u32 m0, s35, 122880
s_add_u32 s36, s33, 1572864
buffer_load_dwordx4 v0, s[16:19], s36 offen lds
s_add_u32 m0, s35, 126976
s_add_u32 s36, s33, 1703936
buffer_load_dwordx4 v0, s[16:19], s36 offen lds
s_add_u32 m0, s35, 131072
s_add_u32 s36, s33, 1835008
buffer_load_dwordx4 v0, s[16:19], s36 offen lds
s_add_u32 m0, s35, 135168
s_add_u32 s36, s33, 1966080
buffer_load_dwordx4 v0, s[16:19], s36 offen lds
s_waitcnt vmcnt(19)
v_add_u32 v4, 73728, v2
ds_read_b64_tr_b16 a[80:81], v4 offset:0
ds_read_b64_tr_b16 a[82:83], v4 offset:256
ds_read_b64_tr_b16 a[84:85], v4 offset:8192
ds_read_b64_tr_b16 a[86:87], v4 offset:8448
ds_read_b64_tr_b16 a[88:89], v4 offset:32
ds_read_b64_tr_b16 a[90:91], v4 offset:288
ds_read_b64_tr_b16 a[92:93], v4 offset:8224
ds_read_b64_tr_b16 a[94:95], v4 offset:8480
s_waitcnt lgkmcnt(0)
s_barrier
s_add_u32 m0, s35, 139264
s_add_u32 s36, s33, 2097152
buffer_load_dwordx4 v0, s[12:15], s36 offen lds
s_add_u32 m0, s35, 143360
s_add_u32 s36, s33, 2228224
buffer_load_dwordx4 v0, s[12:15], s36 offen lds
s_add_u32 m0, s35, 147456
s_add_u32 s36, s33, 2359296
buffer_load_dwordx4 v0, s[12:15], s36 offen lds
s_add_u32 m0, s35, 151552
s_add_u32 s36, s33, 2490368
buffer_load_dwordx4 v0, s[12:15], s36 offen lds
s_waitcnt vmcnt(19)
v_add_u32 v4, 90112, v2
ds_read_b64_tr_b16 a[96:97], v4 offset:0
ds_read_b64_tr_b16 a[98:99], v4 offset:256
ds_read_b64_tr_b16 a[100:101], v4 offset:8192
ds_read_b64_tr_b16 a[102:103], v4 offset:8448
ds_read_b64_tr_b16 a[104:105], v4 offset:32
ds_read_b64_tr_b16 a[106:107], v4 offset:288
ds_read_b64_tr_b16 a[108:109], v4 offset:8224
ds_read_b64_tr_b16 a[110:111], v4 offset:8480
s_waitcnt lgkmcnt(0)
s_barrier
s_add_u32 m0, s35, 40960
s_add_u32 s36, s33, 2097152
buffer_load_dwordx4 v0, s[16:19], s36 offen lds
s_add_u32 m0, s35, 45056
s_add_u32 s36, s33, 2228224
buffer_load_dwordx4 v0, s[16:19], s36 offen lds
s_add_u32 m0, s35, 49152
s_add_u32 s36, s33, 2359296
buffer_load_dwordx4 v0, s[16:19], s36 offen lds
s_add_u32 m0, s35, 53248
s_add_u32 s36, s33, 2490368
buffer_load_dwordx4 v0, s[16:19], s36 offen lds
s_waitcnt vmcnt(12)
v_add_u32 v4, 106496, v2
ds_read_b64_tr_b16 v[224:225], v4 offset:0
ds_read_b64_tr_b16 v[226:227], v4 offset:256
ds_read_b64_tr_b16 v[228:229], v4 offset:8192
ds_read_b64_tr_b16 v[230:231], v4 offset:8448
ds_read_b64_tr_b16 v[232:233], v4 offset:32
ds_read_b64_tr_b16 v[234:235], v4 offset:288
ds_read_b64_tr_b16 v[236:237], v4 offset:8224
ds_read_b64_tr_b16 v[238:239], v4 offset:8480
s_waitcnt lgkmcnt(0)
s_barrier
s_add_u32 m0, s35, 57344
s_add_u32 s36, s34, 0
buffer_load_dwordx4 v0, s[12:15], s36 offen lds
s_add_u32 m0, s35, 61440
s_add_u32 s36, s34, 131072
buffer_load_dwordx4 v0, s[12:15], s36 offen lds
s_add_u32 m0, s35, 65536
s_add_u32 s36, s34, 262144
buffer_load_dwordx4 v0, s[12:15], s36 offen lds
s_add_u32 m0, s35, 69632
s_add_u32 s36, s34, 393216
buffer_load_dwordx4 v0, s[12:15], s36 offen lds
v_lshl_or_b32 v200, v201, 16, v200
v_min_u32 v200, -2, v200
s_add_u32 s3, s60, 0
buffer_store_dword v200, v202, s[4:7], s3 offen
s_add_u32 s3, s61, 0
buffer_store_dword v200, v202, s[4:7], s3 offen sc1
s_add_u32 s3, s61, 8192
buffer_store_dword v200, v202, s[4:7], s3 offen sc1
s_add_u32 s3, s61, 16384
buffer_store_dword v200, v202, s[4:7], s3 offen sc1
s_add_u32 s3, s61, 24576
buffer_store_dword v200, v202, s[4:7], s3 offen sc1
s_waitcnt vmcnt(17)
v_add_u32 v4, 122880, v2
ds_read_b64_tr_b16 v[32:33], v4 offset:0
ds_read_b64_tr_b16 v[34:35], v4 offset:256
ds_read_b64_tr_b16 v[36:37], v4 offset:8192
ds_read_b64_tr_b16 v[38:39], v4 offset:8448
ds_read_b64_tr_b16 a[112:113], v4 offset:32
ds_read_b64_tr_b16 a[114:115], v4 offset:288
ds_read_b64_tr_b16 a[116:117], v4 offset:8224
ds_read_b64_tr_b16 a[118:119], v4 offset:8480
s_waitcnt lgkmcnt(0)
s_barrier
s_add_u32 m0, s35, 73728
s_add_u32 s36, s34, 0
buffer_load_dwordx4 v0, s[16:19], s36 offen lds
s_add_u32 m0, s35, 77824
s_add_u32 s36, s34, 131072
buffer_load_dwordx4 v0, s[16:19], s36 offen lds
s_add_u32 m0, s35, 81920
s_add_u32 s36, s34, 262144
buffer_load_dwordx4 v0, s[16:19], s36 offen lds
s_add_u32 m0, s35, 86016
s_add_u32 s36, s34, 393216
buffer_load_dwordx4 v0, s[16:19], s36 offen lds
s_waitcnt vmcnt(17)
v_add_u32 v4, 139264, v2
ds_read_b64_tr_b16 v[240:241], v4 offset:0
ds_read_b64_tr_b16 v[242:243], v4 offset:256
ds_read_b64_tr_b16 v[244:245], v4 offset:8192
ds_read_b64_tr_b16 v[246:247], v4 offset:8448
ds_read_b64_tr_b16 v[248:249], v4 offset:32
ds_read_b64_tr_b16 v[250:251], v4 offset:288
ds_read_b64_tr_b16 v[252:253], v4 offset:8224
ds_read_b64_tr_b16 v[254:255], v4 offset:8480
s_waitcnt lgkmcnt(0)
s_barrier
s_add_u32 m0, s35, 90112
s_add_u32 s36, s34, 524288
buffer_load_dwordx4 v0, s[12:15], s36 offen lds
s_add_u32 m0, s35, 94208
s_add_u32 s36, s34, 655360
buffer_load_dwordx4 v0, s[12:15], s36 offen lds
s_add_u32 m0, s35, 98304
s_add_u32 s36, s34, 786432
buffer_load_dwordx4 v0, s[12:15], s36 offen lds
s_add_u32 m0, s35, 102400
s_add_u32 s36, s34, 917504
buffer_load_dwordx4 v0, s[12:15], s36 offen lds
s_waitcnt vmcnt(17)
v_add_u32 v4, 40960, v2
ds_read_b64_tr_b16 a[120:121], v4 offset:0
ds_read_b64_tr_b16 a[122:123], v4 offset:256
ds_read_b64_tr_b16 a[124:125], v4 offset:8192
ds_read_b64_tr_b16 a[126:127], v4 offset:8448
ds_read_b64_tr_b16 a[128:129], v4 offset:32
ds_read_b64_tr_b16 a[130:131], v4 offset:288
ds_read_b64_tr_b16 a[132:133], v4 offset:8224
ds_read_b64_tr_b16 a[134:135], v4 offset:8480
s_waitcnt lgkmcnt(0)
s_barrier
s_add_u32 m0, s35, 106496
s_add_u32 s36, s34, 524288
buffer_load_dwordx4 v0, s[16:19], s36 offen lds
s_add_u32 m0, s35, 110592
s_add_u32 s36, s34, 655360
buffer_load_dwordx4 v0, s[16:19], s36 offen lds
s_add_u32 m0, s35, 114688
s_add_u32 s36, s34, 786432
buffer_load_dwordx4 v0, s[16:19], s36 offen lds
s_add_u32 m0, s35, 118784
s_add_u32 s36, s34, 917504
buffer_load_dwordx4 v0, s[16:19], s36 offen lds
s_waitcnt vmcnt(17)
v_add_u32 v4, 57344, v2
ds_read_b64_tr_b16 a[0:1], v4 offset:0
ds_read_b64_tr_b16 a[2:3], v4 offset:256
ds_read_b64_tr_b16 a[4:5], v4 offset:8192
ds_read_b64_tr_b16 a[6:7], v4 offset:8448
ds_read_b64_tr_b16 a[8:9], v4 offset:32
ds_read_b64_tr_b16 a[10:11], v4 offset:288
ds_read_b64_tr_b16 a[12:13], v4 offset:8224
ds_read_b64_tr_b16 a[14:15], v4 offset:8480
s_waitcnt lgkmcnt(0)
s_barrier
s_add_u32 m0, s35, 122880
s_add_u32 s36, s34, 1048576
buffer_load_dwordx4 v0, s[12:15], s36 offen lds
s_add_u32 m0, s35, 126976
s_add_u32 s36, s34, 1179648
buffer_load_dwordx4 v0, s[12:15], s36 offen lds
s_add_u32 m0, s35, 131072
s_add_u32 s36, s34, 1310720
buffer_load_dwordx4 v0, s[12:15], s36 offen lds
s_add_u32 m0, s35, 135168
s_add_u32 s36, s34, 1441792
buffer_load_dwordx4 v0, s[12:15], s36 offen lds
s_waitcnt vmcnt(12)
v_add_u32 v4, 73728, v2
ds_read_b64_tr_b16 a[136:137], v4 offset:0
ds_read_b64_tr_b16 a[138:139], v4 offset:256
ds_read_b64_tr_b16 a[140:141], v4 offset:8192
ds_read_b64_tr_b16 a[142:143], v4 offset:8448
ds_read_b64_tr_b16 a[144:145], v4 offset:32
ds_read_b64_tr_b16 a[146:147], v4 offset:288
ds_read_b64_tr_b16 a[148:149], v4 offset:8224
ds_read_b64_tr_b16 a[150:151], v4 offset:8480
s_waitcnt lgkmcnt(0)
s_barrier
s_add_u32 m0, s35, 139264
s_add_u32 s36, s34, 1048576
buffer_load_dwordx4 v0, s[16:19], s36 offen lds
s_add_u32 m0, s35, 143360
s_add_u32 s36, s34, 1179648
buffer_load_dwordx4 v0, s[16:19], s36 offen lds
s_add_u32 m0, s35, 147456
s_add_u32 s36, s34, 1310720
buffer_load_dwordx4 v0, s[16:19], s36 offen lds
s_add_u32 m0, s35, 151552
s_add_u32 s36, s34, 1441792
buffer_load_dwordx4 v0, s[16:19], s36 offen lds
s_barrier
s_cmp_lg_u32 s26, 0
s_cbranch_scc1 L_rrr_f
s_lshl_b32 s3, s77, 6
s_add_u32 s3, s3, 60
v_mov_b32 v200, s3
v_mov_b32 v201, 1
s_mov_b64 exec, 1
global_atomic_add v200, v201, s[28:29] sc1
s_mov_b64 exec, -1
L_rrr_f:
s_waitcnt vmcnt(12)
v_add_u32 v4, 90112, v2
ds_read_b64_tr_b16 v[48:49], v4 offset:0
ds_read_b64_tr_b16 v[50:51], v4 offset:256
ds_read_b64_tr_b16 v[52:53], v4 offset:8192
ds_read_b64_tr_b16 v[54:55], v4 offset:8448
ds_read_b64_tr_b16 a[16:17], v4 offset:32
ds_read_b64_tr_b16 a[18:19], v4 offset:288
ds_read_b64_tr_b16 a[20:21], v4 offset:8224
ds_read_b64_tr_b16 a[22:23], v4 offset:8480
s_waitcnt lgkmcnt(0)
s_barrier
s_add_u32 m0, s35, 40960
s_add_u32 s36, s34, 1572864
buffer_load_dwordx4 v0, s[12:15], s36 offen lds
s_add_u32 m0, s35, 45056
s_add_u32 s36, s34, 1703936
buffer_load_dwordx4 v0, s[12:15], s36 offen lds
s_add_u32 m0, s35, 49152
s_add_u32 s36, s34, 1835008
buffer_load_dwordx4 v0, s[12:15], s36 offen lds
s_add_u32 m0, s35, 53248
s_add_u32 s36, s34, 1966080
buffer_load_dwordx4 v0, s[12:15], s36 offen lds
s_waitcnt vmcnt(12)
v_add_u32 v4, 106496, v2
ds_read_b64_tr_b16 a[152:153], v4 offset:0
ds_read_b64_tr_b16 a[154:155], v4 offset:256
ds_read_b64_tr_b16 a[156:157], v4 offset:8192
ds_read_b64_tr_b16 a[158:159], v4 offset:8448
ds_read_b64_tr_b16 a[160:161], v4 offset:32
ds_read_b64_tr_b16 a[162:163], v4 offset:288
ds_read_b64_tr_b16 a[164:165], v4 offset:8224
ds_read_b64_tr_b16 a[166:167], v4 offset:8480
s_waitcnt lgkmcnt(0)
s_barrier
s_add_u32 m0, s35, 57344
s_add_u32 s36, s34, 1572864
buffer_load_dwordx4 v0, s[16:19], s36 offen lds
s_add_u32 m0, s35, 61440
s_add_u32 s36, s34, 1703936
buffer_load_dwordx4 v0, s[16:19], s36 offen lds
s_add_u32 m0, s35, 65536
s_add_u32 s36, s34, 1835008
buffer_load_dwordx4 v0, s[16:19], s36 offen lds
s_add_u32 m0, s35, 69632
s_add_u32 s36, s34, 1966080
buffer_load_dwordx4 v0, s[16:19], s36 offen lds
s_waitcnt vmcnt(12)
v_add_u32 v4, 122880, v2
ds_read_b64_tr_b16 a[24:25], v4 offset:0
ds_read_b64_tr_b16 a[26:27], v4 offset:256
ds_read_b64_tr_b16 a[28:29], v4 offset:8192
ds_read_b64_tr_b16 a[30:31], v4 offset:8448
ds_read_b64_tr_b16 v[56:57], v4 offset:32
ds_read_b64_tr_b16 v[58:59], v4 offset:288
ds_read_b64_tr_b16 v[60:61], v4 offset:8224
ds_read_b64_tr_b16 v[62:63], v4 offset:8480
s_waitcnt lgkmcnt(0)
s_barrier
s_add_u32 m0, s35, 73728
s_add_u32 s36, s34, 2097152
buffer_load_dwordx4 v0, s[12:15], s36 offen lds
s_add_u32 m0, s35, 77824
s_add_u32 s36, s34, 2228224
buffer_load_dwordx4 v0, s[12:15], s36 offen lds
s_add_u32 m0, s35, 81920
s_add_u32 s36, s34, 2359296
buffer_load_dwordx4 v0, s[12:15], s36 offen lds
s_add_u32 m0, s35, 86016
s_add_u32 s36, s34, 2490368
buffer_load_dwordx4 v0, s[12:15], s36 offen lds
s_waitcnt vmcnt(12)
v_add_u32 v4, 139264, v2
ds_read_b64_tr_b16 a[168:169], v4 offset:0
ds_read_b64_tr_b16 a[170:171], v4 offset:256
ds_read_b64_tr_b16 a[172:173], v4 offset:8192
ds_read_b64_tr_b16 a[174:175], v4 offset:8448
ds_read_b64_tr_b16 a[176:177], v4 offset:32
ds_read_b64_tr_b16 a[178:179], v4 offset:288
ds_read_b64_tr_b16 a[180:181], v4 offset:8224
ds_read_b64_tr_b16 a[182:183], v4 offset:8480
s_waitcnt lgkmcnt(0)
s_barrier
s_add_u32 m0, s35, 90112
s_add_u32 s36, s34, 2097152
buffer_load_dwordx4 v0, s[16:19], s36 offen lds
s_add_u32 m0, s35, 94208
s_add_u32 s36, s34, 2228224
buffer_load_dwordx4 v0, s[16:19], s36 offen lds
s_add_u32 m0, s35, 98304
s_add_u32 s36, s34, 2359296
buffer_load_dwordx4 v0, s[16:19], s36 offen lds
s_add_u32 m0, s35, 102400
s_add_u32 s36, s34, 2490368
buffer_load_dwordx4 v0, s[16:19], s36 offen lds
s_waitcnt vmcnt(12)
v_add_u32 v4, 40960, v2
ds_read_b64_tr_b16 a[32:33], v4 offset:0
ds_read_b64_tr_b16 a[34:35], v4 offset:256
ds_read_b64_tr_b16 a[36:37], v4 offset:8192
ds_read_b64_tr_b16 a[38:39], v4 offset:8448
ds_read_b64_tr_b16 a[40:41], v4 offset:32
ds_read_b64_tr_b16 a[42:43], v4 offset:288
ds_read_b64_tr_b16 a[44:45], v4 offset:8224
ds_read_b64_tr_b16 a[46:47], v4 offset:8480
s_waitcnt lgkmcnt(0)
s_barrier
s_add_u32 m0, s35, 106496
s_add_u32 s36, s33, 0
buffer_load_dwordx4 v0, s[8:11], s36 offen lds
s_add_u32 m0, s35, 110592
s_add_u32 s36, s33, 131072
buffer_load_dwordx4 v0, s[8:11], s36 offen lds
s_add_u32 m0, s35, 114688
s_add_u32 s36, s33, 262144
buffer_load_dwordx4 v0, s[8:11], s36 offen lds
s_add_u32 m0, s35, 118784
s_add_u32 s36, s33, 393216
buffer_load_dwordx4 v0, s[8:11], s36 offen lds
s_waitcnt vmcnt(12)
v_add_u32 v4, 57344, v2
ds_read_b64_tr_b16 a[184:185], v4 offset:0
ds_read_b64_tr_b16 a[186:187], v4 offset:256
ds_read_b64_tr_b16 a[188:189], v4 offset:8192
ds_read_b64_tr_b16 a[190:191], v4 offset:8448
ds_read_b64_tr_b16 a[192:193], v4 offset:32
ds_read_b64_tr_b16 a[194:195], v4 offset:288
ds_read_b64_tr_b16 a[196:197], v4 offset:8224
ds_read_b64_tr_b16 a[198:199], v4 offset:8480
s_waitcnt lgkmcnt(0)
s_barrier
s_add_u32 m0, s35, 122880
s_add_u32 s36, s33, 524288
buffer_load_dwordx4 v0, s[8:11], s36 offen lds
s_add_u32 m0, s35, 126976
s_add_u32 s36, s33, 655360
buffer_load_dwordx4 v0, s[8:11], s36 offen lds
s_add_u32 m0, s35, 131072
s_add_u32 s36, s33, 786432
buffer_load_dwordx4 v0, s[8:11], s36 offen lds
s_add_u32 m0, s35, 135168
s_add_u32 s36, s33, 917504
buffer_load_dwordx4 v0, s[8:11], s36 offen lds
s_waitcnt vmcnt(12)
v_add_u32 v4, 73728, v2
ds_read_b64_tr_b16 a[48:49], v4 offset:0
ds_read_b64_tr_b16 a[50:51], v4 offset:256
ds_read_b64_tr_b16 a[52:53], v4 offset:8192
ds_read_b64_tr_b16 a[54:55], v4 offset:8448
ds_read_b64_tr_b16 a[56:57], v4 offset:32
ds_read_b64_tr_b16 a[58:59], v4 offset:288
ds_read_b64_tr_b16 a[60:61], v4 offset:8224
ds_read_b64_tr_b16 a[62:63], v4 offset:8480
s_waitcnt lgkmcnt(0)
s_barrier
s_add_u32 m0, s35, 139264
s_add_u32 s36, s33, 1048576
buffer_load_dwordx4 v0, s[8:11], s36 offen lds
s_add_u32 m0, s35, 143360
s_add_u32 s36, s33, 1179648
buffer_load_dwordx4 v0, s[8:11], s36 offen lds
s_add_u32 m0, s35, 147456
s_add_u32 s36, s33, 1310720
buffer_load_dwordx4 v0, s[8:11], s36 offen lds
s_add_u32 m0, s35, 151552
s_add_u32 s36, s33, 1441792
buffer_load_dwordx4 v0, s[8:11], s36 offen lds
s_waitcnt vmcnt(12)
v_add_u32 v4, 90112, v2
ds_read_b64_tr_b16 a[200:201], v4 offset:0
ds_read_b64_tr_b16 a[202:203], v4 offset:256
ds_read_b64_tr_b16 a[204:205], v4 offset:8192
ds_read_b64_tr_b16 a[206:207], v4 offset:8448
ds_read_b64_tr_b16 a[208:209], v4 offset:32
ds_read_b64_tr_b16 a[210:211], v4 offset:288
ds_read_b64_tr_b16 a[212:213], v4 offset:8224
ds_read_b64_tr_b16 a[214:215], v4 offset:8480
s_waitcnt lgkmcnt(0)
s_barrier
s_add_u32 m0, s35, 40960
s_add_u32 s36, s33, 1572864
buffer_load_dwordx4 v0, s[8:11], s36 offen lds
s_add_u32 m0, s35, 45056
s_add_u32 s36, s33, 1703936
buffer_load_dwordx4 v0, s[8:11], s36 offen lds
s_add_u32 m0, s35, 49152
s_add_u32 s36, s33, 1835008
buffer_load_dwordx4 v0, s[8:11], s36 offen lds
s_add_u32 m0, s35, 53248
s_add_u32 s36, s33, 1966080
buffer_load_dwordx4 v0, s[8:11], s36 offen lds
s_waitcnt vmcnt(12)
v_add_u32 v4, 106496, v2
ds_read_b64_tr_b16 v[72:73], v4 offset:0
ds_read_b64_tr_b16 v[74:75], v4 offset:256
ds_read_b64_tr_b16 v[76:77], v4 offset:8192
ds_read_b64_tr_b16 v[78:79], v4 offset:8448
ds_read_b64_tr_b16 v[80:81], v4 offset:32
ds_read_b64_tr_b16 v[82:83], v4 offset:288
ds_read_b64_tr_b16 v[84:85], v4 offset:8224
ds_read_b64_tr_b16 v[86:87], v4 offset:8480
s_waitcnt lgkmcnt(0)
s_barrier
s_add_u32 m0, s35, 57344
s_add_u32 s36, s33, 2097152
buffer_load_dwordx4 v0, s[8:11], s36 offen lds
s_add_u32 m0, s35, 61440
s_add_u32 s36, s33, 2228224
buffer_load_dwordx4 v0, s[8:11], s36 offen lds
s_add_u32 m0, s35, 65536
s_add_u32 s36, s33, 2359296
buffer_load_dwordx4 v0, s[8:11], s36 offen lds
s_add_u32 m0, s35, 69632
s_add_u32 s36, s33, 2490368
buffer_load_dwordx4 v0, s[8:11], s36 offen lds
s_waitcnt vmcnt(12)
v_add_u32 v4, 122880, v2
ds_read_b64_tr_b16 v[88:89], v4 offset:0
ds_read_b64_tr_b16 v[90:91], v4 offset:256
ds_read_b64_tr_b16 v[92:93], v4 offset:8192
ds_read_b64_tr_b16 v[94:95], v4 offset:8448
ds_read_b64_tr_b16 v[96:97], v4 offset:32
ds_read_b64_tr_b16 v[98:99], v4 offset:288
ds_read_b64_tr_b16 v[100:101], v4 offset:8224
ds_read_b64_tr_b16 v[102:103], v4 offset:8480
s_waitcnt lgkmcnt(0)
s_barrier
s_add_u32 m0, s35, 73728
s_add_u32 s36, s34, 0
buffer_load_dwordx4 v0, s[8:11], s36 offen lds
s_add_u32 m0, s35, 77824
s_add_u32 s36, s34, 131072
buffer_load_dwordx4 v0, s[8:11], s36 offen lds
s_add_u32 m0, s35, 81920
s_add_u32 s36, s34, 262144
buffer_load_dwordx4 v0, s[8:11], s36 offen lds
s_add_u32 m0, s35, 86016
s_add_u32 s36, s34, 393216
buffer_load_dwordx4 v0, s[8:11], s36 offen lds
s_waitcnt vmcnt(12)
v_add_u32 v4, 139264, v2
ds_read_b64_tr_b16 v[104:105], v4 offset:0
ds_read_b64_tr_b16 v[106:107], v4 offset:256
ds_read_b64_tr_b16 v[108:109], v4 offset:8192
ds_read_b64_tr_b16 v[110:111], v4 offset:8448
ds_read_b64_tr_b16 v[112:113], v4 offset:32
ds_read_b64_tr_b16 v[114:115], v4 offset:288
ds_read_b64_tr_b16 v[116:117], v4 offset:8224
ds_read_b64_tr_b16 v[118:119], v4 offset:8480
s_waitcnt lgkmcnt(0)
s_barrier
s_add_u32 m0, s35, 90112
s_add_u32 s36, s34, 524288
buffer_load_dwordx4 v0, s[8:11], s36 offen lds
s_add_u32 m0, s35, 94208
s_add_u32 s36, s34, 655360
buffer_load_dwordx4 v0, s[8:11], s36 offen lds
s_add_u32 m0, s35, 98304
s_add_u32 s36, s34, 786432
buffer_load_dwordx4 v0, s[8:11], s36 offen lds
s_add_u32 m0, s35, 102400
s_add_u32 s36, s34, 917504
buffer_load_dwordx4 v0, s[8:11], s36 offen lds
s_waitcnt vmcnt(12)
v_add_u32 v4, 40960, v2
ds_read_b64_tr_b16 v[120:121], v4 offset:0
ds_read_b64_tr_b16 v[122:123], v4 offset:256
ds_read_b64_tr_b16 v[124:125], v4 offset:8192
ds_read_b64_tr_b16 v[126:127], v4 offset:8448
ds_read_b64_tr_b16 v[128:129], v4 offset:32
ds_read_b64_tr_b16 v[130:131], v4 offset:288
ds_read_b64_tr_b16 v[132:133], v4 offset:8224
ds_read_b64_tr_b16 v[134:135], v4 offset:8480
s_waitcnt lgkmcnt(0)
s_barrier
s_add_u32 m0, s35, 106496
s_add_u32 s36, s34, 1048576
buffer_load_dwordx4 v0, s[8:11], s36 offen lds
s_add_u32 m0, s35, 110592
s_add_u32 s36, s34, 1179648
buffer_load_dwordx4 v0, s[8:11], s36 offen lds
s_add_u32 m0, s35, 114688
s_add_u32 s36, s34, 1310720
buffer_load_dwordx4 v0, s[8:11], s36 offen lds
s_add_u32 m0, s35, 118784
s_add_u32 s36, s34, 1441792
buffer_load_dwordx4 v0, s[8:11], s36 offen lds
s_waitcnt vmcnt(12)
v_add_u32 v4, 57344, v2
ds_read_b64_tr_b16 v[136:137], v4 offset:0
ds_read_b64_tr_b16 v[138:139], v4 offset:256
ds_read_b64_tr_b16 v[140:141], v4 offset:8192
ds_read_b64_tr_b16 v[142:143], v4 offset:8448
ds_read_b64_tr_b16 v[40:41], v4 offset:32
ds_read_b64_tr_b16 v[42:43], v4 offset:288
ds_read_b64_tr_b16 v[44:45], v4 offset:8224
ds_read_b64_tr_b16 v[46:47], v4 offset:8480
s_waitcnt lgkmcnt(0)
s_barrier
s_add_u32 m0, s35, 122880
s_add_u32 s36, s34, 1572864
buffer_load_dwordx4 v0, s[8:11], s36 offen lds
s_add_u32 m0, s35, 126976
s_add_u32 s36, s34, 1703936
buffer_load_dwordx4 v0, s[8:11], s36 offen lds
s_add_u32 m0, s35, 131072
s_add_u32 s36, s34, 1835008
buffer_load_dwordx4 v0, s[8:11], s36 offen lds
s_add_u32 m0, s35, 135168
s_add_u32 s36, s34, 1966080
buffer_load_dwordx4 v0, s[8:11], s36 offen lds
s_waitcnt vmcnt(12)
v_add_u32 v4, 73728, v2
ds_read_b64_tr_b16 v[144:145], v4 offset:0
ds_read_b64_tr_b16 v[146:147], v4 offset:256
ds_read_b64_tr_b16 v[148:149], v4 offset:8192
ds_read_b64_tr_b16 v[150:151], v4 offset:8448
ds_read_b64_tr_b16 v[152:153], v4 offset:32
ds_read_b64_tr_b16 v[154:155], v4 offset:288
ds_read_b64_tr_b16 v[156:157], v4 offset:8224
ds_read_b64_tr_b16 v[158:159], v4 offset:8480
s_waitcnt lgkmcnt(0)
s_barrier
s_add_u32 m0, s35, 139264
s_add_u32 s36, s34, 2097152
buffer_load_dwordx4 v0, s[8:11], s36 offen lds
s_add_u32 m0, s35, 143360
s_add_u32 s36, s34, 2228224
buffer_load_dwordx4 v0, s[8:11], s36 offen lds
s_add_u32 m0, s35, 147456
s_add_u32 s36, s34, 2359296
buffer_load_dwordx4 v0, s[8:11], s36 offen lds
s_add_u32 m0, s35, 151552
s_add_u32 s36, s34, 2490368
buffer_load_dwordx4 v0, s[8:11], s36 offen lds
s_mov_b32 m0, s35
v_lshlrev_b32 v7, 2, v6
global_load_lds_dword v7, s[28:29] sc1
s_waitcnt vmcnt(13)
v_add_u32 v4, 90112, v2
ds_read_b64_tr_b16 v[160:161], v4 offset:0
ds_read_b64_tr_b16 v[162:163], v4 offset:256
ds_read_b64_tr_b16 v[164:165], v4 offset:8192
ds_read_b64_tr_b16 v[166:167], v4 offset:8448
ds_read_b64_tr_b16 v[168:169], v4 offset:32
ds_read_b64_tr_b16 v[170:171], v4 offset:288
ds_read_b64_tr_b16 v[172:173], v4 offset:8224
ds_read_b64_tr_b16 v[174:175], v4 offset:8480
s_waitcnt lgkmcnt(0)
s_barrier
s_add_u32 m0, s35, 40960
s_add_u32 s36, s32, 0
buffer_load_dwordx4 v1, s[20:23], s36 offen lds
s_add_u32 m0, s35, 45056
s_add_u32 s36, s32, 20480
buffer_load_dwordx4 v1, s[20:23], s36 offen lds
s_add_u32 m0, s35, 49152
s_add_u32 s36, s32, 40960
buffer_load_dwordx4 v1, s[20:23], s36 offen lds
s_add_u32 m0, s35, 53248
s_add_u32 s36, s32, 61440
buffer_load_dwordx4 v1, s[20:23], s36 offen lds
s_waitcnt vmcnt(13)
v_add_u32 v4, 106496, v2
ds_read_b64_tr_b16 v[64:65], v4 offset:0
ds_read_b64_tr_b16 v[66:67], v4 offset:256
ds_read_b64_tr_b16 v[68:69], v4 offset:8192
ds_read_b64_tr_b16 v[70:71], v4 offset:8448
ds_read_b64_tr_b16 v[16:17], v4 offset:32
ds_read_b64_tr_b16 v[18:19], v4 offset:288
ds_read_b64_tr_b16 v[20:21], v4 offset:8224
ds_read_b64_tr_b16 v[22:23], v4 offset:8480
s_waitcnt lgkmcnt(0)
s_barrier
s_add_u32 m0, s35, 57344
s_add_u32 s36, s32, 82176
buffer_load_dwordx4 v1, s[20:23], s36 offen lds
s_add_u32 m0, s35, 61440
s_add_u32 s36, s32, 102656
buffer_load_dwordx4 v1, s[20:23], s36 offen lds
s_add_u32 m0, s35, 65536
s_add_u32 s36, s32, 123136
buffer_load_dwordx4 v1, s[20:23], s36 offen lds
s_add_u32 m0, s35, 69632
s_add_u32 s36, s32, 143616
buffer_load_dwordx4 v1, s[20:23], s36 offen lds
v_add_u32 v7, 155648, v5
ds_write_b128 v7, v[16:19] offset:0
ds_write_b128 v7, v[20:23] offset:4096
s_waitcnt vmcnt(13)
v_add_u32 v4, 122880, v2
ds_read_b64_tr_b16 v[176:177], v4 offset:0
ds_read_b64_tr_b16 v[178:179], v4 offset:256
ds_read_b64_tr_b16 v[180:181], v4 offset:8192
ds_read_b64_tr_b16 v[182:183], v4 offset:8448
ds_read_b64_tr_b16 v[184:185], v4 offset:32
ds_read_b64_tr_b16 v[186:187], v4 offset:288
ds_read_b64_tr_b16 v[188:189], v4 offset:8224
ds_read_b64_tr_b16 v[190:191], v4 offset:8480
s_waitcnt lgkmcnt(0)
s_barrier
s_add_u32 m0, s35, 73728
s_add_u32 s36, s33, 0
buffer_load_dwordx4 v0, s[12:15], s36 offen lds
s_add_u32 m0, s35, 77824
s_add_u32 s36, s33, 131072
buffer_load_dwordx4 v0, s[12:15], s36 offen lds
s_add_u32 m0, s35, 81920
s_add_u32 s36, s33, 262144
buffer_load_dwordx4 v0, s[12:15], s36 offen lds
s_add_u32 m0, s35, 86016
s_add_u32 s36, s33, 393216
buffer_load_dwordx4 v0, s[12:15], s36 offen lds
s_waitcnt vmcnt(13)
v_add_u32 v4, 139264, v2
ds_read_b64_tr_b16 v[192:193], v4 offset:0
ds_read_b64_tr_b16 v[194:195], v4 offset:256
ds_read_b64_tr_b16 v[196:197], v4 offset:8192
ds_read_b64_tr_b16 v[198:199], v4 offset:8448
ds_read_b64_tr_b16 v[200:201], v4 offset:32
ds_read_b64_tr_b16 v[202:203], v4 offset:288
ds_read_b64_tr_b16 v[204:205], v4 offset:8224
ds_read_b64_tr_b16 v[206:207], v4 offset:8480
s_waitcnt lgkmcnt(0)
s_barrier
s_add_u32 m0, s35, 90112
s_add_u32 s36, s33, 1048576
buffer_load_dwordx4 v0, s[12:15], s36 offen lds
s_add_u32 m0, s35, 94208
s_add_u32 s36, s33, 1179648
buffer_load_dwordx4 v0, s[12:15], s36 offen lds
s_add_u32 m0, s35, 98304
s_add_u32 s36, s33, 1310720
buffer_load_dwordx4 v0, s[12:15], s36 offen lds
s_add_u32 m0, s35, 102400
s_add_u32 s36, s33, 1441792
buffer_load_dwordx4 v0, s[12:15], s36 offen lds
s_waitcnt vmcnt(12)
v_add_u32 v4, 40960, v3
ds_read_b64_tr_b16 v[8:9], v4 offset:0
ds_read_b64_tr_b16 v[10:11], v4 offset:128
ds_read_b64_tr_b16 v[12:13], v4 offset:512
ds_read_b64_tr_b16 v[14:15], v4 offset:640
ds_read_b64_tr_b16 v[16:17], v4 offset:8192
ds_read_b64_tr_b16 v[18:19], v4 offset:8320
ds_read_b64_tr_b16 v[20:21], v4 offset:8704
ds_read_b64_tr_b16 v[22:23], v4 offset:8832
s_waitcnt lgkmcnt(0)
s_barrier
s_add_u32 m0, s35, 106496
s_add_u32 s36, s32, 81920
buffer_load_dwordx4 v1, s[20:23], s36 offen lds
s_add_u32 m0, s35, 110592
s_add_u32 s36, s32, 102400
buffer_load_dwordx4 v1, s[20:23], s36 offen lds
s_add_u32 m0, s35, 114688
s_add_u32 s36, s32, 122880
buffer_load_dwordx4 v1, s[20:23], s36 offen lds
s_add_u32 m0, s35, 118784
s_add_u32 s36, s32, 143360
buffer_load_dwordx4 v1, s[20:23], s36 offen lds
v_add_u32 v7, 40960, v5
ds_write_b128 v7, v[8:11] offset:0
ds_write_b128 v7, v[12:15] offset:4096
v_add_u32 v7, 49152, v5
ds_write_b128 v7, v[16:19] offset:0
ds_write_b128 v7, v[20:23] offset:4096
s_branch L_rce_f
L_rca_f:
s_sleep 8
s_add_u32 s27, s27, 1
s_cmp_gt_u32 s27, 262144
s_cbranch_scc1 L_fail_f
s_mov_b32 m0, s35
v_lshlrev_b32 v7, 2, v6
global_load_lds_dword v7, s[28:29] sc1
s_waitcnt vmcnt(0) lgkmcnt(0)
L_rce_f:
v_lshlrev_b32 v7, 2, v6
v_add_u32 v7, s35, v7
ds_read_b32 v7, v7
s_lshr_b32 s3, s76, 2
s_lshl_b32 s80, 0x50005, s3
s_mov_b32 s81, s80
s_waitcnt lgkmcnt(0)
v_cmp_eq_u32 s[82:83], -1, v7
v_cmp_eq_u32 vcc, 0x200000, v7
s_lshr_b64 s[30:31], vcc, 1
s_and_b64 s[30:31], s[30:31], s[82:83]
s_and_b64 s[30:31], s[30:31], s[80:81]
s_cmp_eq_u64 s[30:31], s[80:81]
s_cbranch_scc1 L_ceokL_rca_f
s_mov_b32 s31, 0
s_add_u32 s80, s3, 1
v_readlane_b32 s30, v7, s80
s_lshr_b32 s30, s30, 16
s_add_u32 s31, s31, s30
s_add_u32 s80, s3, 3
v_readlane_b32 s30, v7, s80
s_lshr_b32 s30, s30, 16
s_add_u32 s31, s31, s30
s_add_u32 s80, s3, 17
v_readlane_b32 s30, v7, s80
s_lshr_b32 s30, s30, 16
s_add_u32 s31, s31, s30
s_add_u32 s80, s3, 19
v_readlane_b32 s30, v7, s80
s_lshr_b32 s30, s30, 16
s_add_u32 s31, s31, s30
s_add_u32 s80, s3, 33
v_readlane_b32 s30, v7, s80
s_lshr_b32 s30, s30, 16
s_add_u32 s31, s31, s30
s_add_u32 s80, s3, 35
v_readlane_b32 s30, v7, s80
s_lshr_b32 s30, s30, 16
s_add_u32 s31, s31, s30
s_add_u32 s80, s3, 49
v_readlane_b32 s30, v7, s80
s_lshr_b32 s30, s30, 16
s_add_u32 s31, s31, s30
s_add_u32 s80, s3, 51
v_readlane_b32 s30, v7, s80
s_lshr_b32 s30, s30, 16
s_add_u32 s31, s31, s30
s_cmp_lt_u32 s31, 256
s_cbranch_scc1 L_rca_f
s_branch L_next
L_ceokL_rca_f:
s_lshl_b32 s3, s77, 4
s_add_u32 s3, s3, 15
v_readlane_b32 s3, v7, s3
s_cmp_lt_u32 s3, 64
s_cbranch_scc1 L_rca_f
s_lshl_b32 s3, s77, 4
s_add_u32 s3, s3, 14
v_readlane_b32 s3, v7, s3
s_cmp_lt_u32 s3, 0x400000
s_cbranch_scc1 L_rca_f
s_and_b32 s31, s3, 0xff
s_cmp_ge_u32 s31, 32
s_cselect_b32 s30, 8192, 0
s_bfe_u32 s31, s3, 0x80008
s_cmp_ge_u32 s31, 32
s_cselect_b32 s31, 0, 16384
s_add_u32 s30, s30, s31
s_add_u32 s61, s61, s30
s_add_u32 s62, s62, s30
s_add_u32 s55, s55, s30
s_mul_i32 s48, s25, 2097152
s_add_u32 s48, s48, 50331648
s_mul_i32 s50, s25, 1048576
s_add_u32 s50, s50, 16777216
s_lshr_b32 s3, s48, 8
s_xor_b32 s3, s3, s30
s_and_b32 s3, s3, 8192
s_add_u32 s48, s48, s3
s_lshr_b32 s3, s50, 8
s_xor_b32 s3, s3, s30
s_and_b32 s3, s3, 8192
s_add_u32 s50, s50, s3
s_lshl_b32 s30, s26, 11
s_add_u32 s48, s48, s30
s_add_u32 s49, s48, 16384
s_add_u32 s59, s30, 24576
s_add_u32 m0, s35, 256
v_and_b32 v7, 7, v6
v_lshlrev_b32 v7, 2, v7
buffer_load_dword v7, s[4:7], s54 offen sc1 lds
s_waitcnt vmcnt(13)
v_add_u32 v4, 57344, v3
ds_read_b64_tr_b16 v[8:9], v4 offset:0
ds_read_b64_tr_b16 v[10:11], v4 offset:128
ds_read_b64_tr_b16 v[12:13], v4 offset:512
ds_read_b64_tr_b16 v[14:15], v4 offset:640
ds_read_b64_tr_b16 v[16:17], v4 offset:8192
ds_read_b64_tr_b16 v[18:19], v4 offset:8320
ds_read_b64_tr_b16 v[20:21], v4 offset:8704
ds_read_b64_tr_b16 v[22:23], v4 offset:8832
s_waitcnt lgkmcnt(0)
s_barrier
s_add_u32 m0, s35, 122880
s_add_u32 s36, s32, 256
buffer_load_dwordx4 v1, s[20:23], s36 offen lds
s_add_u32 m0, s35, 126976
s_add_u32 s36, s32, 20736
buffer_load_dwordx4 v1, s[20:23], s36 offen lds
s_add_u32 m0, s35, 131072
s_add_u32 s36, s32, 41216
buffer_load_dwordx4 v1, s[20:23], s36 offen lds
s_add_u32 m0, s35, 135168
s_add_u32 s36, s32, 61696
buffer_load_dwordx4 v1, s[20:23], s36 offen lds
v_add_u32 v7, 57344, v5
ds_write_b128 v7, v[8:11] offset:0
ds_write_b128 v7, v[12:15] offset:4096
v_add_u32 v7, 65536, v5
ds_write_b128 v7, v[16:19] offset:0
ds_write_b128 v7, v[20:23] offset:4096
s_waitcnt vmcnt(13)
v_add_u32 v4, 73728, v2
ds_read_b64_tr_b16 v[8:9], v4 offset:0
ds_read_b64_tr_b16 v[10:11], v4 offset:256
ds_read_b64_tr_b16 v[12:13], v4 offset:8192
ds_read_b64_tr_b16 v[14:15], v4 offset:8448
ds_read_b64_tr_b16 v[16:17], v4 offset:32
ds_read_b64_tr_b16 v[18:19], v4 offset:288
ds_read_b64_tr_b16 v[20:21], v4 offset:8224
ds_read_b64_tr_b16 v[22:23], v4 offset:8480
s_waitcnt lgkmcnt(0)
s_barrier
s_add_u32 m0, s35, 139264
s_add_u32 s36, s37, 0
buffer_load_dwordx4 v1, s[20:23], s36 offen lds
s_add_u32 m0, s35, 143360
s_add_u32 s36, s37, 20480
buffer_load_dwordx4 v1, s[20:23], s36 offen lds
s_add_u32 m0, s35, 147456
s_add_u32 s36, s37, 40960
buffer_load_dwordx4 v1, s[20:23], s36 offen lds
s_add_u32 m0, s35, 151552
s_add_u32 s36, s37, 61440
buffer_load_dwordx4 v1, s[20:23], s36 offen lds
v_add_u32 v7, 73728, v5
ds_write_b128 v7, v[8:11] offset:0
ds_write_b128 v7, v[12:15] offset:4096
v_add_u32 v7, 81920, v5
ds_write_b128 v7, v[16:19] offset:0
ds_write_b128 v7, v[20:23] offset:4096
s_waitcnt vmcnt(13)
v_add_u32 v4, 90112, v2
ds_read_b64_tr_b16 v[8:9], v4 offset:0
ds_read_b64_tr_b16 v[10:11], v4 offset:256
ds_read_b64_tr_b16 v[12:13], v4 offset:8192
ds_read_b64_tr_b16 v[14:15], v4 offset:8448
ds_read_b64_tr_b16 v[16:17], v4 offset:32
ds_read_b64_tr_b16 v[18:19], v4 offset:288
ds_read_b64_tr_b16 v[20:21], v4 offset:8224
ds_read_b64_tr_b16 v[22:23], v4 offset:8480
s_waitcnt lgkmcnt(0)
v_add_u32 v7, 90112, v5
ds_write_b128 v7, v[8:11] offset:0
ds_write_b128 v7, v[12:15] offset:4096
v_add_u32 v7, 98304, v5
ds_write_b128 v7, v[16:19] offset:0
ds_write_b128 v7, v[20:23] offset:4096
s_waitcnt vmcnt(9)
v_add_u32 v4, 106496, v3
ds_read_b64_tr_b16 a[216:217], v4 offset:0
ds_read_b64_tr_b16 a[218:219], v4 offset:128
ds_read_b64_tr_b16 a[220:221], v4 offset:512
ds_read_b64_tr_b16 a[222:223], v4 offset:640
ds_read_b64_tr_b16 a[224:225], v4 offset:8192
ds_read_b64_tr_b16 a[226:227], v4 offset:8320
ds_read_b64_tr_b16 a[228:229], v4 offset:8704
ds_read_b64_tr_b16 a[230:231], v4 offset:8832
s_waitcnt lgkmcnt(0)
s_waitcnt vmcnt(4)
v_add_u32 v4, 122880, v3
ds_read_b64_tr_b16 a[232:233], v4 offset:0
ds_read_b64_tr_b16 a[234:235], v4 offset:128
ds_read_b64_tr_b16 a[236:237], v4 offset:512
ds_read_b64_tr_b16 a[238:239], v4 offset:640
ds_read_b64_tr_b16 a[240:241], v4 offset:8192
ds_read_b64_tr_b16 a[242:243], v4 offset:8320
ds_read_b64_tr_b16 a[244:245], v4 offset:8704
ds_read_b64_tr_b16 a[246:247], v4 offset:8832
s_waitcnt lgkmcnt(0)
v_lshlrev_b32 v7, 2, v6
v_add_u32 v7, s35, v7
ds_read_b32 v7, v7 offset:256
s_waitcnt lgkmcnt(0)
v_cmp_gt_u32 s[84:85], 2, v7
v_cmp_gt_u32 vcc, 1, v7
s_cbranch_vccz L_rk1_f
v_and_b32 v8, 7, v6
v_lshlrev_b32 v8, 2, v8
L_rkv1_f:
buffer_load_dword v9, v8, s[4:7], s54 offen sc1
s_add_u32 s27, s27, 1
s_cmp_gt_u32 s27, 262144
s_cbranch_scc1 L_fail_f
s_waitcnt vmcnt(0)
v_cmp_gt_u32 vcc, 1, v9
s_cbranch_vccz L_rkvok1_f
s_sleep 2
s_branch L_rkv1_f
L_rkvok1_f:
L_rk1_f:
s_lshl_b32 s30, s26, 11
s_add_u32 m0, s30, 16384
v_lshlrev_b32 v7, 4, v6
buffer_load_dwordx4 v7, s[4:7], s48 offen sc1 lds
buffer_load_dwordx4 v7, s[4:7], s48 offen offset:1024 sc1 lds
s_add_u32 m0, s30, 32768
s_add_u32 s48, s48, 32768
buffer_load_dwordx4 v7, s[4:7], s49 offen sc1 lds
buffer_load_dwordx4 v7, s[4:7], s49 offen offset:1024 sc1 lds
s_add_u32 s49, s49, 32768
s_waitcnt vmcnt(4)
v_add_u32 v4, 139264, v3
ds_read_b64_tr_b16 v[24:25], v4 offset:0
ds_read_b64_tr_b16 v[26:27], v4 offset:128
ds_read_b64_tr_b16 v[28:29], v4 offset:512
ds_read_b64_tr_b16 v[30:31], v4 offset:640
ds_read_b64_tr_b16 a[248:249], v4 offset:8192
ds_read_b64_tr_b16 a[250:251], v4 offset:8320
ds_read_b64_tr_b16 a[252:253], v4 offset:8704
ds_read_b64_tr_b16 a[254:255], v4 offset:8832
s_waitcnt lgkmcnt(0)
v_add_u32 v7, 114688, v5
ds_write_b128 v7, v[32:35] offset:0
ds_write_b128 v7, v[36:39] offset:4096
v_add_u32 v7, 131072, v5
ds_write_b128 v7, v[48:51] offset:0
ds_write_b128 v7, v[52:55] offset:4096
v_add_u32 v7, 139264, v5
ds_write_b128 v7, v[56:59] offset:0
ds_write_b128 v7, v[60:63] offset:4096
v_add_u32 v7, 122880, v5
ds_write_b128 v7, v[40:43] offset:0
ds_write_b128 v7, v[44:47] offset:4096
v_add_u32 v7, 147456, v5
ds_write_b128 v7, v[64:67] offset:0
ds_write_b128 v7, v[68:71] offset:4096
v_add_u32 v7, 106496, v5
ds_write_b128 v7, v[24:27] offset:0
ds_write_b128 v7, v[28:31] offset:4096
s_waitcnt lgkmcnt(0)
v_mov_b32 v8, v6
v_lshrrev_b32 v9, 4, v8
v_and_b32 v10, 15, v8
v_lshlrev_b32 v1, 4, v8
v_add_u32 v2, 0x10000, v1
v_lshrrev_b32 v11, 5, v8
v_lshlrev_b32 v11, 6, v11
v_lshlrev_b32 v12, 3, v10
v_xor_b32 v11, v11, v12
v_lshl_add_u32 v3, v9, 7, v11
v_lshrrev_b32 v11, 2, v8
v_lshlrev_b32 v11, 3, v11
v_bfe_u32 v13, v8, 1, 1
v_lshlrev_b32 v14, 6, v13
v_xor_b32 v11, v11, v14
v_and_b32 v14, 3, v8
v_lshl_add_u32 v4, v14, 7, v11
v_lshl_add_u32 v5, v9, 12, v12
v_lshrrev_b32 v6, 2, v8
v_lshlrev_b32 v6, 7, v6
v_lshl_add_u32 v6, v14, 4, v6
v_and_b32 v15, 1, v8
v_mul_u32_u24 v0, 0xaaaa, v13
v_add_u32 v0, 0x4444, v0
v_bfe_u32 v11, v8, 2, 1
v_lshlrev_b32 v7, 8, v13
v_lshl_add_u32 v7, v11, 5, v7
v_lshl_add_u32 v7, v15, 4, v7
s_xor_b32 s3, s41, 1
v_and_b32 v25, s3, v9
v_add_u32 v25, s42, v25
v_lshrrev_b32 v26, 5, v8
v_lshl_add_u32 v25, v25, 1, v26
v_lshl_add_u32 v7, v25, 2, v7
v_add_u32 v7, s53, v7
s_mov_b32 s64, 50529027
s_mov_b32 s65, 50529027
s_mov_b32 s66, 202116108
s_mov_b32 s67, 202116108
s_mov_b32 s68, 808464432
s_mov_b32 s69, 808464432
s_mov_b32 s70, 3233857728
s_mov_b32 s71, 3233857728
s_mov_b32 s56, 1040356334
s_mov_b32 s57, 0x3f80
s_mov_b32 s74, 0x3f803f80
s_mov_b32 s75, 0x3f803f80
s_mov_b32 s63, 1006632960
s_mov_b32 s32, 0
s_mov_b32 s33, 0
s_mov_b32 s34, 0
s_mov_b32 s52, 0
s_mov_b32 s100, 0
s_sub_u32 s50, s50, 16384
s_add_u32 s51, s50, 4096
s_cmp_eq_u32 s24, 0
s_cselect_b32 s30, 0, 0x40000000
s_cselect_b32 s31, 0x40000000, 0
s_add_u32 s50, s50, s30
s_add_u32 s51, s51, s31
s_lshl_b32 s3, s26, 10
s_add_u32 s35, s60, s3
s_add_u32 s37, s62, s3
s_lshr_b32 s3, s3, 2
s_add_u32 s3, s3, 4096
s_add_u32 s36, s60, s3
s_add_u32 s38, s62, s3
s_and_b32 s3, s25, 7
s_lshl_b32 s3, s3, 7
s_lshl_b32 s30, s25, 2
s_cmp_eq_u32 s26, 2
s_cselect_b32 s3, s30, s3
s_lshl_b32 s8, s24, 10
s_add_u32 s8, s8, s3
s_add_u32 s8, s8, 49152
s_mov_b32 s53, s8
s_mov_b32 s9, 0x40000000
s_mov_b32 s12, 32768
s_cmp_eq_u32 s26, 0
s_cselect_b32 s10, s61, s62
s_add_u32 s10, s10, 5376
s_cmp_eq_u32 s25, 31
s_cselect_b32 s10, s10, 0x40000000
s_cmp_eq_u64 s[84:85], 0
s_cbranch_scc1 L_rk2_f
v_and_b32 v16, 7, v8
v_lshlrev_b32 v16, 2, v16
L_rkv2_f:
buffer_load_dword v17, v16, s[4:7], s54 offen sc1
s_add_u32 s27, s27, 1
s_cmp_gt_u32 s27, 262144
s_cbranch_scc1 L_fail_f
s_waitcnt vmcnt(0)
v_cmp_gt_u32 vcc, 2, v17
s_cbranch_vccz L_rkvok2_f
s_sleep 2
s_branch L_rkv2_f
L_rkvok2_f:
L_rk2_f:
s_waitcnt vmcnt(0) lgkmcnt(0)
s_cmp_eq_u32 s26, 2
s_cbranch_scc1 L_rw2_f
s_cmp_eq_u32 s26, 3
s_cbranch_scc1 L_rw3_f
s_cmp_eq_u32 s26, 0
s_cbranch_scc1 L_rw0_f
s_cmp_lt_u32 s25, 16
s_cbranch_scc1 L_rw1_f
v_lshrrev_b32 v6, 2, v1
ds_read_b128 v[56:59], v1 offset:34816
ds_read_b128 v[60:63], v1 offset:35840
ds_read_b128 v[64:67], v2 offset:9216
ds_read_b128 v[68:71], v2 offset:13312
v_mov_b64 v[8:9], 0
v_mov_b64 v[10:11], 0
v_mov_b64 v[12:13], 0
v_mov_b64 v[14:15], 0
v_mov_b64 v[16:17], 0
v_mov_b64 v[18:19], 0
v_mov_b64 v[20:21], 0
v_mov_b64 v[22:23], 0
v_mov_b64 v[24:25], 0
v_mov_b64 v[26:27], 0
v_mov_b64 v[28:29], 0
v_mov_b64 v[30:31], 0
s_mov_b32 s41, 0x40000000
.p2align 6
L_step10_f:
buffer_load_dwordx4 v[48:51], v1, s[4:7], s35 offen sc1
s_nop 15
s_nop 0
buffer_load_dwordx4 v[52:55], v1, s[4:7], s35 offen sc1
s_nop 15
s_nop 0
buffer_load_dwordx4 v[44:47], v1, s[4:7], s35 offen sc1
s_nop 15
s_nop 0
buffer_load_dwordx4 v[40:43], v1, s[4:7], s35 offen sc1
s_waitcnt vmcnt(3)
ds_write_b128 v1, v[48:51] offset:1024
v_max3_u32 v32, v48, v49, v50
v_max_u32 v32, v32, v51
v_cmp_eq_u32 vcc, -1, v32
s_cbranch_vccnz L_aretry10_f
L_aback10_f:
buffer_load_dword v44, v6, s[4:7], s36 offen sc1
s_waitcnt lgkmcnt(0)
s_barrier
ds_read_b128 v[32:35], v1 offset:0
buffer_load_dwordx4 v[48:51], v1, s[4:7], s37 offen sc1
buffer_load_dword v52, v6, s[4:7], s38 offen sc1
ds_read_b128 v[36:39], v1 offset:1024
s_waitcnt lgkmcnt(1)
v_smfmac_f32_16x16x64_bf16 v[8:11], v[32:35], v[64:71], v0
ds_read_b128 v[64:67], v2 offset:17408
ds_read_b128 v[68:71], v2 offset:21504
v_smfmac_f32_16x16x64_bf16 v[16:19], v[32:35], v[72:79], v0
s_mul_i32 s3, s52, 5120
s_add_u32 s40, s60, s3
s_add_u32 s52, s52, 1
v_smfmac_f32_16x16x64_bf16 v[20:23], v[32:35], v[80:87], v0
v_smfmac_f32_16x16x64_bf16 v[24:27], v[32:35], a[64:71], v0
v_smfmac_f32_16x16x64_bf16 v[28:31], v[32:35], a[72:79], v0
s_waitcnt lgkmcnt(0)
v_smfmac_f32_16x16x64_bf16 v[12:15], v[32:35], v[64:71], v0
ds_read_b128 v[64:67], v2 offset:25600
ds_read_b128 v[68:71], v2 offset:29696
v_smfmac_f32_16x16x64_bf16 v[8:11], v[36:39], v[208:215], v0
s_and_b32 s52, s52, 3
s_xor_b32 s30, s52, 2
s_lshl_b32 s30, s30, 15
v_smfmac_f32_16x16x64_bf16 v[12:15], v[36:39], v[216:223], v0
s_waitcnt vmcnt(3)
ds_read_b128 v[40:43], v1 offset:2048
v_smfmac_f32_16x16x64_bf16 v[16:19], v[36:39], v[88:95], v0
s_mul_i32 s3, s52, 5120
s_add_u32 s39, s60, s3
s_lshl_b32 s31, s52, 15
v_smfmac_f32_16x16x64_bf16 v[20:23], v[36:39], v[96:103], v0
ds_read_b128 v[32:35], v1 offset:3072
s_add_u32 s42, s61, s30
v_smfmac_f32_16x16x64_bf16 v[24:27], v[36:39], a[80:87], v0
s_waitcnt vmcnt(2)
ds_write_b32 v6, v44 offset:4352
v_cmp_eq_u32 vcc, -1, v44
v_smfmac_f32_16x16x64_bf16 v[28:31], v[36:39], a[88:95], v0
s_waitcnt lgkmcnt(2)
v_smfmac_f32_16x16x64_bf16 v[8:11], v[40:43], v[64:71], v0
ds_read_b128 v[64:67], v2 offset:33792
ds_read_b128 v[68:71], v2 offset:37888
s_cbranch_vccnz L_fretry10_f
L_fback10_f:
v_smfmac_f32_16x16x64_bf16 v[16:19], v[40:43], v[104:111], v0
v_smfmac_f32_16x16x64_bf16 v[20:23], v[40:43], v[112:119], v0
s_add_u32 s41, s61, s31
s_add_u32 s31, s31, s62
s_add_u32 s35, s39, 1024
v_smfmac_f32_16x16x64_bf16 v[24:27], v[40:43], a[96:103], v0
s_waitcnt lgkmcnt(2)
s_barrier
v_smfmac_f32_16x16x64_bf16 v[28:31], v[40:43], a[104:111], v0
s_waitcnt lgkmcnt(0)
v_smfmac_f32_16x16x64_bf16 v[12:15], v[40:43], v[64:71], v0
ds_read_b128 v[64:67], v2 offset:50176
ds_read_b128 v[68:71], v2 offset:54272
v_smfmac_f32_16x16x64_bf16 v[8:11], v[32:35], v[224:231], v0
ds_read_b128 v[36:39], v1 offset:4096
v_smfmac_f32_16x16x64_bf16 v[12:15], v[32:35], v[232:239], v0
s_add_u32 s36, s39, 4352
v_smfmac_f32_16x16x64_bf16 v[16:19], v[32:35], v[120:127], v0
s_waitcnt vmcnt(1)
ds_write_b128 v1, v[48:51] offset:6144
s_add_u32 s58, s32, 3
s_min_u32 s58, s58, 64
v_max3_u32 v53, v48, v49, v50
v_smfmac_f32_16x16x64_bf16 v[20:23], v[32:35], v[128:135], v0
s_waitcnt vmcnt(0)
ds_write_b32 v6, v52 offset:9472
s_mov_b32 m0, s59
s_xor_b32 s59, s59, 8192
v_max3_u32 v53, v53, v51, v52
s_waitcnt lgkmcnt(3)
v_smfmac_f32_16x16x64_bf16 v[24:27], v[32:35], v[64:71], v0
ds_read_b128 v[64:67], v2 offset:58368
ds_read_b128 v[68:71], v2 offset:62464
v_cmp_eq_u32 vcc, -1, v53
v_smfmac_f32_16x16x64_bf16 v[28:31], v[32:35], a[112:119], v0
s_waitcnt lgkmcnt(4)
v_smfmac_f32_16x16x64_bf16 v[8:11], v[36:39], v[240:247], v0
s_cbranch_vccnz L_bretry10_f
L_bback10_f:
v_add_u32 v2, 0x10000, v2
v_smfmac_f32_16x16x64_bf16 v[12:15], v[36:39], v[248:255], v0
s_waitcnt lgkmcnt(2)
s_barrier
ds_read_b128 v[40:43], v1 offset:5120
v_smfmac_f32_16x16x64_bf16 v[16:19], v[36:39], v[136:143], v0
ds_read_b128 v[44:47], v1 offset:6144
buffer_load_dwordx4 v1, s[4:7], s48 offen sc1 lds
s_waitcnt lgkmcnt(2)
v_smfmac_f32_16x16x64_bf16 v[20:23], v[36:39], v[64:71], v0
ds_read_b128 v[64:67], v2 offset:1024
ds_read_b128 v[68:71], v2 offset:5120
v_smfmac_f32_16x16x64_bf16 v[24:27], v[36:39], a[120:127], v0
ds_read_b128 v[32:35], v1 offset:7168
buffer_load_dwordx4 v1, s[4:7], s48 offen offset:1024 sc1 lds
s_mov_b32 m0, 34816
v_smfmac_f32_16x16x64_bf16 v[28:31], v[36:39], a[128:135], v0
ds_read_b128 v[48:51], v1 offset:8192
s_waitcnt lgkmcnt(5)
v_smfmac_f32_16x16x64_bf16 v[8:11], v[40:43], a[0:7], v0
ds_read_b128 v[36:39], v1 offset:9216
v_smfmac_f32_16x16x64_bf16 v[12:15], v[40:43], a[8:15], v0
buffer_load_dwordx4 v1, s[4:7], s49 offen sc1 lds
s_waitcnt lgkmcnt(3)
v_smfmac_f32_16x16x64_bf16 v[8:11], v[44:47], v[64:71], v0
ds_read_b128 v[64:67], v2 offset:9216
ds_read_b128 v[68:71], v2 offset:13312
v_smfmac_f32_16x16x64_bf16 v[12:15], v[44:47], a[16:23], v0
buffer_load_dwordx4 v1, s[4:7], s49 offen offset:1024 sc1 lds
s_waitcnt lgkmcnt(4)
v_smfmac_f32_16x16x64_bf16 v[8:11], v[32:35], a[24:31], v0
s_cmp_eq_u32 s32, 62
s_cselect_b32 s11, 0x40000000, s12
s_waitcnt lgkmcnt(3)
v_smfmac_f32_16x16x64_bf16 v[8:11], v[48:51], a[32:39], v0
s_waitcnt lgkmcnt(2)
v_smfmac_f32_16x16x64_bf16 v[8:11], v[36:39], a[48:55], v0
s_add_u32 s37, s31, 1024
s_add_u32 s38, s31, 4352
s_waitcnt lgkmcnt(0)
v_smfmac_f32_16x16x64_bf16 v[12:15], v[32:35], v[64:71], v0
ds_read_b128 v[64:67], v2 offset:17408
ds_read_b128 v[68:71], v2 offset:21504
v_smfmac_f32_16x16x64_bf16 v[12:15], v[48:51], a[40:47], v0
s_sub_u32 s3, s59, 2048
v_add_u32 v6, s3, v1
v_smfmac_f32_16x16x64_bf16 v[12:15], v[36:39], a[56:63], v0
s_add_u32 s48, s48, s11
s_add_u32 s49, s49, s11
v_add_f32 v8, v8, v10
v_smfmac_f32_16x16x64_bf16 v[16:19], v[40:43], v[144:151], v0
v_add_f32 v9, v9, v11
v_smfmac_f32_16x16x64_bf16 v[16:19], v[44:47], v[160:167], v0
v_mul_f32 v8, s56, v8
s_waitcnt lgkmcnt(0)
v_smfmac_f32_16x16x64_bf16 v[16:19], v[32:35], v[64:71], v0
ds_read_b128 v[64:67], v2 offset:25600
ds_read_b128 v[68:71], v2 offset:29696
v_mul_f32 v9, s56, v9
v_smfmac_f32_16x16x64_bf16 v[16:19], v[48:51], v[176:183], v0
s_add_u32 s50, s50, 16384
s_add_u32 s51, s51, 16384
v_add_f32 v12, v12, v14
v_smfmac_f32_16x16x64_bf16 v[16:19], v[36:39], v[192:199], v0
s_nop 1
v_add_f32 v13, v13, v15
v_smfmac_f32_16x16x64_bf16 v[20:23], v[40:43], v[152:159], v0
s_nop 1
v_mul_f32 v12, s56, v12
v_smfmac_f32_16x16x64_bf16 v[20:23], v[44:47], v[168:175], v0
v_mul_f32 v13, s56, v13
s_waitcnt lgkmcnt(0)
v_smfmac_f32_16x16x64_bf16 v[20:23], v[32:35], v[64:71], v0
ds_read_b128 v[64:67], v6 offset:0
v_add_f32 v16, v16, v18
v_smfmac_f32_16x16x64_bf16 v[20:23], v[48:51], v[184:191], v0
s_cmp_eq_u32 s32, 63
ds_read_b128 v[68:71], v6 offset:1024
v_add_f32 v17, v17, v19
v_smfmac_f32_16x16x64_bf16 v[20:23], v[36:39], v[200:207], v0
s_nop 1
v_cvt_pk_bf16_f32 v53, v8, v9
v_cvt_pk_bf16_f32 v52, v16, v17
v_smfmac_f32_16x16x64_bf16 v[24:27], v[32:35], a[168:175], v0
s_nop 0
ds_write_b64 v3, v[52:53] offset:10752
v_cvt_pk_bf16_f32 v55, v12, v13
v_add_f32 v20, v20, v22
v_add_f32 v21, v21, v23
v_cvt_pk_bf16_f32 v54, v20, v21
ds_write_b64 v3, v[54:55] offset:12800
v_smfmac_f32_16x16x64_bf16 v[28:31], v[32:35], a[176:183], v0
v_smfmac_f32_16x16x64_bf16 v[24:27], v[36:39], a[200:207], v0
ds_read_b128 v[32:35], v6 offset:2048
v_add_u32 v2, 0x10000, v1
v_smfmac_f32_16x16x64_bf16 v[28:31], v[36:39], a[208:215], v0
v_smfmac_f32_16x16x64_bf16 v[24:27], v[44:47], a[152:159], v0
s_waitcnt lgkmcnt(1)
s_barrier
ds_read_b64_tr_b16 v[8:9], v4 offset:10240
ds_read_b64_tr_b16 v[10:11], v4 offset:12288
v_smfmac_f32_16x16x64_bf16 v[28:31], v[44:47], a[160:167], v0
ds_read_b64_tr_b16 v[12:13], v4 offset:10752
ds_read_b64_tr_b16 v[14:15], v4 offset:12800
v_smfmac_f32_16x16x64_bf16 v[24:27], v[40:43], a[136:143], v0
ds_read_b64_tr_b16 v[16:17], v4 offset:11264
ds_read_b64_tr_b16 v[18:19], v4 offset:13312
v_smfmac_f32_16x16x64_bf16 v[28:31], v[40:43], a[144:151], v0
ds_read_b64_tr_b16 v[20:21], v4 offset:11776
ds_read_b64_tr_b16 v[22:23], v4 offset:13824
v_smfmac_f32_16x16x64_bf16 v[24:27], v[48:51], a[184:191], v0
ds_read_b128 v[36:39], v6 offset:3072
ds_read_b128 v[44:47], v6 offset:4096
v_smfmac_f32_16x16x64_bf16 v[28:31], v[48:51], a[192:199], v0
ds_read_b128 v[40:43], v6 offset:5120
s_waitcnt lgkmcnt(9)
v_mfma_f32_16x16x32_bf16 v[52:55], v[8:11], v[8:11], 0
s_waitcnt lgkmcnt(7)
v_mfma_f32_16x16x32_bf16 v[52:55], v[12:15], v[12:15], v[52:55]
buffer_store_dwordx4 v[12:15], v1, s[4:7], s50 offen offset:1024 sc1
s_waitcnt lgkmcnt(5)
v_add_f32 v24, v24, v26
v_add_f32 v25, v25, v27
v_mfma_f32_16x16x32_bf16 v[52:55], v[16:19], v[16:19], v[52:55]
s_waitcnt lgkmcnt(3)
v_add_f32 v28, v28, v30
v_add_f32 v29, v29, v31
v_mfma_f32_16x16x32_bf16 v[52:55], v[20:23], v[20:23], v[52:55]
v_cvt_pk_bf16_f32 v24, v24, v25
v_cvt_pk_bf16_f32 v25, v28, v29
v_mfma_f32_16x16x32_bf16 v[48:51], v[64:67], v[8:11], 0
ds_read_b128 v[64:67], v6 offset:6144
v_mov_b64 v[26:27], s[74:75]
v_mfma_f32_16x16x32_bf16 v[48:51], v[68:71], v[12:15], v[48:51]
ds_read_b128 v[68:71], v6 offset:7168
buffer_store_dwordx2 v[24:25], v3, s[4:7], s51 offen offset:512 sc1
v_mov_b32 v29, 0
v_mfma_f32_16x16x32_bf16 v[48:51], v[32:35], v[16:19], v[48:51]
s_cbranch_scc1 L_last10_f
s_waitcnt lgkmcnt(4)
v_exp_f32 v54, v54
v_mfma_f32_16x16x32_bf16 v[48:51], v[36:39], v[20:23], v[48:51]
s_waitcnt lgkmcnt(3)
v_exp_f32 v55, v55
v_mfma_f32_16x16x32_bf16 v[32:35], v[44:47], v[8:11], 0
s_waitcnt lgkmcnt(2)
v_cvt_pk_bf16_f32 v28, v54, v55
v_cvt_pk_bf16_f32 v31, v54, v55
v_mfma_f32_16x16x32_bf16 v[32:35], v[40:43], v[12:15], v[32:35]
s_waitcnt lgkmcnt(1)
v_mov_b32 v30, 0
v_mfma_f32_16x16x32_bf16 v[32:35], v[64:67], v[16:19], v[32:35]
s_waitcnt lgkmcnt(0)
v_exp_f32 v48, v48
v_mfma_f32_16x16x32_bf16 v[32:35], v[68:71], v[20:23], v[32:35]
s_add_u32 s32, s32, 1
v_exp_f32 v49, v49
v_mfma_f32_16x16x16_bf16 v[52:55], v[28:29], v[26:27], 0
ds_read_b128 v[8:11], v2 offset:41984
v_exp_f32 v50, v50
v_mfma_f32_16x16x16_bf16 v[44:47], v[28:29], v[24:25], 0
ds_read_b128 v[12:15], v2 offset:46080
v_exp_f32 v51, v51
v_mfma_f32_16x16x16_bf16 v[40:43], v[30:31], v[24:25], 0
v_exp_f32 v32, v32
v_cvt_pk_bf16_f32 v36, v48, v49
v_cvt_pk_bf16_f32 v37, v50, v51
v_exp_f32 v33, v33
v_exp_f32 v34, v34
v_mfma_f32_16x16x16_bf16 v[52:55], v[36:37], v[26:27], v[52:55]
v_exp_f32 v35, v35
v_cvt_pk_bf16_f32 v38, v32, v33
v_cvt_pk_bf16_f32 v39, v34, v35
s_nop 1
v_mfma_f32_16x16x16_bf16 v[52:55], v[38:39], v[26:27], v[52:55]
ds_read_b128 v[16:19], v1 offset:41984
ds_read_b128 v[20:23], v1 offset:46080
v_mfma_f32_16x16x32_bf16 v[44:47], v[36:39], v[56:59], v[44:47]
ds_read_b128 v[64:67], v1 offset:50176
ds_read_b128 v[68:71], v1 offset:54272
v_mfma_f32_16x16x32_bf16 v[40:43], v[36:39], v[60:63], v[40:43]
s_nop 1
v_rcp_f32 v52, v52
v_rcp_f32 v53, v53
v_subrev_u32 v54, 562036736, v52
v_mul_f32 v44, v44, v52
v_mul_f32 v45, v45, v53
v_cvt_pk_bf16_f32 v48, v44, v45
v_cvt_pk_bf16_f32 v49, v44, v45
ds_write_b64 v3, v[48:49] offset:5632
v_pk_mul_f32 v[40:41], v[40:41], v[52:53]
v_cvt_pk_bf16_f32 v50, v40, v41
v_cvt_pk_bf16_f32 v51, v40, v41
ds_write_b64 v3, v[50:51] offset:7680
v_subrev_u32 v53, 562036736, v53
v_max_u32 v52, v54, v53
v_cmp_le_u32 vcc, s63, v52
v_mov_b64 v[52:53], 0
v_mov_b64 v[54:55], 0
v_mov_b64 v[40:41], 0
v_mov_b64 v[42:43], 0
s_cbranch_vccnz L_sretry10_f
L_sback10_f:
s_waitcnt lgkmcnt(0)
s_barrier
ds_read_b64_tr_b16 v[24:25], v4 offset:5120
ds_read_b64_tr_b16 v[26:27], v4 offset:7168
ds_read_b64_tr_b16 v[28:29], v4 offset:5632
ds_read_b64_tr_b16 v[30:31], v4 offset:7680
ds_read_b64_tr_b16 v[32:33], v4 offset:6144
ds_read_b64_tr_b16 v[34:35], v4 offset:8192
s_waitcnt lgkmcnt(4)
v_smfmac_f32_16x16x64_bf16 v[52:55], v[24:27], v[8:15], v0
ds_read_b64_tr_b16 v[36:37], v4 offset:6656
ds_read_b64_tr_b16 v[38:39], v4 offset:8704
s_waitcnt lgkmcnt(4)
v_mov_b64 v[44:45], 0
v_smfmac_f32_16x16x64_bf16 v[52:55], v[28:31], a[248:255], v0
v_mov_b64 v[46:47], 0
v_smfmac_f32_16x16x64_bf16 v[40:43], v[24:27], v[16:23], v0
ds_read_b128 v[56:59], v1 offset:58368
ds_read_b128 v[60:63], v1 offset:62464
v_smfmac_f32_16x16x64_bf16 v[40:43], v[28:31], v[64:71], v0
ds_read_b128 v[8:11], v2 offset:1024
ds_read_b128 v[12:15], v2 offset:5120
s_waitcnt lgkmcnt(6)
v_cvt_pk_bf16_f32 v52, v52, v53
v_smfmac_f32_16x16x64_bf16 v[40:43], v[32:35], a[216:223], v0
s_waitcnt lgkmcnt(4)
v_cvt_pk_bf16_f32 v53, v54, v55
v_and_or_b32 v52, v52, -2, s33
v_smfmac_f32_16x16x64_bf16 v[40:43], v[36:39], a[224:231], v0
buffer_store_dwordx2 v[52:53], v5, s[4:7], s45 offen
s_nop 0
v_smfmac_f32_16x16x64_bf16 v[44:47], v[24:27], a[232:239], v0
s_nop 1
v_smfmac_f32_16x16x64_bf16 v[44:47], v[28:31], a[240:247], v0
s_waitcnt lgkmcnt(2)
s_nop 0
v_cvt_pk_bf16_f32 v40, v40, v41
v_smfmac_f32_16x16x64_bf16 v[44:47], v[32:35], v[56:63], v0
s_waitcnt lgkmcnt(0)
v_cvt_pk_bf16_f32 v41, v42, v43
v_and_or_b32 v40, v40, -2, s33
v_smfmac_f32_16x16x64_bf16 v[44:47], v[36:39], v[8:15], v0
buffer_store_dwordx2 v[40:41], v5, s[4:7], s43 offen
s_nop 6
v_cvt_pk_bf16_f32 v44, v44, v45
v_cvt_pk_bf16_f32 v45, v46, v47
v_and_or_b32 v44, v44, -2, s33
buffer_store_dwordx2 v[44:45], v5, s[4:7], s44 offen
s_xor_b32 s33, s33, 1
s_barrier
s_waitcnt vmcnt(0)
ds_read_b128 v[56:59], v1 offset:34816
ds_read_b128 v[60:63], v1 offset:35840
ds_read_b128 v[64:67], v2 offset:9216
ds_read_b128 v[68:71], v2 offset:13312
v_mov_b64 v[8:9], 0
v_mov_b64 v[10:11], 0
v_mov_b64 v[12:13], 0
v_mov_b64 v[14:15], 0
v_mov_b64 v[16:17], 0
v_mov_b64 v[18:19], 0
v_mov_b64 v[20:21], 0
v_mov_b64 v[22:23], 0
v_mov_b64 v[24:25], 0
v_mov_b64 v[26:27], 0
v_mov_b64 v[28:29], 0
v_mov_b64 v[30:31], 0
s_barrier
v_lshrrev_b32 v6, 2, v1
s_nop 15
s_nop 15
s_nop 9
s_branch L_step10_f
L_aretry10_f:
buffer_load_dwordx4 v[48:51], v1, s[4:7], s35 offen sc1
s_waitcnt vmcnt(3)
v_max3_u32 v32, v52, v53, v54
v_max_u32 v32, v32, v55
v_cmp_eq_u32 vcc, -1, v32
s_cbranch_vccz L_aw010_f
buffer_load_dwordx4 v[52:55], v1, s[4:7], s35 offen sc1
s_waitcnt vmcnt(3)
v_max3_u32 v32, v44, v45, v46
v_max_u32 v32, v32, v47
v_cmp_eq_u32 vcc, -1, v32
s_cbranch_vccz L_aw110_f
buffer_load_dwordx4 v[44:47], v1, s[4:7], s35 offen sc1
s_waitcnt vmcnt(3)
v_max3_u32 v32, v40, v41, v42
v_max_u32 v32, v32, v43
v_cmp_eq_u32 vcc, -1, v32
s_cbranch_vccz L_aw210_f
buffer_load_dwordx4 v[40:43], v1, s[4:7], s35 offen sc1
s_waitcnt vmcnt(3)
v_max3_u32 v32, v48, v49, v50
v_max_u32 v32, v32, v51
v_cmp_eq_u32 vcc, -1, v32
s_cbranch_vccz L_aw310_f
s_add_u32 s27, s27, 1
s_cmp_gt_u32 s27, 262144
s_cbranch_scc0 L_aretry10_f
s_branch L_fail_f
L_aw010_f:
ds_write_b128 v1, v[52:55] offset:1024
s_branch L_aback10_f
L_aw110_f:
ds_write_b128 v1, v[44:47] offset:1024
s_branch L_aback10_f
L_aw210_f:
ds_write_b128 v1, v[40:43] offset:1024
s_branch L_aback10_f
L_aw310_f:
ds_write_b128 v1, v[48:51] offset:1024
s_branch L_aback10_f
L_fretry10_f:
s_waitcnt lgkmcnt(0)
buffer_load_dword v44, v6, s[4:7], s36 offen sc1
s_add_u32 s27, s27, 1
s_cmp_gt_u32 s27, 262144
s_cbranch_scc1 L_fail_f
s_waitcnt vmcnt(0)
ds_write_b32 v6, v44 offset:4352
v_cmp_eq_u32 vcc, -1, v44
s_waitcnt lgkmcnt(0)
s_cbranch_vccnz L_fretry10_f
s_branch L_fback10_f
L_bretry10_f:
s_waitcnt lgkmcnt(0)
buffer_load_dwordx4 v[48:51], v1, s[4:7], s37 offen sc1
buffer_load_dword v52, v6, s[4:7], s38 offen sc1
s_add_u32 s27, s27, 1
s_cmp_gt_u32 s27, 262144
s_cbranch_scc1 L_fail_f
s_waitcnt vmcnt(0)
ds_write_b128 v1, v[48:51] offset:6144
ds_write_b32 v6, v52 offset:9472
v_max3_u32 v53, v48, v49, v50
v_max3_u32 v53, v53, v51, v52
v_cmp_eq_u32 vcc, -1, v53
s_waitcnt lgkmcnt(0)
s_cbranch_vccnz L_bretry10_f
s_branch L_bback10_f
L_last10_f:
s_waitcnt vmcnt(0) lgkmcnt(0)
s_barrier
s_endpgm
L_sretry10_f:
s_waitcnt lgkmcnt(0)
s_sub_u32 s3, s59, 2048
v_add_u32 v6, s3, v1
ds_read_b64_tr_b16 v[8:9], v4 offset:10240
ds_read_b64_tr_b16 v[10:11], v4 offset:12288
ds_read_b64_tr_b16 v[12:13], v4 offset:10752
ds_read_b64_tr_b16 v[14:15], v4 offset:12800
ds_read_b64_tr_b16 v[16:17], v4 offset:11264
ds_read_b64_tr_b16 v[18:19], v4 offset:13312
ds_read_b64_tr_b16 v[20:21], v4 offset:11776
ds_read_b64_tr_b16 v[22:23], v4 offset:13824
s_waitcnt lgkmcnt(6)
v_mfma_f32_16x16x32_bf16 v[52:55], v[8:11], v[8:11], 0
s_waitcnt lgkmcnt(4)
v_mfma_f32_16x16x32_bf16 v[52:55], v[12:15], v[12:15], v[52:55]
s_waitcnt lgkmcnt(2)
v_mfma_f32_16x16x32_bf16 v[52:55], v[16:19], v[16:19], v[52:55]
s_waitcnt lgkmcnt(0)
v_mfma_f32_16x16x32_bf16 v[52:55], v[20:23], v[20:23], v[52:55]
ds_read_b128 v[64:67], v6 offset:0
ds_read_b128 v[68:71], v6 offset:1024
ds_read_b128 v[40:43], v6 offset:2048
ds_read_b128 v[44:47], v6 offset:3072
s_waitcnt lgkmcnt(3)
v_mfma_f32_16x16x32_bf16 v[48:51], v[64:67], v[8:11], 0
s_waitcnt lgkmcnt(2)
v_mfma_f32_16x16x32_bf16 v[48:51], v[68:71], v[12:15], v[48:51]
s_waitcnt lgkmcnt(1)
v_mfma_f32_16x16x32_bf16 v[48:51], v[40:43], v[16:19], v[48:51]
s_waitcnt lgkmcnt(0)
v_mfma_f32_16x16x32_bf16 v[48:51], v[44:47], v[20:23], v[48:51]
ds_read_b128 v[64:67], v6 offset:4096
ds_read_b128 v[68:71], v6 offset:5120
ds_read_b128 v[40:43], v6 offset:6144
ds_read_b128 v[44:47], v6 offset:7168
s_waitcnt lgkmcnt(3)
v_mfma_f32_16x16x32_bf16 v[32:35], v[64:67], v[8:11], 0
s_waitcnt lgkmcnt(2)
v_mfma_f32_16x16x32_bf16 v[32:35], v[68:71], v[12:15], v[32:35]
s_waitcnt lgkmcnt(1)
v_mfma_f32_16x16x32_bf16 v[32:35], v[40:43], v[16:19], v[32:35]
s_waitcnt lgkmcnt(0)
v_mfma_f32_16x16x32_bf16 v[32:35], v[44:47], v[20:23], v[32:35]
v_max3_f32 v52, v54, v55, v48
v_max3_f32 v52, v52, v49, v50
s_nop 5
v_max3_f32 v52, v52, v51, v32
v_max3_f32 v52, v52, v33, v34
v_max_f32 v52, v52, v35
v_mov_b32 v53, v52
s_nop 1
v_permlane32_swap_b32 v52, v53
v_max_f32 v52, v52, v53
v_mov_b32 v53, v52
s_nop 1
v_permlane16_swap_b32 v52, v53
v_max_f32 v52, v52, v53
v_sub_f32 v54, v54, v52
v_sub_f32 v55, v55, v52
v_sub_f32 v48, v48, v52
v_sub_f32 v49, v49, v52
v_sub_f32 v50, v50, v52
v_sub_f32 v51, v51, v52
v_sub_f32 v32, v32, v52
v_sub_f32 v33, v33, v52
v_sub_f32 v34, v34, v52
v_sub_f32 v35, v35, v52
v_exp_f32 v54, v54
v_exp_f32 v55, v55
v_exp_f32 v48, v48
v_exp_f32 v49, v49
v_exp_f32 v50, v50
v_exp_f32 v51, v51
v_exp_f32 v32, v32
v_exp_f32 v33, v33
v_exp_f32 v34, v34
v_exp_f32 v35, v35
v_cvt_pk_bf16_f32 v28, v54, v55
v_cvt_pk_bf16_f32 v31, v54, v55
v_cvt_pk_bf16_f32 v36, v48, v49
v_cvt_pk_bf16_f32 v37, v50, v51
v_cvt_pk_bf16_f32 v38, v32, v33
v_cvt_pk_bf16_f32 v39, v34, v35
v_mfma_f32_16x16x16_bf16 v[52:55], v[28:29], v[26:27], 0
v_mfma_f32_16x16x16_bf16 v[44:47], v[28:29], v[24:25], 0
v_mfma_f32_16x16x16_bf16 v[40:43], v[30:31], v[24:25], 0
v_mfma_f32_16x16x16_bf16 v[52:55], v[36:37], v[26:27], v[52:55]
v_mfma_f32_16x16x16_bf16 v[52:55], v[38:39], v[26:27], v[52:55]
v_mfma_f32_16x16x32_bf16 v[44:47], v[36:39], v[56:59], v[44:47]
v_mfma_f32_16x16x32_bf16 v[40:43], v[36:39], v[60:63], v[40:43]
ds_read_b128 v[8:11], v2 offset:41984
ds_read_b128 v[12:15], v2 offset:46080
ds_read_b128 v[16:19], v1 offset:41984
ds_read_b128 v[20:23], v1 offset:46080
ds_read_b128 v[64:67], v1 offset:50176
ds_read_b128 v[68:71], v1 offset:54272
v_rcp_f32 v52, v52
v_rcp_f32 v53, v53
v_subrev_u32 v54, 562036736, v52
v_mul_f32 v44, v44, v52
v_mul_f32 v45, v45, v53
v_cvt_pk_bf16_f32 v48, v44, v45
v_cvt_pk_bf16_f32 v49, v44, v45
ds_write_b64 v3, v[48:49] offset:5632
v_pk_mul_f32 v[40:41], v[40:41], v[52:53]
v_cvt_pk_bf16_f32 v50, v40, v41
v_cvt_pk_bf16_f32 v51, v40, v41
ds_write_b64 v3, v[50:51] offset:7680
v_mov_b64 v[40:41], 0
v_mov_b64 v[42:43], 0
v_mov_b64 v[44:45], 0
v_mov_b64 v[46:47], 0
v_mov_b64 v[52:53], 0
v_mov_b64 v[54:55], 0
s_waitcnt lgkmcnt(0)
s_branch L_sback10_f
L_rw0_f:
v_lshrrev_b32 v6, 2, v1
s_mov_b32 s41, 0x40000000
.p2align 6
L_step01_f:
buffer_load_dwordx4 v[48:51], v1, s[4:7], s35 offen sc1
s_nop 15
s_nop 0
buffer_load_dwordx4 v[52:55], v1, s[4:7], s35 offen sc1
s_nop 15
s_nop 0
buffer_load_dwordx4 v[44:47], v1, s[4:7], s35 offen sc1
s_waitcnt vmcnt(7)
ds_read_b128 v[56:59], v1 offset:32768
s_waitcnt vmcnt(6)
ds_read_b128 v[60:63], v1 offset:33792
ds_read_b128 v[64:67], v2 offset:8192
ds_read_b128 v[68:71], v2 offset:12288
v_mov_b64 v[8:9], 0
v_mov_b64 v[10:11], 0
v_mov_b64 v[12:13], 0
v_mov_b64 v[14:15], 0
v_mov_b64 v[16:17], 0
v_mov_b64 v[18:19], 0
v_mov_b64 v[20:21], 0
v_mov_b64 v[22:23], 0
v_mov_b64 v[24:25], 0
v_mov_b64 v[26:27], 0
v_mov_b64 v[28:29], 0
v_mov_b64 v[30:31], 0
s_nop 0
buffer_load_dwordx4 v[40:43], v1, s[4:7], s35 offen sc1
s_waitcnt vmcnt(3)
ds_write_b128 v1, v[48:51] offset:0
v_max3_u32 v32, v48, v49, v50
v_max_u32 v32, v32, v51
v_cmp_eq_u32 vcc, -1, v32
s_cbranch_vccnz L_aretry01_f
L_aback01_f:
buffer_load_dword v44, v6, s[4:7], s36 offen sc1
s_waitcnt lgkmcnt(0)
s_barrier
ds_read_b128 v[32:35], v1 offset:0
buffer_load_dwordx4 v[48:51], v1, s[4:7], s37 offen sc1
buffer_load_dword v52, v6, s[4:7], s38 offen sc1
ds_read_b128 v[36:39], v1 offset:1024
s_waitcnt lgkmcnt(1)
v_smfmac_f32_16x16x64_bf16 v[8:11], v[32:35], v[64:71], v0
ds_read_b128 v[64:67], v2 offset:16384
ds_read_b128 v[68:71], v2 offset:20480
v_smfmac_f32_16x16x64_bf16 v[16:19], v[32:35], v[72:79], v0
s_mul_i32 s3, s52, 5120
s_add_u32 s40, s60, s3
s_add_u32 s52, s52, 1
v_smfmac_f32_16x16x64_bf16 v[20:23], v[32:35], v[80:87], v0
v_smfmac_f32_16x16x64_bf16 v[24:27], v[32:35], a[64:71], v0
v_smfmac_f32_16x16x64_bf16 v[28:31], v[32:35], a[72:79], v0
s_waitcnt lgkmcnt(0)
v_smfmac_f32_16x16x64_bf16 v[12:15], v[32:35], v[64:71], v0
ds_read_b128 v[64:67], v2 offset:24576
ds_read_b128 v[68:71], v2 offset:28672
v_smfmac_f32_16x16x64_bf16 v[8:11], v[36:39], v[208:215], v0
s_and_b32 s52, s52, 3
s_xor_b32 s30, s52, 2
s_lshl_b32 s30, s30, 15
v_smfmac_f32_16x16x64_bf16 v[12:15], v[36:39], v[216:223], v0
s_waitcnt vmcnt(3)
ds_read_b128 v[40:43], v1 offset:2048
v_smfmac_f32_16x16x64_bf16 v[16:19], v[36:39], v[88:95], v0
s_mul_i32 s3, s52, 5120
s_add_u32 s39, s60, s3
s_lshl_b32 s31, s52, 15
v_smfmac_f32_16x16x64_bf16 v[20:23], v[36:39], v[96:103], v0
ds_read_b128 v[32:35], v1 offset:3072
s_add_u32 s42, s61, s30
v_smfmac_f32_16x16x64_bf16 v[24:27], v[36:39], a[80:87], v0
s_waitcnt vmcnt(2)
ds_write_b32 v6, v44 offset:4096
v_cmp_eq_u32 vcc, -1, v44
v_smfmac_f32_16x16x64_bf16 v[28:31], v[36:39], a[88:95], v0
s_waitcnt lgkmcnt(2)
v_smfmac_f32_16x16x64_bf16 v[8:11], v[40:43], v[64:71], v0
ds_read_b128 v[64:67], v2 offset:32768
ds_read_b128 v[68:71], v2 offset:36864
s_cbranch_vccnz L_fretry01_f
L_fback01_f:
v_smfmac_f32_16x16x64_bf16 v[16:19], v[40:43], v[104:111], v0
v_smfmac_f32_16x16x64_bf16 v[20:23], v[40:43], v[112:119], v0
s_add_u32 s41, s61, s31
s_add_u32 s31, s31, s62
s_add_u32 s35, s39, 0
v_smfmac_f32_16x16x64_bf16 v[24:27], v[40:43], a[96:103], v0
s_waitcnt lgkmcnt(2)
s_barrier
v_smfmac_f32_16x16x64_bf16 v[28:31], v[40:43], a[104:111], v0
s_waitcnt lgkmcnt(0)
v_smfmac_f32_16x16x64_bf16 v[12:15], v[40:43], v[64:71], v0
ds_read_b128 v[64:67], v2 offset:49152
ds_read_b128 v[68:71], v2 offset:53248
v_smfmac_f32_16x16x64_bf16 v[8:11], v[32:35], v[224:231], v0
ds_read_b128 v[36:39], v1 offset:4096
v_smfmac_f32_16x16x64_bf16 v[12:15], v[32:35], v[232:239], v0
s_add_u32 s36, s39, 4096
v_smfmac_f32_16x16x64_bf16 v[16:19], v[32:35], v[120:127], v0
s_waitcnt vmcnt(1)
ds_write_b128 v1, v[48:51] offset:5120
s_add_u32 s58, s32, 3
s_min_u32 s58, s58, 64
v_max3_u32 v53, v48, v49, v50
v_smfmac_f32_16x16x64_bf16 v[20:23], v[32:35], v[128:135], v0
s_waitcnt vmcnt(0)
ds_write_b32 v6, v52 offset:9216
s_mov_b32 m0, s59
s_xor_b32 s59, s59, 8192
v_max3_u32 v53, v53, v51, v52
s_waitcnt lgkmcnt(3)
v_smfmac_f32_16x16x64_bf16 v[24:27], v[32:35], v[64:71], v0
ds_read_b128 v[64:67], v2 offset:57344
ds_read_b128 v[68:71], v2 offset:61440
v_cmp_eq_u32 vcc, -1, v53
v_smfmac_f32_16x16x64_bf16 v[28:31], v[32:35], a[112:119], v0
s_waitcnt lgkmcnt(4)
v_smfmac_f32_16x16x64_bf16 v[8:11], v[36:39], v[240:247], v0
s_cbranch_vccnz L_bretry01_f
L_bback01_f:
v_add_u32 v2, 0x10000, v2
v_smfmac_f32_16x16x64_bf16 v[12:15], v[36:39], v[248:255], v0
s_waitcnt lgkmcnt(2)
s_barrier
ds_read_b128 v[40:43], v1 offset:5120
v_smfmac_f32_16x16x64_bf16 v[16:19], v[36:39], v[136:143], v0
ds_read_b128 v[44:47], v1 offset:6144
buffer_load_dwordx4 v1, s[4:7], s48 offen sc1 lds
s_waitcnt lgkmcnt(2)
v_smfmac_f32_16x16x64_bf16 v[20:23], v[36:39], v[64:71], v0
ds_read_b128 v[64:67], v2 offset:0
ds_read_b128 v[68:71], v2 offset:4096
v_smfmac_f32_16x16x64_bf16 v[24:27], v[36:39], a[120:127], v0
ds_read_b128 v[32:35], v1 offset:7168
buffer_load_dwordx4 v1, s[4:7], s48 offen offset:1024 sc1 lds
s_mov_b32 m0, 32768
v_smfmac_f32_16x16x64_bf16 v[28:31], v[36:39], a[128:135], v0
ds_read_b128 v[48:51], v1 offset:8192
s_waitcnt lgkmcnt(5)
v_smfmac_f32_16x16x64_bf16 v[8:11], v[40:43], a[0:7], v0
ds_read_b128 v[36:39], v1 offset:9216
v_smfmac_f32_16x16x64_bf16 v[12:15], v[40:43], a[8:15], v0
buffer_load_dwordx4 v1, s[4:7], s49 offen sc1 lds
v_mov_b32 v54, -1
s_waitcnt lgkmcnt(3)
v_smfmac_f32_16x16x64_bf16 v[8:11], v[44:47], v[64:71], v0
ds_read_b128 v[64:67], v2 offset:8192
ds_read_b128 v[68:71], v2 offset:12288
v_smfmac_f32_16x16x64_bf16 v[12:15], v[44:47], a[16:23], v0
buffer_load_dwordx4 v1, s[4:7], s49 offen offset:1024 sc1 lds
s_waitcnt lgkmcnt(4)
v_smfmac_f32_16x16x64_bf16 v[8:11], v[32:35], a[24:31], v0
s_cmp_eq_u32 s32, 62
s_cselect_b32 s11, 0x40000000, s12
s_waitcnt lgkmcnt(3)
v_smfmac_f32_16x16x64_bf16 v[8:11], v[48:51], a[32:39], v0
s_waitcnt lgkmcnt(2)
v_smfmac_f32_16x16x64_bf16 v[8:11], v[36:39], a[48:55], v0
s_add_u32 s37, s31, 0
s_add_u32 s38, s31, 4096
s_waitcnt lgkmcnt(0)
v_smfmac_f32_16x16x64_bf16 v[12:15], v[32:35], v[64:71], v0
ds_read_b128 v[64:67], v2 offset:16384
ds_read_b128 v[68:71], v2 offset:20480
v_smfmac_f32_16x16x64_bf16 v[12:15], v[48:51], a[40:47], v0
buffer_store_dword v54, v7, s[4:7], s42 offen sc1
s_sub_u32 s3, s59, 0
v_add_u32 v6, s3, v1
v_smfmac_f32_16x16x64_bf16 v[12:15], v[36:39], a[56:63], v0
s_add_u32 s48, s48, s11
s_add_u32 s49, s49, s11
v_add_f32 v8, v8, v10
v_smfmac_f32_16x16x64_bf16 v[16:19], v[40:43], v[144:151], v0
v_add_f32 v9, v9, v11
v_smfmac_f32_16x16x64_bf16 v[16:19], v[44:47], v[160:167], v0
v_mul_f32 v8, s56, v8
s_waitcnt lgkmcnt(0)
v_smfmac_f32_16x16x64_bf16 v[16:19], v[32:35], v[64:71], v0
ds_read_b128 v[64:67], v2 offset:24576
ds_read_b128 v[68:71], v2 offset:28672
v_mul_f32 v9, s56, v9
v_smfmac_f32_16x16x64_bf16 v[16:19], v[48:51], v[176:183], v0
s_add_u32 s50, s50, 16384
s_add_u32 s51, s51, 16384
v_add_f32 v12, v12, v14
v_smfmac_f32_16x16x64_bf16 v[16:19], v[36:39], v[192:199], v0
s_nop 1
v_add_f32 v13, v13, v15
v_smfmac_f32_16x16x64_bf16 v[20:23], v[40:43], v[152:159], v0
s_nop 1
v_mul_f32 v12, s56, v12
v_smfmac_f32_16x16x64_bf16 v[20:23], v[44:47], v[168:175], v0
v_mul_f32 v13, s56, v13
s_waitcnt lgkmcnt(0)
v_smfmac_f32_16x16x64_bf16 v[20:23], v[32:35], v[64:71], v0
ds_read_b128 v[64:67], v6 offset:0
v_add_f32 v16, v16, v18
v_smfmac_f32_16x16x64_bf16 v[20:23], v[48:51], v[184:191], v0
s_cmp_eq_u32 s32, 63
ds_read_b128 v[68:71], v6 offset:1024
v_add_f32 v17, v17, v19
v_smfmac_f32_16x16x64_bf16 v[20:23], v[36:39], v[200:207], v0
s_nop 1
v_cvt_pk_bf16_f32 v53, v8, v9
v_cvt_pk_bf16_f32 v52, v16, v17
v_smfmac_f32_16x16x64_bf16 v[24:27], v[32:35], a[168:175], v0
s_nop 0
ds_write_b64 v3, v[52:53] offset:10240
v_cvt_pk_bf16_f32 v55, v12, v13
v_add_f32 v20, v20, v22
v_add_f32 v21, v21, v23
v_cvt_pk_bf16_f32 v54, v20, v21
ds_write_b64 v3, v[54:55] offset:12288
v_smfmac_f32_16x16x64_bf16 v[28:31], v[32:35], a[176:183], v0
v_smfmac_f32_16x16x64_bf16 v[24:27], v[36:39], a[200:207], v0
ds_read_b128 v[32:35], v6 offset:2048
v_add_u32 v2, 0x10000, v1
v_smfmac_f32_16x16x64_bf16 v[28:31], v[36:39], a[208:215], v0
v_smfmac_f32_16x16x64_bf16 v[24:27], v[44:47], a[152:159], v0
s_waitcnt lgkmcnt(1)
s_barrier
ds_read_b64_tr_b16 v[8:9], v4 offset:10240
ds_read_b64_tr_b16 v[10:11], v4 offset:12288
v_smfmac_f32_16x16x64_bf16 v[28:31], v[44:47], a[160:167], v0
ds_read_b64_tr_b16 v[12:13], v4 offset:10752
ds_read_b64_tr_b16 v[14:15], v4 offset:12800
v_smfmac_f32_16x16x64_bf16 v[24:27], v[40:43], a[136:143], v0
ds_read_b64_tr_b16 v[16:17], v4 offset:11264
ds_read_b64_tr_b16 v[18:19], v4 offset:13312
v_smfmac_f32_16x16x64_bf16 v[28:31], v[40:43], a[144:151], v0
ds_read_b64_tr_b16 v[20:21], v4 offset:11776
ds_read_b64_tr_b16 v[22:23], v4 offset:13824
v_smfmac_f32_16x16x64_bf16 v[24:27], v[48:51], a[184:191], v0
ds_read_b128 v[36:39], v6 offset:3072
ds_read_b128 v[44:47], v6 offset:4096
v_smfmac_f32_16x16x64_bf16 v[28:31], v[48:51], a[192:199], v0
ds_read_b128 v[40:43], v6 offset:5120
s_waitcnt lgkmcnt(9)
v_mfma_f32_16x16x32_bf16 v[52:55], v[8:11], v[8:11], 0
buffer_store_dwordx4 v[8:11], v1, s[4:7], s50 offen offset:0 sc1
s_waitcnt lgkmcnt(7)
v_mfma_f32_16x16x32_bf16 v[52:55], v[12:15], v[12:15], v[52:55]
s_waitcnt lgkmcnt(5)
v_add_f32 v24, v24, v26
v_add_f32 v25, v25, v27
v_mfma_f32_16x16x32_bf16 v[52:55], v[16:19], v[16:19], v[52:55]
s_waitcnt lgkmcnt(3)
v_add_f32 v28, v28, v30
v_add_f32 v29, v29, v31
v_mfma_f32_16x16x32_bf16 v[52:55], v[20:23], v[20:23], v[52:55]
v_cvt_pk_bf16_f32 v24, v24, v25
v_cvt_pk_bf16_f32 v25, v28, v29
v_mfma_f32_16x16x32_bf16 v[48:51], v[64:67], v[8:11], 0
ds_read_b128 v[64:67], v6 offset:6144
v_mov_b64 v[26:27], s[74:75]
v_mfma_f32_16x16x32_bf16 v[48:51], v[68:71], v[12:15], v[48:51]
ds_read_b128 v[68:71], v6 offset:7168
buffer_store_dwordx2 v[24:25], v3, s[4:7], s51 offen offset:0 sc1
v_mov_b32 v29, 0
v_mfma_f32_16x16x32_bf16 v[48:51], v[32:35], v[16:19], v[48:51]
s_cbranch_scc1 L_last01_f
s_waitcnt lgkmcnt(4)
v_exp_f32 v54, v54
v_mfma_f32_16x16x32_bf16 v[48:51], v[36:39], v[20:23], v[48:51]
s_waitcnt lgkmcnt(3)
v_exp_f32 v55, v55
v_mfma_f32_16x16x32_bf16 v[32:35], v[44:47], v[8:11], 0
s_waitcnt lgkmcnt(2)
v_cvt_pk_bf16_f32 v28, v54, v55
v_cvt_pk_bf16_f32 v31, v54, v55
v_mfma_f32_16x16x32_bf16 v[32:35], v[40:43], v[12:15], v[32:35]
s_waitcnt lgkmcnt(1)
v_mov_b32 v30, 0
v_bfe_u32 v6, v1, 2, 7
v_mfma_f32_16x16x32_bf16 v[32:35], v[64:67], v[16:19], v[32:35]
s_waitcnt lgkmcnt(0)
v_exp_f32 v48, v48
v_mfma_f32_16x16x32_bf16 v[32:35], v[68:71], v[20:23], v[32:35]
s_add_u32 s32, s32, 1
v_exp_f32 v49, v49
v_mfma_f32_16x16x16_bf16 v[52:55], v[28:29], v[26:27], 0
ds_read_b128 v[8:11], v2 offset:40960
v_exp_f32 v50, v50
v_mfma_f32_16x16x16_bf16 v[44:47], v[28:29], v[24:25], 0
ds_read_b128 v[12:15], v2 offset:45056
v_exp_f32 v51, v51
v_mfma_f32_16x16x16_bf16 v[40:43], v[30:31], v[24:25], 0
v_exp_f32 v32, v32
v_cvt_pk_bf16_f32 v36, v48, v49
v_cvt_pk_bf16_f32 v37, v50, v51
v_exp_f32 v33, v33
v_exp_f32 v34, v34
v_mfma_f32_16x16x16_bf16 v[52:55], v[36:37], v[26:27], v[52:55]
v_exp_f32 v35, v35
v_cvt_pk_bf16_f32 v38, v32, v33
v_cvt_pk_bf16_f32 v39, v34, v35
s_nop 1
v_mfma_f32_16x16x16_bf16 v[52:55], v[38:39], v[26:27], v[52:55]
ds_read_b128 v[16:19], v1 offset:40960
ds_read_b128 v[20:23], v1 offset:45056
v_mfma_f32_16x16x32_bf16 v[44:47], v[36:39], v[56:59], v[44:47]
ds_read_b128 v[64:67], v1 offset:49152
ds_read_b128 v[68:71], v1 offset:53248
v_mfma_f32_16x16x32_bf16 v[40:43], v[36:39], v[60:63], v[40:43]
s_nop 1
v_rcp_f32 v52, v52
v_rcp_f32 v53, v53
v_subrev_u32 v54, 562036736, v52
v_mul_f32 v44, v44, v52
v_mul_f32 v45, v45, v53
v_cvt_pk_bf16_f32 v48, v44, v45
v_cvt_pk_bf16_f32 v49, v44, v45
ds_write_b64 v3, v[48:49] offset:5120
v_pk_mul_f32 v[40:41], v[40:41], v[52:53]
v_cvt_pk_bf16_f32 v50, v40, v41
v_cvt_pk_bf16_f32 v51, v40, v41
ds_write_b64 v3, v[50:51] offset:7168
v_subrev_u32 v53, 562036736, v53
v_max_u32 v52, v54, v53
v_cmp_le_u32 vcc, s63, v52
v_mov_b64 v[52:53], 0
v_mov_b64 v[54:55], 0
v_mov_b64 v[40:41], 0
v_mov_b64 v[42:43], 0
s_cbranch_vccnz L_sretry01_f
L_sback01_f:
s_waitcnt lgkmcnt(0)
s_barrier
ds_read_b64_tr_b16 v[24:25], v4 offset:5120
ds_read_b64_tr_b16 v[26:27], v4 offset:7168
ds_read_b64_tr_b16 v[28:29], v4 offset:5632
ds_read_b64_tr_b16 v[30:31], v4 offset:7680
ds_read_b64_tr_b16 v[32:33], v4 offset:6144
ds_read_b64_tr_b16 v[34:35], v4 offset:8192
s_waitcnt lgkmcnt(4)
v_smfmac_f32_16x16x64_bf16 v[52:55], v[24:27], v[8:15], v0
ds_read_b64_tr_b16 v[36:37], v4 offset:6656
ds_read_b64_tr_b16 v[38:39], v4 offset:8704
s_waitcnt lgkmcnt(4)
v_mov_b64 v[44:45], 0
v_smfmac_f32_16x16x64_bf16 v[52:55], v[28:31], a[248:255], v0
v_mov_b64 v[46:47], 0
v_smfmac_f32_16x16x64_bf16 v[40:43], v[24:27], v[16:23], v0
ds_read_b128 v[56:59], v1 offset:57344
ds_read_b128 v[60:63], v1 offset:61440
v_smfmac_f32_16x16x64_bf16 v[40:43], v[28:31], v[64:71], v0
ds_read_b128 v[8:11], v2 offset:0
ds_read_b128 v[12:15], v2 offset:4096
s_waitcnt lgkmcnt(6)
v_cvt_pk_bf16_f32 v52, v52, v53
v_smfmac_f32_16x16x64_bf16 v[40:43], v[32:35], a[216:223], v0
buffer_load_dword v16, v6, s[4:7], s8 offen sc1
s_waitcnt lgkmcnt(4)
v_cvt_pk_bf16_f32 v53, v54, v55
v_and_or_b32 v52, v52, -2, s33
v_smfmac_f32_16x16x64_bf16 v[40:43], v[36:39], a[224:231], v0
buffer_store_dwordx2 v[52:53], v5, s[4:7], s45 offen
s_nop 0
v_smfmac_f32_16x16x64_bf16 v[44:47], v[24:27], a[232:239], v0
buffer_load_dword v17, v6, s[4:7], s8 offen sc1
s_nop 1
v_smfmac_f32_16x16x64_bf16 v[44:47], v[28:31], a[240:247], v0
s_waitcnt lgkmcnt(2)
v_cvt_pk_bf16_f32 v40, v40, v41
v_smfmac_f32_16x16x64_bf16 v[44:47], v[32:35], v[56:63], v0
buffer_load_dword v18, v6, s[4:7], s8 offen sc1
s_waitcnt lgkmcnt(0)
v_cvt_pk_bf16_f32 v41, v42, v43
v_and_or_b32 v40, v40, -2, s33
v_smfmac_f32_16x16x64_bf16 v[44:47], v[36:39], v[8:15], v0
buffer_store_dwordx2 v[40:41], v5, s[4:7], s43 offen
buffer_load_dword v19, v6, s[4:7], s8 offen sc1
s_nop 5
v_cvt_pk_bf16_f32 v44, v44, v45
v_cvt_pk_bf16_f32 v45, v46, v47
v_and_or_b32 v44, v44, -2, s33
buffer_store_dwordx2 v[44:45], v5, s[4:7], s44 offen
s_xor_b32 s33, s33, 1
buffer_load_dword v20, v6, s[4:7], s8 offen sc1
s_nop 6
buffer_load_dword v21, v6, s[4:7], s8 offen sc1
s_waitcnt vmcnt(8)
v_cmp_gt_u32 vcc, s32, v16
buffer_load_dword v16, v6, s[4:7], s8 offen sc1
s_cbranch_vccz L_mok01_f
s_waitcnt vmcnt(7)
v_cmp_gt_u32 vcc, s32, v17
buffer_load_dword v17, v6, s[4:7], s8 offen sc1
s_cbranch_vccz L_mok01_f
s_waitcnt vmcnt(7)
v_cmp_gt_u32 vcc, s32, v18
buffer_load_dword v18, v6, s[4:7], s8 offen sc1
s_cbranch_vccz L_mok01_f
s_waitcnt vmcnt(6)
v_cmp_gt_u32 vcc, s32, v19
buffer_load_dword v19, v6, s[4:7], s8 offen sc1
s_cbranch_vccz L_mok01_f
s_waitcnt vmcnt(5)
v_cmp_gt_u32 vcc, s32, v20
buffer_load_dword v20, v6, s[4:7], s8 offen sc1
s_cbranch_vccz L_mok01_f
s_waitcnt vmcnt(5)
v_cmp_gt_u32 vcc, s32, v21
buffer_load_dword v21, v6, s[4:7], s8 offen sc1
s_cbranch_vccz L_mok01_f
L_mk01_f:
s_waitcnt vmcnt(5)
v_cmp_gt_u32 vcc, s32, v16
buffer_load_dword v16, v6, s[4:7], s8 offen sc1
s_cbranch_vccz L_mok01_f
s_waitcnt vmcnt(5)
v_cmp_gt_u32 vcc, s32, v17
buffer_load_dword v17, v6, s[4:7], s8 offen sc1
s_cbranch_vccz L_mok01_f
s_waitcnt vmcnt(5)
v_cmp_gt_u32 vcc, s32, v18
buffer_load_dword v18, v6, s[4:7], s8 offen sc1
s_cbranch_vccz L_mok01_f
s_waitcnt vmcnt(5)
v_cmp_gt_u32 vcc, s32, v19
buffer_load_dword v19, v6, s[4:7], s8 offen sc1
s_cbranch_vccz L_mok01_f
s_waitcnt vmcnt(5)
v_cmp_gt_u32 vcc, s32, v20
buffer_load_dword v20, v6, s[4:7], s8 offen sc1
s_cbranch_vccz L_mok01_f
s_waitcnt vmcnt(5)
v_cmp_gt_u32 vcc, s32, v21
buffer_load_dword v21, v6, s[4:7], s8 offen sc1
s_cbranch_vccz L_mok01_f
s_add_u32 s27, s27, 1
s_cmp_gt_u32 s27, 262144
s_cbranch_scc0 L_mk01_f
s_branch L_fail_f
L_mok01_f:
s_barrier
s_cmp_lt_u32 s25, 16
s_cbranch_scc1 L_glo01_f
s_nop 4
L_glo01_f:
s_nop 9
buffer_load_dwordx4 v[8:11], v1, s[4:7], s46 offen offset:0 sc1
buffer_load_dwordx4 v[12:15], v1, s[4:7], s46 offen offset:1024 sc1
buffer_load_dwordx4 v[16:19], v1, s[4:7], s46 offen offset:2048 sc1
buffer_load_dwordx4 v[20:23], v1, s[4:7], s46 offen offset:3072 sc1
v_and_b32 v32, 16, v1
v_lshlrev_b32 v32, v32, s57
v_cndmask_b32 v24, 0, v32, s[64:65]
v_cndmask_b32 v25, 0, v32, s[66:67]
v_cndmask_b32 v26, 0, v32, s[68:69]
v_cndmask_b32 v27, 0, v32, s[70:71]
v_mov_b32 v37, -1
v_mov_b32 v38, s32
s_nop 14
buffer_load_dwordx4 v[64:67], v1, s[4:7], s46 offen offset:0 sc1
buffer_load_dwordx4 v[68:71], v1, s[4:7], s46 offen offset:1024 sc1
buffer_load_dwordx4 v[56:59], v1, s[4:7], s46 offen offset:2048 sc1
buffer_load_dwordx4 v[60:63], v1, s[4:7], s46 offen offset:3072 sc1
s_waitcnt vmcnt(7)
v_mfma_f32_16x16x32_bf16 v[28:31], v[8:11], v[24:27], 0
v_bitop3_b32 v32, v8, v10, s34 bitop3:0x7e
s_waitcnt vmcnt(6)
v_mfma_f32_16x16x32_bf16 v[28:31], v[12:15], v[24:27], v[28:31]
v_bitop3_b32 v33, v12, v14, s34 bitop3:0x7e
v_or_b32 v32, v32, v33
s_waitcnt vmcnt(5)
v_mfma_f32_16x16x32_bf16 v[28:31], v[16:19], v[24:27], v[28:31]
v_bitop3_b32 v33, v16, v18, s34 bitop3:0x7e
v_or_b32 v32, v32, v33
s_waitcnt vmcnt(4)
v_mfma_f32_16x16x32_bf16 v[28:31], v[20:23], v[24:27], v[28:31]
v_bitop3_b32 v33, v20, v22, s34 bitop3:0x7e
v_bitop3_b32 v32, v32, v33, 1 bitop3:0xa8
v_cmp_ne_u32 vcc, 0, v32
s_nop 3
s_cbranch_vccnz L_gretry01_f
L_gback01_f:
v_permlane32_swap_b32 v28, v30
v_permlane32_swap_b32 v29, v31
v_pk_add_f32 v[28:29], v[28:29], v[30:31]
v_cvt_pk_bf16_f32 v28, v28, v29
v_min_u32 v28, -2, v28
buffer_store_dword v28, v7, s[4:7], s39 offen
s_barrier
buffer_store_dword v28, v7, s[4:7], s41 offen sc1
buffer_store_dword v37, v7, s[4:7], s40 offen
s_not_b32 s34, s34
v_lshrrev_b32 v6, 2, v1
s_nop 15
s_nop 15
s_nop 7
s_branch L_step01_f
L_aretry01_f:
buffer_load_dwordx4 v[48:51], v1, s[4:7], s35 offen sc1
s_waitcnt vmcnt(3)
v_max3_u32 v32, v52, v53, v54
v_max_u32 v32, v32, v55
v_cmp_eq_u32 vcc, -1, v32
s_cbranch_vccz L_aw001_f
buffer_load_dwordx4 v[52:55], v1, s[4:7], s35 offen sc1
s_waitcnt vmcnt(3)
v_max3_u32 v32, v44, v45, v46
v_max_u32 v32, v32, v47
v_cmp_eq_u32 vcc, -1, v32
s_cbranch_vccz L_aw101_f
buffer_load_dwordx4 v[44:47], v1, s[4:7], s35 offen sc1
s_waitcnt vmcnt(3)
v_max3_u32 v32, v40, v41, v42
v_max_u32 v32, v32, v43
v_cmp_eq_u32 vcc, -1, v32
s_cbranch_vccz L_aw201_f
buffer_load_dwordx4 v[40:43], v1, s[4:7], s35 offen sc1
s_waitcnt vmcnt(3)
v_max3_u32 v32, v48, v49, v50
v_max_u32 v32, v32, v51
v_cmp_eq_u32 vcc, -1, v32
s_cbranch_vccz L_aw301_f
s_add_u32 s27, s27, 1
s_cmp_gt_u32 s27, 262144
s_cbranch_scc0 L_aretry01_f
s_branch L_fail_f
L_aw001_f:
ds_write_b128 v1, v[52:55] offset:0
s_branch L_aback01_f
L_aw101_f:
ds_write_b128 v1, v[44:47] offset:0
s_branch L_aback01_f
L_aw201_f:
ds_write_b128 v1, v[40:43] offset:0
s_branch L_aback01_f
L_aw301_f:
ds_write_b128 v1, v[48:51] offset:0
s_branch L_aback01_f
L_fretry01_f:
s_waitcnt lgkmcnt(0)
buffer_load_dword v44, v6, s[4:7], s36 offen sc1
s_add_u32 s27, s27, 1
s_cmp_gt_u32 s27, 262144
s_cbranch_scc1 L_fail_f
s_waitcnt vmcnt(0)
ds_write_b32 v6, v44 offset:4096
v_cmp_eq_u32 vcc, -1, v44
s_waitcnt lgkmcnt(0)
s_cbranch_vccnz L_fretry01_f
s_branch L_fback01_f
L_bretry01_f:
s_waitcnt lgkmcnt(0)
buffer_load_dwordx4 v[48:51], v1, s[4:7], s37 offen sc1
buffer_load_dword v52, v6, s[4:7], s38 offen sc1
s_add_u32 s27, s27, 1
s_cmp_gt_u32 s27, 262144
s_cbranch_scc1 L_fail_f
s_waitcnt vmcnt(0)
ds_write_b128 v1, v[48:51] offset:5120
ds_write_b32 v6, v52 offset:9216
v_max3_u32 v53, v48, v49, v50
v_max3_u32 v53, v53, v51, v52
v_cmp_eq_u32 vcc, -1, v53
s_waitcnt lgkmcnt(0)
s_cbranch_vccnz L_bretry01_f
s_branch L_bback01_f
L_last01_f:
s_waitcnt vmcnt(0) lgkmcnt(0)
s_barrier
s_endpgm
L_sretry01_f:
s_waitcnt lgkmcnt(0)
s_sub_u32 s3, s59, 0
v_add_u32 v6, s3, v1
ds_read_b64_tr_b16 v[8:9], v4 offset:10240
ds_read_b64_tr_b16 v[10:11], v4 offset:12288
ds_read_b64_tr_b16 v[12:13], v4 offset:10752
ds_read_b64_tr_b16 v[14:15], v4 offset:12800
ds_read_b64_tr_b16 v[16:17], v4 offset:11264
ds_read_b64_tr_b16 v[18:19], v4 offset:13312
ds_read_b64_tr_b16 v[20:21], v4 offset:11776
ds_read_b64_tr_b16 v[22:23], v4 offset:13824
s_waitcnt lgkmcnt(6)
v_mfma_f32_16x16x32_bf16 v[52:55], v[8:11], v[8:11], 0
s_waitcnt lgkmcnt(4)
v_mfma_f32_16x16x32_bf16 v[52:55], v[12:15], v[12:15], v[52:55]
s_waitcnt lgkmcnt(2)
v_mfma_f32_16x16x32_bf16 v[52:55], v[16:19], v[16:19], v[52:55]
s_waitcnt lgkmcnt(0)
v_mfma_f32_16x16x32_bf16 v[52:55], v[20:23], v[20:23], v[52:55]
ds_read_b128 v[64:67], v6 offset:0
ds_read_b128 v[68:71], v6 offset:1024
ds_read_b128 v[40:43], v6 offset:2048
ds_read_b128 v[44:47], v6 offset:3072
s_waitcnt lgkmcnt(3)
v_mfma_f32_16x16x32_bf16 v[48:51], v[64:67], v[8:11], 0
s_waitcnt lgkmcnt(2)
v_mfma_f32_16x16x32_bf16 v[48:51], v[68:71], v[12:15], v[48:51]
s_waitcnt lgkmcnt(1)
v_mfma_f32_16x16x32_bf16 v[48:51], v[40:43], v[16:19], v[48:51]
s_waitcnt lgkmcnt(0)
v_mfma_f32_16x16x32_bf16 v[48:51], v[44:47], v[20:23], v[48:51]
ds_read_b128 v[64:67], v6 offset:4096
ds_read_b128 v[68:71], v6 offset:5120
ds_read_b128 v[40:43], v6 offset:6144
ds_read_b128 v[44:47], v6 offset:7168
s_waitcnt lgkmcnt(3)
v_mfma_f32_16x16x32_bf16 v[32:35], v[64:67], v[8:11], 0
s_waitcnt lgkmcnt(2)
v_mfma_f32_16x16x32_bf16 v[32:35], v[68:71], v[12:15], v[32:35]
s_waitcnt lgkmcnt(1)
v_mfma_f32_16x16x32_bf16 v[32:35], v[40:43], v[16:19], v[32:35]
s_waitcnt lgkmcnt(0)
v_mfma_f32_16x16x32_bf16 v[32:35], v[44:47], v[20:23], v[32:35]
v_max3_f32 v52, v54, v55, v48
v_max3_f32 v52, v52, v49, v50
s_nop 5
v_max3_f32 v52, v52, v51, v32
v_max3_f32 v52, v52, v33, v34
v_max_f32 v52, v52, v35
v_mov_b32 v53, v52
s_nop 1
v_permlane32_swap_b32 v52, v53
v_max_f32 v52, v52, v53
v_mov_b32 v53, v52
s_nop 1
v_permlane16_swap_b32 v52, v53
v_max_f32 v52, v52, v53
v_sub_f32 v54, v54, v52
v_sub_f32 v55, v55, v52
v_sub_f32 v48, v48, v52
v_sub_f32 v49, v49, v52
v_sub_f32 v50, v50, v52
v_sub_f32 v51, v51, v52
v_sub_f32 v32, v32, v52
v_sub_f32 v33, v33, v52
v_sub_f32 v34, v34, v52
v_sub_f32 v35, v35, v52
v_exp_f32 v54, v54
v_exp_f32 v55, v55
v_exp_f32 v48, v48
v_exp_f32 v49, v49
v_exp_f32 v50, v50
v_exp_f32 v51, v51
v_exp_f32 v32, v32
v_exp_f32 v33, v33
v_exp_f32 v34, v34
v_exp_f32 v35, v35
v_cvt_pk_bf16_f32 v28, v54, v55
v_cvt_pk_bf16_f32 v31, v54, v55
v_cvt_pk_bf16_f32 v36, v48, v49
v_cvt_pk_bf16_f32 v37, v50, v51
v_cvt_pk_bf16_f32 v38, v32, v33
v_cvt_pk_bf16_f32 v39, v34, v35
v_mfma_f32_16x16x16_bf16 v[52:55], v[28:29], v[26:27], 0
v_mfma_f32_16x16x16_bf16 v[44:47], v[28:29], v[24:25], 0
v_mfma_f32_16x16x16_bf16 v[40:43], v[30:31], v[24:25], 0
v_mfma_f32_16x16x16_bf16 v[52:55], v[36:37], v[26:27], v[52:55]
v_mfma_f32_16x16x16_bf16 v[52:55], v[38:39], v[26:27], v[52:55]
v_mfma_f32_16x16x32_bf16 v[44:47], v[36:39], v[56:59], v[44:47]
v_mfma_f32_16x16x32_bf16 v[40:43], v[36:39], v[60:63], v[40:43]
ds_read_b128 v[8:11], v2 offset:40960
ds_read_b128 v[12:15], v2 offset:45056
ds_read_b128 v[16:19], v1 offset:40960
ds_read_b128 v[20:23], v1 offset:45056
ds_read_b128 v[64:67], v1 offset:49152
ds_read_b128 v[68:71], v1 offset:53248
v_bfe_u32 v6, v1, 2, 7
v_rcp_f32 v52, v52
v_rcp_f32 v53, v53
v_subrev_u32 v54, 562036736, v52
v_mul_f32 v44, v44, v52
v_mul_f32 v45, v45, v53
v_cvt_pk_bf16_f32 v48, v44, v45
v_cvt_pk_bf16_f32 v49, v44, v45
ds_write_b64 v3, v[48:49] offset:5120
v_pk_mul_f32 v[40:41], v[40:41], v[52:53]
v_cvt_pk_bf16_f32 v50, v40, v41
v_cvt_pk_bf16_f32 v51, v40, v41
ds_write_b64 v3, v[50:51] offset:7168
v_mov_b64 v[40:41], 0
v_mov_b64 v[42:43], 0
v_mov_b64 v[44:45], 0
v_mov_b64 v[46:47], 0
v_mov_b64 v[52:53], 0
v_mov_b64 v[54:55], 0
s_waitcnt lgkmcnt(0)
s_branch L_sback01_f
L_gretry01_f:
L_gloop01_f:
buffer_load_dwordx4 v[8:11], v1, s[4:7], s46 offen offset:0 sc1
buffer_load_dwordx4 v[12:15], v1, s[4:7], s46 offen offset:1024 sc1
buffer_load_dwordx4 v[16:19], v1, s[4:7], s46 offen offset:2048 sc1
buffer_load_dwordx4 v[20:23], v1, s[4:7], s46 offen offset:3072 sc1
s_add_u32 s27, s27, 1
s_waitcnt vmcnt(7)
v_mfma_f32_16x16x32_bf16 v[28:31], v[64:67], v[24:27], 0
v_bitop3_b32 v32, v64, v66, s34 bitop3:0x7e
s_waitcnt vmcnt(6)
v_mfma_f32_16x16x32_bf16 v[28:31], v[68:71], v[24:27], v[28:31]
v_bitop3_b32 v33, v68, v70, s34 bitop3:0x7e
v_or_b32 v32, v32, v33
s_waitcnt vmcnt(5)
v_mfma_f32_16x16x32_bf16 v[28:31], v[56:59], v[24:27], v[28:31]
v_bitop3_b32 v33, v56, v58, s34 bitop3:0x7e
v_or_b32 v32, v32, v33
s_waitcnt vmcnt(4)
v_mfma_f32_16x16x32_bf16 v[28:31], v[60:63], v[24:27], v[28:31]
v_bitop3_b32 v33, v60, v62, s34 bitop3:0x7e
v_bitop3_b32 v32, v32, v33, 1 bitop3:0xa8
v_cmp_ne_u32 vcc, 0, v32
s_nop 3
s_cbranch_vccz L_gback01_f
buffer_load_dwordx4 v[64:67], v1, s[4:7], s46 offen offset:0 sc1
buffer_load_dwordx4 v[68:71], v1, s[4:7], s46 offen offset:1024 sc1
buffer_load_dwordx4 v[56:59], v1, s[4:7], s46 offen offset:2048 sc1
buffer_load_dwordx4 v[60:63], v1, s[4:7], s46 offen offset:3072 sc1
s_add_u32 s27, s27, 1
s_waitcnt vmcnt(7)
v_mfma_f32_16x16x32_bf16 v[28:31], v[8:11], v[24:27], 0
v_bitop3_b32 v32, v8, v10, s34 bitop3:0x7e
s_waitcnt vmcnt(6)
v_mfma_f32_16x16x32_bf16 v[28:31], v[12:15], v[24:27], v[28:31]
v_bitop3_b32 v33, v12, v14, s34 bitop3:0x7e
v_or_b32 v32, v32, v33
s_waitcnt vmcnt(5)
v_mfma_f32_16x16x32_bf16 v[28:31], v[16:19], v[24:27], v[28:31]
v_bitop3_b32 v33, v16, v18, s34 bitop3:0x7e
v_or_b32 v32, v32, v33
s_waitcnt vmcnt(4)
v_mfma_f32_16x16x32_bf16 v[28:31], v[20:23], v[24:27], v[28:31]
v_bitop3_b32 v33, v20, v22, s34 bitop3:0x7e
v_bitop3_b32 v32, v32, v33, 1 bitop3:0xa8
v_cmp_ne_u32 vcc, 0, v32
s_nop 3
s_cbranch_vccz L_gback01_f
s_cmp_gt_u32 s27, 262144
s_cbranch_scc0 L_gloop01_f
s_branch L_fail_f
L_rw1_f:
v_lshrrev_b32 v6, 2, v1
s_mov_b32 s41, 0x40000000
.p2align 6
L_step12_f:
buffer_load_dwordx4 v[48:51], v1, s[4:7], s35 offen sc1
s_nop 15
s_nop 0
buffer_load_dwordx4 v[52:55], v1, s[4:7], s35 offen sc1
s_nop 15
s_nop 0
buffer_load_dwordx4 v[44:47], v1, s[4:7], s35 offen sc1
s_waitcnt vmcnt(7)
ds_read_b128 v[56:59], v1 offset:34816
s_waitcnt vmcnt(6)
ds_read_b128 v[60:63], v1 offset:35840
ds_read_b128 v[64:67], v2 offset:9216
ds_read_b128 v[68:71], v2 offset:13312
v_mov_b64 v[8:9], 0
v_mov_b64 v[10:11], 0
v_mov_b64 v[12:13], 0
v_mov_b64 v[14:15], 0
v_mov_b64 v[16:17], 0
v_mov_b64 v[18:19], 0
v_mov_b64 v[20:21], 0
v_mov_b64 v[22:23], 0
v_mov_b64 v[24:25], 0
v_mov_b64 v[26:27], 0
v_mov_b64 v[28:29], 0
v_mov_b64 v[30:31], 0
s_nop 0
buffer_load_dwordx4 v[40:43], v1, s[4:7], s35 offen sc1
s_waitcnt vmcnt(3)
ds_write_b128 v1, v[48:51] offset:1024
v_max3_u32 v32, v48, v49, v50
v_max_u32 v32, v32, v51
v_cmp_eq_u32 vcc, -1, v32
s_cbranch_vccnz L_aretry12_f
L_aback12_f:
buffer_load_dword v44, v6, s[4:7], s36 offen sc1
s_waitcnt lgkmcnt(0)
s_barrier
ds_read_b128 v[32:35], v1 offset:0
buffer_load_dwordx4 v[48:51], v1, s[4:7], s37 offen sc1
buffer_load_dword v52, v6, s[4:7], s38 offen sc1
ds_read_b128 v[36:39], v1 offset:1024
s_waitcnt lgkmcnt(1)
v_smfmac_f32_16x16x64_bf16 v[8:11], v[32:35], v[64:71], v0
ds_read_b128 v[64:67], v2 offset:17408
ds_read_b128 v[68:71], v2 offset:21504
v_smfmac_f32_16x16x64_bf16 v[16:19], v[32:35], v[72:79], v0
s_mul_i32 s3, s52, 5120
s_add_u32 s40, s60, s3
s_add_u32 s52, s52, 1
v_smfmac_f32_16x16x64_bf16 v[20:23], v[32:35], v[80:87], v0
v_smfmac_f32_16x16x64_bf16 v[24:27], v[32:35], a[64:71], v0
v_smfmac_f32_16x16x64_bf16 v[28:31], v[32:35], a[72:79], v0
s_waitcnt lgkmcnt(0)
v_smfmac_f32_16x16x64_bf16 v[12:15], v[32:35], v[64:71], v0
ds_read_b128 v[64:67], v2 offset:25600
ds_read_b128 v[68:71], v2 offset:29696
v_smfmac_f32_16x16x64_bf16 v[8:11], v[36:39], v[208:215], v0
s_and_b32 s52, s52, 3
s_xor_b32 s30, s52, 2
s_lshl_b32 s30, s30, 15
v_smfmac_f32_16x16x64_bf16 v[12:15], v[36:39], v[216:223], v0
s_waitcnt vmcnt(3)
ds_read_b128 v[40:43], v1 offset:2048
v_smfmac_f32_16x16x64_bf16 v[16:19], v[36:39], v[88:95], v0
s_mul_i32 s3, s52, 5120
s_add_u32 s39, s60, s3
s_lshl_b32 s31, s52, 15
v_smfmac_f32_16x16x64_bf16 v[20:23], v[36:39], v[96:103], v0
ds_read_b128 v[32:35], v1 offset:3072
s_add_u32 s42, s61, s30
v_smfmac_f32_16x16x64_bf16 v[24:27], v[36:39], a[80:87], v0
s_waitcnt vmcnt(2)
ds_write_b32 v6, v44 offset:4352
v_cmp_eq_u32 vcc, -1, v44
v_smfmac_f32_16x16x64_bf16 v[28:31], v[36:39], a[88:95], v0
s_waitcnt lgkmcnt(2)
v_smfmac_f32_16x16x64_bf16 v[8:11], v[40:43], v[64:71], v0
ds_read_b128 v[64:67], v2 offset:33792
ds_read_b128 v[68:71], v2 offset:37888
s_cbranch_vccnz L_fretry12_f
L_fback12_f:
v_smfmac_f32_16x16x64_bf16 v[16:19], v[40:43], v[104:111], v0
v_smfmac_f32_16x16x64_bf16 v[20:23], v[40:43], v[112:119], v0
s_add_u32 s41, s61, s31
s_add_u32 s31, s31, s62
s_add_u32 s35, s39, 1024
v_smfmac_f32_16x16x64_bf16 v[24:27], v[40:43], a[96:103], v0
s_waitcnt lgkmcnt(2)
s_barrier
v_smfmac_f32_16x16x64_bf16 v[28:31], v[40:43], a[104:111], v0
s_waitcnt lgkmcnt(0)
v_smfmac_f32_16x16x64_bf16 v[12:15], v[40:43], v[64:71], v0
ds_read_b128 v[64:67], v2 offset:50176
ds_read_b128 v[68:71], v2 offset:54272
v_smfmac_f32_16x16x64_bf16 v[8:11], v[32:35], v[224:231], v0
ds_read_b128 v[36:39], v1 offset:4096
v_smfmac_f32_16x16x64_bf16 v[12:15], v[32:35], v[232:239], v0
s_add_u32 s36, s39, 4352
v_smfmac_f32_16x16x64_bf16 v[16:19], v[32:35], v[120:127], v0
s_waitcnt vmcnt(1)
ds_write_b128 v1, v[48:51] offset:6144
s_add_u32 s58, s32, 3
s_min_u32 s58, s58, 64
v_max3_u32 v53, v48, v49, v50
v_smfmac_f32_16x16x64_bf16 v[20:23], v[32:35], v[128:135], v0
s_waitcnt vmcnt(0)
ds_write_b32 v6, v52 offset:9472
s_mov_b32 m0, s59
s_xor_b32 s59, s59, 8192
v_max3_u32 v53, v53, v51, v52
s_waitcnt lgkmcnt(3)
v_smfmac_f32_16x16x64_bf16 v[24:27], v[32:35], v[64:71], v0
ds_read_b128 v[64:67], v2 offset:58368
ds_read_b128 v[68:71], v2 offset:62464
v_cmp_eq_u32 vcc, -1, v53
v_smfmac_f32_16x16x64_bf16 v[28:31], v[32:35], a[112:119], v0
s_waitcnt lgkmcnt(4)
v_smfmac_f32_16x16x64_bf16 v[8:11], v[36:39], v[240:247], v0
s_cbranch_vccnz L_bretry12_f
L_bback12_f:
v_add_u32 v2, 0x10000, v2
v_smfmac_f32_16x16x64_bf16 v[12:15], v[36:39], v[248:255], v0
s_waitcnt lgkmcnt(2)
s_barrier
ds_read_b128 v[40:43], v1 offset:5120
v_smfmac_f32_16x16x64_bf16 v[16:19], v[36:39], v[136:143], v0
ds_read_b128 v[44:47], v1 offset:6144
buffer_load_dwordx4 v1, s[4:7], s48 offen sc1 lds
s_waitcnt lgkmcnt(2)
v_smfmac_f32_16x16x64_bf16 v[20:23], v[36:39], v[64:71], v0
ds_read_b128 v[64:67], v2 offset:1024
ds_read_b128 v[68:71], v2 offset:5120
v_smfmac_f32_16x16x64_bf16 v[24:27], v[36:39], a[120:127], v0
ds_read_b128 v[32:35], v1 offset:7168
buffer_load_dwordx4 v1, s[4:7], s48 offen offset:1024 sc1 lds
s_mov_b32 m0, 34816
v_smfmac_f32_16x16x64_bf16 v[28:31], v[36:39], a[128:135], v0
ds_read_b128 v[48:51], v1 offset:8192
s_waitcnt lgkmcnt(5)
v_smfmac_f32_16x16x64_bf16 v[8:11], v[40:43], a[0:7], v0
ds_read_b128 v[36:39], v1 offset:9216
v_smfmac_f32_16x16x64_bf16 v[12:15], v[40:43], a[8:15], v0
buffer_load_dwordx4 v1, s[4:7], s49 offen sc1 lds
v_mov_b32 v54, -1
s_waitcnt lgkmcnt(3)
v_smfmac_f32_16x16x64_bf16 v[8:11], v[44:47], v[64:71], v0
ds_read_b128 v[64:67], v2 offset:9216
ds_read_b128 v[68:71], v2 offset:13312
v_smfmac_f32_16x16x64_bf16 v[12:15], v[44:47], a[16:23], v0
buffer_load_dwordx4 v1, s[4:7], s49 offen offset:1024 sc1 lds
s_waitcnt lgkmcnt(4)
v_smfmac_f32_16x16x64_bf16 v[8:11], v[32:35], a[24:31], v0
s_cmp_eq_u32 s32, 62
s_cselect_b32 s11, 0x40000000, s12
s_waitcnt lgkmcnt(3)
v_smfmac_f32_16x16x64_bf16 v[8:11], v[48:51], a[32:39], v0
s_waitcnt lgkmcnt(2)
v_smfmac_f32_16x16x64_bf16 v[8:11], v[36:39], a[48:55], v0
s_add_u32 s37, s31, 1024
s_add_u32 s38, s31, 4352
s_waitcnt lgkmcnt(0)
v_smfmac_f32_16x16x64_bf16 v[12:15], v[32:35], v[64:71], v0
ds_read_b128 v[64:67], v2 offset:17408
ds_read_b128 v[68:71], v2 offset:21504
v_smfmac_f32_16x16x64_bf16 v[12:15], v[48:51], a[40:47], v0
buffer_store_dword v54, v7, s[4:7], s42 offen sc1
s_sub_u32 s3, s59, 2048
v_add_u32 v6, s3, v1
v_smfmac_f32_16x16x64_bf16 v[12:15], v[36:39], a[56:63], v0
s_add_u32 s48, s48, s11
s_add_u32 s49, s49, s11
v_add_f32 v8, v8, v10
v_smfmac_f32_16x16x64_bf16 v[16:19], v[40:43], v[144:151], v0
v_add_f32 v9, v9, v11
v_smfmac_f32_16x16x64_bf16 v[16:19], v[44:47], v[160:167], v0
v_mul_f32 v8, s56, v8
s_waitcnt lgkmcnt(0)
v_smfmac_f32_16x16x64_bf16 v[16:19], v[32:35], v[64:71], v0
ds_read_b128 v[64:67], v2 offset:25600
ds_read_b128 v[68:71], v2 offset:29696
v_mul_f32 v9, s56, v9
v_smfmac_f32_16x16x64_bf16 v[16:19], v[48:51], v[176:183], v0
s_add_u32 s50, s50, 16384
s_add_u32 s51, s51, 16384
v_add_f32 v12, v12, v14
v_smfmac_f32_16x16x64_bf16 v[16:19], v[36:39], v[192:199], v0
s_nop 1
v_add_f32 v13, v13, v15
v_smfmac_f32_16x16x64_bf16 v[20:23], v[40:43], v[152:159], v0
s_nop 1
v_mul_f32 v12, s56, v12
v_smfmac_f32_16x16x64_bf16 v[20:23], v[44:47], v[168:175], v0
v_mul_f32 v13, s56, v13
s_waitcnt lgkmcnt(0)
v_smfmac_f32_16x16x64_bf16 v[20:23], v[32:35], v[64:71], v0
ds_read_b128 v[64:67], v6 offset:0
v_add_f32 v16, v16, v18
v_smfmac_f32_16x16x64_bf16 v[20:23], v[48:51], v[184:191], v0
s_cmp_eq_u32 s32, 63
ds_read_b128 v[68:71], v6 offset:1024
v_add_f32 v17, v17, v19
v_smfmac_f32_16x16x64_bf16 v[20:23], v[36:39], v[200:207], v0
s_nop 1
v_cvt_pk_bf16_f32 v53, v8, v9
v_cvt_pk_bf16_f32 v52, v16, v17
v_smfmac_f32_16x16x64_bf16 v[24:27], v[32:35], a[168:175], v0
s_nop 0
ds_write_b64 v3, v[52:53] offset:10752
v_cvt_pk_bf16_f32 v55, v12, v13
v_add_f32 v20, v20, v22
v_add_f32 v21, v21, v23
v_cvt_pk_bf16_f32 v54, v20, v21
ds_write_b64 v3, v[54:55] offset:12800
v_smfmac_f32_16x16x64_bf16 v[28:31], v[32:35], a[176:183], v0
v_smfmac_f32_16x16x64_bf16 v[24:27], v[36:39], a[200:207], v0
ds_read_b128 v[32:35], v6 offset:2048
v_add_u32 v2, 0x10000, v1
v_smfmac_f32_16x16x64_bf16 v[28:31], v[36:39], a[208:215], v0
v_smfmac_f32_16x16x64_bf16 v[24:27], v[44:47], a[152:159], v0
s_waitcnt lgkmcnt(1)
s_barrier
ds_read_b64_tr_b16 v[8:9], v4 offset:10240
ds_read_b64_tr_b16 v[10:11], v4 offset:12288
v_smfmac_f32_16x16x64_bf16 v[28:31], v[44:47], a[160:167], v0
ds_read_b64_tr_b16 v[12:13], v4 offset:10752
ds_read_b64_tr_b16 v[14:15], v4 offset:12800
v_smfmac_f32_16x16x64_bf16 v[24:27], v[40:43], a[136:143], v0
ds_read_b64_tr_b16 v[16:17], v4 offset:11264
ds_read_b64_tr_b16 v[18:19], v4 offset:13312
v_smfmac_f32_16x16x64_bf16 v[28:31], v[40:43], a[144:151], v0
ds_read_b64_tr_b16 v[20:21], v4 offset:11776
ds_read_b64_tr_b16 v[22:23], v4 offset:13824
v_smfmac_f32_16x16x64_bf16 v[24:27], v[48:51], a[184:191], v0
ds_read_b128 v[36:39], v6 offset:3072
ds_read_b128 v[44:47], v6 offset:4096
v_smfmac_f32_16x16x64_bf16 v[28:31], v[48:51], a[192:199], v0
ds_read_b128 v[40:43], v6 offset:5120
s_waitcnt lgkmcnt(9)
v_mfma_f32_16x16x32_bf16 v[52:55], v[8:11], v[8:11], 0
s_waitcnt lgkmcnt(7)
v_mfma_f32_16x16x32_bf16 v[52:55], v[12:15], v[12:15], v[52:55]
buffer_store_dwordx4 v[12:15], v1, s[4:7], s50 offen offset:1024 sc1
s_waitcnt lgkmcnt(5)
v_add_f32 v24, v24, v26
v_add_f32 v25, v25, v27
v_mfma_f32_16x16x32_bf16 v[52:55], v[16:19], v[16:19], v[52:55]
s_waitcnt lgkmcnt(3)
v_add_f32 v28, v28, v30
v_add_f32 v29, v29, v31
v_mfma_f32_16x16x32_bf16 v[52:55], v[20:23], v[20:23], v[52:55]
v_cvt_pk_bf16_f32 v24, v24, v25
v_cvt_pk_bf16_f32 v25, v28, v29
v_mfma_f32_16x16x32_bf16 v[48:51], v[64:67], v[8:11], 0
ds_read_b128 v[64:67], v6 offset:6144
v_mov_b64 v[26:27], s[74:75]
v_mfma_f32_16x16x32_bf16 v[48:51], v[68:71], v[12:15], v[48:51]
ds_read_b128 v[68:71], v6 offset:7168
buffer_store_dwordx2 v[24:25], v3, s[4:7], s51 offen offset:512 sc1
v_mov_b32 v29, 0
v_mfma_f32_16x16x32_bf16 v[48:51], v[32:35], v[16:19], v[48:51]
s_cbranch_scc1 L_last12_f
s_waitcnt lgkmcnt(4)
v_exp_f32 v54, v54
v_mfma_f32_16x16x32_bf16 v[48:51], v[36:39], v[20:23], v[48:51]
s_waitcnt lgkmcnt(3)
v_exp_f32 v55, v55
v_mfma_f32_16x16x32_bf16 v[32:35], v[44:47], v[8:11], 0
s_waitcnt lgkmcnt(2)
v_cvt_pk_bf16_f32 v28, v54, v55
v_cvt_pk_bf16_f32 v31, v54, v55
v_mfma_f32_16x16x32_bf16 v[32:35], v[40:43], v[12:15], v[32:35]
s_waitcnt lgkmcnt(1)
v_mov_b32 v30, 0
v_mfma_f32_16x16x32_bf16 v[32:35], v[64:67], v[16:19], v[32:35]
s_waitcnt lgkmcnt(0)
v_exp_f32 v48, v48
v_mfma_f32_16x16x32_bf16 v[32:35], v[68:71], v[20:23], v[32:35]
s_add_u32 s32, s32, 1
v_exp_f32 v49, v49
v_mfma_f32_16x16x16_bf16 v[52:55], v[28:29], v[26:27], 0
ds_read_b128 v[8:11], v2 offset:41984
v_exp_f32 v50, v50
v_mfma_f32_16x16x16_bf16 v[44:47], v[28:29], v[24:25], 0
ds_read_b128 v[12:15], v2 offset:46080
v_exp_f32 v51, v51
v_mfma_f32_16x16x16_bf16 v[40:43], v[30:31], v[24:25], 0
v_exp_f32 v32, v32
v_cvt_pk_bf16_f32 v36, v48, v49
v_cvt_pk_bf16_f32 v37, v50, v51
v_exp_f32 v33, v33
v_exp_f32 v34, v34
v_mfma_f32_16x16x16_bf16 v[52:55], v[36:37], v[26:27], v[52:55]
v_exp_f32 v35, v35
v_cvt_pk_bf16_f32 v38, v32, v33
v_cvt_pk_bf16_f32 v39, v34, v35
s_nop 1
v_mfma_f32_16x16x16_bf16 v[52:55], v[38:39], v[26:27], v[52:55]
ds_read_b128 v[16:19], v1 offset:41984
ds_read_b128 v[20:23], v1 offset:46080
v_mfma_f32_16x16x32_bf16 v[44:47], v[36:39], v[56:59], v[44:47]
ds_read_b128 v[64:67], v1 offset:50176
ds_read_b128 v[68:71], v1 offset:54272
v_mfma_f32_16x16x32_bf16 v[40:43], v[36:39], v[60:63], v[40:43]
s_nop 1
v_rcp_f32 v52, v52
v_rcp_f32 v53, v53
v_subrev_u32 v54, 562036736, v52
v_mul_f32 v44, v44, v52
v_mul_f32 v45, v45, v53
v_cvt_pk_bf16_f32 v48, v44, v45
v_cvt_pk_bf16_f32 v49, v44, v45
ds_write_b64 v3, v[48:49] offset:5632
v_pk_mul_f32 v[40:41], v[40:41], v[52:53]
v_cvt_pk_bf16_f32 v50, v40, v41
v_cvt_pk_bf16_f32 v51, v40, v41
ds_write_b64 v3, v[50:51] offset:7680
v_subrev_u32 v53, 562036736, v53
v_max_u32 v52, v54, v53
v_cmp_le_u32 vcc, s63, v52
v_mov_b64 v[52:53], 0
v_mov_b64 v[54:55], 0
v_mov_b64 v[40:41], 0
v_mov_b64 v[42:43], 0
s_cbranch_vccnz L_sretry12_f
L_sback12_f:
s_waitcnt lgkmcnt(0)
s_barrier
ds_read_b64_tr_b16 v[24:25], v4 offset:5120
ds_read_b64_tr_b16 v[26:27], v4 offset:7168
ds_read_b64_tr_b16 v[28:29], v4 offset:5632
ds_read_b64_tr_b16 v[30:31], v4 offset:7680
ds_read_b64_tr_b16 v[32:33], v4 offset:6144
ds_read_b64_tr_b16 v[34:35], v4 offset:8192
s_waitcnt lgkmcnt(4)
v_smfmac_f32_16x16x64_bf16 v[52:55], v[24:27], v[8:15], v0
ds_read_b64_tr_b16 v[36:37], v4 offset:6656
ds_read_b64_tr_b16 v[38:39], v4 offset:8704
s_waitcnt lgkmcnt(4)
v_mov_b64 v[44:45], 0
v_smfmac_f32_16x16x64_bf16 v[52:55], v[28:31], a[248:255], v0
v_mov_b64 v[46:47], 0
v_smfmac_f32_16x16x64_bf16 v[40:43], v[24:27], v[16:23], v0
ds_read_b128 v[56:59], v1 offset:58368
ds_read_b128 v[60:63], v1 offset:62464
v_smfmac_f32_16x16x64_bf16 v[40:43], v[28:31], v[64:71], v0
ds_read_b128 v[8:11], v2 offset:1024
ds_read_b128 v[12:15], v2 offset:5120
s_waitcnt lgkmcnt(6)
v_cvt_pk_bf16_f32 v52, v52, v53
v_smfmac_f32_16x16x64_bf16 v[40:43], v[32:35], a[216:223], v0
s_waitcnt lgkmcnt(4)
v_cvt_pk_bf16_f32 v53, v54, v55
v_and_or_b32 v52, v52, -2, s33
v_smfmac_f32_16x16x64_bf16 v[40:43], v[36:39], a[224:231], v0
buffer_store_dwordx2 v[52:53], v5, s[4:7], s45 offen
s_nop 0
v_smfmac_f32_16x16x64_bf16 v[44:47], v[24:27], a[232:239], v0
s_nop 1
v_smfmac_f32_16x16x64_bf16 v[44:47], v[28:31], a[240:247], v0
s_waitcnt lgkmcnt(2)
s_nop 0
v_cvt_pk_bf16_f32 v40, v40, v41
v_smfmac_f32_16x16x64_bf16 v[44:47], v[32:35], v[56:63], v0
s_waitcnt lgkmcnt(0)
v_cvt_pk_bf16_f32 v41, v42, v43
v_and_or_b32 v40, v40, -2, s33
v_smfmac_f32_16x16x64_bf16 v[44:47], v[36:39], v[8:15], v0
buffer_store_dwordx2 v[40:41], v5, s[4:7], s43 offen
s_nop 6
v_cvt_pk_bf16_f32 v44, v44, v45
v_cvt_pk_bf16_f32 v45, v46, v47
v_and_or_b32 v44, v44, -2, s33
buffer_store_dwordx2 v[44:45], v5, s[4:7], s44 offen
s_xor_b32 s33, s33, 1
s_barrier
v_and_b32 v6, 0x3c0, v1
v_add_u32 v6, v6, v1
buffer_load_dwordx4 v[8:11], v6, s[4:7], s46 offen offset:0 sc1
buffer_load_dwordx4 v[12:15], v6, s[4:7], s46 offen offset:2048 sc1
buffer_load_dwordx4 v[16:19], v6, s[4:7], s47 offen offset:0 sc1
buffer_load_dwordx4 v[20:23], v6, s[4:7], s47 offen offset:2048 sc1
v_and_b32 v32, 16, v1
v_lshlrev_b32 v32, v32, s57
v_cndmask_b32 v24, 0, v32, s[64:65]
v_cndmask_b32 v25, 0, v32, s[66:67]
v_cndmask_b32 v26, 0, v32, s[68:69]
v_cndmask_b32 v27, 0, v32, s[70:71]
v_mov_b32 v37, -1
v_mov_b32 v38, s32
s_waitcnt vmcnt(3)
v_mfma_f32_16x16x32_bf16 v[28:31], v[8:11], v[24:27], 0
v_bitop3_b32 v32, v8, v10, s34 bitop3:0x7e
s_waitcnt vmcnt(2)
v_mfma_f32_16x16x32_bf16 v[28:31], v[12:15], v[24:27], v[28:31]
v_bitop3_b32 v33, v12, v14, s34 bitop3:0x7e
v_or_b32 v32, v32, v33
s_waitcnt vmcnt(1)
v_mfma_f32_16x16x32_bf16 v[28:31], v[16:19], v[24:27], v[28:31]
v_bitop3_b32 v33, v16, v18, s34 bitop3:0x7e
v_or_b32 v32, v32, v33
s_waitcnt vmcnt(0)
v_mfma_f32_16x16x32_bf16 v[28:31], v[20:23], v[24:27], v[28:31]
v_bitop3_b32 v33, v20, v22, s34 bitop3:0x7e
v_bitop3_b32 v32, v32, v33, 1 bitop3:0xa8
v_cmp_ne_u32 vcc, 0, v32
s_nop 3
s_cbranch_vccnz L_gretry12_f
L_gback12_f:
v_permlane32_swap_b32 v28, v30
v_permlane32_swap_b32 v29, v31
v_pk_add_f32 v[28:29], v[28:29], v[30:31]
v_mov_b64 v[30:31], v[28:29]
s_nop 1
v_permlane16_swap_b32 v28, v30
v_permlane16_swap_b32 v29, v31
v_pk_add_f32 v[28:29], v[28:29], v[30:31]
v_cvt_pk_bf16_f32 v28, v28, v29
v_min_u32 v28, -2, v28
buffer_store_dword v28, v7, s[4:7], s39 offen
s_barrier
buffer_store_dword v28, v7, s[4:7], s41 offen sc1
buffer_store_dword v37, v7, s[4:7], s40 offen
s_not_b32 s34, s34
v_lshrrev_b32 v6, 2, v1
s_nop 15
s_nop 15
s_nop 7
s_branch L_step12_f
L_aretry12_f:
buffer_load_dwordx4 v[48:51], v1, s[4:7], s35 offen sc1
s_waitcnt vmcnt(3)
v_max3_u32 v32, v52, v53, v54
v_max_u32 v32, v32, v55
v_cmp_eq_u32 vcc, -1, v32
s_cbranch_vccz L_aw012_f
buffer_load_dwordx4 v[52:55], v1, s[4:7], s35 offen sc1
s_waitcnt vmcnt(3)
v_max3_u32 v32, v44, v45, v46
v_max_u32 v32, v32, v47
v_cmp_eq_u32 vcc, -1, v32
s_cbranch_vccz L_aw112_f
buffer_load_dwordx4 v[44:47], v1, s[4:7], s35 offen sc1
s_waitcnt vmcnt(3)
v_max3_u32 v32, v40, v41, v42
v_max_u32 v32, v32, v43
v_cmp_eq_u32 vcc, -1, v32
s_cbranch_vccz L_aw212_f
buffer_load_dwordx4 v[40:43], v1, s[4:7], s35 offen sc1
s_waitcnt vmcnt(3)
v_max3_u32 v32, v48, v49, v50
v_max_u32 v32, v32, v51
v_cmp_eq_u32 vcc, -1, v32
s_cbranch_vccz L_aw312_f
s_add_u32 s27, s27, 1
s_cmp_gt_u32 s27, 262144
s_cbranch_scc0 L_aretry12_f
s_branch L_fail_f
L_aw012_f:
ds_write_b128 v1, v[52:55] offset:1024
s_branch L_aback12_f
L_aw112_f:
ds_write_b128 v1, v[44:47] offset:1024
s_branch L_aback12_f
L_aw212_f:
ds_write_b128 v1, v[40:43] offset:1024
s_branch L_aback12_f
L_aw312_f:
ds_write_b128 v1, v[48:51] offset:1024
s_branch L_aback12_f
L_fretry12_f:
s_waitcnt lgkmcnt(0)
buffer_load_dword v44, v6, s[4:7], s36 offen sc1
s_add_u32 s27, s27, 1
s_cmp_gt_u32 s27, 262144
s_cbranch_scc1 L_fail_f
s_waitcnt vmcnt(0)
ds_write_b32 v6, v44 offset:4352
v_cmp_eq_u32 vcc, -1, v44
s_waitcnt lgkmcnt(0)
s_cbranch_vccnz L_fretry12_f
s_branch L_fback12_f
L_bretry12_f:
s_waitcnt lgkmcnt(0)
buffer_load_dwordx4 v[48:51], v1, s[4:7], s37 offen sc1
buffer_load_dword v52, v6, s[4:7], s38 offen sc1
s_add_u32 s27, s27, 1
s_cmp_gt_u32 s27, 262144
s_cbranch_scc1 L_fail_f
s_waitcnt vmcnt(0)
ds_write_b128 v1, v[48:51] offset:6144
ds_write_b32 v6, v52 offset:9472
v_max3_u32 v53, v48, v49, v50
v_max3_u32 v53, v53, v51, v52
v_cmp_eq_u32 vcc, -1, v53
s_waitcnt lgkmcnt(0)
s_cbranch_vccnz L_bretry12_f
s_branch L_bback12_f
L_last12_f:
s_waitcnt vmcnt(0) lgkmcnt(0)
s_barrier
s_endpgm
L_sretry12_f:
s_waitcnt lgkmcnt(0)
s_sub_u32 s3, s59, 2048
v_add_u32 v6, s3, v1
ds_read_b64_tr_b16 v[8:9], v4 offset:10240
ds_read_b64_tr_b16 v[10:11], v4 offset:12288
ds_read_b64_tr_b16 v[12:13], v4 offset:10752
ds_read_b64_tr_b16 v[14:15], v4 offset:12800
ds_read_b64_tr_b16 v[16:17], v4 offset:11264
ds_read_b64_tr_b16 v[18:19], v4 offset:13312
ds_read_b64_tr_b16 v[20:21], v4 offset:11776
ds_read_b64_tr_b16 v[22:23], v4 offset:13824
s_waitcnt lgkmcnt(6)
v_mfma_f32_16x16x32_bf16 v[52:55], v[8:11], v[8:11], 0
s_waitcnt lgkmcnt(4)
v_mfma_f32_16x16x32_bf16 v[52:55], v[12:15], v[12:15], v[52:55]
s_waitcnt lgkmcnt(2)
v_mfma_f32_16x16x32_bf16 v[52:55], v[16:19], v[16:19], v[52:55]
s_waitcnt lgkmcnt(0)
v_mfma_f32_16x16x32_bf16 v[52:55], v[20:23], v[20:23], v[52:55]
ds_read_b128 v[64:67], v6 offset:0
ds_read_b128 v[68:71], v6 offset:1024
ds_read_b128 v[40:43], v6 offset:2048
ds_read_b128 v[44:47], v6 offset:3072
s_waitcnt lgkmcnt(3)
v_mfma_f32_16x16x32_bf16 v[48:51], v[64:67], v[8:11], 0
s_waitcnt lgkmcnt(2)
v_mfma_f32_16x16x32_bf16 v[48:51], v[68:71], v[12:15], v[48:51]
s_waitcnt lgkmcnt(1)
v_mfma_f32_16x16x32_bf16 v[48:51], v[40:43], v[16:19], v[48:51]
s_waitcnt lgkmcnt(0)
v_mfma_f32_16x16x32_bf16 v[48:51], v[44:47], v[20:23], v[48:51]
ds_read_b128 v[64:67], v6 offset:4096
ds_read_b128 v[68:71], v6 offset:5120
ds_read_b128 v[40:43], v6 offset:6144
ds_read_b128 v[44:47], v6 offset:7168
s_waitcnt lgkmcnt(3)
v_mfma_f32_16x16x32_bf16 v[32:35], v[64:67], v[8:11], 0
s_waitcnt lgkmcnt(2)
v_mfma_f32_16x16x32_bf16 v[32:35], v[68:71], v[12:15], v[32:35]
s_waitcnt lgkmcnt(1)
v_mfma_f32_16x16x32_bf16 v[32:35], v[40:43], v[16:19], v[32:35]
s_waitcnt lgkmcnt(0)
v_mfma_f32_16x16x32_bf16 v[32:35], v[44:47], v[20:23], v[32:35]
v_max3_f32 v52, v54, v55, v48
v_max3_f32 v52, v52, v49, v50
s_nop 5
v_max3_f32 v52, v52, v51, v32
v_max3_f32 v52, v52, v33, v34
v_max_f32 v52, v52, v35
v_mov_b32 v53, v52
s_nop 1
v_permlane32_swap_b32 v52, v53
v_max_f32 v52, v52, v53
v_mov_b32 v53, v52
s_nop 1
v_permlane16_swap_b32 v52, v53
v_max_f32 v52, v52, v53
v_sub_f32 v54, v54, v52
v_sub_f32 v55, v55, v52
v_sub_f32 v48, v48, v52
v_sub_f32 v49, v49, v52
v_sub_f32 v50, v50, v52
v_sub_f32 v51, v51, v52
v_sub_f32 v32, v32, v52
v_sub_f32 v33, v33, v52
v_sub_f32 v34, v34, v52
v_sub_f32 v35, v35, v52
v_exp_f32 v54, v54
v_exp_f32 v55, v55
v_exp_f32 v48, v48
v_exp_f32 v49, v49
v_exp_f32 v50, v50
v_exp_f32 v51, v51
v_exp_f32 v32, v32
v_exp_f32 v33, v33
v_exp_f32 v34, v34
v_exp_f32 v35, v35
v_cvt_pk_bf16_f32 v28, v54, v55
v_cvt_pk_bf16_f32 v31, v54, v55
v_cvt_pk_bf16_f32 v36, v48, v49
v_cvt_pk_bf16_f32 v37, v50, v51
v_cvt_pk_bf16_f32 v38, v32, v33
v_cvt_pk_bf16_f32 v39, v34, v35
v_mfma_f32_16x16x16_bf16 v[52:55], v[28:29], v[26:27], 0
v_mfma_f32_16x16x16_bf16 v[44:47], v[28:29], v[24:25], 0
v_mfma_f32_16x16x16_bf16 v[40:43], v[30:31], v[24:25], 0
v_mfma_f32_16x16x16_bf16 v[52:55], v[36:37], v[26:27], v[52:55]
v_mfma_f32_16x16x16_bf16 v[52:55], v[38:39], v[26:27], v[52:55]
v_mfma_f32_16x16x32_bf16 v[44:47], v[36:39], v[56:59], v[44:47]
v_mfma_f32_16x16x32_bf16 v[40:43], v[36:39], v[60:63], v[40:43]
ds_read_b128 v[8:11], v2 offset:41984
ds_read_b128 v[12:15], v2 offset:46080
ds_read_b128 v[16:19], v1 offset:41984
ds_read_b128 v[20:23], v1 offset:46080
ds_read_b128 v[64:67], v1 offset:50176
ds_read_b128 v[68:71], v1 offset:54272
v_rcp_f32 v52, v52
v_rcp_f32 v53, v53
v_subrev_u32 v54, 562036736, v52
v_mul_f32 v44, v44, v52
v_mul_f32 v45, v45, v53
v_cvt_pk_bf16_f32 v48, v44, v45
v_cvt_pk_bf16_f32 v49, v44, v45
ds_write_b64 v3, v[48:49] offset:5632
v_pk_mul_f32 v[40:41], v[40:41], v[52:53]
v_cvt_pk_bf16_f32 v50, v40, v41
v_cvt_pk_bf16_f32 v51, v40, v41
ds_write_b64 v3, v[50:51] offset:7680
v_mov_b64 v[40:41], 0
v_mov_b64 v[42:43], 0
v_mov_b64 v[44:45], 0
v_mov_b64 v[46:47], 0
v_mov_b64 v[52:53], 0
v_mov_b64 v[54:55], 0
s_waitcnt lgkmcnt(0)
s_branch L_sback12_f
L_gretry12_f:
buffer_load_dwordx4 v[64:67], v6, s[4:7], s46 offen offset:0 sc1
buffer_load_dwordx4 v[68:71], v6, s[4:7], s46 offen offset:2048 sc1
buffer_load_dwordx4 v[56:59], v6, s[4:7], s47 offen offset:0 sc1
buffer_load_dwordx4 v[60:63], v6, s[4:7], s47 offen offset:2048 sc1
s_nop 15
s_nop 8
L_gloop12_f:
buffer_load_dwordx4 v[8:11], v6, s[4:7], s46 offen offset:0 sc1
buffer_load_dwordx4 v[12:15], v6, s[4:7], s46 offen offset:2048 sc1
buffer_load_dwordx4 v[16:19], v6, s[4:7], s47 offen offset:0 sc1
buffer_load_dwordx4 v[20:23], v6, s[4:7], s47 offen offset:2048 sc1
s_add_u32 s27, s27, 1
s_waitcnt vmcnt(7)
v_mfma_f32_16x16x32_bf16 v[28:31], v[64:67], v[24:27], 0
v_bitop3_b32 v32, v64, v66, s34 bitop3:0x7e
s_waitcnt vmcnt(6)
v_mfma_f32_16x16x32_bf16 v[28:31], v[68:71], v[24:27], v[28:31]
v_bitop3_b32 v33, v68, v70, s34 bitop3:0x7e
v_or_b32 v32, v32, v33
s_waitcnt vmcnt(5)
v_mfma_f32_16x16x32_bf16 v[28:31], v[56:59], v[24:27], v[28:31]
v_bitop3_b32 v33, v56, v58, s34 bitop3:0x7e
v_or_b32 v32, v32, v33
s_waitcnt vmcnt(4)
v_mfma_f32_16x16x32_bf16 v[28:31], v[60:63], v[24:27], v[28:31]
v_bitop3_b32 v33, v60, v62, s34 bitop3:0x7e
v_bitop3_b32 v32, v32, v33, 1 bitop3:0xa8
v_cmp_ne_u32 vcc, 0, v32
s_nop 3
s_cbranch_vccz L_gback12_f
buffer_load_dwordx4 v[64:67], v6, s[4:7], s46 offen offset:0 sc1
buffer_load_dwordx4 v[68:71], v6, s[4:7], s46 offen offset:2048 sc1
buffer_load_dwordx4 v[56:59], v6, s[4:7], s47 offen offset:0 sc1
buffer_load_dwordx4 v[60:63], v6, s[4:7], s47 offen offset:2048 sc1
s_add_u32 s27, s27, 1
s_waitcnt vmcnt(7)
v_mfma_f32_16x16x32_bf16 v[28:31], v[8:11], v[24:27], 0
v_bitop3_b32 v32, v8, v10, s34 bitop3:0x7e
s_waitcnt vmcnt(6)
v_mfma_f32_16x16x32_bf16 v[28:31], v[12:15], v[24:27], v[28:31]
v_bitop3_b32 v33, v12, v14, s34 bitop3:0x7e
v_or_b32 v32, v32, v33
s_waitcnt vmcnt(5)
v_mfma_f32_16x16x32_bf16 v[28:31], v[16:19], v[24:27], v[28:31]
v_bitop3_b32 v33, v16, v18, s34 bitop3:0x7e
v_or_b32 v32, v32, v33
s_waitcnt vmcnt(4)
v_mfma_f32_16x16x32_bf16 v[28:31], v[20:23], v[24:27], v[28:31]
v_bitop3_b32 v33, v20, v22, s34 bitop3:0x7e
v_bitop3_b32 v32, v32, v33, 1 bitop3:0xa8
v_cmp_ne_u32 vcc, 0, v32
s_nop 3
s_cbranch_vccz L_gback12_f
s_cmp_gt_u32 s27, 262144
s_cbranch_scc0 L_gloop12_f
s_branch L_fail_f
L_rw2_f:
v_lshrrev_b32 v6, 2, v1
ds_read_b128 v[56:59], v1 offset:36864
ds_read_b128 v[60:63], v1 offset:37888
ds_read_b128 v[64:67], v2 offset:10240
ds_read_b128 v[68:71], v2 offset:14336
v_mov_b64 v[8:9], 0
v_mov_b64 v[10:11], 0
v_mov_b64 v[12:13], 0
v_mov_b64 v[14:15], 0
v_mov_b64 v[16:17], 0
v_mov_b64 v[18:19], 0
v_mov_b64 v[20:21], 0
v_mov_b64 v[22:23], 0
v_mov_b64 v[24:25], 0
v_mov_b64 v[26:27], 0
v_mov_b64 v[28:29], 0
v_mov_b64 v[30:31], 0
v_mov_b32 v7, 0
s_mov_b32 s41, 0x40000000
.p2align 6
L_step20_f:
buffer_load_dwordx4 v[48:51], v1, s[4:7], s35 offen sc1
s_nop 15
s_nop 0
buffer_load_dwordx4 v[52:55], v1, s[4:7], s35 offen sc1
s_nop 15
s_nop 0
buffer_load_dwordx4 v[44:47], v1, s[4:7], s35 offen sc1
s_nop 15
s_nop 0
buffer_load_dwordx4 v[40:43], v1, s[4:7], s35 offen sc1
s_waitcnt vmcnt(3)
ds_write_b128 v1, v[48:51] offset:2048
v_max3_u32 v32, v48, v49, v50
v_max_u32 v32, v32, v51
v_cmp_eq_u32 vcc, -1, v32
s_cbranch_vccnz L_aretry20_f
L_aback20_f:
buffer_load_dword v44, v6, s[4:7], s36 offen sc1
s_waitcnt lgkmcnt(0)
s_barrier
ds_read_b128 v[32:35], v1 offset:0
buffer_load_dwordx4 v[48:51], v1, s[4:7], s37 offen sc1
buffer_load_dword v52, v6, s[4:7], s38 offen sc1
ds_read_b128 v[36:39], v1 offset:1024
s_waitcnt lgkmcnt(1)
v_smfmac_f32_16x16x64_bf16 v[8:11], v[32:35], v[64:71], v0
ds_read_b128 v[64:67], v2 offset:18432
ds_read_b128 v[68:71], v2 offset:22528
v_smfmac_f32_16x16x64_bf16 v[16:19], v[32:35], v[72:79], v0
s_mul_i32 s3, s52, 5120
s_add_u32 s40, s60, s3
s_add_u32 s52, s52, 1
v_smfmac_f32_16x16x64_bf16 v[20:23], v[32:35], v[80:87], v0
v_smfmac_f32_16x16x64_bf16 v[24:27], v[32:35], a[64:71], v0
v_smfmac_f32_16x16x64_bf16 v[28:31], v[32:35], a[72:79], v0
s_waitcnt lgkmcnt(0)
v_smfmac_f32_16x16x64_bf16 v[12:15], v[32:35], v[64:71], v0
ds_read_b128 v[64:67], v2 offset:26624
ds_read_b128 v[68:71], v2 offset:30720
v_smfmac_f32_16x16x64_bf16 v[8:11], v[36:39], v[208:215], v0
s_and_b32 s52, s52, 3
s_xor_b32 s30, s52, 2
s_lshl_b32 s30, s30, 15
v_smfmac_f32_16x16x64_bf16 v[12:15], v[36:39], v[216:223], v0
s_waitcnt vmcnt(3)
ds_read_b128 v[40:43], v1 offset:2048
v_smfmac_f32_16x16x64_bf16 v[16:19], v[36:39], v[88:95], v0
s_mul_i32 s3, s52, 5120
s_add_u32 s39, s60, s3
s_lshl_b32 s31, s52, 15
v_smfmac_f32_16x16x64_bf16 v[20:23], v[36:39], v[96:103], v0
ds_read_b128 v[32:35], v1 offset:3072
s_add_u32 s42, s61, s30
v_smfmac_f32_16x16x64_bf16 v[24:27], v[36:39], a[80:87], v0
s_waitcnt vmcnt(2)
ds_write_b32 v6, v44 offset:4608
v_cmp_eq_u32 vcc, -1, v44
v_smfmac_f32_16x16x64_bf16 v[28:31], v[36:39], a[88:95], v0
buffer_store_dword v7, off, s[4:7], s55 sc1
s_waitcnt lgkmcnt(2)
v_smfmac_f32_16x16x64_bf16 v[8:11], v[40:43], v[64:71], v0
ds_read_b128 v[64:67], v2 offset:34816
ds_read_b128 v[68:71], v2 offset:38912
s_cbranch_vccnz L_fretry20_f
L_fback20_f:
v_smfmac_f32_16x16x64_bf16 v[16:19], v[40:43], v[104:111], v0
v_smfmac_f32_16x16x64_bf16 v[20:23], v[40:43], v[112:119], v0
s_add_u32 s41, s61, s31
s_add_u32 s31, s31, s62
s_add_u32 s35, s39, 2048
v_smfmac_f32_16x16x64_bf16 v[24:27], v[40:43], a[96:103], v0
s_waitcnt lgkmcnt(2)
s_barrier
v_smfmac_f32_16x16x64_bf16 v[28:31], v[40:43], a[104:111], v0
s_waitcnt lgkmcnt(0)
v_smfmac_f32_16x16x64_bf16 v[12:15], v[40:43], v[64:71], v0
ds_read_b128 v[64:67], v2 offset:51200
ds_read_b128 v[68:71], v2 offset:55296
v_smfmac_f32_16x16x64_bf16 v[8:11], v[32:35], v[224:231], v0
ds_read_b128 v[36:39], v1 offset:4096
v_smfmac_f32_16x16x64_bf16 v[12:15], v[32:35], v[232:239], v0
s_add_u32 s36, s39, 4608
v_smfmac_f32_16x16x64_bf16 v[16:19], v[32:35], v[120:127], v0
s_waitcnt vmcnt(2)
ds_write_b128 v1, v[48:51] offset:7168
s_add_u32 s58, s32, 3
s_min_u32 s58, s58, 64
v_max3_u32 v53, v48, v49, v50
v_smfmac_f32_16x16x64_bf16 v[20:23], v[32:35], v[128:135], v0
s_waitcnt vmcnt(1)
ds_write_b32 v6, v52 offset:9728
s_mov_b32 m0, s59
s_xor_b32 s59, s59, 8192
v_max3_u32 v53, v53, v51, v52
s_waitcnt lgkmcnt(3)
v_smfmac_f32_16x16x64_bf16 v[24:27], v[32:35], v[64:71], v0
ds_read_b128 v[64:67], v2 offset:59392
ds_read_b128 v[68:71], v2 offset:63488
v_cmp_eq_u32 vcc, -1, v53
v_smfmac_f32_16x16x64_bf16 v[28:31], v[32:35], a[112:119], v0
s_waitcnt lgkmcnt(4)
v_smfmac_f32_16x16x64_bf16 v[8:11], v[36:39], v[240:247], v0
s_cbranch_vccnz L_bretry20_f
L_bback20_f:
v_add_u32 v2, 0x10000, v2
v_smfmac_f32_16x16x64_bf16 v[12:15], v[36:39], v[248:255], v0
s_waitcnt lgkmcnt(2)
s_barrier
ds_read_b128 v[40:43], v1 offset:5120
v_smfmac_f32_16x16x64_bf16 v[16:19], v[36:39], v[136:143], v0
ds_read_b128 v[44:47], v1 offset:6144
buffer_load_dwordx4 v1, s[4:7], s48 offen sc1 lds
s_waitcnt lgkmcnt(2)
v_smfmac_f32_16x16x64_bf16 v[20:23], v[36:39], v[64:71], v0
ds_read_b128 v[64:67], v2 offset:2048
ds_read_b128 v[68:71], v2 offset:6144
v_smfmac_f32_16x16x64_bf16 v[24:27], v[36:39], a[120:127], v0
ds_read_b128 v[32:35], v1 offset:7168
buffer_load_dwordx4 v1, s[4:7], s48 offen offset:1024 sc1 lds
s_mov_b32 m0, 36864
v_smfmac_f32_16x16x64_bf16 v[28:31], v[36:39], a[128:135], v0
ds_read_b128 v[48:51], v1 offset:8192
s_waitcnt lgkmcnt(5)
v_smfmac_f32_16x16x64_bf16 v[8:11], v[40:43], a[0:7], v0
ds_read_b128 v[36:39], v1 offset:9216
v_smfmac_f32_16x16x64_bf16 v[12:15], v[40:43], a[8:15], v0
buffer_load_dwordx4 v1, s[4:7], s49 offen sc1 lds
s_waitcnt lgkmcnt(3)
v_smfmac_f32_16x16x64_bf16 v[8:11], v[44:47], v[64:71], v0
ds_read_b128 v[64:67], v2 offset:10240
ds_read_b128 v[68:71], v2 offset:14336
v_smfmac_f32_16x16x64_bf16 v[12:15], v[44:47], a[16:23], v0
buffer_load_dwordx4 v1, s[4:7], s49 offen offset:1024 sc1 lds
s_waitcnt lgkmcnt(4)
v_smfmac_f32_16x16x64_bf16 v[8:11], v[32:35], a[24:31], v0
s_cmp_eq_u32 s32, 62
s_cselect_b32 s11, 0x40000000, s12
s_waitcnt lgkmcnt(3)
v_smfmac_f32_16x16x64_bf16 v[8:11], v[48:51], a[32:39], v0
s_waitcnt lgkmcnt(2)
v_smfmac_f32_16x16x64_bf16 v[8:11], v[36:39], a[48:55], v0
s_add_u32 s37, s31, 2048
s_add_u32 s38, s31, 4608
s_waitcnt lgkmcnt(0)
v_smfmac_f32_16x16x64_bf16 v[12:15], v[32:35], v[64:71], v0
ds_read_b128 v[64:67], v2 offset:18432
ds_read_b128 v[68:71], v2 offset:22528
v_smfmac_f32_16x16x64_bf16 v[12:15], v[48:51], a[40:47], v0
s_sub_u32 s3, s59, 4096
v_add_u32 v6, s3, v1
v_smfmac_f32_16x16x64_bf16 v[12:15], v[36:39], a[56:63], v0
s_add_u32 s48, s48, s11
s_add_u32 s49, s49, s11
v_add_f32 v8, v8, v10
v_smfmac_f32_16x16x64_bf16 v[16:19], v[40:43], v[144:151], v0
v_add_f32 v9, v9, v11
v_smfmac_f32_16x16x64_bf16 v[16:19], v[44:47], v[160:167], v0
v_mul_f32 v8, s56, v8
s_waitcnt lgkmcnt(0)
v_smfmac_f32_16x16x64_bf16 v[16:19], v[32:35], v[64:71], v0
ds_read_b128 v[64:67], v2 offset:26624
ds_read_b128 v[68:71], v2 offset:30720
v_mul_f32 v9, s56, v9
v_smfmac_f32_16x16x64_bf16 v[16:19], v[48:51], v[176:183], v0
s_add_u32 s50, s50, 16384
s_add_u32 s51, s51, 16384
v_add_f32 v12, v12, v14
v_smfmac_f32_16x16x64_bf16 v[16:19], v[36:39], v[192:199], v0
s_nop 1
v_add_f32 v13, v13, v15
v_smfmac_f32_16x16x64_bf16 v[20:23], v[40:43], v[152:159], v0
s_nop 1
v_mul_f32 v12, s56, v12
v_smfmac_f32_16x16x64_bf16 v[20:23], v[44:47], v[168:175], v0
v_mul_f32 v13, s56, v13
s_waitcnt lgkmcnt(0)
v_smfmac_f32_16x16x64_bf16 v[20:23], v[32:35], v[64:71], v0
ds_read_b128 v[64:67], v6 offset:0
v_add_f32 v16, v16, v18
v_smfmac_f32_16x16x64_bf16 v[20:23], v[48:51], v[184:191], v0
s_cmp_eq_u32 s32, 63
ds_read_b128 v[68:71], v6 offset:1024
v_add_f32 v17, v17, v19
v_smfmac_f32_16x16x64_bf16 v[20:23], v[36:39], v[200:207], v0
s_nop 1
v_cvt_pk_bf16_f32 v53, v8, v9
v_cvt_pk_bf16_f32 v52, v16, v17
v_smfmac_f32_16x16x64_bf16 v[24:27], v[32:35], a[168:175], v0
s_nop 0
ds_write_b64 v3, v[52:53] offset:11264
v_cvt_pk_bf16_f32 v55, v12, v13
v_add_f32 v20, v20, v22
v_add_f32 v21, v21, v23
v_cvt_pk_bf16_f32 v54, v20, v21
ds_write_b64 v3, v[54:55] offset:13312
v_smfmac_f32_16x16x64_bf16 v[28:31], v[32:35], a[176:183], v0
v_smfmac_f32_16x16x64_bf16 v[24:27], v[36:39], a[200:207], v0
ds_read_b128 v[32:35], v6 offset:2048
v_add_u32 v2, 0x10000, v1
v_smfmac_f32_16x16x64_bf16 v[28:31], v[36:39], a[208:215], v0
v_smfmac_f32_16x16x64_bf16 v[24:27], v[44:47], a[152:159], v0
s_waitcnt lgkmcnt(1)
s_barrier
ds_read_b64_tr_b16 v[8:9], v4 offset:10240
ds_read_b64_tr_b16 v[10:11], v4 offset:12288
v_smfmac_f32_16x16x64_bf16 v[28:31], v[44:47], a[160:167], v0
ds_read_b64_tr_b16 v[12:13], v4 offset:10752
ds_read_b64_tr_b16 v[14:15], v4 offset:12800
v_smfmac_f32_16x16x64_bf16 v[24:27], v[40:43], a[136:143], v0
ds_read_b64_tr_b16 v[16:17], v4 offset:11264
ds_read_b64_tr_b16 v[18:19], v4 offset:13312
v_smfmac_f32_16x16x64_bf16 v[28:31], v[40:43], a[144:151], v0
ds_read_b64_tr_b16 v[20:21], v4 offset:11776
ds_read_b64_tr_b16 v[22:23], v4 offset:13824
v_smfmac_f32_16x16x64_bf16 v[24:27], v[48:51], a[184:191], v0
ds_read_b128 v[36:39], v6 offset:3072
ds_read_b128 v[44:47], v6 offset:4096
v_smfmac_f32_16x16x64_bf16 v[28:31], v[48:51], a[192:199], v0
ds_read_b128 v[40:43], v6 offset:5120
s_waitcnt lgkmcnt(9)
v_mfma_f32_16x16x32_bf16 v[52:55], v[8:11], v[8:11], 0
s_waitcnt lgkmcnt(7)
v_mfma_f32_16x16x32_bf16 v[52:55], v[12:15], v[12:15], v[52:55]
s_waitcnt lgkmcnt(5)
v_add_f32 v24, v24, v26
v_add_f32 v25, v25, v27
v_mfma_f32_16x16x32_bf16 v[52:55], v[16:19], v[16:19], v[52:55]
buffer_store_dwordx4 v[16:19], v1, s[4:7], s50 offen offset:2048 sc1
s_waitcnt lgkmcnt(3)
v_add_f32 v28, v28, v30
v_add_f32 v29, v29, v31
v_mfma_f32_16x16x32_bf16 v[52:55], v[20:23], v[20:23], v[52:55]
v_cvt_pk_bf16_f32 v24, v24, v25
v_cvt_pk_bf16_f32 v25, v28, v29
v_mfma_f32_16x16x32_bf16 v[48:51], v[64:67], v[8:11], 0
ds_read_b128 v[64:67], v6 offset:6144
v_mov_b64 v[26:27], s[74:75]
v_mfma_f32_16x16x32_bf16 v[48:51], v[68:71], v[12:15], v[48:51]
ds_read_b128 v[68:71], v6 offset:7168
buffer_store_dwordx2 v[24:25], v3, s[4:7], s51 offen offset:1024 sc1
v_mov_b32 v29, 0
v_mfma_f32_16x16x32_bf16 v[48:51], v[32:35], v[16:19], v[48:51]
s_cbranch_scc1 L_last20_f
s_waitcnt lgkmcnt(4)
v_exp_f32 v54, v54
v_mfma_f32_16x16x32_bf16 v[48:51], v[36:39], v[20:23], v[48:51]
s_waitcnt lgkmcnt(3)
v_exp_f32 v55, v55
v_mfma_f32_16x16x32_bf16 v[32:35], v[44:47], v[8:11], 0
s_waitcnt lgkmcnt(2)
v_cvt_pk_bf16_f32 v28, v54, v55
v_cvt_pk_bf16_f32 v31, v54, v55
v_mfma_f32_16x16x32_bf16 v[32:35], v[40:43], v[12:15], v[32:35]
s_waitcnt lgkmcnt(1)
v_mov_b32 v30, 0
v_and_b32 v6, 0x70, v1
v_mfma_f32_16x16x32_bf16 v[32:35], v[64:67], v[16:19], v[32:35]
s_waitcnt lgkmcnt(0)
v_exp_f32 v48, v48
v_mfma_f32_16x16x32_bf16 v[32:35], v[68:71], v[20:23], v[32:35]
s_add_u32 s32, s32, 1
v_exp_f32 v49, v49
v_mfma_f32_16x16x16_bf16 v[52:55], v[28:29], v[26:27], 0
ds_read_b128 v[8:11], v2 offset:43008
v_exp_f32 v50, v50
v_mfma_f32_16x16x16_bf16 v[44:47], v[28:29], v[24:25], 0
ds_read_b128 v[12:15], v2 offset:47104
v_exp_f32 v51, v51
v_mfma_f32_16x16x16_bf16 v[40:43], v[30:31], v[24:25], 0
v_exp_f32 v32, v32
v_cvt_pk_bf16_f32 v36, v48, v49
v_cvt_pk_bf16_f32 v37, v50, v51
v_exp_f32 v33, v33
v_exp_f32 v34, v34
v_mfma_f32_16x16x16_bf16 v[52:55], v[36:37], v[26:27], v[52:55]
v_exp_f32 v35, v35
v_cvt_pk_bf16_f32 v38, v32, v33
v_cvt_pk_bf16_f32 v39, v34, v35
s_nop 1
v_mfma_f32_16x16x16_bf16 v[52:55], v[38:39], v[26:27], v[52:55]
ds_read_b128 v[16:19], v1 offset:43008
ds_read_b128 v[20:23], v1 offset:47104
v_lshlrev_b32 v6, 3, v6
v_mfma_f32_16x16x32_bf16 v[44:47], v[36:39], v[56:59], v[44:47]
ds_read_b128 v[64:67], v1 offset:51200
ds_read_b128 v[68:71], v1 offset:55296
v_mov_b32 v7, s32
v_mfma_f32_16x16x32_bf16 v[40:43], v[36:39], v[60:63], v[40:43]
v_rcp_f32 v52, v52
v_rcp_f32 v53, v53
v_subrev_u32 v54, 562036736, v52
s_nop 0
v_mul_f32 v44, v44, v52
v_mul_f32 v45, v45, v53
v_cvt_pk_bf16_f32 v48, v44, v45
v_cvt_pk_bf16_f32 v49, v44, v45
ds_write_b64 v3, v[48:49] offset:6144
v_pk_mul_f32 v[40:41], v[40:41], v[52:53]
v_cvt_pk_bf16_f32 v50, v40, v41
v_cvt_pk_bf16_f32 v51, v40, v41
ds_write_b64 v3, v[50:51] offset:8192
v_subrev_u32 v53, 562036736, v53
v_max_u32 v52, v54, v53
v_cmp_le_u32 vcc, s63, v52
v_mov_b64 v[52:53], 0
v_mov_b64 v[54:55], 0
v_mov_b64 v[40:41], 0
v_mov_b64 v[42:43], 0
s_cbranch_vccnz L_sretry20_f
L_sback20_f:
s_mov_b64 exec, 0xff
s_waitcnt lgkmcnt(0)
s_barrier
buffer_store_dword v7, v6, s[4:7], s8 offen
s_mov_b64 exec, -1
ds_read_b64_tr_b16 v[32:33], v4 offset:6144
ds_read_b64_tr_b16 v[34:35], v4 offset:8192
ds_read_b64_tr_b16 v[36:37], v4 offset:6656
ds_read_b64_tr_b16 v[38:39], v4 offset:8704
ds_read_b64_tr_b16 v[24:25], v4 offset:5120
ds_read_b64_tr_b16 v[26:27], v4 offset:7168
s_waitcnt lgkmcnt(4)
v_smfmac_f32_16x16x64_bf16 v[52:55], v[32:35], v[8:15], v0
ds_read_b64_tr_b16 v[28:29], v4 offset:5632
ds_read_b64_tr_b16 v[30:31], v4 offset:7680
s_waitcnt lgkmcnt(4)
v_mov_b64 v[44:45], 0
v_smfmac_f32_16x16x64_bf16 v[52:55], v[36:39], a[248:255], v0
s_waitcnt lgkmcnt(2)
v_mov_b64 v[46:47], 0
v_smfmac_f32_16x16x64_bf16 v[40:43], v[24:27], v[16:23], v0
ds_read_b128 v[56:59], v1 offset:59392
ds_read_b128 v[60:63], v1 offset:63488
s_waitcnt lgkmcnt(2)
v_smfmac_f32_16x16x64_bf16 v[40:43], v[28:31], v[64:71], v0
ds_read_b128 v[8:11], v2 offset:2048
ds_read_b128 v[12:15], v2 offset:6144
v_cvt_pk_bf16_f32 v52, v52, v53
v_smfmac_f32_16x16x64_bf16 v[40:43], v[32:35], a[216:223], v0
v_cvt_pk_bf16_f32 v53, v54, v55
v_and_or_b32 v52, v52, -2, s33
v_smfmac_f32_16x16x64_bf16 v[40:43], v[36:39], a[224:231], v0
buffer_store_dwordx2 v[52:53], v5, s[4:7], s45 offen
s_nop 0
v_smfmac_f32_16x16x64_bf16 v[44:47], v[24:27], a[232:239], v0
s_nop 1
v_smfmac_f32_16x16x64_bf16 v[44:47], v[28:31], a[240:247], v0
s_waitcnt lgkmcnt(2)
s_nop 0
v_cvt_pk_bf16_f32 v40, v40, v41
v_smfmac_f32_16x16x64_bf16 v[44:47], v[32:35], v[56:63], v0
s_waitcnt lgkmcnt(0)
v_cvt_pk_bf16_f32 v41, v42, v43
v_and_or_b32 v40, v40, -2, s33
v_smfmac_f32_16x16x64_bf16 v[44:47], v[36:39], v[8:15], v0
buffer_store_dwordx2 v[40:41], v5, s[4:7], s43 offen
s_nop 6
v_cvt_pk_bf16_f32 v44, v44, v45
v_cvt_pk_bf16_f32 v45, v46, v47
v_and_or_b32 v44, v44, -2, s33
buffer_store_dwordx2 v[44:45], v5, s[4:7], s44 offen
s_xor_b32 s33, s33, 1
s_barrier
s_waitcnt vmcnt(0)
ds_read_b128 v[56:59], v1 offset:36864
ds_read_b128 v[60:63], v1 offset:37888
ds_read_b128 v[64:67], v2 offset:10240
ds_read_b128 v[68:71], v2 offset:14336
v_mov_b64 v[8:9], 0
v_mov_b64 v[10:11], 0
v_mov_b64 v[12:13], 0
v_mov_b64 v[14:15], 0
v_mov_b64 v[16:17], 0
v_mov_b64 v[18:19], 0
v_mov_b64 v[20:21], 0
v_mov_b64 v[22:23], 0
v_mov_b64 v[24:25], 0
v_mov_b64 v[26:27], 0
v_mov_b64 v[28:29], 0
v_mov_b64 v[30:31], 0
v_mov_b32 v7, s32
s_barrier
v_lshrrev_b32 v6, 2, v1
s_nop 15
s_nop 15
s_nop 9
s_branch L_step20_f
L_aretry20_f:
buffer_load_dwordx4 v[48:51], v1, s[4:7], s35 offen sc1
s_waitcnt vmcnt(3)
v_max3_u32 v32, v52, v53, v54
v_max_u32 v32, v32, v55
v_cmp_eq_u32 vcc, -1, v32
s_cbranch_vccz L_aw020_f
buffer_load_dwordx4 v[52:55], v1, s[4:7], s35 offen sc1
s_waitcnt vmcnt(3)
v_max3_u32 v32, v44, v45, v46
v_max_u32 v32, v32, v47
v_cmp_eq_u32 vcc, -1, v32
s_cbranch_vccz L_aw120_f
buffer_load_dwordx4 v[44:47], v1, s[4:7], s35 offen sc1
s_waitcnt vmcnt(3)
v_max3_u32 v32, v40, v41, v42
v_max_u32 v32, v32, v43
v_cmp_eq_u32 vcc, -1, v32
s_cbranch_vccz L_aw220_f
buffer_load_dwordx4 v[40:43], v1, s[4:7], s35 offen sc1
s_waitcnt vmcnt(3)
v_max3_u32 v32, v48, v49, v50
v_max_u32 v32, v32, v51
v_cmp_eq_u32 vcc, -1, v32
s_cbranch_vccz L_aw320_f
s_add_u32 s27, s27, 1
s_cmp_gt_u32 s27, 262144
s_cbranch_scc0 L_aretry20_f
s_branch L_fail_f
L_aw020_f:
ds_write_b128 v1, v[52:55] offset:2048
s_branch L_aback20_f
L_aw120_f:
ds_write_b128 v1, v[44:47] offset:2048
s_branch L_aback20_f
L_aw220_f:
ds_write_b128 v1, v[40:43] offset:2048
s_branch L_aback20_f
L_aw320_f:
ds_write_b128 v1, v[48:51] offset:2048
s_branch L_aback20_f
L_fretry20_f:
s_waitcnt lgkmcnt(0)
buffer_load_dword v44, v6, s[4:7], s36 offen sc1
s_add_u32 s27, s27, 1
s_cmp_gt_u32 s27, 262144
s_cbranch_scc1 L_fail_f
s_waitcnt vmcnt(0)
ds_write_b32 v6, v44 offset:4608
v_cmp_eq_u32 vcc, -1, v44
s_waitcnt lgkmcnt(0)
s_cbranch_vccnz L_fretry20_f
s_branch L_fback20_f
L_bretry20_f:
s_waitcnt lgkmcnt(0)
buffer_load_dwordx4 v[48:51], v1, s[4:7], s37 offen sc1
buffer_load_dword v52, v6, s[4:7], s38 offen sc1
s_add_u32 s27, s27, 1
s_cmp_gt_u32 s27, 262144
s_cbranch_scc1 L_fail_f
s_waitcnt vmcnt(0)
ds_write_b128 v1, v[48:51] offset:7168
ds_write_b32 v6, v52 offset:9728
v_max3_u32 v53, v48, v49, v50
v_max3_u32 v53, v53, v51, v52
v_cmp_eq_u32 vcc, -1, v53
s_waitcnt lgkmcnt(0)
s_cbranch_vccnz L_bretry20_f
s_branch L_bback20_f
L_last20_f:
s_waitcnt vmcnt(0) lgkmcnt(0)
s_barrier
v_mov_b32 v7, 64
buffer_store_dword v7, off, s[4:7], s55 sc1
s_endpgm
L_sretry20_f:
s_waitcnt lgkmcnt(0)
s_sub_u32 s3, s59, 4096
v_add_u32 v6, s3, v1
ds_read_b64_tr_b16 v[8:9], v4 offset:10240
ds_read_b64_tr_b16 v[10:11], v4 offset:12288
ds_read_b64_tr_b16 v[12:13], v4 offset:10752
ds_read_b64_tr_b16 v[14:15], v4 offset:12800
ds_read_b64_tr_b16 v[16:17], v4 offset:11264
ds_read_b64_tr_b16 v[18:19], v4 offset:13312
ds_read_b64_tr_b16 v[20:21], v4 offset:11776
ds_read_b64_tr_b16 v[22:23], v4 offset:13824
s_waitcnt lgkmcnt(6)
v_mfma_f32_16x16x32_bf16 v[52:55], v[8:11], v[8:11], 0
s_waitcnt lgkmcnt(4)
v_mfma_f32_16x16x32_bf16 v[52:55], v[12:15], v[12:15], v[52:55]
s_waitcnt lgkmcnt(2)
v_mfma_f32_16x16x32_bf16 v[52:55], v[16:19], v[16:19], v[52:55]
s_waitcnt lgkmcnt(0)
v_mfma_f32_16x16x32_bf16 v[52:55], v[20:23], v[20:23], v[52:55]
ds_read_b128 v[64:67], v6 offset:0
ds_read_b128 v[68:71], v6 offset:1024
ds_read_b128 v[40:43], v6 offset:2048
ds_read_b128 v[44:47], v6 offset:3072
s_waitcnt lgkmcnt(3)
v_mfma_f32_16x16x32_bf16 v[48:51], v[64:67], v[8:11], 0
s_waitcnt lgkmcnt(2)
v_mfma_f32_16x16x32_bf16 v[48:51], v[68:71], v[12:15], v[48:51]
s_waitcnt lgkmcnt(1)
v_mfma_f32_16x16x32_bf16 v[48:51], v[40:43], v[16:19], v[48:51]
s_waitcnt lgkmcnt(0)
v_mfma_f32_16x16x32_bf16 v[48:51], v[44:47], v[20:23], v[48:51]
ds_read_b128 v[64:67], v6 offset:4096
ds_read_b128 v[68:71], v6 offset:5120
ds_read_b128 v[40:43], v6 offset:6144
ds_read_b128 v[44:47], v6 offset:7168
s_waitcnt lgkmcnt(3)
v_mfma_f32_16x16x32_bf16 v[32:35], v[64:67], v[8:11], 0
s_waitcnt lgkmcnt(2)
v_mfma_f32_16x16x32_bf16 v[32:35], v[68:71], v[12:15], v[32:35]
s_waitcnt lgkmcnt(1)
v_mfma_f32_16x16x32_bf16 v[32:35], v[40:43], v[16:19], v[32:35]
s_waitcnt lgkmcnt(0)
v_mfma_f32_16x16x32_bf16 v[32:35], v[44:47], v[20:23], v[32:35]
v_max3_f32 v52, v54, v55, v48
v_max3_f32 v52, v52, v49, v50
s_nop 5
v_max3_f32 v52, v52, v51, v32
v_max3_f32 v52, v52, v33, v34
v_max_f32 v52, v52, v35
v_mov_b32 v53, v52
s_nop 1
v_permlane32_swap_b32 v52, v53
v_max_f32 v52, v52, v53
v_mov_b32 v53, v52
s_nop 1
v_permlane16_swap_b32 v52, v53
v_max_f32 v52, v52, v53
v_sub_f32 v54, v54, v52
v_sub_f32 v55, v55, v52
v_sub_f32 v48, v48, v52
v_sub_f32 v49, v49, v52
v_sub_f32 v50, v50, v52
v_sub_f32 v51, v51, v52
v_sub_f32 v32, v32, v52
v_sub_f32 v33, v33, v52
v_sub_f32 v34, v34, v52
v_sub_f32 v35, v35, v52
v_exp_f32 v54, v54
v_exp_f32 v55, v55
v_exp_f32 v48, v48
v_exp_f32 v49, v49
v_exp_f32 v50, v50
v_exp_f32 v51, v51
v_exp_f32 v32, v32
v_exp_f32 v33, v33
v_exp_f32 v34, v34
v_exp_f32 v35, v35
v_cvt_pk_bf16_f32 v28, v54, v55
v_cvt_pk_bf16_f32 v31, v54, v55
v_cvt_pk_bf16_f32 v36, v48, v49
v_cvt_pk_bf16_f32 v37, v50, v51
v_cvt_pk_bf16_f32 v38, v32, v33
v_cvt_pk_bf16_f32 v39, v34, v35
v_mfma_f32_16x16x16_bf16 v[52:55], v[28:29], v[26:27], 0
v_mfma_f32_16x16x16_bf16 v[44:47], v[28:29], v[24:25], 0
v_mfma_f32_16x16x16_bf16 v[40:43], v[30:31], v[24:25], 0
v_mfma_f32_16x16x16_bf16 v[52:55], v[36:37], v[26:27], v[52:55]
v_mfma_f32_16x16x16_bf16 v[52:55], v[38:39], v[26:27], v[52:55]
v_mfma_f32_16x16x32_bf16 v[44:47], v[36:39], v[56:59], v[44:47]
v_mfma_f32_16x16x32_bf16 v[40:43], v[36:39], v[60:63], v[40:43]
ds_read_b128 v[8:11], v2 offset:43008
ds_read_b128 v[12:15], v2 offset:47104
ds_read_b128 v[16:19], v1 offset:43008
ds_read_b128 v[20:23], v1 offset:47104
ds_read_b128 v[64:67], v1 offset:51200
ds_read_b128 v[68:71], v1 offset:55296
v_and_b32 v6, 0x70, v1
v_lshlrev_b32 v6, 3, v6
v_mov_b32 v7, s32
v_rcp_f32 v52, v52
v_rcp_f32 v53, v53
v_subrev_u32 v54, 562036736, v52
v_mul_f32 v44, v44, v52
v_mul_f32 v45, v45, v53
v_cvt_pk_bf16_f32 v48, v44, v45
v_cvt_pk_bf16_f32 v49, v44, v45
ds_write_b64 v3, v[48:49] offset:6144
v_pk_mul_f32 v[40:41], v[40:41], v[52:53]
v_cvt_pk_bf16_f32 v50, v40, v41
v_cvt_pk_bf16_f32 v51, v40, v41
ds_write_b64 v3, v[50:51] offset:8192
v_mov_b64 v[40:41], 0
v_mov_b64 v[42:43], 0
v_mov_b64 v[44:45], 0
v_mov_b64 v[46:47], 0
v_mov_b64 v[52:53], 0
v_mov_b64 v[54:55], 0
s_waitcnt lgkmcnt(0)
s_branch L_sback20_f
L_rw3_f:
v_lshrrev_b32 v6, 2, v1
ds_read_b128 v[56:59], v1 offset:38912
ds_read_b128 v[60:63], v1 offset:39936
ds_read_b128 v[64:67], v2 offset:11264
ds_read_b128 v[68:71], v2 offset:15360
v_mov_b64 v[8:9], 0
v_mov_b64 v[10:11], 0
v_mov_b64 v[12:13], 0
v_mov_b64 v[14:15], 0
v_mov_b64 v[16:17], 0
v_mov_b64 v[18:19], 0
v_mov_b64 v[20:21], 0
v_mov_b64 v[22:23], 0
v_mov_b64 v[24:25], 0
v_mov_b64 v[26:27], 0
v_mov_b64 v[28:29], 0
v_mov_b64 v[30:31], 0
s_mov_b32 s41, 0x40000000
.p2align 6
L_step30_f:
buffer_load_dwordx4 v[48:51], v1, s[4:7], s35 offen sc1
s_nop 15
s_nop 0
buffer_load_dwordx4 v[52:55], v1, s[4:7], s35 offen sc1
s_nop 15
s_nop 0
buffer_load_dwordx4 v[44:47], v1, s[4:7], s35 offen sc1
s_nop 15
s_nop 0
buffer_load_dwordx4 v[40:43], v1, s[4:7], s35 offen sc1
s_waitcnt vmcnt(3)
ds_write_b128 v1, v[48:51] offset:3072
v_max3_u32 v32, v48, v49, v50
v_max_u32 v32, v32, v51
v_cmp_eq_u32 vcc, -1, v32
s_cbranch_vccnz L_aretry30_f
L_aback30_f:
buffer_load_dword v44, v6, s[4:7], s36 offen sc1
s_waitcnt lgkmcnt(0)
s_barrier
ds_read_b128 v[32:35], v1 offset:0
buffer_load_dwordx4 v[48:51], v1, s[4:7], s37 offen sc1
buffer_load_dword v52, v6, s[4:7], s38 offen sc1
ds_read_b128 v[36:39], v1 offset:1024
s_waitcnt lgkmcnt(1)
v_smfmac_f32_16x16x64_bf16 v[8:11], v[32:35], v[64:71], v0
ds_read_b128 v[64:67], v2 offset:19456
ds_read_b128 v[68:71], v2 offset:23552
v_smfmac_f32_16x16x64_bf16 v[16:19], v[32:35], v[72:79], v0
s_mul_i32 s3, s52, 5120
s_add_u32 s40, s60, s3
s_add_u32 s52, s52, 1
v_smfmac_f32_16x16x64_bf16 v[20:23], v[32:35], v[80:87], v0
v_smfmac_f32_16x16x64_bf16 v[24:27], v[32:35], a[64:71], v0
v_smfmac_f32_16x16x64_bf16 v[28:31], v[32:35], a[72:79], v0
s_waitcnt lgkmcnt(0)
v_smfmac_f32_16x16x64_bf16 v[12:15], v[32:35], v[64:71], v0
ds_read_b128 v[64:67], v2 offset:27648
ds_read_b128 v[68:71], v2 offset:31744
v_smfmac_f32_16x16x64_bf16 v[8:11], v[36:39], v[208:215], v0
s_and_b32 s52, s52, 3
s_xor_b32 s30, s52, 2
s_lshl_b32 s30, s30, 15
v_smfmac_f32_16x16x64_bf16 v[12:15], v[36:39], v[216:223], v0
s_waitcnt vmcnt(3)
ds_read_b128 v[40:43], v1 offset:2048
v_smfmac_f32_16x16x64_bf16 v[16:19], v[36:39], v[88:95], v0
s_mul_i32 s3, s52, 5120
s_add_u32 s39, s60, s3
s_lshl_b32 s31, s52, 15
v_smfmac_f32_16x16x64_bf16 v[20:23], v[36:39], v[96:103], v0
ds_read_b128 v[32:35], v1 offset:3072
s_add_u32 s42, s61, s30
v_smfmac_f32_16x16x64_bf16 v[24:27], v[36:39], a[80:87], v0
s_waitcnt vmcnt(2)
ds_write_b32 v6, v44 offset:4864
v_cmp_eq_u32 vcc, -1, v44
v_smfmac_f32_16x16x64_bf16 v[28:31], v[36:39], a[88:95], v0
s_waitcnt lgkmcnt(2)
v_smfmac_f32_16x16x64_bf16 v[8:11], v[40:43], v[64:71], v0
ds_read_b128 v[64:67], v2 offset:35840
ds_read_b128 v[68:71], v2 offset:39936
s_cbranch_vccnz L_fretry30_f
L_fback30_f:
v_smfmac_f32_16x16x64_bf16 v[16:19], v[40:43], v[104:111], v0
v_smfmac_f32_16x16x64_bf16 v[20:23], v[40:43], v[112:119], v0
s_add_u32 s41, s61, s31
s_add_u32 s31, s31, s62
s_add_u32 s35, s39, 3072
v_smfmac_f32_16x16x64_bf16 v[24:27], v[40:43], a[96:103], v0
s_waitcnt lgkmcnt(2)
s_barrier
v_smfmac_f32_16x16x64_bf16 v[28:31], v[40:43], a[104:111], v0
s_waitcnt lgkmcnt(0)
v_smfmac_f32_16x16x64_bf16 v[12:15], v[40:43], v[64:71], v0
ds_read_b128 v[64:67], v2 offset:52224
ds_read_b128 v[68:71], v2 offset:56320
v_smfmac_f32_16x16x64_bf16 v[8:11], v[32:35], v[224:231], v0
ds_read_b128 v[36:39], v1 offset:4096
v_bfe_u32 v7, v1, 2, 5
v_smfmac_f32_16x16x64_bf16 v[12:15], v[32:35], v[232:239], v0
s_add_u32 s36, s39, 4864
v_smfmac_f32_16x16x64_bf16 v[16:19], v[32:35], v[120:127], v0
s_waitcnt vmcnt(1)
ds_write_b128 v1, v[48:51] offset:8192
s_add_u32 s58, s32, 3
s_min_u32 s58, s58, 64
v_max3_u32 v53, v48, v49, v50
v_smfmac_f32_16x16x64_bf16 v[20:23], v[32:35], v[128:135], v0
s_waitcnt vmcnt(0)
ds_write_b32 v6, v52 offset:9984
s_mov_b32 m0, s59
s_xor_b32 s59, s59, 8192
v_max3_u32 v53, v53, v51, v52
s_waitcnt lgkmcnt(3)
v_smfmac_f32_16x16x64_bf16 v[24:27], v[32:35], v[64:71], v0
ds_read_b128 v[64:67], v2 offset:60416
ds_read_b128 v[68:71], v2 offset:64512
v_cmp_eq_u32 vcc, -1, v53
v_smfmac_f32_16x16x64_bf16 v[28:31], v[32:35], a[112:119], v0
s_waitcnt lgkmcnt(4)
v_smfmac_f32_16x16x64_bf16 v[8:11], v[36:39], v[240:247], v0
s_cbranch_vccnz L_bretry30_f
L_bback30_f:
v_add_u32 v2, 0x10000, v2
v_smfmac_f32_16x16x64_bf16 v[12:15], v[36:39], v[248:255], v0
s_waitcnt lgkmcnt(2)
s_barrier
ds_read_b128 v[40:43], v1 offset:5120
v_smfmac_f32_16x16x64_bf16 v[16:19], v[36:39], v[136:143], v0
ds_read_b128 v[44:47], v1 offset:6144
buffer_load_dwordx4 v1, s[4:7], s48 offen sc1 lds
s_waitcnt lgkmcnt(2)
v_smfmac_f32_16x16x64_bf16 v[20:23], v[36:39], v[64:71], v0
ds_read_b128 v[64:67], v2 offset:3072
ds_read_b128 v[68:71], v2 offset:7168
v_smfmac_f32_16x16x64_bf16 v[24:27], v[36:39], a[120:127], v0
ds_read_b128 v[32:35], v1 offset:7168
buffer_load_dwordx4 v1, s[4:7], s48 offen offset:1024 sc1 lds
s_mov_b32 m0, 38912
v_smfmac_f32_16x16x64_bf16 v[28:31], v[36:39], a[128:135], v0
ds_read_b128 v[48:51], v1 offset:8192
s_waitcnt lgkmcnt(5)
v_smfmac_f32_16x16x64_bf16 v[8:11], v[40:43], a[0:7], v0
ds_read_b128 v[36:39], v1 offset:9216
v_smfmac_f32_16x16x64_bf16 v[12:15], v[40:43], a[8:15], v0
buffer_load_dwordx4 v1, s[4:7], s49 offen sc1 lds
s_waitcnt lgkmcnt(3)
v_smfmac_f32_16x16x64_bf16 v[8:11], v[44:47], v[64:71], v0
ds_read_b128 v[64:67], v2 offset:11264
ds_read_b128 v[68:71], v2 offset:15360
v_smfmac_f32_16x16x64_bf16 v[12:15], v[44:47], a[16:23], v0
buffer_load_dwordx4 v1, s[4:7], s49 offen offset:1024 sc1 lds
s_waitcnt lgkmcnt(4)
v_smfmac_f32_16x16x64_bf16 v[8:11], v[32:35], a[24:31], v0
s_cmp_eq_u32 s32, 62
s_cselect_b32 s11, 0x40000000, s12
s_waitcnt lgkmcnt(3)
v_smfmac_f32_16x16x64_bf16 v[8:11], v[48:51], a[32:39], v0
s_waitcnt lgkmcnt(2)
v_smfmac_f32_16x16x64_bf16 v[8:11], v[36:39], a[48:55], v0
s_add_u32 s37, s31, 3072
s_add_u32 s38, s31, 4864
s_waitcnt lgkmcnt(0)
v_smfmac_f32_16x16x64_bf16 v[12:15], v[32:35], v[64:71], v0
ds_read_b128 v[64:67], v2 offset:19456
ds_read_b128 v[68:71], v2 offset:23552
v_smfmac_f32_16x16x64_bf16 v[12:15], v[48:51], a[40:47], v0
buffer_load_dword v7, v7, s[4:7], s54 offen sc1
s_sub_u32 s3, s59, 6144
v_add_u32 v6, s3, v1
v_smfmac_f32_16x16x64_bf16 v[12:15], v[36:39], a[56:63], v0
s_add_u32 s48, s48, s11
s_add_u32 s49, s49, s11
v_add_f32 v8, v8, v10
v_smfmac_f32_16x16x64_bf16 v[16:19], v[40:43], v[144:151], v0
v_add_f32 v9, v9, v11
v_smfmac_f32_16x16x64_bf16 v[16:19], v[44:47], v[160:167], v0
v_mul_f32 v8, s56, v8
s_waitcnt lgkmcnt(0)
v_smfmac_f32_16x16x64_bf16 v[16:19], v[32:35], v[64:71], v0
ds_read_b128 v[64:67], v2 offset:27648
ds_read_b128 v[68:71], v2 offset:31744
v_mul_f32 v9, s56, v9
v_smfmac_f32_16x16x64_bf16 v[16:19], v[48:51], v[176:183], v0
s_add_u32 s50, s50, 16384
s_add_u32 s51, s51, 16384
v_add_f32 v12, v12, v14
v_smfmac_f32_16x16x64_bf16 v[16:19], v[36:39], v[192:199], v0
s_nop 1
v_add_f32 v13, v13, v15
v_smfmac_f32_16x16x64_bf16 v[20:23], v[40:43], v[152:159], v0
s_nop 1
v_mul_f32 v12, s56, v12
v_smfmac_f32_16x16x64_bf16 v[20:23], v[44:47], v[168:175], v0
v_mul_f32 v13, s56, v13
s_waitcnt lgkmcnt(0)
v_smfmac_f32_16x16x64_bf16 v[20:23], v[32:35], v[64:71], v0
ds_read_b128 v[64:67], v6 offset:0
v_add_f32 v16, v16, v18
v_smfmac_f32_16x16x64_bf16 v[20:23], v[48:51], v[184:191], v0
s_cmp_eq_u32 s32, 63
ds_read_b128 v[68:71], v6 offset:1024
v_add_f32 v17, v17, v19
v_smfmac_f32_16x16x64_bf16 v[20:23], v[36:39], v[200:207], v0
s_nop 1
v_cvt_pk_bf16_f32 v53, v8, v9
v_cvt_pk_bf16_f32 v52, v16, v17
v_smfmac_f32_16x16x64_bf16 v[24:27], v[32:35], a[168:175], v0
s_nop 0
ds_write_b64 v3, v[52:53] offset:11776
v_cvt_pk_bf16_f32 v55, v12, v13
v_add_f32 v20, v20, v22
v_add_f32 v21, v21, v23
v_cvt_pk_bf16_f32 v54, v20, v21
ds_write_b64 v3, v[54:55] offset:13824
v_smfmac_f32_16x16x64_bf16 v[28:31], v[32:35], a[176:183], v0
v_smfmac_f32_16x16x64_bf16 v[24:27], v[36:39], a[200:207], v0
ds_read_b128 v[32:35], v6 offset:2048
v_add_u32 v2, 0x10000, v1
v_smfmac_f32_16x16x64_bf16 v[28:31], v[36:39], a[208:215], v0
v_smfmac_f32_16x16x64_bf16 v[24:27], v[44:47], a[152:159], v0
s_waitcnt lgkmcnt(1)
s_barrier
ds_read_b64_tr_b16 v[8:9], v4 offset:10240
ds_read_b64_tr_b16 v[10:11], v4 offset:12288
v_smfmac_f32_16x16x64_bf16 v[28:31], v[44:47], a[160:167], v0
ds_read_b64_tr_b16 v[12:13], v4 offset:10752
ds_read_b64_tr_b16 v[14:15], v4 offset:12800
v_smfmac_f32_16x16x64_bf16 v[24:27], v[40:43], a[136:143], v0
ds_read_b64_tr_b16 v[16:17], v4 offset:11264
ds_read_b64_tr_b16 v[18:19], v4 offset:13312
v_smfmac_f32_16x16x64_bf16 v[28:31], v[40:43], a[144:151], v0
ds_read_b64_tr_b16 v[20:21], v4 offset:11776
ds_read_b64_tr_b16 v[22:23], v4 offset:13824
v_smfmac_f32_16x16x64_bf16 v[24:27], v[48:51], a[184:191], v0
ds_read_b128 v[36:39], v6 offset:3072
ds_read_b128 v[44:47], v6 offset:4096
v_smfmac_f32_16x16x64_bf16 v[28:31], v[48:51], a[192:199], v0
ds_read_b128 v[40:43], v6 offset:5120
s_waitcnt lgkmcnt(9)
v_mfma_f32_16x16x32_bf16 v[52:55], v[8:11], v[8:11], 0
s_waitcnt lgkmcnt(7)
v_mfma_f32_16x16x32_bf16 v[52:55], v[12:15], v[12:15], v[52:55]
s_waitcnt lgkmcnt(5)
v_add_f32 v24, v24, v26
v_add_f32 v25, v25, v27
v_mfma_f32_16x16x32_bf16 v[52:55], v[16:19], v[16:19], v[52:55]
s_waitcnt lgkmcnt(3)
v_add_f32 v28, v28, v30
v_add_f32 v29, v29, v31
v_mfma_f32_16x16x32_bf16 v[52:55], v[20:23], v[20:23], v[52:55]
buffer_store_dwordx4 v[20:23], v1, s[4:7], s50 offen offset:3072 sc1
v_cvt_pk_bf16_f32 v24, v24, v25
v_cvt_pk_bf16_f32 v25, v28, v29
v_mfma_f32_16x16x32_bf16 v[48:51], v[64:67], v[8:11], 0
ds_read_b128 v[64:67], v6 offset:6144
v_mov_b64 v[26:27], s[74:75]
v_mfma_f32_16x16x32_bf16 v[48:51], v[68:71], v[12:15], v[48:51]
ds_read_b128 v[68:71], v6 offset:7168
buffer_store_dwordx2 v[24:25], v3, s[4:7], s51 offen offset:1536 sc1
v_mov_b32 v29, 0
v_mfma_f32_16x16x32_bf16 v[48:51], v[32:35], v[16:19], v[48:51]
s_cbranch_scc1 L_last30_f
s_waitcnt lgkmcnt(4)
v_exp_f32 v54, v54
v_mfma_f32_16x16x32_bf16 v[48:51], v[36:39], v[20:23], v[48:51]
s_waitcnt lgkmcnt(3)
v_exp_f32 v55, v55
v_mfma_f32_16x16x32_bf16 v[32:35], v[44:47], v[8:11], 0
s_waitcnt lgkmcnt(2)
v_cvt_pk_bf16_f32 v28, v54, v55
v_cvt_pk_bf16_f32 v31, v54, v55
v_mfma_f32_16x16x32_bf16 v[32:35], v[40:43], v[12:15], v[32:35]
s_waitcnt lgkmcnt(1)
v_mov_b32 v30, 0
v_mfma_f32_16x16x32_bf16 v[32:35], v[64:67], v[16:19], v[32:35]
s_waitcnt lgkmcnt(0)
v_exp_f32 v48, v48
v_mfma_f32_16x16x32_bf16 v[32:35], v[68:71], v[20:23], v[32:35]
s_add_u32 s32, s32, 1
v_exp_f32 v49, v49
v_mfma_f32_16x16x16_bf16 v[52:55], v[28:29], v[26:27], 0
ds_read_b128 v[8:11], v2 offset:44032
v_exp_f32 v50, v50
v_mfma_f32_16x16x16_bf16 v[44:47], v[28:29], v[24:25], 0
ds_read_b128 v[12:15], v2 offset:48128
v_exp_f32 v51, v51
v_mfma_f32_16x16x16_bf16 v[40:43], v[30:31], v[24:25], 0
v_exp_f32 v32, v32
v_cvt_pk_bf16_f32 v36, v48, v49
v_cvt_pk_bf16_f32 v37, v50, v51
v_exp_f32 v33, v33
v_exp_f32 v34, v34
v_mfma_f32_16x16x16_bf16 v[52:55], v[36:37], v[26:27], v[52:55]
v_exp_f32 v35, v35
v_cvt_pk_bf16_f32 v38, v32, v33
v_cvt_pk_bf16_f32 v39, v34, v35
s_nop 1
v_mfma_f32_16x16x16_bf16 v[52:55], v[38:39], v[26:27], v[52:55]
ds_read_b128 v[16:19], v1 offset:44032
ds_read_b128 v[20:23], v1 offset:48128
v_mfma_f32_16x16x32_bf16 v[44:47], v[36:39], v[56:59], v[44:47]
ds_read_b128 v[64:67], v1 offset:52224
ds_read_b128 v[68:71], v1 offset:56320
v_mfma_f32_16x16x32_bf16 v[40:43], v[36:39], v[60:63], v[40:43]
s_nop 1
v_rcp_f32 v52, v52
v_rcp_f32 v53, v53
v_subrev_u32 v54, 562036736, v52
v_mul_f32 v44, v44, v52
v_mul_f32 v45, v45, v53
v_cvt_pk_bf16_f32 v48, v44, v45
v_cvt_pk_bf16_f32 v49, v44, v45
ds_write_b64 v3, v[48:49] offset:6656
v_pk_mul_f32 v[40:41], v[40:41], v[52:53]
v_cvt_pk_bf16_f32 v50, v40, v41
v_cvt_pk_bf16_f32 v51, v40, v41
ds_write_b64 v3, v[50:51] offset:8704
v_subrev_u32 v53, 562036736, v53
v_max_u32 v52, v54, v53
v_cmp_le_u32 vcc, s63, v52
v_mov_b64 v[52:53], 0
v_mov_b64 v[54:55], 0
v_mov_b64 v[40:41], 0
v_mov_b64 v[42:43], 0
s_cbranch_vccnz L_sretry30_f
L_sback30_f:
s_waitcnt lgkmcnt(0)
s_barrier
ds_read_b64_tr_b16 v[32:33], v4 offset:6144
ds_read_b64_tr_b16 v[34:35], v4 offset:8192
ds_read_b64_tr_b16 v[36:37], v4 offset:6656
ds_read_b64_tr_b16 v[38:39], v4 offset:8704
ds_read_b64_tr_b16 v[24:25], v4 offset:5120
ds_read_b64_tr_b16 v[26:27], v4 offset:7168
s_waitcnt lgkmcnt(4)
v_smfmac_f32_16x16x64_bf16 v[52:55], v[32:35], v[8:15], v0
ds_read_b64_tr_b16 v[28:29], v4 offset:5632
ds_read_b64_tr_b16 v[30:31], v4 offset:7680
s_waitcnt lgkmcnt(4)
v_mov_b64 v[44:45], 0
v_smfmac_f32_16x16x64_bf16 v[52:55], v[36:39], a[248:255], v0
s_waitcnt lgkmcnt(2)
v_mov_b64 v[46:47], 0
v_smfmac_f32_16x16x64_bf16 v[40:43], v[24:27], v[16:23], v0
ds_read_b128 v[56:59], v1 offset:60416
ds_read_b128 v[60:63], v1 offset:64512
s_waitcnt lgkmcnt(2)
v_smfmac_f32_16x16x64_bf16 v[40:43], v[28:31], v[64:71], v0
ds_read_b128 v[8:11], v2 offset:3072
ds_read_b128 v[12:15], v2 offset:7168
v_cvt_pk_bf16_f32 v52, v52, v53
v_smfmac_f32_16x16x64_bf16 v[40:43], v[32:35], a[216:223], v0
v_cvt_pk_bf16_f32 v53, v54, v55
v_and_or_b32 v52, v52, -2, s33
v_smfmac_f32_16x16x64_bf16 v[40:43], v[36:39], a[224:231], v0
buffer_store_dwordx2 v[52:53], v5, s[4:7], s45 offen
s_nop 0
v_smfmac_f32_16x16x64_bf16 v[44:47], v[24:27], a[232:239], v0
s_nop 1
v_smfmac_f32_16x16x64_bf16 v[44:47], v[28:31], a[240:247], v0
s_waitcnt lgkmcnt(2)
s_nop 0
v_cvt_pk_bf16_f32 v40, v40, v41
v_smfmac_f32_16x16x64_bf16 v[44:47], v[32:35], v[56:63], v0
s_waitcnt lgkmcnt(0)
v_cvt_pk_bf16_f32 v41, v42, v43
v_and_or_b32 v40, v40, -2, s33
v_smfmac_f32_16x16x64_bf16 v[44:47], v[36:39], v[8:15], v0
buffer_store_dwordx2 v[40:41], v5, s[4:7], s43 offen
s_nop 6
v_cvt_pk_bf16_f32 v44, v44, v45
v_cvt_pk_bf16_f32 v45, v46, v47
v_and_or_b32 v44, v44, -2, s33
buffer_store_dwordx2 v[44:45], v5, s[4:7], s44 offen
s_xor_b32 s33, s33, 1
s_barrier
s_waitcnt vmcnt(0)
ds_read_b128 v[56:59], v1 offset:38912
ds_read_b128 v[60:63], v1 offset:39936
ds_read_b128 v[64:67], v2 offset:11264
ds_read_b128 v[68:71], v2 offset:15360
v_mov_b64 v[8:9], 0
v_mov_b64 v[10:11], 0
v_mov_b64 v[12:13], 0
v_mov_b64 v[14:15], 0
v_mov_b64 v[16:17], 0
v_mov_b64 v[18:19], 0
v_mov_b64 v[20:21], 0
v_mov_b64 v[22:23], 0
v_mov_b64 v[24:25], 0
v_mov_b64 v[26:27], 0
v_mov_b64 v[28:29], 0
v_mov_b64 v[30:31], 0
v_cmp_gt_u32 vcc, s58, v7
s_cbranch_vccnz L_kretry30_f
L_kback30_f:
s_barrier
v_lshrrev_b32 v6, 2, v1
s_nop 15
s_nop 15
s_nop 9
s_branch L_step30_f
L_aretry30_f:
buffer_load_dwordx4 v[48:51], v1, s[4:7], s35 offen sc1
s_waitcnt vmcnt(3)
v_max3_u32 v32, v52, v53, v54
v_max_u32 v32, v32, v55
v_cmp_eq_u32 vcc, -1, v32
s_cbranch_vccz L_aw030_f
buffer_load_dwordx4 v[52:55], v1, s[4:7], s35 offen sc1
s_waitcnt vmcnt(3)
v_max3_u32 v32, v44, v45, v46
v_max_u32 v32, v32, v47
v_cmp_eq_u32 vcc, -1, v32
s_cbranch_vccz L_aw130_f
buffer_load_dwordx4 v[44:47], v1, s[4:7], s35 offen sc1
s_waitcnt vmcnt(3)
v_max3_u32 v32, v40, v41, v42
v_max_u32 v32, v32, v43
v_cmp_eq_u32 vcc, -1, v32
s_cbranch_vccz L_aw230_f
buffer_load_dwordx4 v[40:43], v1, s[4:7], s35 offen sc1
s_waitcnt vmcnt(3)
v_max3_u32 v32, v48, v49, v50
v_max_u32 v32, v32, v51
v_cmp_eq_u32 vcc, -1, v32
s_cbranch_vccz L_aw330_f
s_add_u32 s27, s27, 1
s_cmp_gt_u32 s27, 262144
s_cbranch_scc0 L_aretry30_f
s_branch L_fail_f
L_aw030_f:
ds_write_b128 v1, v[52:55] offset:3072
s_branch L_aback30_f
L_aw130_f:
ds_write_b128 v1, v[44:47] offset:3072
s_branch L_aback30_f
L_aw230_f:
ds_write_b128 v1, v[40:43] offset:3072
s_branch L_aback30_f
L_aw330_f:
ds_write_b128 v1, v[48:51] offset:3072
s_branch L_aback30_f
L_fretry30_f:
s_waitcnt lgkmcnt(0)
buffer_load_dword v44, v6, s[4:7], s36 offen sc1
s_add_u32 s27, s27, 1
s_cmp_gt_u32 s27, 262144
s_cbranch_scc1 L_fail_f
s_waitcnt vmcnt(0)
ds_write_b32 v6, v44 offset:4864
v_cmp_eq_u32 vcc, -1, v44
s_waitcnt lgkmcnt(0)
s_cbranch_vccnz L_fretry30_f
s_branch L_fback30_f
L_bretry30_f:
s_waitcnt lgkmcnt(0)
buffer_load_dwordx4 v[48:51], v1, s[4:7], s37 offen sc1
buffer_load_dword v52, v6, s[4:7], s38 offen sc1
s_add_u32 s27, s27, 1
s_cmp_gt_u32 s27, 262144
s_cbranch_scc1 L_fail_f
s_waitcnt vmcnt(0)
ds_write_b128 v1, v[48:51] offset:8192
ds_write_b32 v6, v52 offset:9984
v_max3_u32 v53, v48, v49, v50
v_max3_u32 v53, v53, v51, v52
v_cmp_eq_u32 vcc, -1, v53
s_waitcnt lgkmcnt(0)
s_cbranch_vccnz L_bretry30_f
s_branch L_bback30_f
L_last30_f:
s_waitcnt vmcnt(0) lgkmcnt(0)
s_barrier
s_endpgm
L_sretry30_f:
s_waitcnt lgkmcnt(0)
s_sub_u32 s3, s59, 6144
v_add_u32 v6, s3, v1
ds_read_b64_tr_b16 v[8:9], v4 offset:10240
ds_read_b64_tr_b16 v[10:11], v4 offset:12288
ds_read_b64_tr_b16 v[12:13], v4 offset:10752
ds_read_b64_tr_b16 v[14:15], v4 offset:12800
ds_read_b64_tr_b16 v[16:17], v4 offset:11264
ds_read_b64_tr_b16 v[18:19], v4 offset:13312
ds_read_b64_tr_b16 v[20:21], v4 offset:11776
ds_read_b64_tr_b16 v[22:23], v4 offset:13824
s_waitcnt lgkmcnt(6)
v_mfma_f32_16x16x32_bf16 v[52:55], v[8:11], v[8:11], 0
s_waitcnt lgkmcnt(4)
v_mfma_f32_16x16x32_bf16 v[52:55], v[12:15], v[12:15], v[52:55]
s_waitcnt lgkmcnt(2)
v_mfma_f32_16x16x32_bf16 v[52:55], v[16:19], v[16:19], v[52:55]
s_waitcnt lgkmcnt(0)
v_mfma_f32_16x16x32_bf16 v[52:55], v[20:23], v[20:23], v[52:55]
ds_read_b128 v[64:67], v6 offset:0
ds_read_b128 v[68:71], v6 offset:1024
ds_read_b128 v[40:43], v6 offset:2048
ds_read_b128 v[44:47], v6 offset:3072
s_waitcnt lgkmcnt(3)
v_mfma_f32_16x16x32_bf16 v[48:51], v[64:67], v[8:11], 0
s_waitcnt lgkmcnt(2)
v_mfma_f32_16x16x32_bf16 v[48:51], v[68:71], v[12:15], v[48:51]
s_waitcnt lgkmcnt(1)
v_mfma_f32_16x16x32_bf16 v[48:51], v[40:43], v[16:19], v[48:51]
s_waitcnt lgkmcnt(0)
v_mfma_f32_16x16x32_bf16 v[48:51], v[44:47], v[20:23], v[48:51]
ds_read_b128 v[64:67], v6 offset:4096
ds_read_b128 v[68:71], v6 offset:5120
ds_read_b128 v[40:43], v6 offset:6144
ds_read_b128 v[44:47], v6 offset:7168
s_waitcnt lgkmcnt(3)
v_mfma_f32_16x16x32_bf16 v[32:35], v[64:67], v[8:11], 0
s_waitcnt lgkmcnt(2)
v_mfma_f32_16x16x32_bf16 v[32:35], v[68:71], v[12:15], v[32:35]
s_waitcnt lgkmcnt(1)
v_mfma_f32_16x16x32_bf16 v[32:35], v[40:43], v[16:19], v[32:35]
s_waitcnt lgkmcnt(0)
v_mfma_f32_16x16x32_bf16 v[32:35], v[44:47], v[20:23], v[32:35]
v_max3_f32 v52, v54, v55, v48
v_max3_f32 v52, v52, v49, v50
s_nop 5
v_max3_f32 v52, v52, v51, v32
v_max3_f32 v52, v52, v33, v34
v_max_f32 v52, v52, v35
v_mov_b32 v53, v52
s_nop 1
v_permlane32_swap_b32 v52, v53
v_max_f32 v52, v52, v53
v_mov_b32 v53, v52
s_nop 1
v_permlane16_swap_b32 v52, v53
v_max_f32 v52, v52, v53
v_sub_f32 v54, v54, v52
v_sub_f32 v55, v55, v52
v_sub_f32 v48, v48, v52
v_sub_f32 v49, v49, v52
v_sub_f32 v50, v50, v52
v_sub_f32 v51, v51, v52
v_sub_f32 v32, v32, v52
v_sub_f32 v33, v33, v52
v_sub_f32 v34, v34, v52
v_sub_f32 v35, v35, v52
v_exp_f32 v54, v54
v_exp_f32 v55, v55
v_exp_f32 v48, v48
v_exp_f32 v49, v49
v_exp_f32 v50, v50
v_exp_f32 v51, v51
v_exp_f32 v32, v32
v_exp_f32 v33, v33
v_exp_f32 v34, v34
v_exp_f32 v35, v35
v_cvt_pk_bf16_f32 v28, v54, v55
v_cvt_pk_bf16_f32 v31, v54, v55
v_cvt_pk_bf16_f32 v36, v48, v49
v_cvt_pk_bf16_f32 v37, v50, v51
v_cvt_pk_bf16_f32 v38, v32, v33
v_cvt_pk_bf16_f32 v39, v34, v35
v_mfma_f32_16x16x16_bf16 v[52:55], v[28:29], v[26:27], 0
v_mfma_f32_16x16x16_bf16 v[44:47], v[28:29], v[24:25], 0
v_mfma_f32_16x16x16_bf16 v[40:43], v[30:31], v[24:25], 0
v_mfma_f32_16x16x16_bf16 v[52:55], v[36:37], v[26:27], v[52:55]
v_mfma_f32_16x16x16_bf16 v[52:55], v[38:39], v[26:27], v[52:55]
v_mfma_f32_16x16x32_bf16 v[44:47], v[36:39], v[56:59], v[44:47]
v_mfma_f32_16x16x32_bf16 v[40:43], v[36:39], v[60:63], v[40:43]
ds_read_b128 v[8:11], v2 offset:44032
ds_read_b128 v[12:15], v2 offset:48128
ds_read_b128 v[16:19], v1 offset:44032
ds_read_b128 v[20:23], v1 offset:48128
ds_read_b128 v[64:67], v1 offset:52224
ds_read_b128 v[68:71], v1 offset:56320
v_rcp_f32 v52, v52
v_rcp_f32 v53, v53
v_subrev_u32 v54, 562036736, v52
v_mul_f32 v44, v44, v52
v_mul_f32 v45, v45, v53
v_cvt_pk_bf16_f32 v48, v44, v45
v_cvt_pk_bf16_f32 v49, v44, v45
ds_write_b64 v3, v[48:49] offset:6656
v_pk_mul_f32 v[40:41], v[40:41], v[52:53]
v_cvt_pk_bf16_f32 v50, v40, v41
v_cvt_pk_bf16_f32 v51, v40, v41
ds_write_b64 v3, v[50:51] offset:8704
v_mov_b64 v[40:41], 0
v_mov_b64 v[42:43], 0
v_mov_b64 v[44:45], 0
v_mov_b64 v[46:47], 0
v_mov_b64 v[52:53], 0
v_mov_b64 v[54:55], 0
s_waitcnt lgkmcnt(0)
s_branch L_sback30_f
L_kretry30_f:
s_add_u32 s27, s27, 1
s_cmp_gt_u32 s27, 262144
s_cbranch_scc1 L_fail_f
v_bfe_u32 v7, v1, 2, 5
buffer_load_dword v7, v7, s[4:7], s54 offen sc1
s_waitcnt vmcnt(0)
v_cmp_gt_u32 vcc, s58, v7
s_cbranch_vccnz L_kretry30_f
s_branch L_kback30_f
L_role_p_f:
s_mov_b32 s8, s64
s_mov_b32 s9, s65
s_mov_b32 s10, 2621440
s_mov_b32 s11, 0x20000
s_mov_b32 s12, s88
s_mov_b32 s13, s89
s_mov_b32 s14, 4915200
s_mov_b32 s15, 0x20000
s_mov_b32 s16, s86
s_mov_b32 s17, s87
s_mov_b32 s18, 1280
s_mov_b32 s19, 0x20000
v_mbcnt_lo_u32_b32 v0, -1, 0
v_mbcnt_hi_u32_b32 v0, -1, v0
s_sub_u32 s3, s24, 4
s_lshl_b32 s32, s3, 5
s_add_u32 s32, s32, s25
s_mul_i32 s41, s3, 1536
s_add_u32 s41, s41, 12288
s_lshl_b32 s30, s25, 4
s_lshl_b32 s31, s26, 2
s_add_u32 s40, s41, s30
s_add_u32 s40, s40, s31
s_lshl_b32 s33, s32, 2
s_add_u32 s34, s33, 9216
s_add_u32 s33, s33, 8192
v_mov_b32 v2, 0
s_lshl_b32 s3, s26, 6
v_add_u32 v1, s3, v0
s_lshl_b32 s30, s25, 2
s_add_u32 s60, s41, s30
buffer_store_dword v2, off, s[4:7], s40 offset:0
buffer_store_dword v2, off, s[4:7], s60 offset:512
buffer_store_dword v2, off, s[4:7], s40 offset:1024
buffer_store_dword v2, off, s[4:7], s60 offset:640
v_mov_b32 v3, 0
v_mov_b32 v4, 0
v_mov_b32 v5, 0
v_lshlrev_b32 v6, 4, v1
s_cmp_eq_u32 s32, 126
s_cselect_b32 s3, 0, 0x40000000
s_cmp_eq_u32 s32, 127
s_cselect_b32 s3, 8192, s3
buffer_store_dwordx4 v[2:5], v6, s[4:7], s3 offen sc1
s_nop 1
v_lshrrev_b32 v3, 2, v1
v_and_b32 v4, 3, v1
v_mul_u32_u24 v5, 7680, v3
v_lshl_add_u32 v5, v4, 4, v5
v_lshlrev_b32 v6, 1, v3
s_lshl_b32 s35, s32, 6
s_cmp_lt_u32 s32, 120
s_cselect_b32 s35, s35, 0x40000000
s_waitcnt vmcnt(0)
s_barrier
s_cmp_lg_u32 s26, 0
s_cbranch_scc1 L_arrp_f
s_mul_i32 s3, s24, 66
s_and_b32 s3, s3, 0xc8
s_add_u32 s3, s3, s76
v_mov_b32 v92, s3
s_lshl_b32 s3, 1, s25
v_mov_b32 v90, s3
s_add_u32 s3, s78, 0x10000
v_mov_b32 v91, s3
s_mov_b64 exec, 1
global_atomic_add_x2 v92, v[90:91], s[28:29] sc1
s_mov_b64 exec, -1
L_arrp_f:
s_sub_u32 s3, s32, 120
s_cmp_ge_u32 s3, 3
s_cbranch_scc1 L_pmpf_f
s_getpc_b64 s[44:45]
L_ppc_f:
s_sub_u32 s44, s44, L_ppc_f-L_roles_f
s_subb_u32 s45, s45, 0
s_lshl_b32 s3, s3, 15
v_lshl_add_u32 v94, v1, 7, s3
v_min_u32 v94, L_fail_f-L_roles_f, v94
global_load_dword v94, v94, s[44:45]
L_pmpf_f:
s_cmp_lt_u32 s24, 6
s_cbranch_scc1 L_pearly_f
s_cmp_lg_u32 s26, 0
s_cbranch_scc1 L_plate_f
s_and_b32 s46, s32, 3
s_lshl_b32 s46, s46, 15
s_bfe_u32 s3, s32, 0x40002
s_lshl_b32 s3, s3, 7
s_add_u32 s46, s46, s3
s_add_u32 s46, s46, 267776
s_mov_b32 s48, -1
s_mov_b32 s49, 0
s_mov_b32 s50, 0
s_mov_b64 exec, 1
s_waitcnt vmcnt(0) lgkmcnt(0)
L_vote_f:
s_and_b32 s47, s50, 3
s_lshl_b32 s3, s47, 13
s_add_u32 s3, s3, s46
s_memtime s[30:31]
s_waitcnt lgkmcnt(0)
buffer_store_dword v90, off, s[4:7], s3 sc1
s_waitcnt vmcnt(0)
s_memtime s[44:45]
s_waitcnt lgkmcnt(0)
s_sub_u32 s3, s44, s30
s_cmp_lt_u32 s3, s48
s_cselect_b32 s48, s3, s48
s_cselect_b32 s49, s47, s49
s_add_u32 s50, s50, 1
s_cmp_lt_u32 s50, 12
s_cbranch_scc1 L_vote_f
s_mul_i32 s3, s49, 0x81
s_and_b32 s3, s3, 0x101
s_add_u32 s3, s3, 0x10000
v_mov_b32 v90, s3
s_lshl_b32 s3, s77, 6
s_add_u32 s3, s3, 56
v_mov_b32 v91, s3
global_atomic_add v91, v90, s[28:29] sc1
s_mov_b64 exec, -1
L_plate_f:
s_barrier
L_pearly_f:
buffer_load_ushort v48, v6, s[16:19], 0 offen offset:0
buffer_load_ushort v49, v6, s[16:19], 0 offen offset:128
buffer_load_ushort v50, v6, s[16:19], 0 offen offset:256
buffer_load_ushort v51, v6, s[16:19], 0 offen offset:384
buffer_load_ushort v52, v6, s[16:19], 0 offen offset:512
buffer_load_ushort v53, v6, s[16:19], 0 offen offset:640
buffer_load_ushort v54, v6, s[16:19], 0 offen offset:768
buffer_load_ushort v55, v6, s[16:19], 0 offen offset:896
buffer_load_ushort v56, v6, s[16:19], 0 offen offset:1024
buffer_load_ushort v57, v6, s[16:19], 0 offen offset:1152
s_add_u32 s3, s35, 0
buffer_load_dwordx4 v[8:11], v5, s[12:15], s3 offen
s_add_u32 s3, s35, 491520
buffer_load_dwordx4 v[12:15], v5, s[12:15], s3 offen
s_add_u32 s3, s35, 983040
buffer_load_dwordx4 v[16:19], v5, s[12:15], s3 offen
s_add_u32 s3, s35, 1474560
buffer_load_dwordx4 v[20:23], v5, s[12:15], s3 offen
s_add_u32 s3, s35, 1966080
buffer_load_dwordx4 v[24:27], v5, s[12:15], s3 offen
s_add_u32 s3, s35, 2457600
buffer_load_dwordx4 v[28:31], v5, s[12:15], s3 offen
s_add_u32 s3, s35, 2949120
buffer_load_dwordx4 v[32:35], v5, s[12:15], s3 offen
s_add_u32 s3, s35, 3440640
buffer_load_dwordx4 v[36:39], v5, s[12:15], s3 offen
s_add_u32 s3, s35, 3932160
buffer_load_dwordx4 v[40:43], v5, s[12:15], s3 offen
s_add_u32 s3, s35, 4423680
buffer_load_dwordx4 v[44:47], v5, s[12:15], s3 offen
v_lshrrev_b32 v7, 4, v1
v_and_b32 v2, 15, v1
v_mul_u32_u24 v5, 1280, v7
v_lshl_add_u32 v5, v2, 4, v5
s_mul_i32 s36, s32, 20480
buffer_load_dwordx4 v[60:63], v5, s[8:11], s36 offen offset:0
buffer_load_dwordx4 v[64:67], v5, s[8:11], s36 offen offset:256
buffer_load_dwordx4 v[68:71], v5, s[8:11], s36 offen offset:512
buffer_load_dwordx4 v[72:75], v5, s[8:11], s36 offen offset:768
buffer_load_dwordx4 v[76:79], v5, s[8:11], s36 offen offset:1024
s_waitcnt vmcnt(24)
v_lshlrev_b32 v48, 16, v48
v_mul_f32 v90, 3216550459, v48
v_exp_f32 v90, v90
s_nop 0
v_add_f32 v90, 1.0, v90
v_rcp_f32 v90, v90
s_nop 0
v_mul_f32 v48, v48, v90
v_cvt_pk_bf16_f32 v48, v48, v48
v_lshlrev_b32 v48, 16, v48
s_waitcnt vmcnt(23)
v_lshlrev_b32 v49, 16, v49
v_mul_f32 v90, 3216550459, v49
v_exp_f32 v90, v90
s_nop 0
v_add_f32 v90, 1.0, v90
v_rcp_f32 v90, v90
s_nop 0
v_mul_f32 v49, v49, v90
v_cvt_pk_bf16_f32 v49, v49, v49
v_lshlrev_b32 v49, 16, v49
s_waitcnt vmcnt(22)
v_lshlrev_b32 v50, 16, v50
v_mul_f32 v90, 3216550459, v50
v_exp_f32 v90, v90
s_nop 0
v_add_f32 v90, 1.0, v90
v_rcp_f32 v90, v90
s_nop 0
v_mul_f32 v50, v50, v90
v_cvt_pk_bf16_f32 v50, v50, v50
v_lshlrev_b32 v50, 16, v50
s_waitcnt vmcnt(21)
v_lshlrev_b32 v51, 16, v51
v_mul_f32 v90, 3216550459, v51
v_exp_f32 v90, v90
s_nop 0
v_add_f32 v90, 1.0, v90
v_rcp_f32 v90, v90
s_nop 0
v_mul_f32 v51, v51, v90
v_cvt_pk_bf16_f32 v51, v51, v51
v_lshlrev_b32 v51, 16, v51
s_waitcnt vmcnt(20)
v_lshlrev_b32 v52, 16, v52
v_mul_f32 v90, 3216550459, v52
v_exp_f32 v90, v90
s_nop 0
v_add_f32 v90, 1.0, v90
v_rcp_f32 v90, v90
s_nop 0
v_mul_f32 v52, v52, v90
v_cvt_pk_bf16_f32 v52, v52, v52
v_lshlrev_b32 v52, 16, v52
s_waitcnt vmcnt(19)
v_lshlrev_b32 v53, 16, v53
v_mul_f32 v90, 3216550459, v53
v_exp_f32 v90, v90
s_nop 0
v_add_f32 v90, 1.0, v90
v_rcp_f32 v90, v90
s_nop 0
v_mul_f32 v53, v53, v90
v_cvt_pk_bf16_f32 v53, v53, v53
v_lshlrev_b32 v53, 16, v53
s_waitcnt vmcnt(18)
v_lshlrev_b32 v54, 16, v54
v_mul_f32 v90, 3216550459, v54
v_exp_f32 v90, v90
s_nop 0
v_add_f32 v90, 1.0, v90
v_rcp_f32 v90, v90
s_nop 0
v_mul_f32 v54, v54, v90
v_cvt_pk_bf16_f32 v54, v54, v54
v_lshlrev_b32 v54, 16, v54
s_waitcnt vmcnt(17)
v_lshlrev_b32 v55, 16, v55
v_mul_f32 v90, 3216550459, v55
v_exp_f32 v90, v90
s_nop 0
v_add_f32 v90, 1.0, v90
v_rcp_f32 v90, v90
s_nop 0
v_mul_f32 v55, v55, v90
v_cvt_pk_bf16_f32 v55, v55, v55
v_lshlrev_b32 v55, 16, v55
s_waitcnt vmcnt(16)
v_lshlrev_b32 v56, 16, v56
v_mul_f32 v90, 3216550459, v56
v_exp_f32 v90, v90
s_nop 0
v_add_f32 v90, 1.0, v90
v_rcp_f32 v90, v90
s_nop 0
v_mul_f32 v56, v56, v90
v_cvt_pk_bf16_f32 v56, v56, v56
v_lshlrev_b32 v56, 16, v56
s_waitcnt vmcnt(15)
v_lshlrev_b32 v57, 16, v57
v_mul_f32 v90, 3216550459, v57
v_exp_f32 v90, v90
s_nop 0
v_add_f32 v90, 1.0, v90
v_rcp_f32 v90, v90
s_nop 0
v_mul_f32 v57, v57, v90
v_cvt_pk_bf16_f32 v57, v57, v57
v_lshlrev_b32 v57, 16, v57
s_waitcnt vmcnt(14)
v_lshlrev_b32 v90, 16, v8
v_and_b32 v91, 0xffff0000, v8
v_mul_f32 v80, v48, v90
v_mul_f32 v81, v48, v91
v_lshlrev_b32 v90, 16, v9
v_and_b32 v91, 0xffff0000, v9
v_mul_f32 v82, v48, v90
v_mul_f32 v83, v48, v91
v_lshlrev_b32 v90, 16, v10
v_and_b32 v91, 0xffff0000, v10
v_mul_f32 v84, v48, v90
v_mul_f32 v85, v48, v91
v_lshlrev_b32 v90, 16, v11
v_and_b32 v91, 0xffff0000, v11
v_mul_f32 v86, v48, v90
v_mul_f32 v87, v48, v91
s_waitcnt vmcnt(13)
v_lshlrev_b32 v90, 16, v12
v_and_b32 v91, 0xffff0000, v12
v_fmac_f32 v80, v49, v90
v_fmac_f32 v81, v49, v91
v_lshlrev_b32 v90, 16, v13
v_and_b32 v91, 0xffff0000, v13
v_fmac_f32 v82, v49, v90
v_fmac_f32 v83, v49, v91
v_lshlrev_b32 v90, 16, v14
v_and_b32 v91, 0xffff0000, v14
v_fmac_f32 v84, v49, v90
v_fmac_f32 v85, v49, v91
v_lshlrev_b32 v90, 16, v15
v_and_b32 v91, 0xffff0000, v15
v_fmac_f32 v86, v49, v90
v_fmac_f32 v87, v49, v91
s_waitcnt vmcnt(12)
v_lshlrev_b32 v90, 16, v16
v_and_b32 v91, 0xffff0000, v16
v_fmac_f32 v80, v50, v90
v_fmac_f32 v81, v50, v91
v_lshlrev_b32 v90, 16, v17
v_and_b32 v91, 0xffff0000, v17
v_fmac_f32 v82, v50, v90
v_fmac_f32 v83, v50, v91
v_lshlrev_b32 v90, 16, v18
v_and_b32 v91, 0xffff0000, v18
v_fmac_f32 v84, v50, v90
v_fmac_f32 v85, v50, v91
v_lshlrev_b32 v90, 16, v19
v_and_b32 v91, 0xffff0000, v19
v_fmac_f32 v86, v50, v90
v_fmac_f32 v87, v50, v91
s_waitcnt vmcnt(11)
v_lshlrev_b32 v90, 16, v20
v_and_b32 v91, 0xffff0000, v20
v_fmac_f32 v80, v51, v90
v_fmac_f32 v81, v51, v91
v_lshlrev_b32 v90, 16, v21
v_and_b32 v91, 0xffff0000, v21
v_fmac_f32 v82, v51, v90
v_fmac_f32 v83, v51, v91
v_lshlrev_b32 v90, 16, v22
v_and_b32 v91, 0xffff0000, v22
v_fmac_f32 v84, v51, v90
v_fmac_f32 v85, v51, v91
v_lshlrev_b32 v90, 16, v23
v_and_b32 v91, 0xffff0000, v23
v_fmac_f32 v86, v51, v90
v_fmac_f32 v87, v51, v91
s_waitcnt vmcnt(10)
v_lshlrev_b32 v90, 16, v24
v_and_b32 v91, 0xffff0000, v24
v_fmac_f32 v80, v52, v90
v_fmac_f32 v81, v52, v91
v_lshlrev_b32 v90, 16, v25
v_and_b32 v91, 0xffff0000, v25
v_fmac_f32 v82, v52, v90
v_fmac_f32 v83, v52, v91
v_lshlrev_b32 v90, 16, v26
v_and_b32 v91, 0xffff0000, v26
v_fmac_f32 v84, v52, v90
v_fmac_f32 v85, v52, v91
v_lshlrev_b32 v90, 16, v27
v_and_b32 v91, 0xffff0000, v27
v_fmac_f32 v86, v52, v90
v_fmac_f32 v87, v52, v91
s_waitcnt vmcnt(9)
v_lshlrev_b32 v90, 16, v28
v_and_b32 v91, 0xffff0000, v28
v_fmac_f32 v80, v53, v90
v_fmac_f32 v81, v53, v91
v_lshlrev_b32 v90, 16, v29
v_and_b32 v91, 0xffff0000, v29
v_fmac_f32 v82, v53, v90
v_fmac_f32 v83, v53, v91
v_lshlrev_b32 v90, 16, v30
v_and_b32 v91, 0xffff0000, v30
v_fmac_f32 v84, v53, v90
v_fmac_f32 v85, v53, v91
v_lshlrev_b32 v90, 16, v31
v_and_b32 v91, 0xffff0000, v31
v_fmac_f32 v86, v53, v90
v_fmac_f32 v87, v53, v91
s_waitcnt vmcnt(8)
v_lshlrev_b32 v90, 16, v32
v_and_b32 v91, 0xffff0000, v32
v_fmac_f32 v80, v54, v90
v_fmac_f32 v81, v54, v91
v_lshlrev_b32 v90, 16, v33
v_and_b32 v91, 0xffff0000, v33
v_fmac_f32 v82, v54, v90
v_fmac_f32 v83, v54, v91
v_lshlrev_b32 v90, 16, v34
v_and_b32 v91, 0xffff0000, v34
v_fmac_f32 v84, v54, v90
v_fmac_f32 v85, v54, v91
v_lshlrev_b32 v90, 16, v35
v_and_b32 v91, 0xffff0000, v35
v_fmac_f32 v86, v54, v90
v_fmac_f32 v87, v54, v91
s_waitcnt vmcnt(7)
v_lshlrev_b32 v90, 16, v36
v_and_b32 v91, 0xffff0000, v36
v_fmac_f32 v80, v55, v90
v_fmac_f32 v81, v55, v91
v_lshlrev_b32 v90, 16, v37
v_and_b32 v91, 0xffff0000, v37
v_fmac_f32 v82, v55, v90
v_fmac_f32 v83, v55, v91
v_lshlrev_b32 v90, 16, v38
v_and_b32 v91, 0xffff0000, v38
v_fmac_f32 v84, v55, v90
v_fmac_f32 v85, v55, v91
v_lshlrev_b32 v90, 16, v39
v_and_b32 v91, 0xffff0000, v39
v_fmac_f32 v86, v55, v90
v_fmac_f32 v87, v55, v91
s_waitcnt vmcnt(6)
v_lshlrev_b32 v90, 16, v40
v_and_b32 v91, 0xffff0000, v40
v_fmac_f32 v80, v56, v90
v_fmac_f32 v81, v56, v91
v_lshlrev_b32 v90, 16, v41
v_and_b32 v91, 0xffff0000, v41
v_fmac_f32 v82, v56, v90
v_fmac_f32 v83, v56, v91
v_lshlrev_b32 v90, 16, v42
v_and_b32 v91, 0xffff0000, v42
v_fmac_f32 v84, v56, v90
v_fmac_f32 v85, v56, v91
v_lshlrev_b32 v90, 16, v43
v_and_b32 v91, 0xffff0000, v43
v_fmac_f32 v86, v56, v90
v_fmac_f32 v87, v56, v91
s_waitcnt vmcnt(5)
v_lshlrev_b32 v90, 16, v44
v_and_b32 v91, 0xffff0000, v44
v_fmac_f32 v80, v57, v90
v_fmac_f32 v81, v57, v91
v_lshlrev_b32 v90, 16, v45
v_and_b32 v91, 0xffff0000, v45
v_fmac_f32 v82, v57, v90
v_fmac_f32 v83, v57, v91
v_lshlrev_b32 v90, 16, v46
v_and_b32 v91, 0xffff0000, v46
v_fmac_f32 v84, v57, v90
v_fmac_f32 v85, v57, v91
v_lshlrev_b32 v90, 16, v47
v_and_b32 v91, 0xffff0000, v47
v_fmac_f32 v86, v57, v90
v_fmac_f32 v87, v57, v91
v_lshlrev_b32 v5, 5, v1
ds_write_b128 v5, v[80:83]
ds_write_b128 v5, v[84:87] offset:16
v_and_b32 v3, 31, v1
v_lshrrev_b32 v4, 5, v1
v_lshlrev_b32 v6, 2, v3
v_lshl_add_u32 v5, v4, 10, v6
s_waitcnt lgkmcnt(0)
s_barrier
ds_read_b32 v8, v5 offset:0
ds_read_b32 v9, v5 offset:128
ds_read_b32 v10, v5 offset:256
ds_read_b32 v11, v5 offset:384
ds_read_b32 v12, v5 offset:512
ds_read_b32 v13, v5 offset:640
ds_read_b32 v14, v5 offset:768
ds_read_b32 v15, v5 offset:896
s_waitcnt lgkmcnt(6)
v_add_f32 v8, v8, v9
s_waitcnt lgkmcnt(5)
v_add_f32 v8, v8, v10
s_waitcnt lgkmcnt(4)
v_add_f32 v8, v8, v11
s_waitcnt lgkmcnt(3)
v_add_f32 v8, v8, v12
s_waitcnt lgkmcnt(2)
v_add_f32 v8, v8, v13
s_waitcnt lgkmcnt(1)
v_add_f32 v8, v8, v14
s_waitcnt lgkmcnt(0)
v_add_f32 v8, v8, v15
v_lshlrev_b32 v5, 2, v1
ds_write_b32 v5, v8 offset:8192
s_waitcnt lgkmcnt(0)
s_barrier
ds_read_b32 v8, v6 offset:8192
ds_read_b32 v9, v6 offset:8320
ds_read_b32 v10, v6 offset:8448
ds_read_b32 v11, v6 offset:8576
ds_read_b32 v12, v6 offset:8704
ds_read_b32 v13, v6 offset:8832
ds_read_b32 v14, v6 offset:8960
ds_read_b32 v15, v6 offset:9088
s_waitcnt lgkmcnt(6)
v_add_f32 v8, v8, v9
s_waitcnt lgkmcnt(5)
v_add_f32 v8, v8, v10
s_waitcnt lgkmcnt(4)
v_add_f32 v8, v8, v11
s_waitcnt lgkmcnt(3)
v_add_f32 v8, v8, v12
s_waitcnt lgkmcnt(2)
v_add_f32 v8, v8, v13
s_waitcnt lgkmcnt(1)
v_add_f32 v8, v8, v14
s_waitcnt lgkmcnt(0)
v_add_f32 v8, v8, v15
v_cvt_pk_bf16_f32 v8, v8, v8
v_lshlrev_b32 v9, 16, v8
v_add_f32 v9, 1.0, v9
v_cvt_pk_bf16_f32 v9, v9, v9
s_sub_u32 s3, s32, 20
s_cmp_lt_u32 s3, 20
s_cselect_b64 s[30:31], -1, 0
s_sub_u32 s3, s32, 80
s_cmp_lt_u32 s3, 20
s_cselect_b64 s[30:31], -1, s[30:31]
v_cndmask_b32 v8, v8, v9, s[30:31]
v_lshlrev_b32 v3, 1, v3
s_add_u32 s35, s35, 32768
s_cmp_lg_u32 s26, 0
s_cbranch_scc1 L_pm_f
buffer_store_short v8, v3, s[4:7], s35 offen sc1
L_pm_f:
v_mov_b32 v95, 65536
s_waitcnt vmcnt(0)
s_cmp_lg_u32 s26, 0
s_cbranch_scc1 L_cenwp_f
v_mbcnt_lo_u32_b32 v94, -1, 0
v_mbcnt_hi_u32_b32 v94, -1, v94
v_and_b32 v94, 7, v94
v_mul_u32_u24 v94, 66, v94
v_and_b32 v94, 0xc8, v94
v_add_u32 v94, s76, v94
L_cenp_f:
global_load_dwordx2 v[92:93], v94, s[28:29] sc1
s_add_u32 s27, s27, 1
s_cmp_gt_u32 s27, 262144
s_cbranch_scc1 L_fail_f
s_waitcnt vmcnt(0)
v_cmp_eq_u32 s[30:31], -1, v92
v_cmp_eq_u32 vcc, 0x200000, v93
s_and_b64 s[30:31], s[30:31], vcc
v_lshrrev_b32 v93, 16, v93
s_nop 1
v_add_u32_dpp v93, v93, v93 row_ror:4 row_mask:0xf bank_mask:0xf
s_nop 1
v_add_u32_dpp v93, v93, v93 row_ror:2 row_mask:0xf bank_mask:0xf
s_nop 1
v_add_u32_dpp v93, v93, v93 row_ror:1 row_mask:0xf bank_mask:0xf
v_cmp_lt_u32 vcc, 255, v93
s_cbranch_vccnz L_cendp_f
s_sleep 12
s_branch L_cenp_f
L_cendp_f:
v_mov_b32 v92, s30
ds_write_b32 v95, v92
s_waitcnt lgkmcnt(0)
L_cenwp_f:
s_barrier
ds_read_b32 v92, v95
s_waitcnt lgkmcnt(0)
v_cmp_ne_u32 vcc, -1, v92
s_cbranch_vccnz L_next
s_cmp_eq_u32 s26, 0
s_cselect_b32 s3, s33, 0x40000000
v_mov_b32 v9, 1
buffer_store_dword v9, off, s[4:7], s3 sc1
v_lshlrev_b32 v8, 16, v60
v_and_b32 v9, 0xffff0000, v60
v_lshlrev_b32 v10, 16, v61
v_and_b32 v11, 0xffff0000, v61
v_lshlrev_b32 v12, 16, v62
v_and_b32 v13, 0xffff0000, v62
v_lshlrev_b32 v14, 16, v63
v_and_b32 v15, 0xffff0000, v63
v_lshlrev_b32 v16, 16, v64
v_and_b32 v17, 0xffff0000, v64
v_lshlrev_b32 v18, 16, v65
v_and_b32 v19, 0xffff0000, v65
v_lshlrev_b32 v20, 16, v66
v_and_b32 v21, 0xffff0000, v66
v_lshlrev_b32 v22, 16, v67
v_and_b32 v23, 0xffff0000, v67
v_lshlrev_b32 v24, 16, v68
v_and_b32 v25, 0xffff0000, v68
v_lshlrev_b32 v26, 16, v69
v_and_b32 v27, 0xffff0000, v69
v_lshlrev_b32 v28, 16, v70
v_and_b32 v29, 0xffff0000, v70
v_lshlrev_b32 v30, 16, v71
v_and_b32 v31, 0xffff0000, v71
v_lshlrev_b32 v32, 16, v72
v_and_b32 v33, 0xffff0000, v72
v_lshlrev_b32 v34, 16, v73
v_and_b32 v35, 0xffff0000, v73
v_lshlrev_b32 v36, 16, v74
v_and_b32 v37, 0xffff0000, v74
v_lshlrev_b32 v38, 16, v75
v_and_b32 v39, 0xffff0000, v75
v_lshlrev_b32 v40, 16, v76
v_and_b32 v41, 0xffff0000, v76
v_lshlrev_b32 v42, 16, v77
v_and_b32 v43, 0xffff0000, v77
v_lshlrev_b32 v44, 16, v78
v_and_b32 v45, 0xffff0000, v78
v_lshlrev_b32 v46, 16, v79
v_and_b32 v47, 0xffff0000, v79
v_add_f32 v90, v8, v9
v_add_f32 v90, v90, v10
v_add_f32 v90, v90, v11
v_add_f32 v90, v90, v12
v_add_f32 v90, v90, v13
v_add_f32 v90, v90, v14
v_add_f32 v90, v90, v15
v_add_f32 v90, v90, v16
v_add_f32 v90, v90, v17
v_add_f32 v90, v90, v18
v_add_f32 v90, v90, v19
v_add_f32 v90, v90, v20
v_add_f32 v90, v90, v21
v_add_f32 v90, v90, v22
v_add_f32 v90, v90, v23
v_add_f32 v90, v90, v24
v_add_f32 v90, v90, v25
v_add_f32 v90, v90, v26
v_add_f32 v90, v90, v27
v_add_f32 v90, v90, v28
v_add_f32 v90, v90, v29
v_add_f32 v90, v90, v30
v_add_f32 v90, v90, v31
v_add_f32 v90, v90, v32
v_add_f32 v90, v90, v33
v_add_f32 v90, v90, v34
v_add_f32 v90, v90, v35
v_add_f32 v90, v90, v36
v_add_f32 v90, v90, v37
v_add_f32 v90, v90, v38
v_add_f32 v90, v90, v39
v_add_f32 v90, v90, v40
v_add_f32 v90, v90, v41
v_add_f32 v90, v90, v42
v_add_f32 v90, v90, v43
v_add_f32 v90, v90, v44
v_add_f32 v90, v90, v45
v_add_f32 v90, v90, v46
v_add_f32 v90, v90, v47
s_nop 1
v_add_f32_dpp v90, v90, v90 row_ror:8 row_mask:0xf bank_mask:0xf
s_nop 1
v_add_f32_dpp v90, v90, v90 row_ror:4 row_mask:0xf bank_mask:0xf
s_nop 1
v_add_f32_dpp v90, v90, v90 row_ror:2 row_mask:0xf bank_mask:0xf
s_nop 1
v_add_f32_dpp v90, v90, v90 row_ror:1 row_mask:0xf bank_mask:0xf
v_mul_f32 v90, 986500301, v90
v_sub_f32 v8, v8, v90
v_sub_f32 v9, v9, v90
v_sub_f32 v10, v10, v90
v_sub_f32 v11, v11, v90
v_sub_f32 v12, v12, v90
v_sub_f32 v13, v13, v90
v_sub_f32 v14, v14, v90
v_sub_f32 v15, v15, v90
v_sub_f32 v16, v16, v90
v_sub_f32 v17, v17, v90
v_sub_f32 v18, v18, v90
v_sub_f32 v19, v19, v90
v_sub_f32 v20, v20, v90
v_sub_f32 v21, v21, v90
v_sub_f32 v22, v22, v90
v_sub_f32 v23, v23, v90
v_sub_f32 v24, v24, v90
v_sub_f32 v25, v25, v90
v_sub_f32 v26, v26, v90
v_sub_f32 v27, v27, v90
v_sub_f32 v28, v28, v90
v_sub_f32 v29, v29, v90
v_sub_f32 v30, v30, v90
v_sub_f32 v31, v31, v90
v_sub_f32 v32, v32, v90
v_sub_f32 v33, v33, v90
v_sub_f32 v34, v34, v90
v_sub_f32 v35, v35, v90
v_sub_f32 v36, v36, v90
v_sub_f32 v37, v37, v90
v_sub_f32 v38, v38, v90
v_sub_f32 v39, v39, v90
v_sub_f32 v40, v40, v90
v_sub_f32 v41, v41, v90
v_sub_f32 v42, v42, v90
v_sub_f32 v43, v43, v90
v_sub_f32 v44, v44, v90
v_sub_f32 v45, v45, v90
v_sub_f32 v46, v46, v90
v_sub_f32 v47, v47, v90
v_mul_f32 v91, v8, v8
v_fmac_f32 v91, v9, v9
v_fmac_f32 v91, v10, v10
v_fmac_f32 v91, v11, v11
v_fmac_f32 v91, v12, v12
v_fmac_f32 v91, v13, v13
v_fmac_f32 v91, v14, v14
v_fmac_f32 v91, v15, v15
v_fmac_f32 v91, v16, v16
v_fmac_f32 v91, v17, v17
v_fmac_f32 v91, v18, v18
v_fmac_f32 v91, v19, v19
v_fmac_f32 v91, v20, v20
v_fmac_f32 v91, v21, v21
v_fmac_f32 v91, v22, v22
v_fmac_f32 v91, v23, v23
v_fmac_f32 v91, v24, v24
v_fmac_f32 v91, v25, v25
v_fmac_f32 v91, v26, v26
v_fmac_f32 v91, v27, v27
v_fmac_f32 v91, v28, v28
v_fmac_f32 v91, v29, v29
v_fmac_f32 v91, v30, v30
v_fmac_f32 v91, v31, v31
v_fmac_f32 v91, v32, v32
v_fmac_f32 v91, v33, v33
v_fmac_f32 v91, v34, v34
v_fmac_f32 v91, v35, v35
v_fmac_f32 v91, v36, v36
v_fmac_f32 v91, v37, v37
v_fmac_f32 v91, v38, v38
v_fmac_f32 v91, v39, v39
v_fmac_f32 v91, v40, v40
v_fmac_f32 v91, v41, v41
v_fmac_f32 v91, v42, v42
v_fmac_f32 v91, v43, v43
v_fmac_f32 v91, v44, v44
v_fmac_f32 v91, v45, v45
v_fmac_f32 v91, v46, v46
v_fmac_f32 v91, v47, v47
s_nop 1
v_add_f32_dpp v91, v91, v91 row_ror:8 row_mask:0xf bank_mask:0xf
s_nop 1
v_add_f32_dpp v91, v91, v91 row_ror:4 row_mask:0xf bank_mask:0xf
s_nop 1
v_add_f32_dpp v91, v91, v91 row_ror:2 row_mask:0xf bank_mask:0xf
s_nop 1
v_add_f32_dpp v91, v91, v91 row_ror:1 row_mask:0xf bank_mask:0xf
v_mov_b32 v90, 925353388
v_fmac_f32 v90, 986500301, v91
v_rsq_f32 v90, v90
s_nop 0
v_mul_f32 v8, v8, v90
v_mul_f32 v9, v9, v90
v_mul_f32 v10, v10, v90
v_mul_f32 v11, v11, v90
v_mul_f32 v12, v12, v90
v_mul_f32 v13, v13, v90
v_mul_f32 v14, v14, v90
v_mul_f32 v15, v15, v90
v_mul_f32 v16, v16, v90
v_mul_f32 v17, v17, v90
v_mul_f32 v18, v18, v90
v_mul_f32 v19, v19, v90
v_mul_f32 v20, v20, v90
v_mul_f32 v21, v21, v90
v_mul_f32 v22, v22, v90
v_mul_f32 v23, v23, v90
v_mul_f32 v24, v24, v90
v_mul_f32 v25, v25, v90
v_mul_f32 v26, v26, v90
v_mul_f32 v27, v27, v90
v_mul_f32 v28, v28, v90
v_mul_f32 v29, v29, v90
v_mul_f32 v30, v30, v90
v_mul_f32 v31, v31, v90
v_mul_f32 v32, v32, v90
v_mul_f32 v33, v33, v90
v_mul_f32 v34, v34, v90
v_mul_f32 v35, v35, v90
v_mul_f32 v36, v36, v90
v_mul_f32 v37, v37, v90
v_mul_f32 v38, v38, v90
v_mul_f32 v39, v39, v90
v_mul_f32 v40, v40, v90
v_mul_f32 v41, v41, v90
v_mul_f32 v42, v42, v90
v_mul_f32 v43, v43, v90
v_mul_f32 v44, v44, v90
v_mul_f32 v45, v45, v90
v_mul_f32 v46, v46, v90
v_mul_f32 v47, v47, v90
s_cmp_lg_u32 s26, 1
s_cbranch_scc1 L_pmw_f
v_min_u32 v92, 39, v0
v_lshlrev_b32 v92, 2, v92
s_mov_b32 s37, 8192
L_pmod_f:
buffer_load_dword v93, v92, s[4:7], s37 offen offset:0 sc1
s_add_u32 s27, s27, 1
s_cmp_gt_u32 s27, 262144
s_cbranch_scc1 L_fail_f
s_waitcnt vmcnt(0)
v_cmp_gt_u32 vcc, 1, v93
s_cbranch_vccz L_pmod_fok
s_sleep 2
s_branch L_pmod_f
L_pmod_fok:
v_lshlrev_b32 v92, 4, v0
s_mov_b32 s37, 32768
s_mov_b32 m0, 12288
s_nop 0
buffer_load_dwordx4 v92, s[4:7], s37 offen offset:0 sc1 lds
buffer_load_dwordx4 v92, s[4:7], s37 offen offset:1024 sc1 lds
buffer_load_dwordx4 v92, s[4:7], s37 offen offset:2048 sc1 lds
s_waitcnt vmcnt(0)
L_pmw_f:
v_lshlrev_b32 v5, 4, v2
s_barrier
ds_read_b128 v[48:51], v5 offset:12288
ds_read_b128 v[68:71], v5 offset:13568
ds_read_b128 v[52:55], v5 offset:12544
ds_read_b128 v[72:75], v5 offset:13824
ds_read_b128 v[56:59], v5 offset:12800
ds_read_b128 v[76:79], v5 offset:14080
ds_read_b128 v[60:63], v5 offset:13056
ds_read_b128 v[80:83], v5 offset:14336
ds_read_b128 v[64:67], v5 offset:13312
ds_read_b128 v[84:87], v5 offset:14592
v_xor_b32 v6, v7, v2
v_lshlrev_b32 v5, 8, v2
v_lshl_add_u32 v5, v6, 4, v5
s_waitcnt lgkmcnt(9)
v_lshlrev_b32 v90, 16, v48
v_and_b32 v91, 0xffff0000, v48
s_waitcnt lgkmcnt(8)
v_lshlrev_b32 v92, 16, v68
v_and_b32 v93, 0xffff0000, v68
v_fmac_f32 v90, v8, v92
v_fmac_f32 v91, v9, v93
v_cvt_pk_bf16_f32 v48, v90, v91
v_lshlrev_b32 v90, 16, v49
v_and_b32 v91, 0xffff0000, v49
v_lshlrev_b32 v92, 16, v69
v_and_b32 v93, 0xffff0000, v69
v_fmac_f32 v90, v10, v92
v_fmac_f32 v91, v11, v93
v_cvt_pk_bf16_f32 v49, v90, v91
v_lshlrev_b32 v90, 16, v50
v_and_b32 v91, 0xffff0000, v50
v_lshlrev_b32 v92, 16, v70
v_and_b32 v93, 0xffff0000, v70
v_fmac_f32 v90, v12, v92
v_fmac_f32 v91, v13, v93
v_cvt_pk_bf16_f32 v50, v90, v91
v_lshlrev_b32 v90, 16, v51
v_and_b32 v91, 0xffff0000, v51
v_lshlrev_b32 v92, 16, v71
v_and_b32 v93, 0xffff0000, v71
v_fmac_f32 v90, v14, v92
v_fmac_f32 v91, v15, v93
v_cvt_pk_bf16_f32 v51, v90, v91
ds_write_b128 v5, v[48:51] offset:16384
s_waitcnt lgkmcnt(8)
v_lshlrev_b32 v90, 16, v52
v_and_b32 v91, 0xffff0000, v52
s_waitcnt lgkmcnt(7)
v_lshlrev_b32 v92, 16, v72
v_and_b32 v93, 0xffff0000, v72
v_fmac_f32 v90, v16, v92
v_fmac_f32 v91, v17, v93
v_cvt_pk_bf16_f32 v52, v90, v91
v_lshlrev_b32 v90, 16, v53
v_and_b32 v91, 0xffff0000, v53
v_lshlrev_b32 v92, 16, v73
v_and_b32 v93, 0xffff0000, v73
v_fmac_f32 v90, v18, v92
v_fmac_f32 v91, v19, v93
v_cvt_pk_bf16_f32 v53, v90, v91
v_lshlrev_b32 v90, 16, v54
v_and_b32 v91, 0xffff0000, v54
v_lshlrev_b32 v92, 16, v74
v_and_b32 v93, 0xffff0000, v74
v_fmac_f32 v90, v20, v92
v_fmac_f32 v91, v21, v93
v_cvt_pk_bf16_f32 v54, v90, v91
v_lshlrev_b32 v90, 16, v55
v_and_b32 v91, 0xffff0000, v55
v_lshlrev_b32 v92, 16, v75
v_and_b32 v93, 0xffff0000, v75
v_fmac_f32 v90, v22, v92
v_fmac_f32 v91, v23, v93
v_cvt_pk_bf16_f32 v55, v90, v91
ds_write_b128 v5, v[52:55] offset:20480
s_waitcnt lgkmcnt(7)
v_lshlrev_b32 v90, 16, v56
v_and_b32 v91, 0xffff0000, v56
s_waitcnt lgkmcnt(6)
v_lshlrev_b32 v92, 16, v76
v_and_b32 v93, 0xffff0000, v76
v_fmac_f32 v90, v24, v92
v_fmac_f32 v91, v25, v93
v_cvt_pk_bf16_f32 v56, v90, v91
v_lshlrev_b32 v90, 16, v57
v_and_b32 v91, 0xffff0000, v57
v_lshlrev_b32 v92, 16, v77
v_and_b32 v93, 0xffff0000, v77
v_fmac_f32 v90, v26, v92
v_fmac_f32 v91, v27, v93
v_cvt_pk_bf16_f32 v57, v90, v91
v_lshlrev_b32 v90, 16, v58
v_and_b32 v91, 0xffff0000, v58
v_lshlrev_b32 v92, 16, v78
v_and_b32 v93, 0xffff0000, v78
v_fmac_f32 v90, v28, v92
v_fmac_f32 v91, v29, v93
v_cvt_pk_bf16_f32 v58, v90, v91
v_lshlrev_b32 v90, 16, v59
v_and_b32 v91, 0xffff0000, v59
v_lshlrev_b32 v92, 16, v79
v_and_b32 v93, 0xffff0000, v79
v_fmac_f32 v90, v30, v92
v_fmac_f32 v91, v31, v93
v_cvt_pk_bf16_f32 v59, v90, v91
ds_write_b128 v5, v[56:59] offset:24576
s_waitcnt lgkmcnt(6)
v_lshlrev_b32 v90, 16, v60
v_and_b32 v91, 0xffff0000, v60
s_waitcnt lgkmcnt(5)
v_lshlrev_b32 v92, 16, v80
v_and_b32 v93, 0xffff0000, v80
v_fmac_f32 v90, v32, v92
v_fmac_f32 v91, v33, v93
v_cvt_pk_bf16_f32 v60, v90, v91
v_lshlrev_b32 v90, 16, v61
v_and_b32 v91, 0xffff0000, v61
v_lshlrev_b32 v92, 16, v81
v_and_b32 v93, 0xffff0000, v81
v_fmac_f32 v90, v34, v92
v_fmac_f32 v91, v35, v93
v_cvt_pk_bf16_f32 v61, v90, v91
v_lshlrev_b32 v90, 16, v62
v_and_b32 v91, 0xffff0000, v62
v_lshlrev_b32 v92, 16, v82
v_and_b32 v93, 0xffff0000, v82
v_fmac_f32 v90, v36, v92
v_fmac_f32 v91, v37, v93
v_cvt_pk_bf16_f32 v62, v90, v91
v_lshlrev_b32 v90, 16, v63
v_and_b32 v91, 0xffff0000, v63
v_lshlrev_b32 v92, 16, v83
v_and_b32 v93, 0xffff0000, v83
v_fmac_f32 v90, v38, v92
v_fmac_f32 v91, v39, v93
v_cvt_pk_bf16_f32 v63, v90, v91
ds_write_b128 v5, v[60:63] offset:28672
s_waitcnt lgkmcnt(5)
v_lshlrev_b32 v90, 16, v64
v_and_b32 v91, 0xffff0000, v64
s_waitcnt lgkmcnt(4)
v_lshlrev_b32 v92, 16, v84
v_and_b32 v93, 0xffff0000, v84
v_fmac_f32 v90, v40, v92
v_fmac_f32 v91, v41, v93
v_cvt_pk_bf16_f32 v64, v90, v91
v_lshlrev_b32 v90, 16, v65
v_and_b32 v91, 0xffff0000, v65
v_lshlrev_b32 v92, 16, v85
v_and_b32 v93, 0xffff0000, v85
v_fmac_f32 v90, v42, v92
v_fmac_f32 v91, v43, v93
v_cvt_pk_bf16_f32 v65, v90, v91
v_lshlrev_b32 v90, 16, v66
v_and_b32 v91, 0xffff0000, v66
v_lshlrev_b32 v92, 16, v86
v_and_b32 v93, 0xffff0000, v86
v_fmac_f32 v90, v44, v92
v_fmac_f32 v91, v45, v93
v_cvt_pk_bf16_f32 v66, v90, v91
v_lshlrev_b32 v90, 16, v67
v_and_b32 v91, 0xffff0000, v67
v_lshlrev_b32 v92, 16, v87
v_and_b32 v93, 0xffff0000, v87
v_fmac_f32 v90, v46, v92
v_fmac_f32 v91, v47, v93
v_cvt_pk_bf16_f32 v67, v90, v91
ds_write_b128 v5, v[64:67] offset:32768
s_mul_i32 s3, s26, 5120
v_lshlrev_b32 v5, 4, v0
v_add_u32 v5, s3, v5
s_mul_i32 s30, s32, 20480
s_add_u32 s30, s30, 6291456
v_add_u32 v30, 0, v5
v_lshrrev_b32 v6, 4, v30
v_and_b32 v6, 0xf0, v6
v_xor_b32 v30, v30, v6
v_add_u32 v31, 1024, v5
v_lshrrev_b32 v6, 4, v31
v_and_b32 v6, 0xf0, v6
v_xor_b32 v31, v31, v6
v_add_u32 v32, 2048, v5
v_lshrrev_b32 v6, 4, v32
v_and_b32 v6, 0xf0, v6
v_xor_b32 v32, v32, v6
v_add_u32 v33, 3072, v5
v_lshrrev_b32 v6, 4, v33
v_and_b32 v6, 0xf0, v6
v_xor_b32 v33, v33, v6
v_add_u32 v34, 4096, v5
v_lshrrev_b32 v6, 4, v34
v_and_b32 v6, 0xf0, v6
v_xor_b32 v34, v34, v6
s_waitcnt lgkmcnt(0)
s_barrier
ds_read_b128 v[8:11], v30 offset:16384
ds_read_b128 v[12:15], v31 offset:16384
ds_read_b128 v[16:19], v32 offset:16384
ds_read_b128 v[20:23], v33 offset:16384
ds_read_b128 v[24:27], v34 offset:16384
s_add_u32 s3, s30, 0
s_waitcnt lgkmcnt(4)
buffer_store_dwordx4 v[8:11], v5, s[4:7], s3 offen sc1
s_add_u32 s3, s30, 1024
s_waitcnt lgkmcnt(3)
buffer_store_dwordx4 v[12:15], v5, s[4:7], s3 offen sc1
s_add_u32 s3, s30, 2048
s_waitcnt lgkmcnt(2)
buffer_store_dwordx4 v[16:19], v5, s[4:7], s3 offen sc1
s_add_u32 s3, s30, 3072
s_waitcnt lgkmcnt(1)
buffer_store_dwordx4 v[20:23], v5, s[4:7], s3 offen sc1
s_add_u32 s3, s30, 4096
s_waitcnt lgkmcnt(0)
buffer_store_dwordx4 v[24:27], v5, s[4:7], s3 offen sc1
s_waitcnt vmcnt(0)
s_barrier
v_mov_b32 v9, 1
s_cmp_lg_u32 s26, 0
s_cbranch_scc1 L_ph_f
buffer_store_dword v9, off, s[4:7], s34 sc1
L_ph_f:
s_waitcnt vmcnt(0) lgkmcnt(0)
s_mov_b32 s8, s74
s_mov_b32 s9, s75
s_mov_b32 s10, 5242880
s_mov_b32 s11, 0x20000
s_mov_b32 s12, s84
s_mov_b32 s13, s85
s_mov_b32 s14, 2211840
s_mov_b32 s15, 0x20000
s_mov_b32 s16, s80
s_mov_b32 s17, s81
s_mov_b32 s18, 2211840
s_mov_b32 s19, 0x20000
s_cmp_lt_u32 s26, 2
s_cbranch_scc1 L_pgate_f
s_mov_b32 s16, s82
s_mov_b32 s17, s83
L_pgate_f:
s_lshl_b32 s53, s26, 10
v_lshrrev_b32 v8, 4, v0
v_and_b32 v9, 15, v0
v_mul_u32_u24 v1, 1280, v8
v_lshl_add_u32 v1, v9, 4, v1
v_lshrrev_b32 v10, 3, v0
v_and_b32 v11, 7, v0
v_mul_u32_u24 v2, 3456, v10
v_lshl_add_u32 v2, v11, 4, v2
v_bfe_u32 v10, v0, 1, 1
v_and_b32 v11, 1, v0
v_lshlrev_b32 v12, 4, v11
v_lshl_add_u32 v12, v10, 3, v12
v_lshrrev_b32 v10, 5, v0
v_bfe_u32 v8, v0, 2, 2
v_lshl_add_u32 v8, v10, 3, v8
v_bfe_u32 v11, v0, 4, 1
v_lshl_add_u32 v3, v8, 8, v12
v_lshl_add_u32 v3, v11, 5, v3
s_lshl_b32 s3, s26, 6
v_add_u32 v3, s3, v3
v_lshl_add_u32 v4, v8, 7, v12
v_lshl_add_u32 v4, v11, 11, v4
s_lshl_b32 s3, s26, 5
v_add_u32 v4, s3, v4
s_mul_i32 s31, s26, 5120
s_mul_i32 s3, s25, 163840
s_add_u32 s34, s3, s31
s_mul_i32 s3, s25, 81920
s_add_u32 s36, s3, s31
s_lshl_b32 s3, s25, 7
s_and_b32 s37, s26, 1
s_mul_i32 s37, s37, 27648
s_add_u32 s37, s37, s3
s_cmp_lt_u32 s25, 27
s_cselect_b32 s37, s37, 0x40000000
s_cmp_lt_u32 s24, 6
s_cselect_b64 vcc, -1, 0
s_add_u32 m0, s53, 0
s_add_u32 s3, s34, 0
buffer_load_dwordx4 v1, s[8:11], s3 offen lds
s_add_u32 m0, s53, 4096
s_add_u32 s3, s34, 20480
buffer_load_dwordx4 v1, s[8:11], s3 offen lds
s_cbranch_vccnz L_pth1_f
s_waitcnt vmcnt(1)
L_pth1_f:
s_add_u32 m0, s53, 8192
s_add_u32 s3, s34, 40960
buffer_load_dwordx4 v1, s[8:11], s3 offen lds
s_add_u32 m0, s53, 12288
s_add_u32 s3, s34, 61440
buffer_load_dwordx4 v1, s[8:11], s3 offen lds
s_cbranch_vccnz L_pth3_f
s_waitcnt vmcnt(1)
L_pth3_f:
s_add_u32 m0, s53, 16384
s_add_u32 s3, s34, 81920
buffer_load_dwordx4 v1, s[8:11], s3 offen lds
s_add_u32 m0, s53, 20480
s_add_u32 s3, s34, 102400
buffer_load_dwordx4 v1, s[8:11], s3 offen lds
s_cbranch_vccnz L_pth5_f
s_waitcnt vmcnt(1)
L_pth5_f:
s_add_u32 m0, s53, 24576
s_add_u32 s3, s34, 122880
buffer_load_dwordx4 v1, s[8:11], s3 offen lds
s_add_u32 m0, s53, 28672
s_add_u32 s3, s34, 143360
buffer_load_dwordx4 v1, s[8:11], s3 offen lds
s_cbranch_vccnz L_pth7_f
s_waitcnt vmcnt(1)
L_pth7_f:
s_add_u32 m0, s53, 32768
s_add_u32 s3, s34, 256
buffer_load_dwordx4 v1, s[8:11], s3 offen lds
s_add_u32 m0, s53, 36864
s_add_u32 s3, s34, 20736
buffer_load_dwordx4 v1, s[8:11], s3 offen lds
s_cbranch_vccnz L_pth9_f
s_waitcnt vmcnt(1)
L_pth9_f:
s_add_u32 m0, s53, 40960
s_add_u32 s3, s34, 41216
buffer_load_dwordx4 v1, s[8:11], s3 offen lds
s_add_u32 m0, s53, 45056
s_add_u32 s3, s34, 61696
buffer_load_dwordx4 v1, s[8:11], s3 offen lds
s_cbranch_vccnz L_pth11_f
s_waitcnt vmcnt(1)
L_pth11_f:
s_add_u32 m0, s53, 49152
s_add_u32 s3, s34, 82176
buffer_load_dwordx4 v1, s[8:11], s3 offen lds
s_add_u32 m0, s53, 53248
s_add_u32 s3, s34, 102656
buffer_load_dwordx4 v1, s[8:11], s3 offen lds
s_cbranch_vccnz L_pth13_f
s_waitcnt vmcnt(1)
L_pth13_f:
s_add_u32 m0, s53, 57344
s_add_u32 s3, s34, 123136
buffer_load_dwordx4 v1, s[8:11], s3 offen lds
s_add_u32 m0, s53, 61440
s_add_u32 s3, s34, 143616
buffer_load_dwordx4 v1, s[8:11], s3 offen lds
s_cbranch_vccnz L_pth15_f
s_waitcnt vmcnt(1)
L_pth15_f:
v_add_u32 v5, 0, v3
s_waitcnt vmcnt(12)
s_barrier
ds_read_b64_tr_b16 v[112:113], v5 offset:0
ds_read_b64_tr_b16 v[114:115], v5 offset:1024
ds_read_b64_tr_b16 v[116:117], v5 offset:4096
ds_read_b64_tr_b16 v[118:119], v5 offset:5120
ds_read_b64_tr_b16 v[120:121], v5 offset:8192
ds_read_b64_tr_b16 v[122:123], v5 offset:9216
ds_read_b64_tr_b16 v[124:125], v5 offset:12288
ds_read_b64_tr_b16 v[126:127], v5 offset:13312
s_add_u32 m0, s53, 65536
s_add_u32 s3, s34, 512
buffer_load_dwordx4 v1, s[8:11], s3 offen lds
s_add_u32 m0, s53, 69632
s_add_u32 s3, s34, 20992
buffer_load_dwordx4 v1, s[8:11], s3 offen lds
s_cbranch_vccnz L_pth17_f
s_waitcnt vmcnt(1)
L_pth17_f:
s_add_u32 m0, s53, 73728
s_add_u32 s3, s34, 41472
buffer_load_dwordx4 v1, s[8:11], s3 offen lds
s_add_u32 m0, s53, 77824
s_add_u32 s3, s34, 61952
buffer_load_dwordx4 v1, s[8:11], s3 offen lds
s_cbranch_vccnz L_pth19_f
s_waitcnt vmcnt(1)
L_pth19_f:
v_add_u32 v5, 16384, v3
s_waitcnt vmcnt(12)
s_waitcnt lgkmcnt(0)
s_barrier
ds_read_b64_tr_b16 v[128:129], v5 offset:0
ds_read_b64_tr_b16 v[130:131], v5 offset:1024
ds_read_b64_tr_b16 v[132:133], v5 offset:4096
ds_read_b64_tr_b16 v[134:135], v5 offset:5120
ds_read_b64_tr_b16 v[136:137], v5 offset:8192
ds_read_b64_tr_b16 v[138:139], v5 offset:9216
ds_read_b64_tr_b16 v[140:141], v5 offset:12288
ds_read_b64_tr_b16 v[142:143], v5 offset:13312
s_add_u32 m0, s53, 81920
s_add_u32 s3, s34, 82432
buffer_load_dwordx4 v1, s[8:11], s3 offen lds
s_add_u32 m0, s53, 86016
s_add_u32 s3, s34, 102912
buffer_load_dwordx4 v1, s[8:11], s3 offen lds
s_cbranch_vccnz L_pth21_f
s_waitcnt vmcnt(1)
L_pth21_f:
s_add_u32 m0, s53, 90112
s_add_u32 s3, s34, 123392
buffer_load_dwordx4 v1, s[8:11], s3 offen lds
s_add_u32 m0, s53, 94208
s_add_u32 s3, s34, 143872
buffer_load_dwordx4 v1, s[8:11], s3 offen lds
s_cbranch_vccnz L_pth23_f
s_waitcnt vmcnt(1)
L_pth23_f:
v_add_u32 v5, 32768, v3
s_waitcnt vmcnt(12)
s_waitcnt lgkmcnt(0)
s_barrier
ds_read_b64_tr_b16 v[144:145], v5 offset:0
ds_read_b64_tr_b16 v[146:147], v5 offset:1024
ds_read_b64_tr_b16 v[148:149], v5 offset:4096
ds_read_b64_tr_b16 v[150:151], v5 offset:5120
ds_read_b64_tr_b16 v[152:153], v5 offset:8192
ds_read_b64_tr_b16 v[154:155], v5 offset:9216
ds_read_b64_tr_b16 v[156:157], v5 offset:12288
ds_read_b64_tr_b16 v[158:159], v5 offset:13312
s_add_u32 m0, s53, 98304
s_add_u32 s3, s34, 768
buffer_load_dwordx4 v1, s[8:11], s3 offen lds
s_add_u32 m0, s53, 102400
s_add_u32 s3, s34, 21248
buffer_load_dwordx4 v1, s[8:11], s3 offen lds
s_cbranch_vccnz L_pth25_f
s_waitcnt vmcnt(1)
L_pth25_f:
s_add_u32 m0, s53, 106496
s_add_u32 s3, s34, 41728
buffer_load_dwordx4 v1, s[8:11], s3 offen lds
s_add_u32 m0, s53, 110592
s_add_u32 s3, s34, 62208
buffer_load_dwordx4 v1, s[8:11], s3 offen lds
s_cbranch_vccnz L_pth27_f
s_waitcnt vmcnt(1)
L_pth27_f:
v_add_u32 v5, 49152, v3
s_waitcnt vmcnt(12)
s_waitcnt lgkmcnt(0)
s_barrier
ds_read_b64_tr_b16 v[160:161], v5 offset:0
ds_read_b64_tr_b16 v[162:163], v5 offset:1024
ds_read_b64_tr_b16 v[164:165], v5 offset:4096
ds_read_b64_tr_b16 v[166:167], v5 offset:5120
ds_read_b64_tr_b16 v[168:169], v5 offset:8192
ds_read_b64_tr_b16 v[170:171], v5 offset:9216
ds_read_b64_tr_b16 v[172:173], v5 offset:12288
ds_read_b64_tr_b16 v[174:175], v5 offset:13312
s_add_u32 m0, s53, 114688
s_add_u32 s3, s34, 82688
buffer_load_dwordx4 v1, s[8:11], s3 offen lds
s_add_u32 m0, s53, 118784
s_add_u32 s3, s34, 103168
buffer_load_dwordx4 v1, s[8:11], s3 offen lds
s_cbranch_vccnz L_pth29_f
s_waitcnt vmcnt(1)
L_pth29_f:
s_add_u32 m0, s53, 122880
s_add_u32 s3, s34, 123648
buffer_load_dwordx4 v1, s[8:11], s3 offen lds
s_add_u32 m0, s53, 126976
s_add_u32 s3, s34, 144128
buffer_load_dwordx4 v1, s[8:11], s3 offen lds
s_cbranch_vccnz L_pth31_f
s_waitcnt vmcnt(1)
L_pth31_f:
v_add_u32 v5, 65536, v3
s_waitcnt vmcnt(12)
s_waitcnt lgkmcnt(0)
s_barrier
ds_read_b64_tr_b16 v[176:177], v5 offset:0
ds_read_b64_tr_b16 v[178:179], v5 offset:1024
ds_read_b64_tr_b16 v[180:181], v5 offset:4096
ds_read_b64_tr_b16 v[182:183], v5 offset:5120
ds_read_b64_tr_b16 v[184:185], v5 offset:8192
ds_read_b64_tr_b16 v[186:187], v5 offset:9216
ds_read_b64_tr_b16 v[188:189], v5 offset:12288
ds_read_b64_tr_b16 v[190:191], v5 offset:13312
s_add_u32 m0, s53, 131072
s_add_u32 s3, s34, 1024
buffer_load_dwordx4 v1, s[8:11], s3 offen lds
s_add_u32 m0, s53, 135168
s_add_u32 s3, s34, 21504
buffer_load_dwordx4 v1, s[8:11], s3 offen lds
s_cbranch_vccnz L_pth33_f
s_waitcnt vmcnt(1)
L_pth33_f:
s_add_u32 m0, s53, 139264
s_add_u32 s3, s34, 41984
buffer_load_dwordx4 v1, s[8:11], s3 offen lds
s_add_u32 m0, s53, 143360
s_add_u32 s3, s34, 62464
buffer_load_dwordx4 v1, s[8:11], s3 offen lds
s_cbranch_vccnz L_pth35_f
s_waitcnt vmcnt(1)
L_pth35_f:
v_add_u32 v5, 81920, v3
s_waitcnt vmcnt(12)
s_waitcnt lgkmcnt(0)
s_barrier
ds_read_b64_tr_b16 v[192:193], v5 offset:0
ds_read_b64_tr_b16 v[194:195], v5 offset:1024
ds_read_b64_tr_b16 v[196:197], v5 offset:4096
ds_read_b64_tr_b16 v[198:199], v5 offset:5120
ds_read_b64_tr_b16 v[200:201], v5 offset:8192
ds_read_b64_tr_b16 v[202:203], v5 offset:9216
ds_read_b64_tr_b16 v[204:205], v5 offset:12288
ds_read_b64_tr_b16 v[206:207], v5 offset:13312
s_add_u32 m0, s53, 147456
s_add_u32 s3, s34, 82944
buffer_load_dwordx4 v1, s[8:11], s3 offen lds
s_add_u32 m0, s53, 151552
s_add_u32 s3, s34, 103424
buffer_load_dwordx4 v1, s[8:11], s3 offen lds
s_cbranch_vccnz L_pth37_f
s_waitcnt vmcnt(1)
L_pth37_f:
s_add_u32 m0, s53, 155648
s_add_u32 s3, s34, 123904
buffer_load_dwordx4 v1, s[8:11], s3 offen lds
s_add_u32 m0, s53, 159744
s_add_u32 s3, s34, 144384
buffer_load_dwordx4 v1, s[8:11], s3 offen lds
s_cbranch_vccnz L_pth39_f
s_waitcnt vmcnt(1)
L_pth39_f:
v_add_u32 v5, 98304, v3
s_waitcnt vmcnt(12)
s_waitcnt lgkmcnt(0)
s_barrier
ds_read_b64_tr_b16 v[208:209], v5 offset:0
ds_read_b64_tr_b16 v[210:211], v5 offset:1024
ds_read_b64_tr_b16 v[212:213], v5 offset:4096
ds_read_b64_tr_b16 v[214:215], v5 offset:5120
ds_read_b64_tr_b16 v[216:217], v5 offset:8192
ds_read_b64_tr_b16 v[218:219], v5 offset:9216
ds_read_b64_tr_b16 v[220:221], v5 offset:12288
ds_read_b64_tr_b16 v[222:223], v5 offset:13312
s_add_u32 m0, s53, 0
s_add_u32 s3, s37, 0
buffer_load_dwordx4 v2, s[16:19], s3 offen lds
s_add_u32 m0, s53, 4096
s_add_u32 s3, s37, 55296
buffer_load_dwordx4 v2, s[16:19], s3 offen lds
s_cbranch_vccnz L_pth41_f
s_waitcnt vmcnt(1)
L_pth41_f:
s_add_u32 m0, s53, 8192
s_add_u32 s3, s37, 110592
buffer_load_dwordx4 v2, s[16:19], s3 offen lds
s_add_u32 m0, s53, 12288
s_add_u32 s3, s37, 165888
buffer_load_dwordx4 v2, s[16:19], s3 offen lds
s_cbranch_vccnz L_pth43_f
s_waitcnt vmcnt(1)
L_pth43_f:
v_add_u32 v5, 114688, v3
s_waitcnt vmcnt(12)
s_waitcnt lgkmcnt(0)
s_barrier
ds_read_b64_tr_b16 v[224:225], v5 offset:0
ds_read_b64_tr_b16 v[226:227], v5 offset:1024
ds_read_b64_tr_b16 v[228:229], v5 offset:4096
ds_read_b64_tr_b16 v[230:231], v5 offset:5120
ds_read_b64_tr_b16 v[232:233], v5 offset:8192
ds_read_b64_tr_b16 v[234:235], v5 offset:9216
ds_read_b64_tr_b16 v[236:237], v5 offset:12288
ds_read_b64_tr_b16 v[238:239], v5 offset:13312
s_add_u32 m0, s53, 16384
s_add_u32 s3, s37, 221184
buffer_load_dwordx4 v2, s[16:19], s3 offen lds
s_add_u32 m0, s53, 20480
s_add_u32 s3, s37, 276480
buffer_load_dwordx4 v2, s[16:19], s3 offen lds
s_cbranch_vccnz L_pth45_f
s_waitcnt vmcnt(1)
L_pth45_f:
s_add_u32 m0, s53, 24576
s_add_u32 s3, s37, 331776
buffer_load_dwordx4 v2, s[16:19], s3 offen lds
s_add_u32 m0, s53, 28672
s_add_u32 s3, s37, 387072
buffer_load_dwordx4 v2, s[16:19], s3 offen lds
s_cbranch_vccnz L_pth47_f
s_waitcnt vmcnt(1)
L_pth47_f:
v_add_u32 v5, 131072, v3
s_waitcnt vmcnt(12)
s_waitcnt lgkmcnt(0)
s_barrier
ds_read_b64_tr_b16 v[240:241], v5 offset:0
ds_read_b64_tr_b16 v[242:243], v5 offset:1024
ds_read_b64_tr_b16 v[244:245], v5 offset:4096
ds_read_b64_tr_b16 v[246:247], v5 offset:5120
ds_read_b64_tr_b16 v[248:249], v5 offset:8192
ds_read_b64_tr_b16 v[250:251], v5 offset:9216
ds_read_b64_tr_b16 v[252:253], v5 offset:12288
ds_read_b64_tr_b16 v[254:255], v5 offset:13312
s_add_u32 m0, s53, 32768
s_add_u32 s3, s37, 442368
buffer_load_dwordx4 v2, s[16:19], s3 offen lds
s_add_u32 m0, s53, 36864
s_add_u32 s3, s37, 497664
buffer_load_dwordx4 v2, s[16:19], s3 offen lds
s_cbranch_vccnz L_pth49_f
s_waitcnt vmcnt(1)
L_pth49_f:
s_add_u32 m0, s53, 40960
s_add_u32 s3, s37, 552960
buffer_load_dwordx4 v2, s[16:19], s3 offen lds
s_add_u32 m0, s53, 45056
s_add_u32 s3, s37, 608256
buffer_load_dwordx4 v2, s[16:19], s3 offen lds
s_cbranch_vccnz L_pth51_f
s_waitcnt vmcnt(1)
L_pth51_f:
v_add_u32 v5, 147456, v3
s_waitcnt vmcnt(12)
s_waitcnt lgkmcnt(0)
s_barrier
ds_read_b64_tr_b16 a[0:1], v5 offset:0
ds_read_b64_tr_b16 a[2:3], v5 offset:1024
ds_read_b64_tr_b16 a[4:5], v5 offset:4096
ds_read_b64_tr_b16 a[6:7], v5 offset:5120
ds_read_b64_tr_b16 a[8:9], v5 offset:8192
ds_read_b64_tr_b16 a[10:11], v5 offset:9216
ds_read_b64_tr_b16 a[12:13], v5 offset:12288
ds_read_b64_tr_b16 a[14:15], v5 offset:13312
s_add_u32 m0, s53, 49152
s_add_u32 s3, s37, 663552
buffer_load_dwordx4 v2, s[16:19], s3 offen lds
s_add_u32 m0, s53, 53248
s_add_u32 s3, s37, 718848
buffer_load_dwordx4 v2, s[16:19], s3 offen lds
s_cbranch_vccnz L_pth53_f
s_waitcnt vmcnt(1)
L_pth53_f:
s_add_u32 m0, s53, 57344
s_add_u32 s3, s37, 774144
buffer_load_dwordx4 v2, s[16:19], s3 offen lds
s_add_u32 m0, s53, 61440
s_add_u32 s3, s37, 829440
buffer_load_dwordx4 v2, s[16:19], s3 offen lds
s_cbranch_vccnz L_pth55_f
s_waitcnt vmcnt(1)
L_pth55_f:
v_add_u32 v5, 0, v4
s_waitcnt vmcnt(12)
s_waitcnt lgkmcnt(0)
s_barrier
ds_read_b64_tr_b16 a[16:17], v5 offset:0
ds_read_b64_tr_b16 a[18:19], v5 offset:512
ds_read_b64_tr_b16 a[20:21], v5 offset:4096
ds_read_b64_tr_b16 a[22:23], v5 offset:4608
ds_read_b64_tr_b16 a[24:25], v5 offset:8192
ds_read_b64_tr_b16 a[26:27], v5 offset:8704
ds_read_b64_tr_b16 a[28:29], v5 offset:12288
ds_read_b64_tr_b16 a[30:31], v5 offset:12800
s_add_u32 m0, s53, 65536
s_add_u32 s3, s37, 884736
buffer_load_dwordx4 v2, s[16:19], s3 offen lds
s_add_u32 m0, s53, 69632
s_add_u32 s3, s37, 940032
buffer_load_dwordx4 v2, s[16:19], s3 offen lds
s_cbranch_vccnz L_pth57_f
s_waitcnt vmcnt(1)
L_pth57_f:
s_add_u32 m0, s53, 73728
s_add_u32 s3, s37, 995328
buffer_load_dwordx4 v2, s[16:19], s3 offen lds
s_add_u32 m0, s53, 77824
s_add_u32 s3, s37, 1050624
buffer_load_dwordx4 v2, s[16:19], s3 offen lds
s_cbranch_vccnz L_pth59_f
s_waitcnt vmcnt(1)
L_pth59_f:
v_add_u32 v5, 16384, v4
s_waitcnt vmcnt(12)
s_waitcnt lgkmcnt(0)
s_barrier
ds_read_b64_tr_b16 a[32:33], v5 offset:0
ds_read_b64_tr_b16 a[34:35], v5 offset:512
ds_read_b64_tr_b16 a[36:37], v5 offset:4096
ds_read_b64_tr_b16 a[38:39], v5 offset:4608
ds_read_b64_tr_b16 a[40:41], v5 offset:8192
ds_read_b64_tr_b16 a[42:43], v5 offset:8704
ds_read_b64_tr_b16 a[44:45], v5 offset:12288
ds_read_b64_tr_b16 a[46:47], v5 offset:12800
s_add_u32 m0, s53, 81920
s_add_u32 s3, s37, 1105920
buffer_load_dwordx4 v2, s[16:19], s3 offen lds
s_add_u32 m0, s53, 86016
s_add_u32 s3, s37, 1161216
buffer_load_dwordx4 v2, s[16:19], s3 offen lds
s_cbranch_vccnz L_pth61_f
s_waitcnt vmcnt(1)
L_pth61_f:
s_add_u32 m0, s53, 90112
s_add_u32 s3, s37, 1216512
buffer_load_dwordx4 v2, s[16:19], s3 offen lds
s_add_u32 m0, s53, 94208
s_add_u32 s3, s37, 1271808
buffer_load_dwordx4 v2, s[16:19], s3 offen lds
s_cbranch_vccnz L_pth63_f
s_waitcnt vmcnt(1)
L_pth63_f:
v_add_u32 v5, 32768, v4
s_waitcnt vmcnt(12)
s_waitcnt lgkmcnt(0)
s_barrier
ds_read_b64_tr_b16 a[48:49], v5 offset:0
ds_read_b64_tr_b16 a[50:51], v5 offset:512
ds_read_b64_tr_b16 a[52:53], v5 offset:4096
ds_read_b64_tr_b16 a[54:55], v5 offset:4608
ds_read_b64_tr_b16 a[56:57], v5 offset:8192
ds_read_b64_tr_b16 a[58:59], v5 offset:8704
ds_read_b64_tr_b16 a[60:61], v5 offset:12288
ds_read_b64_tr_b16 a[62:63], v5 offset:12800
s_add_u32 m0, s53, 98304
s_add_u32 s3, s37, 1327104
buffer_load_dwordx4 v2, s[16:19], s3 offen lds
s_add_u32 m0, s53, 102400
s_add_u32 s3, s37, 1382400
buffer_load_dwordx4 v2, s[16:19], s3 offen lds
s_cbranch_vccnz L_pth65_f
s_waitcnt vmcnt(1)
L_pth65_f:
s_add_u32 m0, s53, 106496
s_add_u32 s3, s37, 1437696
buffer_load_dwordx4 v2, s[16:19], s3 offen lds
s_add_u32 m0, s53, 110592
s_add_u32 s3, s37, 1492992
buffer_load_dwordx4 v2, s[16:19], s3 offen lds
s_cbranch_vccnz L_pth67_f
s_waitcnt vmcnt(1)
L_pth67_f:
v_add_u32 v5, 49152, v4
s_waitcnt vmcnt(12)
s_waitcnt lgkmcnt(0)
s_barrier
ds_read_b64_tr_b16 a[64:65], v5 offset:0
ds_read_b64_tr_b16 a[66:67], v5 offset:512
ds_read_b64_tr_b16 a[68:69], v5 offset:4096
ds_read_b64_tr_b16 a[70:71], v5 offset:4608
ds_read_b64_tr_b16 a[72:73], v5 offset:8192
ds_read_b64_tr_b16 a[74:75], v5 offset:8704
ds_read_b64_tr_b16 a[76:77], v5 offset:12288
ds_read_b64_tr_b16 a[78:79], v5 offset:12800
s_add_u32 m0, s53, 114688
s_add_u32 s3, s37, 1548288
buffer_load_dwordx4 v2, s[16:19], s3 offen lds
s_add_u32 m0, s53, 118784
s_add_u32 s3, s37, 1603584
buffer_load_dwordx4 v2, s[16:19], s3 offen lds
s_cbranch_vccnz L_pth69_f
s_waitcnt vmcnt(1)
L_pth69_f:
s_add_u32 m0, s53, 122880
s_add_u32 s3, s37, 1658880
buffer_load_dwordx4 v2, s[16:19], s3 offen lds
s_add_u32 m0, s53, 126976
s_add_u32 s3, s37, 1714176
buffer_load_dwordx4 v2, s[16:19], s3 offen lds
s_cbranch_vccnz L_pth71_f
s_waitcnt vmcnt(1)
L_pth71_f:
v_add_u32 v5, 65536, v4
s_waitcnt vmcnt(12)
s_waitcnt lgkmcnt(0)
s_barrier
ds_read_b64_tr_b16 a[80:81], v5 offset:0
ds_read_b64_tr_b16 a[82:83], v5 offset:512
ds_read_b64_tr_b16 a[84:85], v5 offset:4096
ds_read_b64_tr_b16 a[86:87], v5 offset:4608
ds_read_b64_tr_b16 a[88:89], v5 offset:8192
ds_read_b64_tr_b16 a[90:91], v5 offset:8704
ds_read_b64_tr_b16 a[92:93], v5 offset:12288
ds_read_b64_tr_b16 a[94:95], v5 offset:12800
s_add_u32 m0, s53, 131072
s_add_u32 s3, s37, 1769472
buffer_load_dwordx4 v2, s[16:19], s3 offen lds
s_add_u32 m0, s53, 135168
s_add_u32 s3, s37, 1824768
buffer_load_dwordx4 v2, s[16:19], s3 offen lds
s_cbranch_vccnz L_pth73_f
s_waitcnt vmcnt(1)
L_pth73_f:
s_add_u32 m0, s53, 139264
s_add_u32 s3, s37, 1880064
buffer_load_dwordx4 v2, s[16:19], s3 offen lds
s_add_u32 m0, s53, 143360
s_add_u32 s3, s37, 1935360
buffer_load_dwordx4 v2, s[16:19], s3 offen lds
s_cbranch_vccnz L_pth75_f
s_waitcnt vmcnt(1)
L_pth75_f:
v_add_u32 v5, 81920, v4
s_waitcnt vmcnt(12)
s_waitcnt lgkmcnt(0)
s_barrier
ds_read_b64_tr_b16 a[96:97], v5 offset:0
ds_read_b64_tr_b16 a[98:99], v5 offset:512
ds_read_b64_tr_b16 a[100:101], v5 offset:4096
ds_read_b64_tr_b16 a[102:103], v5 offset:4608
ds_read_b64_tr_b16 a[104:105], v5 offset:8192
ds_read_b64_tr_b16 a[106:107], v5 offset:8704
ds_read_b64_tr_b16 a[108:109], v5 offset:12288
ds_read_b64_tr_b16 a[110:111], v5 offset:12800
s_add_u32 m0, s53, 147456
s_add_u32 s3, s37, 1990656
buffer_load_dwordx4 v2, s[16:19], s3 offen lds
s_add_u32 m0, s53, 151552
s_add_u32 s3, s37, 2045952
buffer_load_dwordx4 v2, s[16:19], s3 offen lds
s_cbranch_vccnz L_pth77_f
s_waitcnt vmcnt(1)
L_pth77_f:
s_add_u32 m0, s53, 155648
s_add_u32 s3, s37, 2101248
buffer_load_dwordx4 v2, s[16:19], s3 offen lds
s_add_u32 m0, s53, 159744
s_add_u32 s3, s37, 2156544
buffer_load_dwordx4 v2, s[16:19], s3 offen lds
s_cbranch_vccnz L_pth79_f
s_waitcnt vmcnt(1)
L_pth79_f:
v_add_u32 v5, 98304, v4
s_waitcnt vmcnt(12)
s_waitcnt lgkmcnt(0)
s_barrier
ds_read_b64_tr_b16 a[112:113], v5 offset:0
ds_read_b64_tr_b16 a[114:115], v5 offset:512
ds_read_b64_tr_b16 a[116:117], v5 offset:4096
ds_read_b64_tr_b16 a[118:119], v5 offset:4608
ds_read_b64_tr_b16 a[120:121], v5 offset:8192
ds_read_b64_tr_b16 a[122:123], v5 offset:8704
ds_read_b64_tr_b16 a[124:125], v5 offset:12288
ds_read_b64_tr_b16 a[126:127], v5 offset:12800
s_add_u32 m0, s53, 0
s_add_u32 s3, s36, 0
buffer_load_dwordx4 v1, s[12:15], s3 offen lds
s_add_u32 m0, s53, 4096
s_add_u32 s3, s36, 20480
buffer_load_dwordx4 v1, s[12:15], s3 offen lds
s_cbranch_vccnz L_pth81_f
s_waitcnt vmcnt(1)
L_pth81_f:
s_add_u32 m0, s53, 8192
s_add_u32 s3, s36, 40960
buffer_load_dwordx4 v1, s[12:15], s3 offen lds
s_add_u32 m0, s53, 12288
s_add_u32 s3, s36, 61440
buffer_load_dwordx4 v1, s[12:15], s3 offen lds
s_cbranch_vccnz L_pth83_f
s_waitcnt vmcnt(1)
L_pth83_f:
v_add_u32 v5, 114688, v4
s_waitcnt vmcnt(12)
s_waitcnt lgkmcnt(0)
s_barrier
ds_read_b64_tr_b16 a[128:129], v5 offset:0
ds_read_b64_tr_b16 a[130:131], v5 offset:512
ds_read_b64_tr_b16 a[132:133], v5 offset:4096
ds_read_b64_tr_b16 a[134:135], v5 offset:4608
ds_read_b64_tr_b16 a[136:137], v5 offset:8192
ds_read_b64_tr_b16 a[138:139], v5 offset:8704
ds_read_b64_tr_b16 a[140:141], v5 offset:12288
ds_read_b64_tr_b16 a[142:143], v5 offset:12800
s_add_u32 m0, s53, 16384
s_add_u32 s3, s36, 256
buffer_load_dwordx4 v1, s[12:15], s3 offen lds
s_add_u32 m0, s53, 20480
s_add_u32 s3, s36, 20736
buffer_load_dwordx4 v1, s[12:15], s3 offen lds
s_cbranch_vccnz L_pth85_f
s_waitcnt vmcnt(1)
L_pth85_f:
s_add_u32 m0, s53, 24576
s_add_u32 s3, s36, 41216
buffer_load_dwordx4 v1, s[12:15], s3 offen lds
s_add_u32 m0, s53, 28672
s_add_u32 s3, s36, 61696
buffer_load_dwordx4 v1, s[12:15], s3 offen lds
s_cbranch_vccnz L_pth87_f
s_waitcnt vmcnt(1)
L_pth87_f:
v_add_u32 v5, 131072, v4
s_waitcnt vmcnt(12)
s_waitcnt lgkmcnt(0)
s_barrier
ds_read_b64_tr_b16 a[144:145], v5 offset:0
ds_read_b64_tr_b16 a[146:147], v5 offset:512
ds_read_b64_tr_b16 a[148:149], v5 offset:4096
ds_read_b64_tr_b16 a[150:151], v5 offset:4608
ds_read_b64_tr_b16 a[152:153], v5 offset:8192
ds_read_b64_tr_b16 a[154:155], v5 offset:8704
ds_read_b64_tr_b16 a[156:157], v5 offset:12288
ds_read_b64_tr_b16 a[158:159], v5 offset:12800
s_add_u32 m0, s53, 32768
s_add_u32 s3, s36, 512
buffer_load_dwordx4 v1, s[12:15], s3 offen lds
s_add_u32 m0, s53, 36864
s_add_u32 s3, s36, 20992
buffer_load_dwordx4 v1, s[12:15], s3 offen lds
s_cbranch_vccnz L_pth89_f
s_waitcnt vmcnt(1)
L_pth89_f:
s_add_u32 m0, s53, 40960
s_add_u32 s3, s36, 41472
buffer_load_dwordx4 v1, s[12:15], s3 offen lds
s_add_u32 m0, s53, 45056
s_add_u32 s3, s36, 61952
buffer_load_dwordx4 v1, s[12:15], s3 offen lds
s_cbranch_vccnz L_pth91_f
s_waitcnt vmcnt(1)
L_pth91_f:
v_add_u32 v5, 147456, v4
s_waitcnt vmcnt(12)
s_waitcnt lgkmcnt(0)
s_barrier
ds_read_b64_tr_b16 a[160:161], v5 offset:0
ds_read_b64_tr_b16 a[162:163], v5 offset:512
ds_read_b64_tr_b16 a[164:165], v5 offset:4096
ds_read_b64_tr_b16 a[166:167], v5 offset:4608
ds_read_b64_tr_b16 a[168:169], v5 offset:8192
ds_read_b64_tr_b16 a[170:171], v5 offset:8704
ds_read_b64_tr_b16 a[172:173], v5 offset:12288
ds_read_b64_tr_b16 a[174:175], v5 offset:12800
s_add_u32 m0, s53, 49152
s_add_u32 s3, s36, 768
buffer_load_dwordx4 v1, s[12:15], s3 offen lds
s_add_u32 m0, s53, 53248
s_add_u32 s3, s36, 21248
buffer_load_dwordx4 v1, s[12:15], s3 offen lds
s_cbranch_vccnz L_pth93_f
s_waitcnt vmcnt(1)
L_pth93_f:
s_add_u32 m0, s53, 57344
s_add_u32 s3, s36, 41728
buffer_load_dwordx4 v1, s[12:15], s3 offen lds
s_add_u32 m0, s53, 61440
s_add_u32 s3, s36, 62208
buffer_load_dwordx4 v1, s[12:15], s3 offen lds
s_cbranch_vccnz L_pth95_f
s_waitcnt vmcnt(1)
L_pth95_f:
v_add_u32 v5, 0, v3
s_waitcnt vmcnt(12)
s_waitcnt lgkmcnt(0)
s_barrier
ds_read_b64_tr_b16 a[176:177], v5 offset:0
ds_read_b64_tr_b16 a[178:179], v5 offset:1024
ds_read_b64_tr_b16 a[180:181], v5 offset:4096
ds_read_b64_tr_b16 a[182:183], v5 offset:5120
ds_read_b64_tr_b16 a[184:185], v5 offset:8192
ds_read_b64_tr_b16 a[186:187], v5 offset:9216
ds_read_b64_tr_b16 a[188:189], v5 offset:12288
ds_read_b64_tr_b16 a[190:191], v5 offset:13312
s_add_u32 m0, s53, 65536
s_add_u32 s3, s36, 1024
buffer_load_dwordx4 v1, s[12:15], s3 offen lds
s_add_u32 m0, s53, 69632
s_add_u32 s3, s36, 21504
buffer_load_dwordx4 v1, s[12:15], s3 offen lds
s_cbranch_vccnz L_pth97_f
s_waitcnt vmcnt(1)
L_pth97_f:
s_add_u32 m0, s53, 73728
s_add_u32 s3, s36, 41984
buffer_load_dwordx4 v1, s[12:15], s3 offen lds
s_add_u32 m0, s53, 77824
s_add_u32 s3, s36, 62464
buffer_load_dwordx4 v1, s[12:15], s3 offen lds
s_cbranch_vccnz L_pth99_f
s_waitcnt vmcnt(1)
L_pth99_f:
v_add_u32 v5, 16384, v3
s_waitcnt vmcnt(12)
s_waitcnt lgkmcnt(0)
s_barrier
ds_read_b64_tr_b16 a[192:193], v5 offset:0
ds_read_b64_tr_b16 a[194:195], v5 offset:1024
ds_read_b64_tr_b16 a[196:197], v5 offset:4096
ds_read_b64_tr_b16 a[198:199], v5 offset:5120
ds_read_b64_tr_b16 a[200:201], v5 offset:8192
ds_read_b64_tr_b16 a[202:203], v5 offset:9216
ds_read_b64_tr_b16 a[204:205], v5 offset:12288
ds_read_b64_tr_b16 a[206:207], v5 offset:13312
v_add_u32 v5, 32768, v3
s_waitcnt vmcnt(8)
s_waitcnt lgkmcnt(0)
s_barrier
ds_read_b64_tr_b16 a[208:209], v5 offset:0
ds_read_b64_tr_b16 a[210:211], v5 offset:1024
ds_read_b64_tr_b16 a[212:213], v5 offset:4096
ds_read_b64_tr_b16 a[214:215], v5 offset:5120
ds_read_b64_tr_b16 a[216:217], v5 offset:8192
ds_read_b64_tr_b16 a[218:219], v5 offset:9216
ds_read_b64_tr_b16 a[220:221], v5 offset:12288
ds_read_b64_tr_b16 a[222:223], v5 offset:13312
v_add_u32 v5, 49152, v3
s_waitcnt vmcnt(4)
s_waitcnt lgkmcnt(0)
s_barrier
ds_read_b64_tr_b16 a[224:225], v5 offset:0
ds_read_b64_tr_b16 a[226:227], v5 offset:1024
ds_read_b64_tr_b16 a[228:229], v5 offset:4096
ds_read_b64_tr_b16 a[230:231], v5 offset:5120
ds_read_b64_tr_b16 a[232:233], v5 offset:8192
ds_read_b64_tr_b16 a[234:235], v5 offset:9216
ds_read_b64_tr_b16 a[236:237], v5 offset:12288
ds_read_b64_tr_b16 a[238:239], v5 offset:13312
v_add_u32 v5, 65536, v3
s_waitcnt vmcnt(0)
s_waitcnt lgkmcnt(0)
s_barrier
ds_read_b64_tr_b16 a[240:241], v5 offset:0
ds_read_b64_tr_b16 a[242:243], v5 offset:1024
ds_read_b64_tr_b16 a[244:245], v5 offset:4096
ds_read_b64_tr_b16 a[246:247], v5 offset:5120
ds_read_b64_tr_b16 a[248:249], v5 offset:8192
ds_read_b64_tr_b16 a[250:251], v5 offset:9216
ds_read_b64_tr_b16 a[252:253], v5 offset:12288
ds_read_b64_tr_b16 a[254:255], v5 offset:13312
s_waitcnt lgkmcnt(0)
s_barrier
s_mov_b32 s8, s64
s_mov_b32 s9, s65
s_mov_b32 s10, 2621440
s_mov_b32 s11, 0x20000
s_mov_b32 s12, s90
s_mov_b32 s13, s91
s_mov_b32 s14, 2621440
s_mov_b32 s15, 0x20000
v_mbcnt_lo_u32_b32 v40, -1, 0
v_mbcnt_hi_u32_b32 v40, -1, v40
s_mov_b32 s58, s77
v_lshrrev_b32 v41, 4, v40
v_and_b32 v42, 15, v40
v_lshrrev_b32 v43, 5, v40
v_and_b32 v44, 31, v40
v_bfe_u32 v45, v40, 4, 1
v_lshlrev_b32 v0, 4, v40
v_add_u32 v19, 0x10000, v0
s_and_b32 s30, s26, 1
s_lshr_b32 s31, s26, 1
s_lshl_b32 s54, s30, 12
s_lshl_b32 s55, s31, 12
s_lshl_b32 s3, s30, 8
s_add_u32 s3, s3, s55
s_add_u32 s3, s3, 30720
v_lshlrev_b32 v46, 4, v42
v_lshl_add_u32 v47, v45, 3, v46
v_lshl_add_u32 v1, v43, 9, v47
v_add_u32 v1, s3, v1
v_lshl_add_u32 v12, v43, 8, v47
v_mov_b32 v48, 2147483632
v_cmp_eq_u32 vcc, 0, v43
s_nop 1
v_cndmask_b32 v13, v48, v12, vcc
s_and_b32 s3, s25, 15
s_lshl_b32 s3, s3, 4
v_xor_b32 v14, s3, v12
v_cndmask_b32 v15, v48, v14, vcc
v_lshlrev_b32 v49, 6, v43
v_lshlrev_b32 v50, 3, v42
v_xor_b32 v49, v49, v50
v_lshl_add_u32 v2, v41, 7, v49
s_lshl_b32 s3, s31, 10
s_add_u32 s3, s3, 28672
v_add_u32 v2, s3, v2
s_mul_i32 s3, s26, 2560
s_add_u32 s3, s3, 38912
v_mul_u32_u24 v3, 80, v44
v_lshl_add_u32 v3, v43, 4, v3
v_add_u32 v3, s3, v3
v_lshrrev_b32 v49, 2, v40
v_and_b32 v50, 3, v40
v_mul_u32_u24 v5, 80, v49
v_lshl_add_u32 v5, v50, 4, v5
v_add_u32 v5, s3, v5
v_mul_u32_u24 v7, 41216, v49
v_lshl_add_u32 v7, v50, 4, v7
s_lshl_b32 s3, s26, 6
v_add_u32 v7, s3, v7
v_mul_u32_u24 v8, 1280, v41
v_add_u32 v8, v8, v46
v_add_u32 v9, 5120, v8
s_lshl_b32 s3, s26, 3
v_add_u32 v49, s3, v41
v_cmp_gt_u32 vcc, 27, v49
s_nop 1
v_cndmask_b32 v10, v48, v8, vcc
s_mov_b64 s[16:17], vcc
v_cmp_gt_u32 vcc, 23, v49
s_nop 1
v_cndmask_b32 v11, v48, v9, vcc
s_mov_b64 s[18:19], vcc
s_mov_b32 s61, 0x10001
v_xor_b32 v49, v43, v42
v_lshlrev_b32 v16, 8, v44
v_lshl_add_u32 v16, v49, 4, v16
v_add_u32 v16, 65536, v16
s_lshl_b32 s3, s26, 7
v_lshlrev_b32 v17, 2, v44
v_add_u32 v17, s3, v17
v_lshlrev_b32 v18, 2, v44
v_and_b32 v49, 16, v0
v_mov_b32 v50, 0x3f80
v_lshlrev_b32 v49, v49, v50
v_lshrrev_b32 v50, 1, v42
v_cmp_eq_u32 vcc, 0, v50
s_nop 1
v_cndmask_b32 v20, 0, v49, vcc
v_cmp_eq_u32 vcc, 1, v50
s_nop 1
v_cndmask_b32 v21, 0, v49, vcc
v_cmp_eq_u32 vcc, 2, v50
s_nop 1
v_cndmask_b32 v22, 0, v49, vcc
v_cmp_eq_u32 vcc, 3, v50
s_nop 1
v_cndmask_b32 v23, 0, v49, vcc
v_cmp_eq_u32 vcc, 4, v50
s_nop 1
v_cndmask_b32 v24, 0, v49, vcc
v_cmp_eq_u32 vcc, 5, v50
s_nop 1
v_cndmask_b32 v25, 0, v49, vcc
v_cmp_eq_u32 vcc, 6, v50
s_nop 1
v_cndmask_b32 v26, 0, v49, vcc
v_cmp_eq_u32 vcc, 7, v50
s_nop 1
v_cndmask_b32 v27, 0, v49, vcc
v_lshl_add_u32 v49, v41, 2, 0
v_cmp_gt_u32 vcc, v49, v42
s_cmp_eq_u32 s30, 0
s_cselect_b64 s[64:65], vcc, 0
s_cselect_b64 s[72:73], -1, vcc
v_lshl_add_u32 v49, v41, 2, 1
v_cmp_gt_u32 vcc, v49, v42
s_cmp_eq_u32 s30, 0
s_cselect_b64 s[66:67], vcc, 0
s_cselect_b64 s[74:75], -1, vcc
v_lshl_add_u32 v49, v41, 2, 2
v_cmp_gt_u32 vcc, v49, v42
s_cmp_eq_u32 s30, 0
s_cselect_b64 s[68:69], vcc, 0
s_cselect_b64 s[76:77], -1, vcc
v_lshl_add_u32 v49, v41, 2, 3
v_cmp_gt_u32 vcc, v49, v42
s_cmp_eq_u32 s30, 0
s_cselect_b64 s[70:71], vcc, 0
s_cselect_b64 s[78:79], -1, vcc
s_sub_u32 s33, s24, 4
s_mul_i32 s3, s33, 1572864
s_add_u32 s3, s3, 9437184
s_mul_i32 s30, s25, 1280
s_add_u32 s42, s3, s30
s_add_u32 s44, s42, 0
s_add_u32 s43, s42, 659456
s_add_u32 s45, s44, 659456
s_add_u32 s48, s42, 1376256
s_mul_i32 s53, s26, 10240
s_add_u32 s49, s3, s53
s_mul_i32 s31, s25, 41216
s_add_u32 s46, s49, s31
s_add_u32 s47, s46, 0
s_add_u32 s49, s49, 1376256
s_mul_i32 s50, s33, 40960
s_add_u32 s50, s50, s30
s_lshl_b32 s51, s26, 11
s_mul_i32 s36, s25, 2097152
s_mul_i32 s3, s33, 32768
s_add_u32 s36, s36, s3
s_add_u32 s36, s36, s51
s_add_u32 s36, s36, 50331648
s_min_u32 s52, s26, 2
s_lshl_b32 s52, s52, 11
s_mul_i32 s37, s25, 1048576
s_mul_i32 s3, s33, 16384
s_add_u32 s37, s37, s3
s_add_u32 s37, s37, s52
s_add_u32 s37, s37, 16777216
s_lshl_b32 s3, s25, 7
s_add_u32 s38, s3, 0
s_add_u32 s39, s3, 524288
s_mov_b32 s34, 1
s_mov_b32 s56, 4048155338
s_mul_i32 s57, s26, 3072
s_lshl_b32 s59, s26, 11
v_add_u32 v4, s54, v0
v_add_u32 v6, s55, v0
v_lshlrev_b32 v60, 2, v40
L_pcls_f:
global_load_dword v61, v60, s[28:29] sc1
s_add_u32 s27, s27, 1
s_cmp_gt_u32 s27, 262144
s_cbranch_scc1 L_fail_f
s_lshl_b32 s3, s58, 4
s_add_u32 s3, s3, 15
s_waitcnt vmcnt(0)
v_readlane_b32 s3, v61, s3
s_cmp_lt_u32 s3, 64
s_cbranch_scc1 L_pcls_f
s_lshl_b32 s3, s58, 4
s_add_u32 s3, s3, 14
v_readlane_b32 s3, v61, s3
s_cmp_lt_u32 s3, 0x400000
s_cbranch_scc1 L_pcls_f
s_and_b32 s31, s3, 0xff
s_cmp_ge_u32 s31, 32
s_cselect_b32 s30, 8192, 0
s_bfe_u32 s31, s3, 0x80008
s_cmp_ge_u32 s31, 32
s_cselect_b32 s31, 0, 16384
s_add_u32 s30, s30, s31
s_add_u32 s39, s39, s30
s_lshr_b32 s3, s36, 8
s_xor_b32 s3, s3, s30
s_and_b32 s3, s3, 8192
s_add_u32 s36, s36, s3
s_lshr_b32 s3, s37, 8
s_xor_b32 s3, s3, s30
s_and_b32 s3, s3, 8192
s_add_u32 s37, s37, s3
v_lshlrev_b32 v40, 3, v40
s_mov_b32 s3, 8192
L_pmod2_f:
buffer_load_dwordx2 v[42:43], v40, s[4:7], s3 offen sc1
s_add_u32 s27, s27, 1
s_cmp_gt_u32 s27, 262144
s_cbranch_scc1 L_fail_f
s_waitcnt vmcnt(0)
v_and_b32 v42, v42, v43
v_cmp_ne_u32 vcc, 1, v42
s_cbranch_vccnz L_pmod2_f
s_lshl_b32 s3, s26, 2
s_lshr_b32 s3, 0x5342, s3
s_and_b32 s3, s3, 15
s_mul_i32 s3, s3, 1280
s_add_u32 s3, s3, 32768
buffer_load_dwordx2 v[40:41], v12, s[4:7], s3 offen offset:0 sc1
buffer_load_dwordx2 v[42:43], v12, s[4:7], s3 offen offset:512 sc1
buffer_load_dwordx2 v[44:45], v13, s[4:7], s3 offen offset:1024 sc1
v_add_u32 v60, s57, v19
s_waitcnt vmcnt(2)
v_lshlrev_b32 v48, 16, v40
v_and_b32 v49, 0xffff0000, v40
v_lshlrev_b32 v50, 16, v41
v_and_b32 v51, 0xffff0000, v41
ds_write_b128 v60, v[48:51] offset:40960
s_waitcnt vmcnt(1)
v_lshlrev_b32 v52, 16, v42
v_and_b32 v53, 0xffff0000, v42
v_lshlrev_b32 v54, 16, v43
v_and_b32 v55, 0xffff0000, v43
ds_write_b128 v60, v[52:55] offset:41984
s_waitcnt vmcnt(0)
v_lshlrev_b32 v56, 16, v44
v_and_b32 v57, 0xffff0000, v44
v_lshlrev_b32 v58, 16, v45
v_and_b32 v59, 0xffff0000, v45
ds_write_b128 v60, v[56:59] offset:43008
s_waitcnt lgkmcnt(0)
s_add_u32 s35, s33, 1
s_mov_b32 s58, 0
v_bfe_u32 v40, v0, 2, 5
L_pkv0_f:
buffer_load_dword v41, v40, s[4:7], s38 offen offset:0 sc1
s_add_u32 s27, s27, 1
s_cmp_gt_u32 s27, 262144
s_cbranch_scc1 L_fail_f
s_waitcnt vmcnt(0)
v_cmp_gt_u32 vcc, s35, v41
s_cbranch_vccz L_pkv0_fok
s_sleep 8
s_branch L_pkv0_f
L_pkv0_fok:
s_add_u32 m0, s51, 0
s_xor_b32 s3, s36, 0
buffer_load_dwordx4 v0, s[4:7], s3 offen offset:0 sc1 lds
buffer_load_dwordx4 v0, s[4:7], s3 offen offset:1024 sc1 lds
s_add_u32 m0, s51, 8192
s_xor_b32 s3, s36, 16384
buffer_load_dwordx4 v0, s[4:7], s3 offen offset:0 sc1 lds
buffer_load_dwordx4 v0, s[4:7], s3 offen offset:1024 sc1 lds
s_add_u32 m0, s51, 16384
s_xor_b32 s3, s36, 8192
buffer_load_dwordx4 v0, s[4:7], s3 offen offset:0 sc1 lds
buffer_load_dwordx4 v0, s[4:7], s3 offen offset:1024 sc1 lds
s_add_u32 s36, s36, 131072
s_waitcnt vmcnt(0) lgkmcnt(0)
s_barrier
L_unit_f:
buffer_load_dwordx2 v[34:35], v12, s[8:11], s50 offen offset:0
buffer_load_dwordx2 v[36:37], v12, s[8:11], s50 offen offset:512
buffer_load_dwordx2 v[38:39], v13, s[8:11], s50 offen offset:1024
s_cmp_lg_u32 s58, 0
s_cbranch_scc1 L_pwo_f
v_bfe_u32 v104, v0, 2, 3
buffer_load_dword v105, v104, s[4:7], s39 offen sc1
ds_read_b128 v[40:43], v4 offset:16384
ds_read_b128 v[72:75], v0 offset:0
ds_read_b128 v[44:47], v4 offset:17408
ds_read_b128 v[76:79], v0 offset:1024
ds_read_b128 v[48:51], v4 offset:18432
ds_read_b128 v[80:83], v0 offset:2048
ds_read_b128 v[52:55], v4 offset:19456
ds_read_b128 v[84:87], v0 offset:3072
ds_read_b128 v[56:59], v0 offset:4096
ds_read_b128 v[60:63], v0 offset:5120
ds_read_b128 v[64:67], v0 offset:6144
ds_read_b128 v[68:71], v0 offset:7168
s_waitcnt lgkmcnt(10)
v_mfma_f32_16x16x32_bf16 v[92:95], v[72:75], v[40:43], 0
ds_read_b128 v[72:75], v6 offset:8192
s_waitcnt lgkmcnt(9)
v_mfma_f32_16x16x32_bf16 v[92:95], v[76:79], v[44:47], v[92:95]
ds_read_b128 v[76:79], v6 offset:9216
s_waitcnt lgkmcnt(8)
v_mfma_f32_16x16x32_bf16 v[92:95], v[80:83], v[48:51], v[92:95]
ds_read_b128 v[80:83], v6 offset:10240
s_waitcnt lgkmcnt(7)
v_mfma_f32_16x16x32_bf16 v[92:95], v[84:87], v[52:55], v[92:95]
ds_read_b128 v[84:87], v6 offset:11264
s_waitcnt lgkmcnt(7)
v_mfma_f32_16x16x32_bf16 v[96:99], v[56:59], v[40:43], 0
s_waitcnt lgkmcnt(6)
v_mfma_f32_16x16x32_bf16 v[96:99], v[60:63], v[44:47], v[96:99]
s_waitcnt lgkmcnt(5)
v_mfma_f32_16x16x32_bf16 v[96:99], v[64:67], v[48:51], v[96:99]
s_waitcnt lgkmcnt(4)
v_mfma_f32_16x16x32_bf16 v[96:99], v[68:71], v[52:55], v[96:99]
s_waitcnt vmcnt(0)
v_cmp_gt_u32 vcc, s35, v105
s_cbranch_vccz L_proka_f
L_pra_f:
buffer_load_dword v105, v104, s[4:7], s39 offen offset:0 sc1
s_add_u32 s27, s27, 1
s_cmp_gt_u32 s27, 262144
s_cbranch_scc1 L_fail_f
s_waitcnt vmcnt(0)
v_cmp_gt_u32 vcc, s35, v105
s_cbranch_vccz L_pra_fok
s_sleep 1
s_branch L_pra_f
L_pra_fok:
L_proka_f:
s_add_u32 m0, s52, 24576
s_nop 0
buffer_load_dwordx4 v0, s[4:7], s37 offen offset:0 sc1 lds
buffer_load_dwordx4 v0, s[4:7], s37 offen offset:1024 sc1 lds
v_mov_b32 v110, s56
v_mov_b32 v107, 0
v_mov_b32 v108, 0
s_add_u32 s37, s37, 65536
v_cndmask_b32 v92, v92, v110, s[64:65]
v_cndmask_b32 v93, v93, v110, s[66:67]
v_cndmask_b32 v94, v94, v110, s[68:69]
v_cndmask_b32 v95, v95, v110, s[70:71]
v_cndmask_b32 v96, v96, v110, s[72:73]
v_cndmask_b32 v97, v97, v110, s[74:75]
v_cndmask_b32 v98, v98, v110, s[76:77]
v_cndmask_b32 v99, v99, v110, s[78:79]
v_max3_f32 v110, v92, v93, v94
v_max3_f32 v110, v110, v95, v96
v_max3_f32 v110, v110, v97, v98
v_max_f32 v110, v110, v99
s_waitcnt vmcnt(0)
s_barrier
ds_read_b128 v[56:59], v0 offset:24576
ds_read_b128 v[60:63], v0 offset:25600
ds_read_b128 v[64:67], v0 offset:26624
ds_read_b128 v[68:71], v0 offset:27648
ds_read_b64 v[100:101], v2 offset:0
ds_read_b64 v[102:103], v2 offset:512
s_waitcnt lgkmcnt(5)
v_mfma_f32_16x16x32_bf16 v[88:91], v[56:59], v[40:43], 0
s_waitcnt lgkmcnt(4)
v_mfma_f32_16x16x32_bf16 v[88:91], v[60:63], v[44:47], v[88:91]
s_waitcnt lgkmcnt(3)
v_mfma_f32_16x16x32_bf16 v[88:91], v[64:67], v[48:51], v[88:91]
s_waitcnt lgkmcnt(2)
v_mfma_f32_16x16x32_bf16 v[88:91], v[68:71], v[52:55], v[88:91]
s_nop 7
v_max3_f32 v88, v90, v91, v110
v_mov_b32 v89, v88
s_nop 1
v_permlane16_swap_b32 v88, v89
v_max_f32 v88, v88, v89
v_mov_b32 v89, v88
s_nop 1
v_permlane32_swap_b32 v88, v89
v_max_f32 v88, v88, v89
v_sub_f32 v90, v90, v88
v_sub_f32 v91, v91, v88
v_sub_f32 v92, v92, v88
v_sub_f32 v93, v93, v88
v_sub_f32 v94, v94, v88
v_sub_f32 v95, v95, v88
v_sub_f32 v96, v96, v88
v_sub_f32 v97, v97, v88
v_sub_f32 v98, v98, v88
v_sub_f32 v99, v99, v88
v_exp_f32 v90, v90
v_exp_f32 v91, v91
v_exp_f32 v92, v92
v_exp_f32 v93, v93
v_exp_f32 v94, v94
v_exp_f32 v95, v95
v_exp_f32 v96, v96
v_exp_f32 v97, v97
v_exp_f32 v98, v98
v_exp_f32 v99, v99
v_cvt_pk_bf16_f32 v106, v90, v91
v_cvt_pk_bf16_f32 v109, v90, v91
v_cvt_pk_bf16_f32 v56, v92, v93
v_cvt_pk_bf16_f32 v57, v94, v95
v_cvt_pk_bf16_f32 v58, v96, v97
v_cvt_pk_bf16_f32 v59, v98, v99
s_nop 1
v_mfma_f32_16x16x32_bf16 v[40:43], v[72:75], v[56:59], 0
v_add_f32 v88, v90, v91
v_add_f32 v88, v88, v92
v_mfma_f32_16x16x32_bf16 v[44:47], v[76:79], v[56:59], 0
v_add_f32 v88, v88, v93
v_add_f32 v88, v88, v94
v_mfma_f32_16x16x32_bf16 v[48:51], v[80:83], v[56:59], 0
v_add_f32 v88, v88, v95
v_add_f32 v88, v88, v96
v_mfma_f32_16x16x32_bf16 v[52:55], v[84:87], v[56:59], 0
v_add_f32 v88, v88, v97
v_add_f32 v88, v88, v98
v_add_f32 v88, v88, v99
s_waitcnt lgkmcnt(1)
v_mfma_f32_16x16x16_bf16 v[40:43], v[100:101], v[106:107], v[40:43]
v_mov_b32 v89, v88
v_mfma_f32_16x16x16_bf16 v[44:47], v[100:101], v[108:109], v[44:47]
s_nop 0
v_permlane16_swap_b32 v88, v89
v_add_f32 v88, v88, v89
s_waitcnt lgkmcnt(0)
v_mfma_f32_16x16x16_bf16 v[48:51], v[102:103], v[106:107], v[48:51]
v_mov_b32 v89, v88
v_mfma_f32_16x16x16_bf16 v[52:55], v[102:103], v[108:109], v[52:55]
s_nop 0
v_permlane32_swap_b32 v88, v89
v_add_f32 v88, v88, v89
v_rcp_f32 v88, v88
s_nop 0
v_mov_b32 v89, v88
v_pk_mul_f32 v[40:41], v[40:41], v[88:89]
v_pk_mul_f32 v[42:43], v[42:43], v[88:89]
v_cvt_pk_bf16_f32 v40, v40, v41
v_cvt_pk_bf16_f32 v41, v42, v43
ds_write_b64 v1, v[40:41] offset:0
v_pk_mul_f32 v[44:45], v[44:45], v[88:89]
v_pk_mul_f32 v[46:47], v[46:47], v[88:89]
v_cvt_pk_bf16_f32 v44, v44, v45
v_cvt_pk_bf16_f32 v45, v46, v47
ds_write_b64 v1, v[44:45] offset:1024
v_pk_mul_f32 v[48:49], v[48:49], v[88:89]
v_pk_mul_f32 v[50:51], v[50:51], v[88:89]
v_cvt_pk_bf16_f32 v48, v48, v49
v_cvt_pk_bf16_f32 v49, v50, v51
ds_write_b64 v1, v[48:49] offset:2048
v_pk_mul_f32 v[52:53], v[52:53], v[88:89]
v_pk_mul_f32 v[54:55], v[54:55], v[88:89]
v_cvt_pk_bf16_f32 v52, v52, v53
v_cvt_pk_bf16_f32 v53, v54, v55
ds_write_b64 v1, v[52:53] offset:3072
s_waitcnt lgkmcnt(0)
s_barrier
L_pwo_f:
ds_read_b128 v[40:43], v0 offset:30720
ds_read_b128 v[44:47], v0 offset:31744
ds_read_b128 v[48:51], v0 offset:32768
ds_read_b128 v[52:55], v0 offset:33792
ds_read_b128 v[56:59], v0 offset:34816
ds_read_b128 v[60:63], v0 offset:35840
ds_read_b128 v[64:67], v0 offset:36864
ds_read_b128 v[68:71], v0 offset:37888
s_and_b32 s62, s34, 1
s_lshl_b32 s62, s62, 16
s_or_b32 s62, s62, 0
v_mov_b32 v29, s62
s_waitcnt lgkmcnt(7)
v_mfma_f32_32x32x16_bf16 v[72:87], v[112:115], v[40:43], 0
s_waitcnt lgkmcnt(6)
v_mfma_f32_32x32x16_bf16 v[72:87], v[116:119], v[44:47], v[72:87]
s_waitcnt lgkmcnt(5)
v_mfma_f32_32x32x16_bf16 v[72:87], v[120:123], v[48:51], v[72:87]
s_waitcnt lgkmcnt(4)
v_mfma_f32_32x32x16_bf16 v[72:87], v[124:127], v[52:55], v[72:87]
s_waitcnt lgkmcnt(3)
v_mfma_f32_32x32x16_bf16 v[72:87], v[128:131], v[56:59], v[72:87]
buffer_load_dword v28, v18, s[4:7], s41 offen offset:640 sc1
s_sub_u32 s30, s34, 1
s_waitcnt lgkmcnt(2)
v_mfma_f32_32x32x16_bf16 v[72:87], v[132:135], v[60:63], v[72:87]
s_waitcnt lgkmcnt(1)
v_mfma_f32_32x32x16_bf16 v[72:87], v[136:139], v[64:67], v[72:87]
s_waitcnt lgkmcnt(0)
v_mfma_f32_32x32x16_bf16 v[72:87], v[140:143], v[68:71], v[72:87]
v_mfma_f32_32x32x16_bf16 v[88:103], v[144:147], v[40:43], 0
s_nop 3
s_nop 2
v_mfma_f32_32x32x16_bf16 v[88:103], v[148:151], v[44:47], v[88:103]
s_nop 2
v_cvt_pk_bf16_f32 v72, v72, v73
v_cvt_pk_bf16_f32 v73, v74, v75
v_cvt_pk_bf16_f32 v74, v76, v77
v_cvt_pk_bf16_f32 v75, v78, v79
v_mfma_f32_32x32x16_bf16 v[88:103], v[152:155], v[48:51], v[88:103]
v_bfi_b32 v72, s61, v29, v72
ds_write_b128 v3, v[72:75] offset:0
v_cvt_pk_bf16_f32 v76, v80, v81
v_cvt_pk_bf16_f32 v77, v82, v83
v_cvt_pk_bf16_f32 v78, v84, v85
v_mfma_f32_32x32x16_bf16 v[88:103], v[156:159], v[52:55], v[88:103]
v_cvt_pk_bf16_f32 v79, v86, v87
v_bfi_b32 v76, s61, v29, v76
ds_write_b128 v3, v[76:79] offset:32
ds_read_b128 v[104:107], v5 offset:0
ds_read_b128 v[108:111], v5 offset:1280
v_mfma_f32_32x32x16_bf16 v[88:103], v[160:163], v[56:59], v[88:103]
v_mfma_f32_32x32x16_bf16 v[88:103], v[164:167], v[60:63], v[88:103]
s_waitcnt vmcnt(0)
v_cmp_gt_u32 vcc, s30, v28
s_cbranch_vccz L_p4ok_f
L_p4_f:
buffer_load_dword v28, v18, s[4:7], s41 offen offset:640 sc1
s_add_u32 s27, s27, 1
s_cmp_gt_u32 s27, 262144
s_cbranch_scc1 L_fail_f
s_waitcnt vmcnt(0)
v_cmp_gt_u32 vcc, s30, v28
s_cbranch_vccnz L_p4_f
L_p4ok_f:
v_mfma_f32_32x32x16_bf16 v[88:103], v[168:171], v[64:67], v[88:103]
s_waitcnt lgkmcnt(1)
buffer_store_dwordx4 v[104:107], v7, s[4:7], s42 offen offset:0
v_mfma_f32_32x32x16_bf16 v[88:103], v[172:175], v[68:71], v[88:103]
s_waitcnt lgkmcnt(0)
buffer_store_dwordx4 v[108:111], v7, s[4:7], s43 offen offset:0
v_mfma_f32_32x32x16_bf16 v[72:87], v[176:179], v[40:43], 0
s_nop 3
s_nop 2
v_mfma_f32_32x32x16_bf16 v[72:87], v[180:183], v[44:47], v[72:87]
s_nop 0
v_cvt_pk_bf16_f32 v88, v88, v89
v_cvt_pk_bf16_f32 v89, v90, v91
v_cvt_pk_bf16_f32 v90, v92, v93
v_cvt_pk_bf16_f32 v91, v94, v95
v_mfma_f32_32x32x16_bf16 v[72:87], v[184:187], v[48:51], v[72:87]
v_bfi_b32 v88, s61, v29, v88
ds_write_b128 v3, v[88:91] offset:0
v_cvt_pk_bf16_f32 v92, v96, v97
v_cvt_pk_bf16_f32 v93, v98, v99
v_cvt_pk_bf16_f32 v94, v100, v101
v_mfma_f32_32x32x16_bf16 v[72:87], v[188:191], v[52:55], v[72:87]
v_cvt_pk_bf16_f32 v95, v102, v103
v_bfi_b32 v92, s61, v29, v92
ds_write_b128 v3, v[92:95] offset:32
ds_read_b128 v[104:107], v5 offset:0
ds_read_b128 v[108:111], v5 offset:1280
v_mfma_f32_32x32x16_bf16 v[72:87], v[192:195], v[56:59], v[72:87]
v_mfma_f32_32x32x16_bf16 v[72:87], v[196:199], v[60:63], v[72:87]
v_mfma_f32_32x32x16_bf16 v[72:87], v[200:203], v[64:67], v[72:87]
s_waitcnt lgkmcnt(1)
buffer_store_dwordx4 v[104:107], v7, s[4:7], s42 offen offset:256
v_mfma_f32_32x32x16_bf16 v[72:87], v[204:207], v[68:71], v[72:87]
s_waitcnt lgkmcnt(0)
buffer_store_dwordx4 v[108:111], v7, s[4:7], s43 offen offset:256
v_mfma_f32_32x32x16_bf16 v[88:103], v[208:211], v[40:43], 0
s_nop 3
s_nop 2
v_mfma_f32_32x32x16_bf16 v[88:103], v[212:215], v[44:47], v[88:103]
s_nop 0
v_cvt_pk_bf16_f32 v72, v72, v73
v_cvt_pk_bf16_f32 v73, v74, v75
v_cvt_pk_bf16_f32 v74, v76, v77
v_cvt_pk_bf16_f32 v75, v78, v79
v_mfma_f32_32x32x16_bf16 v[88:103], v[216:219], v[48:51], v[88:103]
v_bfi_b32 v72, s61, v29, v72
ds_write_b128 v3, v[72:75] offset:0
v_cvt_pk_bf16_f32 v76, v80, v81
v_cvt_pk_bf16_f32 v77, v82, v83
v_cvt_pk_bf16_f32 v78, v84, v85
v_mfma_f32_32x32x16_bf16 v[88:103], v[220:223], v[52:55], v[88:103]
v_cvt_pk_bf16_f32 v79, v86, v87
v_bfi_b32 v76, s61, v29, v76
ds_write_b128 v3, v[76:79] offset:32
ds_read_b128 v[104:107], v5 offset:0
ds_read_b128 v[108:111], v5 offset:1280
v_mfma_f32_32x32x16_bf16 v[88:103], v[224:227], v[56:59], v[88:103]
v_mfma_f32_32x32x16_bf16 v[88:103], v[228:231], v[60:63], v[88:103]
v_mfma_f32_32x32x16_bf16 v[88:103], v[232:235], v[64:67], v[88:103]
s_waitcnt lgkmcnt(1)
buffer_store_dwordx4 v[104:107], v7, s[4:7], s42 offen offset:512
v_mfma_f32_32x32x16_bf16 v[88:103], v[236:239], v[68:71], v[88:103]
s_waitcnt lgkmcnt(0)
buffer_store_dwordx4 v[108:111], v7, s[4:7], s43 offen offset:512
v_mfma_f32_32x32x16_bf16 v[72:87], v[240:243], v[40:43], 0
s_nop 3
s_nop 2
v_mfma_f32_32x32x16_bf16 v[72:87], v[244:247], v[44:47], v[72:87]
s_nop 0
v_cvt_pk_bf16_f32 v88, v88, v89
v_cvt_pk_bf16_f32 v89, v90, v91
v_cvt_pk_bf16_f32 v90, v92, v93
v_cvt_pk_bf16_f32 v91, v94, v95
v_mfma_f32_32x32x16_bf16 v[72:87], v[248:251], v[48:51], v[72:87]
v_bfi_b32 v88, s61, v29, v88
ds_write_b128 v3, v[88:91] offset:0
v_cvt_pk_bf16_f32 v92, v96, v97
v_cvt_pk_bf16_f32 v93, v98, v99
v_cvt_pk_bf16_f32 v94, v100, v101
v_mfma_f32_32x32x16_bf16 v[72:87], v[252:255], v[52:55], v[72:87]
v_cvt_pk_bf16_f32 v95, v102, v103
v_bfi_b32 v92, s61, v29, v92
ds_write_b128 v3, v[92:95] offset:32
ds_read_b128 v[104:107], v5 offset:0
ds_read_b128 v[108:111], v5 offset:1280
v_mfma_f32_32x32x16_bf16 v[72:87], a[0:3], v[56:59], v[72:87]
v_mfma_f32_32x32x16_bf16 v[72:87], a[4:7], v[60:63], v[72:87]
v_mfma_f32_32x32x16_bf16 v[72:87], a[8:11], v[64:67], v[72:87]
s_waitcnt lgkmcnt(1)
buffer_store_dwordx4 v[104:107], v7, s[4:7], s42 offen offset:768
v_mfma_f32_32x32x16_bf16 v[72:87], a[12:15], v[68:71], v[72:87]
s_waitcnt lgkmcnt(0)
buffer_store_dwordx4 v[108:111], v7, s[4:7], s43 offen offset:768
s_nop 9
v_cvt_pk_bf16_f32 v72, v72, v73
v_cvt_pk_bf16_f32 v73, v74, v75
v_cvt_pk_bf16_f32 v74, v76, v77
v_cvt_pk_bf16_f32 v75, v78, v79
v_bfi_b32 v72, s61, v29, v72
ds_write_b128 v3, v[72:75] offset:0
v_cvt_pk_bf16_f32 v76, v80, v81
v_cvt_pk_bf16_f32 v77, v82, v83
v_cvt_pk_bf16_f32 v78, v84, v85
v_cvt_pk_bf16_f32 v79, v86, v87
v_bfi_b32 v76, s61, v29, v76
ds_write_b128 v3, v[76:79] offset:32
ds_read_b128 v[104:107], v5 offset:0
ds_read_b128 v[108:111], v5 offset:1280
s_waitcnt lgkmcnt(1)
buffer_store_dwordx4 v[104:107], v7, s[4:7], s42 offen offset:1024
s_waitcnt lgkmcnt(0)
buffer_store_dwordx4 v[108:111], v7, s[4:7], s43 offen offset:1024
v_mov_b32 v40, s34
s_cmp_lg_u32 s34, 1
s_cbranch_scc1 L_pf_f
s_waitcnt vmcnt(0)
L_pf_f:
buffer_store_dword v40, off, s[4:7], s40 offset:0
v_lshlrev_b32 v28, 16, v34
v_and_b32 v29, 0xffff0000, v34
v_lshlrev_b32 v30, 16, v35
v_and_b32 v31, 0xffff0000, v35
v_lshlrev_b32 v32, 16, v36
v_and_b32 v33, 0xffff0000, v36
v_lshlrev_b32 v34, 16, v37
v_and_b32 v35, 0xffff0000, v37
v_lshlrev_b32 v36, 16, v38
v_and_b32 v37, 0xffff0000, v38
v_lshlrev_b32 v38, 16, v39
v_and_b32 v39, 0xffff0000, v39
s_add_u32 s35, s35, 4
L_p1_f:
buffer_load_dword v40, v17, s[4:7], s41 offen offset:0 sc1
s_add_u32 s27, s27, 1
s_cmp_gt_u32 s27, 262144
s_cbranch_scc1 L_fail_f
s_waitcnt vmcnt(0)
v_cmp_gt_u32 vcc, s34, v40
s_cbranch_vccnz L_p1_f
L_rr1_f:
buffer_load_dwordx4 v[40:43], v8, s[4:7], s46 offen offset:0 sc1
buffer_load_dwordx4 v[44:47], v9, s[4:7], s46 offen offset:0 sc1
buffer_load_dwordx4 v[48:51], v8, s[4:7], s46 offen offset:256 sc1
buffer_load_dwordx4 v[52:55], v9, s[4:7], s46 offen offset:256 sc1
buffer_load_dwordx4 v[56:59], v8, s[4:7], s46 offen offset:512 sc1
buffer_load_dwordx4 v[60:63], v9, s[4:7], s46 offen offset:512 sc1
buffer_load_dwordx4 v[64:67], v8, s[4:7], s46 offen offset:768 sc1
buffer_load_dwordx4 v[68:71], v9, s[4:7], s46 offen offset:768 sc1
buffer_load_dwordx4 v[72:75], v8, s[4:7], s46 offen offset:1024 sc1
buffer_load_dwordx4 v[76:79], v9, s[4:7], s46 offen offset:1024 sc1
v_add_u32 v92, s57, v0
ds_read_b128 v[96:99], v19 offset:40960
ds_read_b128 v[100:103], v19 offset:41984
ds_read_b128 v[104:107], v19 offset:43008
s_add_u32 s27, s27, 1
s_cmp_gt_u32 s27, 262144
s_cbranch_scc1 L_fail_f
s_waitcnt vmcnt(9)
v_mfma_f32_16x16x32_bf16 v[80:83], v[20:23], v[40:43], 0
v_xor_b32 v94, s62, v40
s_waitcnt vmcnt(8)
v_mfma_f32_16x16x32_bf16 v[80:83], v[20:23], v[44:47], v[80:83]
v_xor_b32 v95, s62, v44
s_waitcnt vmcnt(7)
v_mfma_f32_16x16x32_bf16 v[80:83], v[24:27], v[48:51], v[80:83]
v_bitop3_b32 v94, v94, v48, s62 bitop3:0xf6
s_waitcnt vmcnt(6)
v_mfma_f32_16x16x32_bf16 v[80:83], v[24:27], v[52:55], v[80:83]
v_bitop3_b32 v95, v95, v52, s62 bitop3:0xf6
s_waitcnt vmcnt(5)
v_mfma_f32_16x16x32_bf16 v[84:87], v[20:23], v[56:59], 0
v_bitop3_b32 v94, v94, v56, s62 bitop3:0xf6
s_waitcnt vmcnt(4)
v_mfma_f32_16x16x32_bf16 v[84:87], v[20:23], v[60:63], v[84:87]
v_bitop3_b32 v95, v95, v60, s62 bitop3:0xf6
s_nop 0
ds_write_b128 v92, v[80:83] offset:49152
s_waitcnt vmcnt(3)
v_mfma_f32_16x16x32_bf16 v[84:87], v[24:27], v[64:67], v[84:87]
v_bitop3_b32 v94, v94, v64, s62 bitop3:0xf6
s_waitcnt vmcnt(2)
v_mfma_f32_16x16x32_bf16 v[84:87], v[24:27], v[68:71], v[84:87]
v_bitop3_b32 v95, v95, v68, s62 bitop3:0xf6
s_waitcnt vmcnt(1)
v_mfma_f32_16x16x32_bf16 v[88:91], v[20:23], v[72:75], 0
v_bitop3_b32 v94, v94, v72, s62 bitop3:0xf6
s_waitcnt vmcnt(0)
v_mfma_f32_16x16x32_bf16 v[88:91], v[20:23], v[76:79], v[88:91]
v_bitop3_b32 v95, v95, v76, s62 bitop3:0xf6
s_nop 0
ds_write_b128 v92, v[84:87] offset:50176
v_bitop3_b32 v94, v94, v95, s61 bitop3:0xa8
v_cmp_ne_u32 vcc, 0, v94
s_nop 2
ds_write_b128 v92, v[88:91] offset:51200
s_cbranch_vccnz L_rr1_f
s_waitcnt lgkmcnt(0)
s_barrier
s_cmp_eq_u32 s26, 0
s_cbranch_scc1 L_pw0_f
s_cmp_lg_u32 s26, 1
s_cbranch_scc1 L_pln_f
v_bfe_u32 v40, v0, 2, 3
buffer_load_dword v41, v40, s[4:7], s39 offen sc1
v_bfe_u32 v42, v0, 2, 5
s_min_u32 s30, s35, 64
L_pkv_f:
buffer_load_dword v43, v42, s[4:7], s38 offen offset:0 sc1
s_add_u32 s27, s27, 1
s_cmp_gt_u32 s27, 262144
s_cbranch_scc1 L_fail_f
s_waitcnt vmcnt(0)
v_cmp_gt_u32 vcc, s30, v43
s_cbranch_vccz L_pkv_fok
s_sleep 8
s_branch L_pkv_f
L_pkv_fok:
v_cmp_gt_u32 vcc, s35, v41
s_cmp_eq_u64 vcc, 0
s_cselect_b32 s3, 1, 0
v_mov_b32 v40, s3
ds_write_b32 v19, v40 offset:53248
s_waitcnt lgkmcnt(0)
s_branch L_pln_f
L_pw0_f:
ds_read_b128 v[40:43], v0 offset:52224
ds_read_b128 v[52:55], v0 offset:55296
ds_read_b128 v[64:67], v0 offset:58368
ds_read_b128 v[44:47], v0 offset:53248
ds_read_b128 v[56:59], v0 offset:56320
ds_read_b128 v[68:71], v0 offset:59392
ds_read_b128 v[48:51], v0 offset:54272
ds_read_b128 v[60:63], v0 offset:57344
ds_read_b128 v[72:75], v0 offset:60416
s_waitcnt lgkmcnt(8)
v_pk_add_f32 v[80:81], v[80:81], v[40:41]
s_waitcnt lgkmcnt(6)
v_pk_add_f32 v[52:53], v[52:53], v[64:65]
v_pk_add_f32 v[80:81], v[80:81], v[52:53]
v_pk_fma_f32 v[28:29], v[96:97], v[80:81], v[28:29]
v_pk_add_f32 v[82:83], v[82:83], v[42:43]
v_pk_add_f32 v[54:55], v[54:55], v[66:67]
v_pk_add_f32 v[82:83], v[82:83], v[54:55]
v_pk_fma_f32 v[30:31], v[98:99], v[82:83], v[30:31]
s_waitcnt lgkmcnt(5)
v_pk_add_f32 v[84:85], v[84:85], v[44:45]
s_waitcnt lgkmcnt(3)
v_pk_add_f32 v[56:57], v[56:57], v[68:69]
v_pk_add_f32 v[84:85], v[84:85], v[56:57]
v_pk_fma_f32 v[32:33], v[100:101], v[84:85], v[32:33]
v_pk_add_f32 v[86:87], v[86:87], v[46:47]
v_pk_add_f32 v[58:59], v[58:59], v[70:71]
v_pk_add_f32 v[86:87], v[86:87], v[58:59]
v_pk_fma_f32 v[34:35], v[102:103], v[86:87], v[34:35]
s_waitcnt lgkmcnt(2)
v_pk_add_f32 v[88:89], v[88:89], v[48:49]
s_waitcnt lgkmcnt(0)
v_pk_add_f32 v[60:61], v[60:61], v[72:73]
v_pk_add_f32 v[88:89], v[88:89], v[60:61]
v_pk_fma_f32 v[36:37], v[104:105], v[88:89], v[36:37]
v_pk_add_f32 v[90:91], v[90:91], v[50:51]
v_pk_add_f32 v[62:63], v[62:63], v[74:75]
v_pk_add_f32 v[90:91], v[90:91], v[62:63]
v_pk_fma_f32 v[38:39], v[106:107], v[90:91], v[38:39]
ds_read_b128 v[52:55], v19 offset:44032
ds_read_b128 v[56:59], v19 offset:45056
ds_read_b128 v[60:63], v19 offset:46080
ds_read_b128 v[64:67], v19 offset:47104
ds_read_b128 v[68:71], v19 offset:48128
ds_read_b128 v[72:75], v19 offset:49152
v_pk_add_f32 v[92:93], v[28:29], v[30:31]
v_pk_add_f32 v[94:95], v[32:33], v[34:35]
v_pk_add_f32 v[92:93], v[92:93], v[36:37]
v_pk_add_f32 v[94:95], v[94:95], v[38:39]
v_pk_add_f32 v[92:93], v[92:93], v[94:95]
v_add_f32 v92, v92, v93
s_nop 1
v_add_f32_dpp v92, v92, v92 row_ror:8 row_mask:0xf bank_mask:0xf
s_nop 1
v_add_f32_dpp v92, v92, v92 row_ror:4 row_mask:0xf bank_mask:0xf
s_nop 1
v_add_f32_dpp v92, v92, v92 row_ror:2 row_mask:0xf bank_mask:0xf
s_nop 1
v_add_f32_dpp v92, v92, v92 row_ror:1 row_mask:0xf bank_mask:0xf
v_mov_b32 v94, v92
s_nop 1
v_permlane16_swap_b32 v92, v94
v_add_f32 v92, v92, v94
v_mov_b32 v94, v92
s_nop 1
v_permlane32_swap_b32 v92, v94
v_add_f32 v92, v92, v94
v_mul_f32 v92, 3133983949, v92
s_mov_b32 s30, -1
s_mov_b32 s31, 0
v_mov_b32 v93, v92
v_cndmask_b32 v94, 0, v92, s[30:31]
v_cndmask_b32 v95, 0, v92, s[30:31]
v_pk_add_f32 v[80:81], v[28:29], v[92:93]
v_pk_add_f32 v[82:83], v[30:31], v[92:93]
v_pk_add_f32 v[84:85], v[32:33], v[92:93]
v_pk_add_f32 v[86:87], v[34:35], v[92:93]
v_pk_add_f32 v[88:89], v[36:37], v[94:95]
v_pk_add_f32 v[90:91], v[38:39], v[94:95]
v_pk_mul_f32 v[92:93], v[80:81], v[80:81]
v_pk_fma_f32 v[92:93], v[82:83], v[82:83], v[92:93]
v_pk_fma_f32 v[92:93], v[84:85], v[84:85], v[92:93]
v_pk_fma_f32 v[92:93], v[86:87], v[86:87], v[92:93]
v_pk_fma_f32 v[92:93], v[88:89], v[88:89], v[92:93]
v_pk_fma_f32 v[92:93], v[90:91], v[90:91], v[92:93]
v_add_f32 v92, v92, v93
s_waitcnt lgkmcnt(5)
v_pk_mul_f32 v[80:81], v[80:81], v[52:53]
v_pk_mul_f32 v[82:83], v[82:83], v[54:55]
v_add_f32_dpp v92, v92, v92 row_ror:8 row_mask:0xf bank_mask:0xf
s_waitcnt lgkmcnt(4)
v_pk_mul_f32 v[84:85], v[84:85], v[56:57]
v_pk_mul_f32 v[86:87], v[86:87], v[58:59]
v_add_f32_dpp v92, v92, v92 row_ror:4 row_mask:0xf bank_mask:0xf
s_waitcnt lgkmcnt(3)
v_pk_mul_f32 v[88:89], v[88:89], v[60:61]
v_pk_mul_f32 v[90:91], v[90:91], v[62:63]
v_add_f32_dpp v92, v92, v92 row_ror:2 row_mask:0xf bank_mask:0xf
s_nop 1
v_add_f32_dpp v92, v92, v92 row_ror:1 row_mask:0xf bank_mask:0xf
v_mov_b32 v94, v92
s_nop 1
v_permlane16_swap_b32 v92, v94
v_add_f32 v92, v92, v94
v_mov_b32 v94, v92
s_nop 1
v_permlane32_swap_b32 v92, v94
v_add_f32 v92, v92, v94
v_mov_b32 v94, 925353388
v_fmac_f32 v94, 986500301, v92
v_rsq_f32 v94, v94
s_nop 0
v_mov_b32 v95, v94
s_waitcnt lgkmcnt(2)
v_pk_fma_f32 v[64:65], v[80:81], v[94:95], v[64:65]
v_pk_fma_f32 v[66:67], v[82:83], v[94:95], v[66:67]
v_cvt_pk_bf16_f32 v40, v64, v65
v_cvt_pk_bf16_f32 v41, v66, v67
buffer_store_dwordx2 v[40:41], v14, s[4:7], s48 offen offset:0
s_waitcnt lgkmcnt(1)
v_pk_fma_f32 v[68:69], v[84:85], v[94:95], v[68:69]
v_pk_fma_f32 v[70:71], v[86:87], v[94:95], v[70:71]
v_cvt_pk_bf16_f32 v42, v68, v69
v_cvt_pk_bf16_f32 v43, v70, v71
buffer_store_dwordx2 v[42:43], v14, s[4:7], s48 offen offset:512
s_waitcnt lgkmcnt(0)
v_pk_fma_f32 v[72:73], v[88:89], v[94:95], v[72:73]
v_pk_fma_f32 v[74:75], v[90:91], v[94:95], v[74:75]
v_cvt_pk_bf16_f32 v44, v72, v73
v_cvt_pk_bf16_f32 v45, v74, v75
buffer_store_dwordx2 v[44:45], v15, s[4:7], s48 offen offset:1024
v_mov_b32 v48, s34
s_waitcnt vmcnt(0)
buffer_store_dword v48, off, s[4:7], s60 offset:512
L_p2_f:
buffer_load_dword v40, v18, s[4:7], s41 offen offset:512 sc1
s_add_u32 s27, s27, 1
s_cmp_gt_u32 s27, 262144
s_cbranch_scc1 L_fail_f
s_waitcnt vmcnt(0)
v_cmp_gt_u32 vcc, s34, v40
s_cbranch_vccnz L_p2_f
L_pln_f:
s_barrier
ds_read_b32 v81, v19 offset:53248
s_and_b32 s62, s34, 1
s_lshl_b32 s62, s62, 16
s_or_b32 s62, s62, 1
s_cmp_eq_u32 s34, 16
s_cselect_b32 s36, 0x40000000, s36
s_cmp_ge_u32 s25, 27
s_cbranch_scc1 L_pskip_f
s_add_u32 m0, s59, 65536
s_nop 0
buffer_load_dwordx4 v8, s[4:7], s49 offen offset:0 sc1 lds
s_add_u32 m0, s59, 66560
s_nop 0
buffer_load_dwordx4 v9, s[4:7], s49 offen offset:0 sc1 lds
s_nop 7
s_add_u32 m0, s59, 73472
s_nop 0
buffer_load_dwordx4 v8, s[4:7], s49 offen offset:256 sc1 lds
s_add_u32 m0, s59, 74496
s_nop 0
buffer_load_dwordx4 v9, s[4:7], s49 offen offset:256 sc1 lds
s_add_u32 m0, s59, 81408
s_nop 0
buffer_load_dwordx4 v8, s[4:7], s49 offen offset:512 sc1 lds
s_add_u32 m0, s59, 82432
s_nop 0
buffer_load_dwordx4 v9, s[4:7], s49 offen offset:512 sc1 lds
v_xor_b32 v40, 0, v16
v_xor_b32 v41, 32, v16
v_xor_b32 v42, 64, v16
v_xor_b32 v43, 96, v16
v_xor_b32 v44, 128, v16
v_xor_b32 v45, 160, v16
v_xor_b32 v46, 192, v16
v_xor_b32 v47, 224, v16
s_lshl_b32 s3, s26, 10
v_add_u32 v80, s3, v0
s_waitcnt vmcnt(4)
s_barrier
ds_read_b128 v[48:51], v40 offset:0
ds_read_b128 v[52:55], v41 offset:0
ds_read_b128 v[56:59], v42 offset:0
ds_read_b128 v[60:63], v43 offset:0
s_waitcnt lgkmcnt(3)
v_mfma_f32_32x32x16_bf16 v[64:79], a[16:19], v[48:51], 0
ds_read_b128 v[48:51], v44 offset:0
s_add_u32 m0, s59, 89344
s_nop 0
buffer_load_dwordx4 v8, s[4:7], s49 offen offset:768 sc1 lds
s_waitcnt lgkmcnt(3)
v_mfma_f32_32x32x16_bf16 v[64:79], a[20:23], v[52:55], v[64:79]
ds_read_b128 v[52:55], v45 offset:0
s_add_u32 m0, s59, 90368
s_nop 0
buffer_load_dwordx4 v9, s[4:7], s49 offen offset:768 sc1 lds
s_waitcnt lgkmcnt(3)
v_mfma_f32_32x32x16_bf16 v[64:79], a[24:27], v[56:59], v[64:79]
ds_read_b128 v[56:59], v46 offset:0
s_add_u32 m0, s59, 97280
s_nop 0
buffer_load_dwordx4 v8, s[4:7], s49 offen offset:1024 sc1 lds
s_waitcnt lgkmcnt(3)
v_mfma_f32_32x32x16_bf16 v[64:79], a[28:31], v[60:63], v[64:79]
ds_read_b128 v[60:63], v47 offset:0
s_add_u32 m0, s59, 98304
s_nop 0
buffer_load_dwordx4 v9, s[4:7], s49 offen offset:1024 sc1 lds
s_waitcnt lgkmcnt(3)
v_mfma_f32_32x32x16_bf16 v[64:79], a[32:35], v[48:51], v[64:79]
s_waitcnt vmcnt(6)
s_barrier
ds_read_b128 v[48:51], v40 offset:8192
s_waitcnt lgkmcnt(3)
v_mfma_f32_32x32x16_bf16 v[64:79], a[36:39], v[52:55], v[64:79]
ds_read_b128 v[52:55], v41 offset:8192
s_waitcnt lgkmcnt(3)
v_mfma_f32_32x32x16_bf16 v[64:79], a[40:43], v[56:59], v[64:79]
ds_read_b128 v[56:59], v42 offset:8192
v_readfirstlane_b32 s58, v81
s_cmp_lg_u32 s58, 0
s_cselect_b32 s31, s37, 0x40000000
s_waitcnt lgkmcnt(3)
v_mfma_f32_32x32x16_bf16 v[64:79], a[44:47], v[60:63], v[64:79]
ds_read_b128 v[60:63], v43 offset:8192
s_waitcnt lgkmcnt(3)
v_mfma_f32_32x32x16_bf16 v[64:79], a[48:51], v[48:51], v[64:79]
ds_read_b128 v[48:51], v44 offset:8192
s_waitcnt lgkmcnt(3)
v_mfma_f32_32x32x16_bf16 v[64:79], a[52:55], v[52:55], v[64:79]
ds_read_b128 v[52:55], v45 offset:8192
s_add_u32 m0, s51, 0
s_xor_b32 s3, s36, 0
buffer_load_dwordx4 v0, s[4:7], s3 offen offset:0 sc1 lds
s_waitcnt lgkmcnt(3)
v_mfma_f32_32x32x16_bf16 v[64:79], a[56:59], v[56:59], v[64:79]
ds_read_b128 v[56:59], v46 offset:8192
s_waitcnt lgkmcnt(3)
v_mfma_f32_32x32x16_bf16 v[64:79], a[60:63], v[60:63], v[64:79]
ds_read_b128 v[60:63], v47 offset:8192
buffer_load_dwordx4 v0, s[4:7], s3 offen offset:1024 sc1 lds
s_waitcnt lgkmcnt(3)
v_mfma_f32_32x32x16_bf16 v[64:79], a[64:67], v[48:51], v[64:79]
s_waitcnt vmcnt(6)
s_barrier
ds_read_b128 v[48:51], v40 offset:16384
s_waitcnt lgkmcnt(3)
v_mfma_f32_32x32x16_bf16 v[64:79], a[68:71], v[52:55], v[64:79]
ds_read_b128 v[52:55], v41 offset:16384
s_add_u32 m0, s51, 8192
s_xor_b32 s3, s36, 16384
buffer_load_dwordx4 v0, s[4:7], s3 offen offset:0 sc1 lds
s_waitcnt lgkmcnt(3)
v_mfma_f32_32x32x16_bf16 v[64:79], a[72:75], v[56:59], v[64:79]
ds_read_b128 v[56:59], v42 offset:16384
s_waitcnt lgkmcnt(3)
v_mfma_f32_32x32x16_bf16 v[64:79], a[76:79], v[60:63], v[64:79]
ds_read_b128 v[60:63], v43 offset:16384
buffer_load_dwordx4 v0, s[4:7], s3 offen offset:1024 sc1 lds
s_waitcnt lgkmcnt(3)
v_mfma_f32_32x32x16_bf16 v[64:79], a[80:83], v[48:51], v[64:79]
ds_read_b128 v[48:51], v44 offset:16384
s_waitcnt lgkmcnt(3)
v_mfma_f32_32x32x16_bf16 v[64:79], a[84:87], v[52:55], v[64:79]
ds_read_b128 v[52:55], v45 offset:16384
s_add_u32 m0, s51, 16384
s_xor_b32 s3, s36, 8192
buffer_load_dwordx4 v0, s[4:7], s3 offen offset:0 sc1 lds
s_waitcnt lgkmcnt(3)
v_mfma_f32_32x32x16_bf16 v[64:79], a[88:91], v[56:59], v[64:79]
ds_read_b128 v[56:59], v46 offset:16384
s_waitcnt lgkmcnt(3)
v_mfma_f32_32x32x16_bf16 v[64:79], a[92:95], v[60:63], v[64:79]
ds_read_b128 v[60:63], v47 offset:16384
buffer_load_dwordx4 v0, s[4:7], s3 offen offset:1024 sc1 lds
s_add_u32 s36, s36, 131072
s_waitcnt lgkmcnt(3)
v_mfma_f32_32x32x16_bf16 v[64:79], a[96:99], v[48:51], v[64:79]
s_waitcnt vmcnt(6)
s_barrier
ds_read_b128 v[48:51], v40 offset:24576
s_waitcnt lgkmcnt(3)
v_mfma_f32_32x32x16_bf16 v[64:79], a[100:103], v[52:55], v[64:79]
ds_read_b128 v[52:55], v41 offset:24576
s_waitcnt lgkmcnt(3)
v_mfma_f32_32x32x16_bf16 v[64:79], a[104:107], v[56:59], v[64:79]
ds_read_b128 v[56:59], v42 offset:24576
s_add_u32 m0, s52, 24576
s_nop 0
buffer_load_dwordx4 v0, s[4:7], s31 offen offset:0 sc1 lds
buffer_load_dwordx4 v0, s[4:7], s31 offen offset:1024 sc1 lds
s_waitcnt lgkmcnt(3)
v_mfma_f32_32x32x16_bf16 v[64:79], a[108:111], v[60:63], v[64:79]
ds_read_b128 v[60:63], v43 offset:24576
s_waitcnt lgkmcnt(3)
v_mfma_f32_32x32x16_bf16 v[64:79], a[112:115], v[48:51], v[64:79]
ds_read_b128 v[48:51], v44 offset:24576
s_waitcnt lgkmcnt(3)
v_mfma_f32_32x32x16_bf16 v[64:79], a[116:119], v[52:55], v[64:79]
ds_read_b128 v[52:55], v45 offset:24576
s_waitcnt lgkmcnt(3)
v_mfma_f32_32x32x16_bf16 v[64:79], a[120:123], v[56:59], v[64:79]
ds_read_b128 v[56:59], v46 offset:24576
s_waitcnt lgkmcnt(3)
v_mfma_f32_32x32x16_bf16 v[64:79], a[124:127], v[60:63], v[64:79]
ds_read_b128 v[60:63], v47 offset:24576
s_waitcnt lgkmcnt(3)
v_mfma_f32_32x32x16_bf16 v[64:79], a[128:131], v[48:51], v[64:79]
ds_read_b128 v[48:51], v40 offset:32768
s_waitcnt lgkmcnt(3)
v_mfma_f32_32x32x16_bf16 v[64:79], a[132:135], v[52:55], v[64:79]
ds_read_b128 v[52:55], v41 offset:32768
s_waitcnt lgkmcnt(3)
v_mfma_f32_32x32x16_bf16 v[64:79], a[136:139], v[56:59], v[64:79]
ds_read_b128 v[56:59], v42 offset:32768
s_waitcnt lgkmcnt(3)
v_mfma_f32_32x32x16_bf16 v[64:79], a[140:143], v[60:63], v[64:79]
ds_read_b128 v[60:63], v43 offset:32768
s_waitcnt lgkmcnt(3)
v_mfma_f32_32x32x16_bf16 v[64:79], a[144:147], v[48:51], v[64:79]
ds_read_b128 v[48:51], v44 offset:32768
s_waitcnt lgkmcnt(3)
v_mfma_f32_32x32x16_bf16 v[64:79], a[148:151], v[52:55], v[64:79]
ds_read_b128 v[52:55], v45 offset:32768
s_waitcnt lgkmcnt(3)
v_mfma_f32_32x32x16_bf16 v[64:79], a[152:155], v[56:59], v[64:79]
ds_read_b128 v[56:59], v46 offset:32768
s_waitcnt lgkmcnt(3)
v_mfma_f32_32x32x16_bf16 v[64:79], a[156:159], v[60:63], v[64:79]
ds_read_b128 v[60:63], v47 offset:32768
s_waitcnt lgkmcnt(3)
v_mfma_f32_32x32x16_bf16 v[64:79], a[160:163], v[48:51], v[64:79]
s_waitcnt lgkmcnt(2)
v_mfma_f32_32x32x16_bf16 v[64:79], a[164:167], v[52:55], v[64:79]
s_waitcnt lgkmcnt(1)
v_mfma_f32_32x32x16_bf16 v[64:79], a[168:171], v[56:59], v[64:79]
s_waitcnt lgkmcnt(0)
v_mfma_f32_32x32x16_bf16 v[64:79], a[172:175], v[60:63], v[64:79]
s_nop 11
v_max_f32 v64, 0, v64
v_max_f32 v65, 0, v65
v_max_f32 v66, 0, v66
v_max_f32 v67, 0, v67
v_max_f32 v68, 0, v68
v_max_f32 v69, 0, v69
v_max_f32 v70, 0, v70
v_max_f32 v71, 0, v71
v_pk_mul_f32 v[64:65], v[64:65], v[72:73]
v_pk_mul_f32 v[66:67], v[66:67], v[74:75]
v_pk_mul_f32 v[68:69], v[68:69], v[76:77]
v_pk_mul_f32 v[70:71], v[70:71], v[78:79]
v_cvt_pk_bf16_f32 v64, v64, v65
v_cvt_pk_bf16_f32 v65, v66, v67
v_cvt_pk_bf16_f32 v66, v68, v69
v_cvt_pk_bf16_f32 v67, v70, v71
ds_write_b128 v80, v[64:67] offset:61440
s_waitcnt lgkmcnt(0)
s_barrier
ds_read_b128 v[40:43], v0 offset:61440
ds_read_b128 v[44:47], v0 offset:62464
ds_read_b128 v[48:51], v0 offset:63488
ds_read_b128 v[52:55], v0 offset:64512
v_mov_b32 v56, s62
s_waitcnt lgkmcnt(3)
v_mfma_f32_32x32x16_bf16 v[72:87], a[176:179], v[40:43], 0
s_waitcnt lgkmcnt(2)
v_mfma_f32_32x32x16_bf16 v[72:87], a[180:183], v[44:47], v[72:87]
s_waitcnt lgkmcnt(1)
v_mfma_f32_32x32x16_bf16 v[72:87], a[184:187], v[48:51], v[72:87]
s_waitcnt lgkmcnt(0)
v_mfma_f32_32x32x16_bf16 v[72:87], a[188:191], v[52:55], v[72:87]
v_mfma_f32_32x32x16_bf16 v[88:103], a[192:195], v[40:43], 0
s_nop 3
s_nop 2
v_mfma_f32_32x32x16_bf16 v[88:103], a[196:199], v[44:47], v[88:103]
s_nop 2
v_cvt_pk_bf16_f32 v72, v72, v73
v_cvt_pk_bf16_f32 v73, v74, v75
v_cvt_pk_bf16_f32 v74, v76, v77
v_cvt_pk_bf16_f32 v75, v78, v79
v_mfma_f32_32x32x16_bf16 v[88:103], a[200:203], v[48:51], v[88:103]
v_bfi_b32 v72, s61, v56, v72
ds_write_b128 v3, v[72:75] offset:0
v_cvt_pk_bf16_f32 v76, v80, v81
v_cvt_pk_bf16_f32 v77, v82, v83
v_cvt_pk_bf16_f32 v78, v84, v85
v_mfma_f32_32x32x16_bf16 v[88:103], a[204:207], v[52:55], v[88:103]
v_cvt_pk_bf16_f32 v79, v86, v87
v_bfi_b32 v76, s61, v56, v76
ds_write_b128 v3, v[76:79] offset:32
ds_read_b128 v[104:107], v5 offset:0
ds_read_b128 v[108:111], v5 offset:1280
v_mfma_f32_32x32x16_bf16 v[72:87], a[208:211], v[40:43], 0
s_waitcnt lgkmcnt(1)
buffer_store_dwordx4 v[104:107], v7, s[4:7], s44 offen offset:0
s_waitcnt lgkmcnt(0)
buffer_store_dwordx4 v[108:111], v7, s[4:7], s45 offen offset:0
s_nop 3
v_mfma_f32_32x32x16_bf16 v[72:87], a[212:215], v[44:47], v[72:87]
v_cvt_pk_bf16_f32 v88, v88, v89
v_cvt_pk_bf16_f32 v89, v90, v91
v_cvt_pk_bf16_f32 v90, v92, v93
v_cvt_pk_bf16_f32 v91, v94, v95
v_mfma_f32_32x32x16_bf16 v[72:87], a[216:219], v[48:51], v[72:87]
v_bfi_b32 v88, s61, v56, v88
ds_write_b128 v3, v[88:91] offset:0
v_cvt_pk_bf16_f32 v92, v96, v97
v_cvt_pk_bf16_f32 v93, v98, v99
v_cvt_pk_bf16_f32 v94, v100, v101
v_mfma_f32_32x32x16_bf16 v[72:87], a[220:223], v[52:55], v[72:87]
v_cvt_pk_bf16_f32 v95, v102, v103
v_bfi_b32 v92, s61, v56, v92
ds_write_b128 v3, v[92:95] offset:32
ds_read_b128 v[104:107], v5 offset:0
ds_read_b128 v[108:111], v5 offset:1280
v_mfma_f32_32x32x16_bf16 v[88:103], a[224:227], v[40:43], 0
s_waitcnt lgkmcnt(1)
buffer_store_dwordx4 v[104:107], v7, s[4:7], s44 offen offset:256
s_waitcnt lgkmcnt(0)
buffer_store_dwordx4 v[108:111], v7, s[4:7], s45 offen offset:256
s_nop 3
v_mfma_f32_32x32x16_bf16 v[88:103], a[228:231], v[44:47], v[88:103]
v_cvt_pk_bf16_f32 v72, v72, v73
v_cvt_pk_bf16_f32 v73, v74, v75
v_cvt_pk_bf16_f32 v74, v76, v77
v_cvt_pk_bf16_f32 v75, v78, v79
v_mfma_f32_32x32x16_bf16 v[88:103], a[232:235], v[48:51], v[88:103]
v_bfi_b32 v72, s61, v56, v72
ds_write_b128 v3, v[72:75] offset:0
v_cvt_pk_bf16_f32 v76, v80, v81
v_cvt_pk_bf16_f32 v77, v82, v83
v_cvt_pk_bf16_f32 v78, v84, v85
v_mfma_f32_32x32x16_bf16 v[88:103], a[236:239], v[52:55], v[88:103]
v_cvt_pk_bf16_f32 v79, v86, v87
v_bfi_b32 v76, s61, v56, v76
ds_write_b128 v3, v[76:79] offset:32
ds_read_b128 v[104:107], v5 offset:0
ds_read_b128 v[108:111], v5 offset:1280
v_mfma_f32_32x32x16_bf16 v[72:87], a[240:243], v[40:43], 0
s_waitcnt lgkmcnt(1)
buffer_store_dwordx4 v[104:107], v7, s[4:7], s44 offen offset:512
s_waitcnt lgkmcnt(0)
buffer_store_dwordx4 v[108:111], v7, s[4:7], s45 offen offset:512
s_nop 3
v_mfma_f32_32x32x16_bf16 v[72:87], a[244:247], v[44:47], v[72:87]
v_cvt_pk_bf16_f32 v88, v88, v89
v_cvt_pk_bf16_f32 v89, v90, v91
v_cvt_pk_bf16_f32 v90, v92, v93
v_cvt_pk_bf16_f32 v91, v94, v95
v_mfma_f32_32x32x16_bf16 v[72:87], a[248:251], v[48:51], v[72:87]
v_bfi_b32 v88, s61, v56, v88
ds_write_b128 v3, v[88:91] offset:0
v_cvt_pk_bf16_f32 v92, v96, v97
v_cvt_pk_bf16_f32 v93, v98, v99
v_cvt_pk_bf16_f32 v94, v100, v101
v_mfma_f32_32x32x16_bf16 v[72:87], a[252:255], v[52:55], v[72:87]
v_cvt_pk_bf16_f32 v95, v102, v103
v_bfi_b32 v92, s61, v56, v92
ds_write_b128 v3, v[92:95] offset:32
ds_read_b128 v[104:107], v5 offset:0
ds_read_b128 v[108:111], v5 offset:1280
s_waitcnt lgkmcnt(1)
buffer_store_dwordx4 v[104:107], v7, s[4:7], s44 offen offset:768
s_waitcnt lgkmcnt(0)
buffer_store_dwordx4 v[108:111], v7, s[4:7], s45 offen offset:768
s_nop 2
v_cvt_pk_bf16_f32 v72, v72, v73
v_cvt_pk_bf16_f32 v73, v74, v75
v_cvt_pk_bf16_f32 v74, v76, v77
v_cvt_pk_bf16_f32 v75, v78, v79
v_bfi_b32 v72, s61, v56, v72
ds_write_b128 v3, v[72:75] offset:0
v_cvt_pk_bf16_f32 v76, v80, v81
v_cvt_pk_bf16_f32 v77, v82, v83
v_cvt_pk_bf16_f32 v78, v84, v85
v_cvt_pk_bf16_f32 v79, v86, v87
v_bfi_b32 v76, s61, v56, v76
ds_write_b128 v3, v[76:79] offset:32
ds_read_b128 v[104:107], v5 offset:0
ds_read_b128 v[108:111], v5 offset:1280
s_waitcnt lgkmcnt(1)
buffer_store_dwordx4 v[104:107], v7, s[4:7], s44 offen offset:1024
s_waitcnt lgkmcnt(0)
buffer_store_dwordx4 v[108:111], v7, s[4:7], s45 offen offset:1024
s_branch L_pffn_f
L_pskip_f:
s_waitcnt lgkmcnt(0)
v_readfirstlane_b32 s58, v81
s_cmp_lg_u32 s58, 0
s_cselect_b32 s31, s37, 0x40000000
s_add_u32 m0, s51, 0
s_xor_b32 s3, s36, 0
buffer_load_dwordx4 v0, s[4:7], s3 offen offset:0 sc1 lds
buffer_load_dwordx4 v0, s[4:7], s3 offen offset:1024 sc1 lds
s_add_u32 m0, s51, 8192
s_xor_b32 s3, s36, 16384
buffer_load_dwordx4 v0, s[4:7], s3 offen offset:0 sc1 lds
buffer_load_dwordx4 v0, s[4:7], s3 offen offset:1024 sc1 lds
s_add_u32 m0, s51, 16384
s_xor_b32 s3, s36, 8192
buffer_load_dwordx4 v0, s[4:7], s3 offen offset:0 sc1 lds
buffer_load_dwordx4 v0, s[4:7], s3 offen offset:1024 sc1 lds
s_add_u32 s36, s36, 131072
s_add_u32 m0, s52, 24576
s_nop 0
buffer_load_dwordx4 v0, s[4:7], s31 offen offset:0 sc1 lds
buffer_load_dwordx4 v0, s[4:7], s31 offen offset:1024 sc1 lds
s_waitcnt vmcnt(0)
L_pffn_f:
v_mov_b32 v40, s34
buffer_store_dword v40, off, s[4:7], s40 offset:1024
s_cmp_eq_u32 s58, 0
s_cbranch_scc1 L_pnat_f
s_waitcnt vmcnt(11)
s_barrier
ds_read_b128 v[40:43], v4 offset:16384
ds_read_b128 v[72:75], v0 offset:0
ds_read_b128 v[44:47], v4 offset:17408
ds_read_b128 v[76:79], v0 offset:1024
ds_read_b128 v[48:51], v4 offset:18432
ds_read_b128 v[80:83], v0 offset:2048
ds_read_b128 v[52:55], v4 offset:19456
ds_read_b128 v[84:87], v0 offset:3072
ds_read_b128 v[56:59], v0 offset:4096
ds_read_b128 v[60:63], v0 offset:5120
ds_read_b128 v[64:67], v0 offset:6144
ds_read_b128 v[68:71], v0 offset:7168
s_waitcnt lgkmcnt(10)
v_mfma_f32_16x16x32_bf16 v[92:95], v[72:75], v[40:43], 0
ds_read_b128 v[72:75], v6 offset:8192
s_waitcnt lgkmcnt(9)
v_mfma_f32_16x16x32_bf16 v[92:95], v[76:79], v[44:47], v[92:95]
ds_read_b128 v[76:79], v6 offset:9216
s_waitcnt lgkmcnt(8)
v_mfma_f32_16x16x32_bf16 v[92:95], v[80:83], v[48:51], v[92:95]
ds_read_b128 v[80:83], v6 offset:10240
s_waitcnt lgkmcnt(7)
v_mfma_f32_16x16x32_bf16 v[92:95], v[84:87], v[52:55], v[92:95]
ds_read_b128 v[84:87], v6 offset:11264
s_waitcnt lgkmcnt(7)
v_mfma_f32_16x16x32_bf16 v[96:99], v[56:59], v[40:43], 0
ds_read_b128 v[56:59], v0 offset:24576
s_waitcnt lgkmcnt(7)
v_mfma_f32_16x16x32_bf16 v[96:99], v[60:63], v[44:47], v[96:99]
ds_read_b128 v[60:63], v0 offset:25600
s_waitcnt lgkmcnt(7)
v_mfma_f32_16x16x32_bf16 v[96:99], v[64:67], v[48:51], v[96:99]
ds_read_b128 v[64:67], v0 offset:26624
s_waitcnt lgkmcnt(7)
v_mfma_f32_16x16x32_bf16 v[96:99], v[68:71], v[52:55], v[96:99]
ds_read_b128 v[68:71], v0 offset:27648
v_mov_b32 v110, s56
v_mov_b32 v107, 0
v_mov_b32 v108, 0
s_add_u32 s37, s37, 65536
ds_read_b64 v[100:101], v2 offset:0
ds_read_b64 v[102:103], v2 offset:512
s_waitcnt lgkmcnt(5)
v_mfma_f32_16x16x32_bf16 v[88:91], v[56:59], v[40:43], 0
s_waitcnt lgkmcnt(4)
v_mfma_f32_16x16x32_bf16 v[88:91], v[60:63], v[44:47], v[88:91]
s_waitcnt lgkmcnt(3)
v_mfma_f32_16x16x32_bf16 v[88:91], v[64:67], v[48:51], v[88:91]
s_waitcnt lgkmcnt(2)
v_mfma_f32_16x16x32_bf16 v[88:91], v[68:71], v[52:55], v[88:91]
v_cndmask_b32 v92, v92, v110, s[64:65]
v_cndmask_b32 v93, v93, v110, s[66:67]
v_cndmask_b32 v94, v94, v110, s[68:69]
v_cndmask_b32 v95, v95, v110, s[70:71]
v_cndmask_b32 v96, v96, v110, s[72:73]
v_cndmask_b32 v97, v97, v110, s[74:75]
v_cndmask_b32 v98, v98, v110, s[76:77]
v_cndmask_b32 v99, v99, v110, s[78:79]
v_max3_f32 v110, v92, v93, v94
v_max3_f32 v110, v110, v95, v96
v_max3_f32 v110, v110, v97, v98
v_max_f32 v110, v110, v99
v_max3_f32 v88, v90, v91, v110
v_mov_b32 v89, v88
s_nop 1
v_permlane16_swap_b32 v88, v89
v_max_f32 v88, v88, v89
v_mov_b32 v89, v88
s_nop 1
v_permlane32_swap_b32 v88, v89
v_max_f32 v88, v88, v89
v_sub_f32 v90, v90, v88
v_sub_f32 v91, v91, v88
v_sub_f32 v92, v92, v88
v_sub_f32 v93, v93, v88
v_sub_f32 v94, v94, v88
v_sub_f32 v95, v95, v88
v_sub_f32 v96, v96, v88
v_sub_f32 v97, v97, v88
v_sub_f32 v98, v98, v88
v_sub_f32 v99, v99, v88
v_exp_f32 v90, v90
v_exp_f32 v91, v91
v_exp_f32 v92, v92
v_exp_f32 v93, v93
v_exp_f32 v94, v94
v_exp_f32 v95, v95
v_exp_f32 v96, v96
v_exp_f32 v97, v97
v_exp_f32 v98, v98
v_exp_f32 v99, v99
v_cvt_pk_bf16_f32 v106, v90, v91
v_cvt_pk_bf16_f32 v109, v90, v91
v_cvt_pk_bf16_f32 v56, v92, v93
v_cvt_pk_bf16_f32 v57, v94, v95
v_cvt_pk_bf16_f32 v58, v96, v97
v_cvt_pk_bf16_f32 v59, v98, v99
s_nop 1
v_mfma_f32_16x16x32_bf16 v[40:43], v[72:75], v[56:59], 0
v_add_f32 v88, v90, v91
v_add_f32 v88, v88, v92
v_mfma_f32_16x16x32_bf16 v[44:47], v[76:79], v[56:59], 0
v_add_f32 v88, v88, v93
v_add_f32 v88, v88, v94
v_mfma_f32_16x16x32_bf16 v[48:51], v[80:83], v[56:59], 0
v_add_f32 v88, v88, v95
v_add_f32 v88, v88, v96
v_mfma_f32_16x16x32_bf16 v[52:55], v[84:87], v[56:59], 0
v_add_f32 v88, v88, v97
v_add_f32 v88, v88, v98
v_add_f32 v88, v88, v99
s_waitcnt lgkmcnt(1)
v_mfma_f32_16x16x16_bf16 v[40:43], v[100:101], v[106:107], v[40:43]
v_mov_b32 v89, v88
v_mfma_f32_16x16x16_bf16 v[44:47], v[100:101], v[108:109], v[44:47]
s_nop 0
v_permlane16_swap_b32 v88, v89
v_add_f32 v88, v88, v89
s_waitcnt lgkmcnt(0)
v_mfma_f32_16x16x16_bf16 v[48:51], v[102:103], v[106:107], v[48:51]
v_mov_b32 v89, v88
v_mfma_f32_16x16x16_bf16 v[52:55], v[102:103], v[108:109], v[52:55]
s_nop 0
v_permlane32_swap_b32 v88, v89
v_add_f32 v88, v88, v89
v_rcp_f32 v88, v88
s_nop 0
v_mov_b32 v89, v88
v_pk_mul_f32 v[40:41], v[40:41], v[88:89]
v_pk_mul_f32 v[42:43], v[42:43], v[88:89]
v_cvt_pk_bf16_f32 v40, v40, v41
v_cvt_pk_bf16_f32 v41, v42, v43
ds_write_b64 v1, v[40:41] offset:0
v_pk_mul_f32 v[44:45], v[44:45], v[88:89]
v_pk_mul_f32 v[46:47], v[46:47], v[88:89]
v_cvt_pk_bf16_f32 v44, v44, v45
v_cvt_pk_bf16_f32 v45, v46, v47
ds_write_b64 v1, v[44:45] offset:1024
v_pk_mul_f32 v[48:49], v[48:49], v[88:89]
v_pk_mul_f32 v[50:51], v[50:51], v[88:89]
v_cvt_pk_bf16_f32 v48, v48, v49
v_cvt_pk_bf16_f32 v49, v50, v51
ds_write_b64 v1, v[48:49] offset:2048
v_pk_mul_f32 v[52:53], v[52:53], v[88:89]
v_pk_mul_f32 v[54:55], v[54:55], v[88:89]
v_cvt_pk_bf16_f32 v52, v52, v53
v_cvt_pk_bf16_f32 v53, v54, v55
ds_write_b64 v1, v[52:53] offset:3072
s_waitcnt lgkmcnt(0)
L_pnat_f:
L_p3_f:
buffer_load_dword v40, v17, s[4:7], s41 offen offset:1024 sc1
s_add_u32 s27, s27, 1
s_cmp_gt_u32 s27, 262144
s_cbranch_scc1 L_fail_f
s_waitcnt vmcnt(0)
v_cmp_gt_u32 vcc, s34, v40
s_cbranch_vccnz L_p3_f
L_rr2_f:
buffer_load_dwordx4 v[40:43], v10, s[4:7], s47 offen offset:0 sc1
buffer_load_dwordx4 v[44:47], v11, s[4:7], s47 offen offset:0 sc1
buffer_load_dwordx4 v[48:51], v10, s[4:7], s47 offen offset:256 sc1
buffer_load_dwordx4 v[52:55], v11, s[4:7], s47 offen offset:256 sc1
buffer_load_dwordx4 v[56:59], v10, s[4:7], s47 offen offset:512 sc1
buffer_load_dwordx4 v[60:63], v11, s[4:7], s47 offen offset:512 sc1
buffer_load_dwordx4 v[64:67], v10, s[4:7], s47 offen offset:768 sc1
buffer_load_dwordx4 v[68:71], v11, s[4:7], s47 offen offset:768 sc1
buffer_load_dwordx4 v[72:75], v10, s[4:7], s47 offen offset:1024 sc1
buffer_load_dwordx4 v[76:79], v11, s[4:7], s47 offen offset:1024 sc1
v_add_u32 v92, s57, v0
ds_read_b128 v[96:99], v19 offset:50176
ds_read_b128 v[100:103], v19 offset:51200
ds_read_b128 v[104:107], v19 offset:52224
s_add_u32 s27, s27, 1
s_cmp_gt_u32 s27, 262144
s_cbranch_scc1 L_fail_f
s_waitcnt vmcnt(9)
v_mfma_f32_16x16x32_bf16 v[80:83], v[20:23], v[40:43], 0
v_xor_b32 v94, s62, v40
s_waitcnt vmcnt(8)
v_mfma_f32_16x16x32_bf16 v[80:83], v[20:23], v[44:47], v[80:83]
v_xor_b32 v95, s62, v44
s_waitcnt vmcnt(7)
v_mfma_f32_16x16x32_bf16 v[80:83], v[24:27], v[48:51], v[80:83]
v_bitop3_b32 v94, v94, v48, s62 bitop3:0xf6
s_waitcnt vmcnt(6)
v_mfma_f32_16x16x32_bf16 v[80:83], v[24:27], v[52:55], v[80:83]
v_bitop3_b32 v95, v95, v52, s62 bitop3:0xf6
s_waitcnt vmcnt(5)
v_mfma_f32_16x16x32_bf16 v[84:87], v[20:23], v[56:59], 0
v_bitop3_b32 v94, v94, v56, s62 bitop3:0xf6
s_waitcnt vmcnt(4)
v_mfma_f32_16x16x32_bf16 v[84:87], v[20:23], v[60:63], v[84:87]
v_bitop3_b32 v95, v95, v60, s62 bitop3:0xf6
s_nop 0
ds_write_b128 v92, v[80:83] offset:49152
s_waitcnt vmcnt(3)
v_mfma_f32_16x16x32_bf16 v[84:87], v[24:27], v[64:67], v[84:87]
v_bitop3_b32 v94, v94, v64, s62 bitop3:0xf6
s_waitcnt vmcnt(2)
v_mfma_f32_16x16x32_bf16 v[84:87], v[24:27], v[68:71], v[84:87]
v_bitop3_b32 v95, v95, v68, s62 bitop3:0xf6
s_waitcnt vmcnt(1)
v_mfma_f32_16x16x32_bf16 v[88:91], v[20:23], v[72:75], 0
v_bitop3_b32 v94, v94, v72, s62 bitop3:0xf6
s_waitcnt vmcnt(0)
v_mfma_f32_16x16x32_bf16 v[88:91], v[20:23], v[76:79], v[88:91]
v_bitop3_b32 v95, v95, v76, s62 bitop3:0xf6
s_nop 0
ds_write_b128 v92, v[84:87] offset:50176
v_cndmask_b32 v94, 0, v94, s[16:17]
v_cndmask_b32 v95, 0, v95, s[18:19]
v_bitop3_b32 v94, v94, v95, s61 bitop3:0xa8
v_cmp_ne_u32 vcc, 0, v94
s_nop 0
ds_write_b128 v92, v[88:91] offset:51200
s_cbranch_vccnz L_rr2_f
s_waitcnt lgkmcnt(0)
s_barrier
s_cmp_lg_u32 s26, 0
s_cbranch_scc1 L_pout_f
v_mov_b32 v93, s34
buffer_store_dword v93, off, s[4:7], s60 offset:640
ds_read_b128 v[40:43], v0 offset:52224
ds_read_b128 v[52:55], v0 offset:55296
ds_read_b128 v[64:67], v0 offset:58368
ds_read_b128 v[44:47], v0 offset:53248
ds_read_b128 v[56:59], v0 offset:56320
ds_read_b128 v[68:71], v0 offset:59392
ds_read_b128 v[48:51], v0 offset:54272
ds_read_b128 v[60:63], v0 offset:57344
ds_read_b128 v[72:75], v0 offset:60416
s_waitcnt lgkmcnt(8)
v_pk_add_f32 v[80:81], v[80:81], v[40:41]
s_waitcnt lgkmcnt(6)
v_pk_add_f32 v[52:53], v[52:53], v[64:65]
v_pk_add_f32 v[80:81], v[80:81], v[52:53]
v_pk_fma_f32 v[28:29], v[96:97], v[80:81], v[28:29]
v_pk_add_f32 v[82:83], v[82:83], v[42:43]
v_pk_add_f32 v[54:55], v[54:55], v[66:67]
v_pk_add_f32 v[82:83], v[82:83], v[54:55]
v_pk_fma_f32 v[30:31], v[98:99], v[82:83], v[30:31]
s_waitcnt lgkmcnt(5)
v_pk_add_f32 v[84:85], v[84:85], v[44:45]
s_waitcnt lgkmcnt(3)
v_pk_add_f32 v[56:57], v[56:57], v[68:69]
v_pk_add_f32 v[84:85], v[84:85], v[56:57]
v_pk_fma_f32 v[32:33], v[100:101], v[84:85], v[32:33]
v_pk_add_f32 v[86:87], v[86:87], v[46:47]
v_pk_add_f32 v[58:59], v[58:59], v[70:71]
v_pk_add_f32 v[86:87], v[86:87], v[58:59]
v_pk_fma_f32 v[34:35], v[102:103], v[86:87], v[34:35]
s_waitcnt lgkmcnt(2)
v_pk_add_f32 v[88:89], v[88:89], v[48:49]
s_waitcnt lgkmcnt(0)
v_pk_add_f32 v[60:61], v[60:61], v[72:73]
v_pk_add_f32 v[88:89], v[88:89], v[60:61]
v_pk_fma_f32 v[36:37], v[104:105], v[88:89], v[36:37]
v_pk_add_f32 v[90:91], v[90:91], v[50:51]
v_pk_add_f32 v[62:63], v[62:63], v[74:75]
v_pk_add_f32 v[90:91], v[90:91], v[62:63]
v_pk_fma_f32 v[38:39], v[106:107], v[90:91], v[38:39]
v_cvt_pk_bf16_f32 v52, v28, v29
v_cvt_pk_bf16_f32 v53, v30, v31
buffer_store_dwordx2 v[52:53], v12, s[12:15], s50 offen offset:0
v_cvt_pk_bf16_f32 v54, v32, v33
v_cvt_pk_bf16_f32 v55, v34, v35
buffer_store_dwordx2 v[54:55], v12, s[12:15], s50 offen offset:512
v_cvt_pk_bf16_f32 v56, v36, v37
v_cvt_pk_bf16_f32 v57, v38, v39
buffer_store_dwordx2 v[56:57], v13, s[12:15], s50 offen offset:1024
L_pout_f:
s_add_u32 s33, s33, 4
s_add_u32 s34, s34, 1
s_add_u32 s50, s50, 163840
s_cmp_lt_u32 s33, 64
s_cbranch_scc1 L_unit_f
s_endpgm
L_role_k_f:
s_cmp_eq_u32 s24, 3
s_cbranch_scc1 L_role_v_f
s_mov_b32 s8, s70
s_mov_b32 s9, s71
s_mov_b32 s10, 5242880
s_mov_b32 s11, 0x20000
s_mov_b32 s12, s68
s_mov_b32 s13, s69
s_mov_b32 s14, 5242880
s_mov_b32 s15, 0x20000
v_mbcnt_lo_u32_b32 v0, -1, 0
v_mbcnt_hi_u32_b32 v0, -1, v0
s_lshl_b32 s37, s25, 7
s_lshl_b32 s3, s26, 2
s_add_u32 s37, s37, s3
s_add_u32 s37, s37, 0
s_cmp_lg_u32 s26, 0
s_cbranch_scc1 L_arrk_f
s_mul_i32 s3, s24, 66
s_and_b32 s3, s3, 0xc8
s_add_u32 s3, s3, s76
v_mov_b32 v10, s3
s_lshl_b32 s3, 1, s25
v_mov_b32 v8, s3
s_add_u32 s3, s78, 0x10000
v_mov_b32 v9, s3
s_mov_b64 exec, 1
global_atomic_add_x2 v10, v[8:9], s[28:29] sc1
s_mov_b64 exec, -1
L_arrk_f:
s_lshl_b32 s30, s26, 15
s_lshl_b32 s31, s25, 8
s_add_u32 s31, s31, s30
s_lshl_b32 s38, s26, 10
v_lshrrev_b32 v8, 4, v0
v_and_b32 v9, 15, v0
v_lshlrev_b32 v5, 13, v8
v_lshl_add_u32 v5, v9, 4, v5
v_add_u32 v5, s31, v5
v_bfe_u32 v10, v0, 2, 2
v_and_b32 v9, 3, v0
v_lshlrev_b32 v6, 11, v8
v_lshl_add_u32 v6, v10, 8, v6
v_lshl_add_u32 v6, v9, 3, v6
s_lshl_b32 s30, s26, 6
v_add_u32 v6, s30, v6
v_lshlrev_b32 v1, 4, v0
v_add_u32 v3, 4096, v1
s_add_u32 m0, s38, 0
s_mov_b32 s3, 0
buffer_load_dwordx4 v5, s[8:11], s3 offen lds
s_add_u32 m0, s38, 4096
s_mov_b32 s3, 131072
buffer_load_dwordx4 v5, s[8:11], s3 offen lds
s_add_u32 m0, s38, 8192
s_mov_b32 s3, 262144
buffer_load_dwordx4 v5, s[8:11], s3 offen lds
s_add_u32 m0, s38, 12288
s_mov_b32 s3, 393216
buffer_load_dwordx4 v5, s[8:11], s3 offen lds
s_add_u32 m0, s38, 16384
s_mov_b32 s3, 524288
buffer_load_dwordx4 v5, s[8:11], s3 offen lds
s_add_u32 m0, s38, 20480
s_mov_b32 s3, 655360
buffer_load_dwordx4 v5, s[8:11], s3 offen lds
s_add_u32 m0, s38, 24576
s_mov_b32 s3, 786432
buffer_load_dwordx4 v5, s[8:11], s3 offen lds
s_add_u32 m0, s38, 28672
s_mov_b32 s3, 917504
buffer_load_dwordx4 v5, s[8:11], s3 offen lds
s_add_u32 m0, s38, 32768
s_mov_b32 s3, 1048576
buffer_load_dwordx4 v5, s[8:11], s3 offen lds
s_add_u32 m0, s38, 36864
s_mov_b32 s3, 1179648
buffer_load_dwordx4 v5, s[8:11], s3 offen lds
s_add_u32 m0, s38, 40960
s_mov_b32 s3, 1310720
buffer_load_dwordx4 v5, s[8:11], s3 offen lds
s_add_u32 m0, s38, 45056
s_mov_b32 s3, 1441792
buffer_load_dwordx4 v5, s[8:11], s3 offen lds
s_add_u32 m0, s38, 49152
s_mov_b32 s3, 1572864
buffer_load_dwordx4 v5, s[8:11], s3 offen lds
s_add_u32 m0, s38, 53248
s_mov_b32 s3, 1703936
buffer_load_dwordx4 v5, s[8:11], s3 offen lds
s_add_u32 m0, s38, 57344
s_mov_b32 s3, 1835008
buffer_load_dwordx4 v5, s[8:11], s3 offen lds
s_add_u32 m0, s38, 61440
s_mov_b32 s3, 1966080
buffer_load_dwordx4 v5, s[8:11], s3 offen lds
v_add_u32 v8, 0, v6
s_waitcnt vmcnt(12)
s_barrier
ds_read_b64_tr_b16 v[192:193], v8 offset:0
ds_read_b64_tr_b16 v[194:195], v8 offset:1024
ds_read_b64_tr_b16 v[196:197], v8 offset:32
ds_read_b64_tr_b16 v[198:199], v8 offset:1056
ds_read_b64_tr_b16 v[200:201], v8 offset:8192
ds_read_b64_tr_b16 v[202:203], v8 offset:9216
ds_read_b64_tr_b16 v[204:205], v8 offset:8224
ds_read_b64_tr_b16 v[206:207], v8 offset:9248
s_add_u32 m0, s38, 65536
s_mov_b32 s3, 2097152
buffer_load_dwordx4 v5, s[8:11], s3 offen lds
s_add_u32 m0, s38, 69632
s_mov_b32 s3, 2228224
buffer_load_dwordx4 v5, s[8:11], s3 offen lds
s_add_u32 m0, s38, 73728
s_mov_b32 s3, 2359296
buffer_load_dwordx4 v5, s[8:11], s3 offen lds
s_add_u32 m0, s38, 77824
s_mov_b32 s3, 2490368
buffer_load_dwordx4 v5, s[8:11], s3 offen lds
v_add_u32 v8, 16384, v6
s_waitcnt vmcnt(12)
s_waitcnt lgkmcnt(0)
s_barrier
ds_read_b64_tr_b16 v[208:209], v8 offset:0
ds_read_b64_tr_b16 v[210:211], v8 offset:1024
ds_read_b64_tr_b16 v[212:213], v8 offset:32
ds_read_b64_tr_b16 v[214:215], v8 offset:1056
ds_read_b64_tr_b16 v[216:217], v8 offset:8192
ds_read_b64_tr_b16 v[218:219], v8 offset:9216
ds_read_b64_tr_b16 v[220:221], v8 offset:8224
ds_read_b64_tr_b16 v[222:223], v8 offset:9248
s_add_u32 m0, s38, 81920
s_mov_b32 s3, 2621440
buffer_load_dwordx4 v5, s[8:11], s3 offen lds
s_add_u32 m0, s38, 86016
s_mov_b32 s3, 2752512
buffer_load_dwordx4 v5, s[8:11], s3 offen lds
s_add_u32 m0, s38, 90112
s_mov_b32 s3, 2883584
buffer_load_dwordx4 v5, s[8:11], s3 offen lds
s_add_u32 m0, s38, 94208
s_mov_b32 s3, 3014656
buffer_load_dwordx4 v5, s[8:11], s3 offen lds
v_add_u32 v8, 32768, v6
s_waitcnt vmcnt(12)
s_waitcnt lgkmcnt(0)
s_barrier
ds_read_b64_tr_b16 v[224:225], v8 offset:0
ds_read_b64_tr_b16 v[226:227], v8 offset:1024
ds_read_b64_tr_b16 v[228:229], v8 offset:32
ds_read_b64_tr_b16 v[230:231], v8 offset:1056
ds_read_b64_tr_b16 v[232:233], v8 offset:8192
ds_read_b64_tr_b16 v[234:235], v8 offset:9216
ds_read_b64_tr_b16 v[236:237], v8 offset:8224
ds_read_b64_tr_b16 v[238:239], v8 offset:9248
s_add_u32 m0, s38, 98304
s_mov_b32 s3, 3145728
buffer_load_dwordx4 v5, s[8:11], s3 offen lds
s_add_u32 m0, s38, 102400
s_mov_b32 s3, 3276800
buffer_load_dwordx4 v5, s[8:11], s3 offen lds
s_add_u32 m0, s38, 106496
s_mov_b32 s3, 3407872
buffer_load_dwordx4 v5, s[8:11], s3 offen lds
s_add_u32 m0, s38, 110592
s_mov_b32 s3, 3538944
buffer_load_dwordx4 v5, s[8:11], s3 offen lds
v_add_u32 v8, 49152, v6
s_waitcnt vmcnt(12)
s_waitcnt lgkmcnt(0)
s_barrier
ds_read_b64_tr_b16 v[240:241], v8 offset:0
ds_read_b64_tr_b16 v[242:243], v8 offset:1024
ds_read_b64_tr_b16 v[244:245], v8 offset:32
ds_read_b64_tr_b16 v[246:247], v8 offset:1056
ds_read_b64_tr_b16 v[248:249], v8 offset:8192
ds_read_b64_tr_b16 v[250:251], v8 offset:9216
ds_read_b64_tr_b16 v[252:253], v8 offset:8224
ds_read_b64_tr_b16 v[254:255], v8 offset:9248
s_add_u32 m0, s38, 114688
s_mov_b32 s3, 3670016
buffer_load_dwordx4 v5, s[8:11], s3 offen lds
s_add_u32 m0, s38, 118784
s_mov_b32 s3, 3801088
buffer_load_dwordx4 v5, s[8:11], s3 offen lds
s_add_u32 m0, s38, 122880
s_mov_b32 s3, 3932160
buffer_load_dwordx4 v5, s[8:11], s3 offen lds
s_add_u32 m0, s38, 126976
s_mov_b32 s3, 4063232
buffer_load_dwordx4 v5, s[8:11], s3 offen lds
v_add_u32 v8, 65536, v6
s_waitcnt vmcnt(12)
s_waitcnt lgkmcnt(0)
s_barrier
ds_read_b64_tr_b16 a[0:1], v8 offset:0
ds_read_b64_tr_b16 a[2:3], v8 offset:1024
ds_read_b64_tr_b16 a[4:5], v8 offset:32
ds_read_b64_tr_b16 a[6:7], v8 offset:1056
ds_read_b64_tr_b16 a[8:9], v8 offset:8192
ds_read_b64_tr_b16 a[10:11], v8 offset:9216
ds_read_b64_tr_b16 a[12:13], v8 offset:8224
ds_read_b64_tr_b16 a[14:15], v8 offset:9248
s_add_u32 m0, s38, 131072
s_mov_b32 s3, 4194304
buffer_load_dwordx4 v5, s[8:11], s3 offen lds
s_add_u32 m0, s38, 135168
s_mov_b32 s3, 4325376
buffer_load_dwordx4 v5, s[8:11], s3 offen lds
s_add_u32 m0, s38, 139264
s_mov_b32 s3, 4456448
buffer_load_dwordx4 v5, s[8:11], s3 offen lds
s_add_u32 m0, s38, 143360
s_mov_b32 s3, 4587520
buffer_load_dwordx4 v5, s[8:11], s3 offen lds
v_add_u32 v8, 81920, v6
s_waitcnt vmcnt(12)
s_waitcnt lgkmcnt(0)
s_barrier
ds_read_b64_tr_b16 a[16:17], v8 offset:0
ds_read_b64_tr_b16 a[18:19], v8 offset:1024
ds_read_b64_tr_b16 a[20:21], v8 offset:32
ds_read_b64_tr_b16 a[22:23], v8 offset:1056
ds_read_b64_tr_b16 a[24:25], v8 offset:8192
ds_read_b64_tr_b16 a[26:27], v8 offset:9216
ds_read_b64_tr_b16 a[28:29], v8 offset:8224
ds_read_b64_tr_b16 a[30:31], v8 offset:9248
s_add_u32 m0, s38, 147456
s_mov_b32 s3, 4718592
buffer_load_dwordx4 v5, s[8:11], s3 offen lds
s_add_u32 m0, s38, 151552
s_mov_b32 s3, 4849664
buffer_load_dwordx4 v5, s[8:11], s3 offen lds
s_add_u32 m0, s38, 155648
s_mov_b32 s3, 4980736
buffer_load_dwordx4 v5, s[8:11], s3 offen lds
s_add_u32 m0, s38, 159744
s_mov_b32 s3, 5111808
buffer_load_dwordx4 v5, s[8:11], s3 offen lds
v_add_u32 v8, 98304, v6
s_waitcnt vmcnt(12)
s_waitcnt lgkmcnt(0)
s_barrier
ds_read_b64_tr_b16 a[32:33], v8 offset:0
ds_read_b64_tr_b16 a[34:35], v8 offset:1024
ds_read_b64_tr_b16 a[36:37], v8 offset:32
ds_read_b64_tr_b16 a[38:39], v8 offset:1056
ds_read_b64_tr_b16 a[40:41], v8 offset:8192
ds_read_b64_tr_b16 a[42:43], v8 offset:9216
ds_read_b64_tr_b16 a[44:45], v8 offset:8224
ds_read_b64_tr_b16 a[46:47], v8 offset:9248
s_add_u32 m0, s38, 0
s_mov_b32 s3, 0
buffer_load_dwordx4 v5, s[12:15], s3 offen lds
s_add_u32 m0, s38, 4096
s_mov_b32 s3, 131072
buffer_load_dwordx4 v5, s[12:15], s3 offen lds
s_add_u32 m0, s38, 8192
s_mov_b32 s3, 262144
buffer_load_dwordx4 v5, s[12:15], s3 offen lds
s_add_u32 m0, s38, 12288
s_mov_b32 s3, 393216
buffer_load_dwordx4 v5, s[12:15], s3 offen lds
v_add_u32 v8, 114688, v6
s_waitcnt vmcnt(12)
s_waitcnt lgkmcnt(0)
s_barrier
ds_read_b64_tr_b16 a[48:49], v8 offset:0
ds_read_b64_tr_b16 a[50:51], v8 offset:1024
ds_read_b64_tr_b16 a[52:53], v8 offset:32
ds_read_b64_tr_b16 a[54:55], v8 offset:1056
ds_read_b64_tr_b16 a[56:57], v8 offset:8192
ds_read_b64_tr_b16 a[58:59], v8 offset:9216
ds_read_b64_tr_b16 a[60:61], v8 offset:8224
ds_read_b64_tr_b16 a[62:63], v8 offset:9248
s_add_u32 m0, s38, 16384
s_mov_b32 s3, 524288
buffer_load_dwordx4 v5, s[12:15], s3 offen lds
s_add_u32 m0, s38, 20480
s_mov_b32 s3, 655360
buffer_load_dwordx4 v5, s[12:15], s3 offen lds
s_add_u32 m0, s38, 24576
s_mov_b32 s3, 786432
buffer_load_dwordx4 v5, s[12:15], s3 offen lds
s_add_u32 m0, s38, 28672
s_mov_b32 s3, 917504
buffer_load_dwordx4 v5, s[12:15], s3 offen lds
v_add_u32 v8, 131072, v6
s_waitcnt vmcnt(12)
s_waitcnt lgkmcnt(0)
s_barrier
ds_read_b64_tr_b16 a[64:65], v8 offset:0
ds_read_b64_tr_b16 a[66:67], v8 offset:1024
ds_read_b64_tr_b16 a[68:69], v8 offset:32
ds_read_b64_tr_b16 a[70:71], v8 offset:1056
ds_read_b64_tr_b16 a[72:73], v8 offset:8192
ds_read_b64_tr_b16 a[74:75], v8 offset:9216
ds_read_b64_tr_b16 a[76:77], v8 offset:8224
ds_read_b64_tr_b16 a[78:79], v8 offset:9248
s_add_u32 m0, s38, 32768
s_mov_b32 s3, 1048576
buffer_load_dwordx4 v5, s[12:15], s3 offen lds
s_add_u32 m0, s38, 36864
s_mov_b32 s3, 1179648
buffer_load_dwordx4 v5, s[12:15], s3 offen lds
s_add_u32 m0, s38, 40960
s_mov_b32 s3, 1310720
buffer_load_dwordx4 v5, s[12:15], s3 offen lds
s_add_u32 m0, s38, 45056
s_mov_b32 s3, 1441792
buffer_load_dwordx4 v5, s[12:15], s3 offen lds
v_add_u32 v8, 147456, v6
s_waitcnt vmcnt(12)
s_waitcnt lgkmcnt(0)
s_barrier
ds_read_b64_tr_b16 a[80:81], v8 offset:0
ds_read_b64_tr_b16 a[82:83], v8 offset:1024
ds_read_b64_tr_b16 a[84:85], v8 offset:32
ds_read_b64_tr_b16 a[86:87], v8 offset:1056
ds_read_b64_tr_b16 a[88:89], v8 offset:8192
ds_read_b64_tr_b16 a[90:91], v8 offset:9216
ds_read_b64_tr_b16 a[92:93], v8 offset:8224
ds_read_b64_tr_b16 a[94:95], v8 offset:9248
s_add_u32 m0, s38, 49152
s_mov_b32 s3, 1572864
buffer_load_dwordx4 v5, s[12:15], s3 offen lds
s_add_u32 m0, s38, 53248
s_mov_b32 s3, 1703936
buffer_load_dwordx4 v5, s[12:15], s3 offen lds
s_add_u32 m0, s38, 57344
s_mov_b32 s3, 1835008
buffer_load_dwordx4 v5, s[12:15], s3 offen lds
s_add_u32 m0, s38, 61440
s_mov_b32 s3, 1966080
buffer_load_dwordx4 v5, s[12:15], s3 offen lds
v_add_u32 v8, 0, v6
s_waitcnt vmcnt(12)
s_waitcnt lgkmcnt(0)
s_barrier
ds_read_b64_tr_b16 a[96:97], v8 offset:0
ds_read_b64_tr_b16 a[98:99], v8 offset:1024
ds_read_b64_tr_b16 a[100:101], v8 offset:32
ds_read_b64_tr_b16 a[102:103], v8 offset:1056
ds_read_b64_tr_b16 a[104:105], v8 offset:8192
ds_read_b64_tr_b16 a[106:107], v8 offset:9216
ds_read_b64_tr_b16 a[108:109], v8 offset:8224
ds_read_b64_tr_b16 a[110:111], v8 offset:9248
s_add_u32 m0, s38, 65536
s_mov_b32 s3, 2097152
buffer_load_dwordx4 v5, s[12:15], s3 offen lds
s_add_u32 m0, s38, 69632
s_mov_b32 s3, 2228224
buffer_load_dwordx4 v5, s[12:15], s3 offen lds
s_add_u32 m0, s38, 73728
s_mov_b32 s3, 2359296
buffer_load_dwordx4 v5, s[12:15], s3 offen lds
s_add_u32 m0, s38, 77824
s_mov_b32 s3, 2490368
buffer_load_dwordx4 v5, s[12:15], s3 offen lds
v_add_u32 v8, 16384, v6
s_waitcnt vmcnt(12)
s_waitcnt lgkmcnt(0)
s_barrier
ds_read_b64_tr_b16 a[112:113], v8 offset:0
ds_read_b64_tr_b16 a[114:115], v8 offset:1024
ds_read_b64_tr_b16 a[116:117], v8 offset:32
ds_read_b64_tr_b16 a[118:119], v8 offset:1056
ds_read_b64_tr_b16 a[120:121], v8 offset:8192
ds_read_b64_tr_b16 a[122:123], v8 offset:9216
ds_read_b64_tr_b16 a[124:125], v8 offset:8224
ds_read_b64_tr_b16 a[126:127], v8 offset:9248
s_add_u32 m0, s38, 81920
s_mov_b32 s3, 2621440
buffer_load_dwordx4 v5, s[12:15], s3 offen lds
s_add_u32 m0, s38, 86016
s_mov_b32 s3, 2752512
buffer_load_dwordx4 v5, s[12:15], s3 offen lds
s_add_u32 m0, s38, 90112
s_mov_b32 s3, 2883584
buffer_load_dwordx4 v5, s[12:15], s3 offen lds
s_add_u32 m0, s38, 94208
s_mov_b32 s3, 3014656
buffer_load_dwordx4 v5, s[12:15], s3 offen lds
v_add_u32 v8, 32768, v6
s_waitcnt vmcnt(12)
s_waitcnt lgkmcnt(0)
s_barrier
ds_read_b64_tr_b16 a[128:129], v8 offset:0
ds_read_b64_tr_b16 a[130:131], v8 offset:1024
ds_read_b64_tr_b16 a[132:133], v8 offset:32
ds_read_b64_tr_b16 a[134:135], v8 offset:1056
ds_read_b64_tr_b16 a[136:137], v8 offset:8192
ds_read_b64_tr_b16 a[138:139], v8 offset:9216
ds_read_b64_tr_b16 a[140:141], v8 offset:8224
ds_read_b64_tr_b16 a[142:143], v8 offset:9248
s_add_u32 m0, s38, 98304
s_mov_b32 s3, 3145728
buffer_load_dwordx4 v5, s[12:15], s3 offen lds
s_add_u32 m0, s38, 102400
s_mov_b32 s3, 3276800
buffer_load_dwordx4 v5, s[12:15], s3 offen lds
s_add_u32 m0, s38, 106496
s_mov_b32 s3, 3407872
buffer_load_dwordx4 v5, s[12:15], s3 offen lds
s_add_u32 m0, s38, 110592
s_mov_b32 s3, 3538944
buffer_load_dwordx4 v5, s[12:15], s3 offen lds
v_add_u32 v8, 49152, v6
s_waitcnt vmcnt(12)
s_waitcnt lgkmcnt(0)
s_barrier
ds_read_b64_tr_b16 a[144:145], v8 offset:0
ds_read_b64_tr_b16 a[146:147], v8 offset:1024
ds_read_b64_tr_b16 a[148:149], v8 offset:32
ds_read_b64_tr_b16 a[150:151], v8 offset:1056
ds_read_b64_tr_b16 a[152:153], v8 offset:8192
ds_read_b64_tr_b16 a[154:155], v8 offset:9216
ds_read_b64_tr_b16 a[156:157], v8 offset:8224
ds_read_b64_tr_b16 a[158:159], v8 offset:9248
s_add_u32 m0, s38, 114688
s_mov_b32 s3, 3670016
buffer_load_dwordx4 v5, s[12:15], s3 offen lds
s_add_u32 m0, s38, 118784
s_mov_b32 s3, 3801088
buffer_load_dwordx4 v5, s[12:15], s3 offen lds
s_add_u32 m0, s38, 122880
s_mov_b32 s3, 3932160
buffer_load_dwordx4 v5, s[12:15], s3 offen lds
s_add_u32 m0, s38, 126976
s_mov_b32 s3, 4063232
buffer_load_dwordx4 v5, s[12:15], s3 offen lds
v_add_u32 v8, 65536, v6
s_waitcnt vmcnt(12)
s_waitcnt lgkmcnt(0)
s_barrier
ds_read_b64_tr_b16 a[160:161], v8 offset:0
ds_read_b64_tr_b16 a[162:163], v8 offset:1024
ds_read_b64_tr_b16 a[164:165], v8 offset:32
ds_read_b64_tr_b16 a[166:167], v8 offset:1056
ds_read_b64_tr_b16 a[168:169], v8 offset:8192
ds_read_b64_tr_b16 a[170:171], v8 offset:9216
ds_read_b64_tr_b16 a[172:173], v8 offset:8224
ds_read_b64_tr_b16 a[174:175], v8 offset:9248
s_add_u32 m0, s38, 131072
s_mov_b32 s3, 4194304
buffer_load_dwordx4 v5, s[12:15], s3 offen lds
s_add_u32 m0, s38, 135168
s_mov_b32 s3, 4325376
buffer_load_dwordx4 v5, s[12:15], s3 offen lds
s_add_u32 m0, s38, 139264
s_mov_b32 s3, 4456448
buffer_load_dwordx4 v5, s[12:15], s3 offen lds
s_add_u32 m0, s38, 143360
s_mov_b32 s3, 4587520
buffer_load_dwordx4 v5, s[12:15], s3 offen lds
v_add_u32 v8, 81920, v6
s_waitcnt vmcnt(12)
s_waitcnt lgkmcnt(0)
s_barrier
ds_read_b64_tr_b16 a[176:177], v8 offset:0
ds_read_b64_tr_b16 a[178:179], v8 offset:1024
ds_read_b64_tr_b16 a[180:181], v8 offset:32
ds_read_b64_tr_b16 a[182:183], v8 offset:1056
ds_read_b64_tr_b16 a[184:185], v8 offset:8192
ds_read_b64_tr_b16 a[186:187], v8 offset:9216
ds_read_b64_tr_b16 a[188:189], v8 offset:8224
ds_read_b64_tr_b16 a[190:191], v8 offset:9248
s_add_u32 m0, s38, 147456
s_mov_b32 s3, 4718592
buffer_load_dwordx4 v5, s[12:15], s3 offen lds
s_add_u32 m0, s38, 151552
s_mov_b32 s3, 4849664
buffer_load_dwordx4 v5, s[12:15], s3 offen lds
s_add_u32 m0, s38, 155648
s_mov_b32 s3, 4980736
buffer_load_dwordx4 v5, s[12:15], s3 offen lds
s_add_u32 m0, s38, 159744
s_mov_b32 s3, 5111808
buffer_load_dwordx4 v5, s[12:15], s3 offen lds
v_lshlrev_b32 v82, 2, v0
global_load_dword v83, v82, s[28:29] sc1
v_add_u32 v8, 98304, v6
s_waitcnt vmcnt(13)
s_waitcnt lgkmcnt(0)
s_barrier
ds_read_b64_tr_b16 a[192:193], v8 offset:0
ds_read_b64_tr_b16 a[194:195], v8 offset:1024
ds_read_b64_tr_b16 a[196:197], v8 offset:32
ds_read_b64_tr_b16 a[198:199], v8 offset:1056
ds_read_b64_tr_b16 a[200:201], v8 offset:8192
ds_read_b64_tr_b16 a[202:203], v8 offset:9216
ds_read_b64_tr_b16 a[204:205], v8 offset:8224
ds_read_b64_tr_b16 a[206:207], v8 offset:9248
v_add_u32 v8, 114688, v6
s_waitcnt vmcnt(9)
s_waitcnt lgkmcnt(0)
s_barrier
ds_read_b64_tr_b16 a[208:209], v8 offset:0
ds_read_b64_tr_b16 a[210:211], v8 offset:1024
ds_read_b64_tr_b16 a[212:213], v8 offset:32
ds_read_b64_tr_b16 a[214:215], v8 offset:1056
ds_read_b64_tr_b16 a[216:217], v8 offset:8192
ds_read_b64_tr_b16 a[218:219], v8 offset:9216
ds_read_b64_tr_b16 a[220:221], v8 offset:8224
ds_read_b64_tr_b16 a[222:223], v8 offset:9248
v_add_u32 v8, 131072, v6
s_waitcnt vmcnt(5)
s_waitcnt lgkmcnt(0)
s_barrier
ds_read_b64_tr_b16 a[224:225], v8 offset:0
ds_read_b64_tr_b16 a[226:227], v8 offset:1024
ds_read_b64_tr_b16 a[228:229], v8 offset:32
ds_read_b64_tr_b16 a[230:231], v8 offset:1056
ds_read_b64_tr_b16 a[232:233], v8 offset:8192
ds_read_b64_tr_b16 a[234:235], v8 offset:9216
ds_read_b64_tr_b16 a[236:237], v8 offset:8224
ds_read_b64_tr_b16 a[238:239], v8 offset:9248
v_add_u32 v8, 147456, v6
s_waitcnt vmcnt(1)
s_waitcnt lgkmcnt(0)
s_barrier
ds_read_b64_tr_b16 a[240:241], v8 offset:0
ds_read_b64_tr_b16 a[242:243], v8 offset:1024
ds_read_b64_tr_b16 a[244:245], v8 offset:32
ds_read_b64_tr_b16 a[246:247], v8 offset:1056
ds_read_b64_tr_b16 a[248:249], v8 offset:8192
ds_read_b64_tr_b16 a[250:251], v8 offset:9216
ds_read_b64_tr_b16 a[252:253], v8 offset:8224
ds_read_b64_tr_b16 a[254:255], v8 offset:9248
s_waitcnt lgkmcnt(0)
s_barrier
s_branch L_kc1k_f
L_kc0k_f:
global_load_dword v83, v82, s[28:29] sc1
s_add_u32 s27, s27, 1
s_cmp_gt_u32 s27, 262144
s_cbranch_scc1 L_fail_f
L_kc1k_f:
s_lshl_b32 s3, s77, 4
s_add_u32 s3, s3, 14
s_waitcnt vmcnt(0)
v_readlane_b32 s3, v83, s3
s_cmp_lt_u32 s3, 0x400000
s_cbranch_scc1 L_kc0k_f
s_and_b32 s31, s3, 0xff
s_cmp_ge_u32 s31, 32
s_cselect_b32 s30, 8192, 0
s_bfe_u32 s31, s3, 0x80008
s_cmp_ge_u32 s31, 32
s_cselect_b32 s31, 0, 16384
s_add_u32 s30, s30, s31
s_mul_i32 s35, s25, 2097152
s_add_u32 s35, s35, 50331648
s_lshr_b32 s3, s35, 8
s_xor_b32 s3, s3, s30
s_and_b32 s3, s3, 8192
s_add_u32 s35, s35, s3
s_lshl_b32 s3, s26, 10
s_xor_b32 s36, s35, 8192
s_add_u32 s36, s36, s3
s_lshl_b32 s3, s26, 10
s_add_u32 s35, s35, s3
s_add_u32 s35, s35, 0
s_mul_i32 s38, s26, 10240
s_add_u32 s33, s38, 6291456
s_mov_b32 s34, s38
s_mov_b32 s40, 0
s_mov_b32 s32, 0
s_mov_b32 s39, 1040356334
v_mov_b32 v11, 0
s_cmp_lg_u32 s26, 0
s_cbranch_scc1 L_cenwk_f
v_mbcnt_lo_u32_b32 v10, -1, 0
v_mbcnt_hi_u32_b32 v10, -1, v10
v_and_b32 v10, 7, v10
v_mul_u32_u24 v10, 66, v10
v_and_b32 v10, 0xc8, v10
v_add_u32 v10, s76, v10
L_cenk_f:
global_load_dwordx2 v[8:9], v10, s[28:29] sc1
s_add_u32 s27, s27, 1
s_cmp_gt_u32 s27, 262144
s_cbranch_scc1 L_fail_f
s_waitcnt vmcnt(0)
v_cmp_eq_u32 s[30:31], -1, v8
v_cmp_eq_u32 vcc, 0x200000, v9
s_and_b64 s[30:31], s[30:31], vcc
v_lshrrev_b32 v9, 16, v9
s_nop 1
v_add_u32_dpp v9, v9, v9 row_ror:4 row_mask:0xf bank_mask:0xf
s_nop 1
v_add_u32_dpp v9, v9, v9 row_ror:2 row_mask:0xf bank_mask:0xf
s_nop 1
v_add_u32_dpp v9, v9, v9 row_ror:1 row_mask:0xf bank_mask:0xf
v_cmp_lt_u32 vcc, 255, v9
s_cbranch_vccnz L_cendk_f
s_sleep 12
s_branch L_cenk_f
L_cendk_f:
v_mov_b32 v8, s30
ds_write_b32 v11, v8
s_waitcnt lgkmcnt(0)
L_cenwk_f:
s_barrier
ds_read_b32 v8, v11
s_waitcnt lgkmcnt(0)
v_cmp_ne_u32 vcc, -1, v8
s_cbranch_vccnz L_next
s_cmp_lg_u32 s26, 0
s_cbranch_scc1 L_khwk_f
v_min_u32 v80, 11, v0
v_lshlrev_b32 v80, 2, v80
s_mov_b32 s3, 9216
L_kh0k_f:
buffer_load_dword v81, v80, s[4:7], s3 offen sc1
s_add_u32 s27, s27, 1
s_cmp_gt_u32 s27, 262144
s_cbranch_scc1 L_fail_f
s_waitcnt vmcnt(0)
v_cmp_ne_u32 vcc, 1, v81
s_cbranch_vccz L_khok0k_f
s_sleep 2
s_branch L_kh0k_f
L_khok0k_f:
L_khwk_f:
s_barrier
s_add_u32 m0, s34, 0
s_add_u32 s3, s33, 0
buffer_load_dwordx4 v1, s[4:7], s3 offen offset:0 sc1 lds
buffer_load_dwordx4 v1, s[4:7], s3 offen offset:1024 sc1 lds
buffer_load_dwordx4 v1, s[4:7], s3 offen offset:2048 sc1 lds
buffer_load_dwordx4 v1, s[4:7], s3 offen offset:3072 sc1 lds
s_add_u32 m0, s34, 4096
s_add_u32 s3, s33, 4096
buffer_load_dwordx4 v1, s[4:7], s3 offen offset:0 sc1 lds
buffer_load_dwordx4 v1, s[4:7], s3 offen offset:1024 sc1 lds
buffer_load_dwordx4 v1, s[4:7], s3 offen offset:2048 sc1 lds
buffer_load_dwordx4 v1, s[4:7], s3 offen offset:3072 sc1 lds
s_add_u32 m0, s34, 8192
s_add_u32 s3, s33, 8192
buffer_load_dwordx4 v1, s[4:7], s3 offen offset:0 sc1 lds
buffer_load_dwordx4 v1, s[4:7], s3 offen offset:1024 sc1 lds
s_add_u32 s33, s33, 40960
s_add_u32 s34, s34, 40960
s_cmp_ge_u32 s34, 163840
s_cselect_b32 s3, 163840, 0
s_sub_u32 s34, s34, s3
s_add_u32 m0, s34, 0
s_add_u32 s3, s33, 0
buffer_load_dwordx4 v1, s[4:7], s3 offen offset:0 sc1 lds
buffer_load_dwordx4 v1, s[4:7], s3 offen offset:1024 sc1 lds
buffer_load_dwordx4 v1, s[4:7], s3 offen offset:2048 sc1 lds
buffer_load_dwordx4 v1, s[4:7], s3 offen offset:3072 sc1 lds
s_add_u32 m0, s34, 4096
s_add_u32 s3, s33, 4096
buffer_load_dwordx4 v1, s[4:7], s3 offen offset:0 sc1 lds
buffer_load_dwordx4 v1, s[4:7], s3 offen offset:1024 sc1 lds
buffer_load_dwordx4 v1, s[4:7], s3 offen offset:2048 sc1 lds
buffer_load_dwordx4 v1, s[4:7], s3 offen offset:3072 sc1 lds
s_add_u32 m0, s34, 8192
s_add_u32 s3, s33, 8192
buffer_load_dwordx4 v1, s[4:7], s3 offen offset:0 sc1 lds
buffer_load_dwordx4 v1, s[4:7], s3 offen offset:1024 sc1 lds
s_add_u32 s33, s33, 40960
s_add_u32 s34, s34, 40960
s_cmp_ge_u32 s34, 163840
s_cselect_b32 s3, 163840, 0
s_sub_u32 s34, s34, s3
L_ksegk_f:
s_cmp_lg_u32 s32, 4
s_cbranch_scc1 L_kno1k_f
v_min_u32 v80, 63, v0
v_lshlrev_b32 v80, 2, v80
s_mov_b32 s3, 9216
L_kh1k_f:
buffer_load_dword v81, v80, s[4:7], s3 offen sc1
s_add_u32 s27, s27, 1
s_cmp_gt_u32 s27, 262144
s_cbranch_scc1 L_fail_f
s_waitcnt vmcnt(0)
v_cmp_ne_u32 vcc, 1, v81
s_cbranch_vccz L_khok1k_f
s_sleep 2
s_branch L_kh1k_f
L_khok1k_f:
L_kno1k_f:
s_cmp_lg_u32 s32, 30
s_cbranch_scc1 L_kno2k_f
v_min_u32 v80, 63, v0
v_lshlrev_b32 v80, 2, v80
s_mov_b32 s3, 9472
L_kh2k_f:
buffer_load_dword v81, v80, s[4:7], s3 offen sc1
s_add_u32 s27, s27, 1
s_cmp_gt_u32 s27, 262144
s_cbranch_scc1 L_fail_f
s_waitcnt vmcnt(0)
v_cmp_ne_u32 vcc, 1, v81
s_cbranch_vccz L_khok2k_f
s_sleep 2
s_branch L_kh2k_f
L_khok2k_f:
L_kno2k_f:
s_waitcnt vmcnt(10)
s_barrier
v_add_u32 v2, s40, v1
ds_read_b128 v[8:11], v2 offset:0
ds_read_b128 v[12:15], v2 offset:20480
ds_read_b128 v[16:19], v2 offset:1024
ds_read_b128 v[20:23], v2 offset:21504
ds_read_b128 v[24:27], v2 offset:2048
ds_read_b128 v[28:31], v2 offset:22528
s_add_u32 s40, s40, 40960
s_cmp_ge_u32 s40, 163840
s_cselect_b32 s40, 0, s40
v_mov_b32 v5, s32
s_waitcnt lgkmcnt(5)
v_mfma_f32_16x16x32_bf16 v[32:35], v[192:195], v[8:11], 0
s_add_u32 m0, s34, 0
s_add_u32 s3, s33, 0
buffer_load_dwordx4 v1, s[4:7], s3 offen offset:0 sc1 lds
v_mfma_f32_16x16x32_bf16 v[36:39], v[196:199], v[8:11], 0
v_mfma_f32_16x16x32_bf16 v[48:51], a[96:99], v[8:11], 0
v_mfma_f32_16x16x32_bf16 v[52:55], a[100:103], v[8:11], 0
ds_read_b128 v[8:11], v2 offset:3072
s_waitcnt lgkmcnt(5)
v_mfma_f32_16x16x32_bf16 v[40:43], v[192:195], v[12:15], 0
v_mfma_f32_16x16x32_bf16 v[44:47], v[196:199], v[12:15], 0
v_mfma_f32_16x16x32_bf16 v[56:59], a[96:99], v[12:15], 0
v_mfma_f32_16x16x32_bf16 v[60:63], a[100:103], v[12:15], 0
ds_read_b128 v[12:15], v2 offset:23552
s_waitcnt lgkmcnt(5)
v_mfma_f32_16x16x32_bf16 v[32:35], v[200:203], v[16:19], v[32:35]
v_mfma_f32_16x16x32_bf16 v[36:39], v[204:207], v[16:19], v[36:39]
v_mfma_f32_16x16x32_bf16 v[48:51], a[104:107], v[16:19], v[48:51]
v_mfma_f32_16x16x32_bf16 v[52:55], a[108:111], v[16:19], v[52:55]
ds_read_b128 v[16:19], v2 offset:4096
s_waitcnt lgkmcnt(5)
v_mfma_f32_16x16x32_bf16 v[40:43], v[200:203], v[20:23], v[40:43]
buffer_load_dwordx4 v1, s[4:7], s3 offen offset:1024 sc1 lds
v_mfma_f32_16x16x32_bf16 v[44:47], v[204:207], v[20:23], v[44:47]
v_mfma_f32_16x16x32_bf16 v[56:59], a[104:107], v[20:23], v[56:59]
v_mfma_f32_16x16x32_bf16 v[60:63], a[108:111], v[20:23], v[60:63]
ds_read_b128 v[20:23], v2 offset:24576
s_waitcnt lgkmcnt(5)
v_mfma_f32_16x16x32_bf16 v[32:35], v[208:211], v[24:27], v[32:35]
v_mfma_f32_16x16x32_bf16 v[36:39], v[212:215], v[24:27], v[36:39]
v_mfma_f32_16x16x32_bf16 v[48:51], a[112:115], v[24:27], v[48:51]
v_mfma_f32_16x16x32_bf16 v[52:55], a[116:119], v[24:27], v[52:55]
ds_read_b128 v[24:27], v2 offset:5120
s_waitcnt lgkmcnt(5)
v_mfma_f32_16x16x32_bf16 v[40:43], v[208:211], v[28:31], v[40:43]
v_mfma_f32_16x16x32_bf16 v[44:47], v[212:215], v[28:31], v[44:47]
v_mfma_f32_16x16x32_bf16 v[56:59], a[112:115], v[28:31], v[56:59]
v_mfma_f32_16x16x32_bf16 v[60:63], a[116:119], v[28:31], v[60:63]
ds_read_b128 v[28:31], v2 offset:25600
s_waitcnt lgkmcnt(5)
v_mfma_f32_16x16x32_bf16 v[32:35], v[216:219], v[8:11], v[32:35]
buffer_load_dwordx4 v1, s[4:7], s3 offen offset:2048 sc1 lds
v_mfma_f32_16x16x32_bf16 v[36:39], v[220:223], v[8:11], v[36:39]
v_mfma_f32_16x16x32_bf16 v[48:51], a[120:123], v[8:11], v[48:51]
v_mfma_f32_16x16x32_bf16 v[52:55], a[124:127], v[8:11], v[52:55]
ds_read_b128 v[8:11], v2 offset:6144
s_waitcnt lgkmcnt(5)
v_mfma_f32_16x16x32_bf16 v[40:43], v[216:219], v[12:15], v[40:43]
v_mfma_f32_16x16x32_bf16 v[44:47], v[220:223], v[12:15], v[44:47]
v_mfma_f32_16x16x32_bf16 v[56:59], a[120:123], v[12:15], v[56:59]
v_mfma_f32_16x16x32_bf16 v[60:63], a[124:127], v[12:15], v[60:63]
ds_read_b128 v[12:15], v2 offset:26624
s_waitcnt lgkmcnt(5)
v_mfma_f32_16x16x32_bf16 v[32:35], v[224:227], v[16:19], v[32:35]
v_mfma_f32_16x16x32_bf16 v[36:39], v[228:231], v[16:19], v[36:39]
v_mfma_f32_16x16x32_bf16 v[48:51], a[128:131], v[16:19], v[48:51]
v_mfma_f32_16x16x32_bf16 v[52:55], a[132:135], v[16:19], v[52:55]
ds_read_b128 v[16:19], v2 offset:7168
s_waitcnt lgkmcnt(5)
v_mfma_f32_16x16x32_bf16 v[40:43], v[224:227], v[20:23], v[40:43]
buffer_load_dwordx4 v1, s[4:7], s3 offen offset:3072 sc1 lds
v_mfma_f32_16x16x32_bf16 v[44:47], v[228:231], v[20:23], v[44:47]
v_mfma_f32_16x16x32_bf16 v[56:59], a[128:131], v[20:23], v[56:59]
v_mfma_f32_16x16x32_bf16 v[60:63], a[132:135], v[20:23], v[60:63]
ds_read_b128 v[20:23], v2 offset:27648
s_waitcnt lgkmcnt(5)
v_mfma_f32_16x16x32_bf16 v[32:35], v[232:235], v[24:27], v[32:35]
v_mfma_f32_16x16x32_bf16 v[36:39], v[236:239], v[24:27], v[36:39]
v_mfma_f32_16x16x32_bf16 v[48:51], a[136:139], v[24:27], v[48:51]
v_mfma_f32_16x16x32_bf16 v[52:55], a[140:143], v[24:27], v[52:55]
ds_read_b128 v[24:27], v2 offset:8192
s_waitcnt lgkmcnt(5)
v_mfma_f32_16x16x32_bf16 v[40:43], v[232:235], v[28:31], v[40:43]
v_mfma_f32_16x16x32_bf16 v[44:47], v[236:239], v[28:31], v[44:47]
v_mfma_f32_16x16x32_bf16 v[56:59], a[136:139], v[28:31], v[56:59]
v_mfma_f32_16x16x32_bf16 v[60:63], a[140:143], v[28:31], v[60:63]
ds_read_b128 v[28:31], v2 offset:28672
s_waitcnt lgkmcnt(5)
v_mfma_f32_16x16x32_bf16 v[32:35], v[240:243], v[8:11], v[32:35]
s_add_u32 m0, s34, 4096
s_add_u32 s3, s33, 4096
buffer_load_dwordx4 v1, s[4:7], s3 offen offset:0 sc1 lds
v_mfma_f32_16x16x32_bf16 v[36:39], v[244:247], v[8:11], v[36:39]
v_mfma_f32_16x16x32_bf16 v[48:51], a[144:147], v[8:11], v[48:51]
v_mfma_f32_16x16x32_bf16 v[52:55], a[148:151], v[8:11], v[52:55]
ds_read_b128 v[8:11], v2 offset:9216
s_waitcnt lgkmcnt(5)
v_mfma_f32_16x16x32_bf16 v[40:43], v[240:243], v[12:15], v[40:43]
v_mfma_f32_16x16x32_bf16 v[44:47], v[244:247], v[12:15], v[44:47]
v_mfma_f32_16x16x32_bf16 v[56:59], a[144:147], v[12:15], v[56:59]
v_mfma_f32_16x16x32_bf16 v[60:63], a[148:151], v[12:15], v[60:63]
ds_read_b128 v[12:15], v2 offset:29696
s_waitcnt lgkmcnt(5)
v_mfma_f32_16x16x32_bf16 v[32:35], v[248:251], v[16:19], v[32:35]
v_mfma_f32_16x16x32_bf16 v[36:39], v[252:255], v[16:19], v[36:39]
v_mfma_f32_16x16x32_bf16 v[48:51], a[152:155], v[16:19], v[48:51]
v_mfma_f32_16x16x32_bf16 v[52:55], a[156:159], v[16:19], v[52:55]
ds_read_b128 v[16:19], v2 offset:10240
s_waitcnt lgkmcnt(5)
v_mfma_f32_16x16x32_bf16 v[40:43], v[248:251], v[20:23], v[40:43]
buffer_load_dwordx4 v1, s[4:7], s3 offen offset:1024 sc1 lds
v_mfma_f32_16x16x32_bf16 v[44:47], v[252:255], v[20:23], v[44:47]
v_mfma_f32_16x16x32_bf16 v[56:59], a[152:155], v[20:23], v[56:59]
v_mfma_f32_16x16x32_bf16 v[60:63], a[156:159], v[20:23], v[60:63]
ds_read_b128 v[20:23], v2 offset:30720
s_waitcnt lgkmcnt(5)
v_mfma_f32_16x16x32_bf16 v[32:35], a[0:3], v[24:27], v[32:35]
v_mfma_f32_16x16x32_bf16 v[36:39], a[4:7], v[24:27], v[36:39]
v_mfma_f32_16x16x32_bf16 v[48:51], a[160:163], v[24:27], v[48:51]
v_mfma_f32_16x16x32_bf16 v[52:55], a[164:167], v[24:27], v[52:55]
ds_read_b128 v[24:27], v2 offset:11264
s_waitcnt lgkmcnt(5)
v_mfma_f32_16x16x32_bf16 v[40:43], a[0:3], v[28:31], v[40:43]
v_mfma_f32_16x16x32_bf16 v[44:47], a[4:7], v[28:31], v[44:47]
v_mfma_f32_16x16x32_bf16 v[56:59], a[160:163], v[28:31], v[56:59]
v_mfma_f32_16x16x32_bf16 v[60:63], a[164:167], v[28:31], v[60:63]
ds_read_b128 v[28:31], v2 offset:31744
s_waitcnt vmcnt(6)
buffer_store_dword v5, off, s[4:7], s37 sc1
s_waitcnt lgkmcnt(5)
v_mfma_f32_16x16x32_bf16 v[32:35], a[8:11], v[8:11], v[32:35]
buffer_load_dwordx4 v1, s[4:7], s3 offen offset:2048 sc1 lds
v_mfma_f32_16x16x32_bf16 v[36:39], a[12:15], v[8:11], v[36:39]
v_mfma_f32_16x16x32_bf16 v[48:51], a[168:171], v[8:11], v[48:51]
v_mfma_f32_16x16x32_bf16 v[52:55], a[172:175], v[8:11], v[52:55]
ds_read_b128 v[8:11], v2 offset:12288
s_waitcnt lgkmcnt(5)
v_mfma_f32_16x16x32_bf16 v[40:43], a[8:11], v[12:15], v[40:43]
v_mfma_f32_16x16x32_bf16 v[44:47], a[12:15], v[12:15], v[44:47]
v_mfma_f32_16x16x32_bf16 v[56:59], a[168:171], v[12:15], v[56:59]
v_mfma_f32_16x16x32_bf16 v[60:63], a[172:175], v[12:15], v[60:63]
ds_read_b128 v[12:15], v2 offset:32768
s_waitcnt lgkmcnt(5)
v_mfma_f32_16x16x32_bf16 v[32:35], a[16:19], v[16:19], v[32:35]
v_mfma_f32_16x16x32_bf16 v[36:39], a[20:23], v[16:19], v[36:39]
v_mfma_f32_16x16x32_bf16 v[48:51], a[176:179], v[16:19], v[48:51]
v_mfma_f32_16x16x32_bf16 v[52:55], a[180:183], v[16:19], v[52:55]
ds_read_b128 v[16:19], v2 offset:13312
s_waitcnt lgkmcnt(5)
v_mfma_f32_16x16x32_bf16 v[40:43], a[16:19], v[20:23], v[40:43]
buffer_load_dwordx4 v1, s[4:7], s3 offen offset:3072 sc1 lds
v_mfma_f32_16x16x32_bf16 v[44:47], a[20:23], v[20:23], v[44:47]
v_mfma_f32_16x16x32_bf16 v[56:59], a[176:179], v[20:23], v[56:59]
v_mfma_f32_16x16x32_bf16 v[60:63], a[180:183], v[20:23], v[60:63]
ds_read_b128 v[20:23], v2 offset:33792
s_waitcnt lgkmcnt(5)
v_mfma_f32_16x16x32_bf16 v[32:35], a[24:27], v[24:27], v[32:35]
v_mfma_f32_16x16x32_bf16 v[36:39], a[28:31], v[24:27], v[36:39]
v_mfma_f32_16x16x32_bf16 v[48:51], a[184:187], v[24:27], v[48:51]
v_mfma_f32_16x16x32_bf16 v[52:55], a[188:191], v[24:27], v[52:55]
ds_read_b128 v[24:27], v2 offset:14336
s_waitcnt lgkmcnt(5)
v_mfma_f32_16x16x32_bf16 v[40:43], a[24:27], v[28:31], v[40:43]
v_mfma_f32_16x16x32_bf16 v[44:47], a[28:31], v[28:31], v[44:47]
v_mfma_f32_16x16x32_bf16 v[56:59], a[184:187], v[28:31], v[56:59]
v_mfma_f32_16x16x32_bf16 v[60:63], a[188:191], v[28:31], v[60:63]
ds_read_b128 v[28:31], v2 offset:34816
s_waitcnt lgkmcnt(5)
v_mfma_f32_16x16x32_bf16 v[32:35], a[32:35], v[8:11], v[32:35]
s_add_u32 m0, s34, 8192
s_add_u32 s3, s33, 8192
buffer_load_dwordx4 v1, s[4:7], s3 offen offset:0 sc1 lds
v_mfma_f32_16x16x32_bf16 v[36:39], a[36:39], v[8:11], v[36:39]
v_mfma_f32_16x16x32_bf16 v[48:51], a[192:195], v[8:11], v[48:51]
v_mfma_f32_16x16x32_bf16 v[52:55], a[196:199], v[8:11], v[52:55]
ds_read_b128 v[8:11], v2 offset:15360
s_waitcnt lgkmcnt(5)
v_mfma_f32_16x16x32_bf16 v[40:43], a[32:35], v[12:15], v[40:43]
v_mfma_f32_16x16x32_bf16 v[44:47], a[36:39], v[12:15], v[44:47]
v_mfma_f32_16x16x32_bf16 v[56:59], a[192:195], v[12:15], v[56:59]
v_mfma_f32_16x16x32_bf16 v[60:63], a[196:199], v[12:15], v[60:63]
ds_read_b128 v[12:15], v2 offset:35840
s_waitcnt lgkmcnt(5)
v_mfma_f32_16x16x32_bf16 v[32:35], a[40:43], v[16:19], v[32:35]
v_mfma_f32_16x16x32_bf16 v[36:39], a[44:47], v[16:19], v[36:39]
v_mfma_f32_16x16x32_bf16 v[48:51], a[200:203], v[16:19], v[48:51]
v_mfma_f32_16x16x32_bf16 v[52:55], a[204:207], v[16:19], v[52:55]
ds_read_b128 v[16:19], v2 offset:16384
s_waitcnt lgkmcnt(5)
v_mfma_f32_16x16x32_bf16 v[40:43], a[40:43], v[20:23], v[40:43]
buffer_load_dwordx4 v1, s[4:7], s3 offen offset:1024 sc1 lds
s_add_u32 s33, s33, 40960
s_add_u32 s34, s34, 40960
s_cmp_ge_u32 s34, 163840
s_cselect_b32 s3, 163840, 0
s_sub_u32 s34, s34, s3
v_mfma_f32_16x16x32_bf16 v[44:47], a[44:47], v[20:23], v[44:47]
v_mfma_f32_16x16x32_bf16 v[56:59], a[200:203], v[20:23], v[56:59]
v_mfma_f32_16x16x32_bf16 v[60:63], a[204:207], v[20:23], v[60:63]
ds_read_b128 v[20:23], v2 offset:36864
s_waitcnt lgkmcnt(5)
v_mfma_f32_16x16x32_bf16 v[32:35], a[48:51], v[24:27], v[32:35]
v_mfma_f32_16x16x32_bf16 v[36:39], a[52:55], v[24:27], v[36:39]
v_mfma_f32_16x16x32_bf16 v[48:51], a[208:211], v[24:27], v[48:51]
v_mfma_f32_16x16x32_bf16 v[52:55], a[212:215], v[24:27], v[52:55]
ds_read_b128 v[24:27], v2 offset:17408
s_waitcnt lgkmcnt(5)
v_mfma_f32_16x16x32_bf16 v[40:43], a[48:51], v[28:31], v[40:43]
v_mfma_f32_16x16x32_bf16 v[44:47], a[52:55], v[28:31], v[44:47]
v_mfma_f32_16x16x32_bf16 v[56:59], a[208:211], v[28:31], v[56:59]
v_mfma_f32_16x16x32_bf16 v[60:63], a[212:215], v[28:31], v[60:63]
ds_read_b128 v[28:31], v2 offset:37888
s_waitcnt lgkmcnt(5)
v_mfma_f32_16x16x32_bf16 v[32:35], a[56:59], v[8:11], v[32:35]
v_mfma_f32_16x16x32_bf16 v[36:39], a[60:63], v[8:11], v[36:39]
v_mfma_f32_16x16x32_bf16 v[48:51], a[216:219], v[8:11], v[48:51]
v_mfma_f32_16x16x32_bf16 v[52:55], a[220:223], v[8:11], v[52:55]
ds_read_b128 v[8:11], v2 offset:18432
s_waitcnt lgkmcnt(5)
v_mfma_f32_16x16x32_bf16 v[40:43], a[56:59], v[12:15], v[40:43]
v_mfma_f32_16x16x32_bf16 v[44:47], a[60:63], v[12:15], v[44:47]
v_mfma_f32_16x16x32_bf16 v[56:59], a[216:219], v[12:15], v[56:59]
v_mfma_f32_16x16x32_bf16 v[60:63], a[220:223], v[12:15], v[60:63]
ds_read_b128 v[12:15], v2 offset:38912
s_waitcnt lgkmcnt(5)
v_mfma_f32_16x16x32_bf16 v[32:35], a[64:67], v[16:19], v[32:35]
v_mfma_f32_16x16x32_bf16 v[36:39], a[68:71], v[16:19], v[36:39]
v_mfma_f32_16x16x32_bf16 v[48:51], a[224:227], v[16:19], v[48:51]
v_mfma_f32_16x16x32_bf16 v[52:55], a[228:231], v[16:19], v[52:55]
ds_read_b128 v[16:19], v2 offset:19456
s_waitcnt lgkmcnt(5)
v_mfma_f32_16x16x32_bf16 v[40:43], a[64:67], v[20:23], v[40:43]
v_mfma_f32_16x16x32_bf16 v[44:47], a[68:71], v[20:23], v[44:47]
v_mfma_f32_16x16x32_bf16 v[56:59], a[224:227], v[20:23], v[56:59]
v_mfma_f32_16x16x32_bf16 v[60:63], a[228:231], v[20:23], v[60:63]
ds_read_b128 v[20:23], v2 offset:39936
s_waitcnt lgkmcnt(5)
v_mfma_f32_16x16x32_bf16 v[32:35], a[72:75], v[24:27], v[32:35]
v_mfma_f32_16x16x32_bf16 v[36:39], a[76:79], v[24:27], v[36:39]
v_mfma_f32_16x16x32_bf16 v[48:51], a[232:235], v[24:27], v[48:51]
v_mfma_f32_16x16x32_bf16 v[52:55], a[236:239], v[24:27], v[52:55]
s_waitcnt lgkmcnt(4)
v_mfma_f32_16x16x32_bf16 v[40:43], a[72:75], v[28:31], v[40:43]
v_mfma_f32_16x16x32_bf16 v[44:47], a[76:79], v[28:31], v[44:47]
v_mfma_f32_16x16x32_bf16 v[56:59], a[232:235], v[28:31], v[56:59]
v_mfma_f32_16x16x32_bf16 v[60:63], a[236:239], v[28:31], v[60:63]
s_waitcnt lgkmcnt(3)
v_mfma_f32_16x16x32_bf16 v[32:35], a[80:83], v[8:11], v[32:35]
v_mfma_f32_16x16x32_bf16 v[36:39], a[84:87], v[8:11], v[36:39]
v_mfma_f32_16x16x32_bf16 v[48:51], a[240:243], v[8:11], v[48:51]
v_mfma_f32_16x16x32_bf16 v[52:55], a[244:247], v[8:11], v[52:55]
s_waitcnt lgkmcnt(2)
v_mfma_f32_16x16x32_bf16 v[40:43], a[80:83], v[12:15], v[40:43]
v_mfma_f32_16x16x32_bf16 v[44:47], a[84:87], v[12:15], v[44:47]
v_mfma_f32_16x16x32_bf16 v[56:59], a[240:243], v[12:15], v[56:59]
v_mfma_f32_16x16x32_bf16 v[60:63], a[244:247], v[12:15], v[60:63]
s_waitcnt lgkmcnt(1)
v_mfma_f32_16x16x32_bf16 v[32:35], a[88:91], v[16:19], v[32:35]
v_mfma_f32_16x16x32_bf16 v[36:39], a[92:95], v[16:19], v[36:39]
v_mfma_f32_16x16x32_bf16 v[48:51], a[248:251], v[16:19], v[48:51]
v_mfma_f32_16x16x32_bf16 v[52:55], a[252:255], v[16:19], v[52:55]
s_waitcnt lgkmcnt(0)
v_mfma_f32_16x16x32_bf16 v[40:43], a[88:91], v[20:23], v[40:43]
v_mfma_f32_16x16x32_bf16 v[44:47], a[92:95], v[20:23], v[44:47]
v_mfma_f32_16x16x32_bf16 v[56:59], a[248:251], v[20:23], v[56:59]
v_mfma_f32_16x16x32_bf16 v[60:63], a[252:255], v[20:23], v[60:63]
v_mul_f32 v32, s39, v32
v_mul_f32 v33, s39, v33
v_mul_f32 v34, s39, v34
v_mul_f32 v35, s39, v35
v_mul_f32 v36, s39, v36
v_mul_f32 v37, s39, v37
v_mul_f32 v38, s39, v38
v_mul_f32 v39, s39, v39
v_cvt_pk_bf16_f32 v64, v32, v33
v_cvt_pk_bf16_f32 v65, v34, v35
v_cvt_pk_bf16_f32 v66, v36, v37
v_cvt_pk_bf16_f32 v67, v38, v39
buffer_store_dwordx4 v[64:67], v1, s[4:7], s35 offen offset:0 sc1
v_mul_f32 v40, s39, v40
v_mul_f32 v41, s39, v41
v_mul_f32 v42, s39, v42
v_mul_f32 v43, s39, v43
v_mul_f32 v44, s39, v44
v_mul_f32 v45, s39, v45
v_mul_f32 v46, s39, v46
v_mul_f32 v47, s39, v47
v_cvt_pk_bf16_f32 v68, v40, v41
v_cvt_pk_bf16_f32 v69, v42, v43
v_cvt_pk_bf16_f32 v70, v44, v45
v_cvt_pk_bf16_f32 v71, v46, v47
buffer_store_dwordx4 v[68:71], v3, s[4:7], s35 offen offset:0 sc1
v_cvt_pk_bf16_f32 v72, v48, v49
v_cvt_pk_bf16_f32 v73, v50, v51
v_cvt_pk_bf16_f32 v74, v52, v53
v_cvt_pk_bf16_f32 v75, v54, v55
buffer_store_dwordx4 v[72:75], v1, s[4:7], s36 offen offset:0 sc1
v_cvt_pk_bf16_f32 v76, v56, v57
v_cvt_pk_bf16_f32 v77, v58, v59
v_cvt_pk_bf16_f32 v78, v60, v61
v_cvt_pk_bf16_f32 v79, v62, v63
buffer_store_dwordx4 v[76:79], v3, s[4:7], s36 offen offset:0 sc1
s_add_u32 s35, s35, 32768
s_add_u32 s36, s36, 32768
s_add_u32 s32, s32, 1
s_barrier
v_add_u32 v2, s40, v1
ds_read_b128 v[8:11], v2 offset:0
ds_read_b128 v[12:15], v2 offset:20480
ds_read_b128 v[16:19], v2 offset:1024
ds_read_b128 v[20:23], v2 offset:21504
ds_read_b128 v[24:27], v2 offset:2048
ds_read_b128 v[28:31], v2 offset:22528
s_add_u32 s40, s40, 40960
s_cmp_ge_u32 s40, 163840
s_cselect_b32 s40, 0, s40
v_mov_b32 v5, s32
s_waitcnt lgkmcnt(5)
v_mfma_f32_16x16x32_bf16 v[32:35], v[192:195], v[8:11], 0
s_add_u32 m0, s34, 0
s_add_u32 s3, s33, 0
buffer_load_dwordx4 v1, s[4:7], s3 offen offset:0 sc1 lds
v_mfma_f32_16x16x32_bf16 v[36:39], v[196:199], v[8:11], 0
ds_read_b128 v[8:11], v2 offset:3072
s_waitcnt lgkmcnt(5)
v_mfma_f32_16x16x32_bf16 v[40:43], v[192:195], v[12:15], 0
v_mfma_f32_16x16x32_bf16 v[44:47], v[196:199], v[12:15], 0
ds_read_b128 v[12:15], v2 offset:23552
s_waitcnt lgkmcnt(5)
v_mfma_f32_16x16x32_bf16 v[32:35], v[200:203], v[16:19], v[32:35]
v_mfma_f32_16x16x32_bf16 v[36:39], v[204:207], v[16:19], v[36:39]
ds_read_b128 v[16:19], v2 offset:4096
s_waitcnt lgkmcnt(5)
v_mfma_f32_16x16x32_bf16 v[40:43], v[200:203], v[20:23], v[40:43]
buffer_load_dwordx4 v1, s[4:7], s3 offen offset:1024 sc1 lds
v_mfma_f32_16x16x32_bf16 v[44:47], v[204:207], v[20:23], v[44:47]
ds_read_b128 v[20:23], v2 offset:24576
s_waitcnt lgkmcnt(5)
v_mfma_f32_16x16x32_bf16 v[32:35], v[208:211], v[24:27], v[32:35]
v_mfma_f32_16x16x32_bf16 v[36:39], v[212:215], v[24:27], v[36:39]
ds_read_b128 v[24:27], v2 offset:5120
s_waitcnt lgkmcnt(5)
v_mfma_f32_16x16x32_bf16 v[40:43], v[208:211], v[28:31], v[40:43]
v_mfma_f32_16x16x32_bf16 v[44:47], v[212:215], v[28:31], v[44:47]
ds_read_b128 v[28:31], v2 offset:25600
s_waitcnt lgkmcnt(5)
v_mfma_f32_16x16x32_bf16 v[32:35], v[216:219], v[8:11], v[32:35]
buffer_load_dwordx4 v1, s[4:7], s3 offen offset:2048 sc1 lds
v_mfma_f32_16x16x32_bf16 v[36:39], v[220:223], v[8:11], v[36:39]
ds_read_b128 v[8:11], v2 offset:6144
s_waitcnt lgkmcnt(5)
v_mfma_f32_16x16x32_bf16 v[40:43], v[216:219], v[12:15], v[40:43]
v_mfma_f32_16x16x32_bf16 v[44:47], v[220:223], v[12:15], v[44:47]
ds_read_b128 v[12:15], v2 offset:26624
s_waitcnt lgkmcnt(5)
v_mfma_f32_16x16x32_bf16 v[32:35], v[224:227], v[16:19], v[32:35]
v_mfma_f32_16x16x32_bf16 v[36:39], v[228:231], v[16:19], v[36:39]
ds_read_b128 v[16:19], v2 offset:7168
s_waitcnt lgkmcnt(5)
v_mfma_f32_16x16x32_bf16 v[40:43], v[224:227], v[20:23], v[40:43]
buffer_load_dwordx4 v1, s[4:7], s3 offen offset:3072 sc1 lds
v_mfma_f32_16x16x32_bf16 v[44:47], v[228:231], v[20:23], v[44:47]
ds_read_b128 v[20:23], v2 offset:27648
s_waitcnt lgkmcnt(5)
v_mfma_f32_16x16x32_bf16 v[32:35], v[232:235], v[24:27], v[32:35]
v_mfma_f32_16x16x32_bf16 v[36:39], v[236:239], v[24:27], v[36:39]
ds_read_b128 v[24:27], v2 offset:8192
s_waitcnt lgkmcnt(5)
v_mfma_f32_16x16x32_bf16 v[40:43], v[232:235], v[28:31], v[40:43]
v_mfma_f32_16x16x32_bf16 v[44:47], v[236:239], v[28:31], v[44:47]
ds_read_b128 v[28:31], v2 offset:28672
s_waitcnt lgkmcnt(5)
v_mfma_f32_16x16x32_bf16 v[32:35], v[240:243], v[8:11], v[32:35]
s_add_u32 m0, s34, 4096
s_add_u32 s3, s33, 4096
buffer_load_dwordx4 v1, s[4:7], s3 offen offset:0 sc1 lds
v_mfma_f32_16x16x32_bf16 v[36:39], v[244:247], v[8:11], v[36:39]
ds_read_b128 v[8:11], v2 offset:9216
s_waitcnt lgkmcnt(5)
v_mfma_f32_16x16x32_bf16 v[40:43], v[240:243], v[12:15], v[40:43]
v_mfma_f32_16x16x32_bf16 v[44:47], v[244:247], v[12:15], v[44:47]
ds_read_b128 v[12:15], v2 offset:29696
s_waitcnt lgkmcnt(5)
v_mfma_f32_16x16x32_bf16 v[32:35], v[248:251], v[16:19], v[32:35]
v_mfma_f32_16x16x32_bf16 v[36:39], v[252:255], v[16:19], v[36:39]
ds_read_b128 v[16:19], v2 offset:10240
s_waitcnt lgkmcnt(5)
v_mfma_f32_16x16x32_bf16 v[40:43], v[248:251], v[20:23], v[40:43]
buffer_load_dwordx4 v1, s[4:7], s3 offen offset:1024 sc1 lds
v_mfma_f32_16x16x32_bf16 v[44:47], v[252:255], v[20:23], v[44:47]
ds_read_b128 v[20:23], v2 offset:30720
s_waitcnt lgkmcnt(5)
v_mfma_f32_16x16x32_bf16 v[32:35], a[0:3], v[24:27], v[32:35]
v_mfma_f32_16x16x32_bf16 v[36:39], a[4:7], v[24:27], v[36:39]
ds_read_b128 v[24:27], v2 offset:11264
s_waitcnt lgkmcnt(5)
v_mfma_f32_16x16x32_bf16 v[40:43], a[0:3], v[28:31], v[40:43]
v_mfma_f32_16x16x32_bf16 v[44:47], a[4:7], v[28:31], v[44:47]
ds_read_b128 v[28:31], v2 offset:31744
s_waitcnt lgkmcnt(5)
v_mfma_f32_16x16x32_bf16 v[32:35], a[8:11], v[8:11], v[32:35]
buffer_load_dwordx4 v1, s[4:7], s3 offen offset:2048 sc1 lds
v_mfma_f32_16x16x32_bf16 v[36:39], a[12:15], v[8:11], v[36:39]
ds_read_b128 v[8:11], v2 offset:12288
s_waitcnt lgkmcnt(5)
v_mfma_f32_16x16x32_bf16 v[40:43], a[8:11], v[12:15], v[40:43]
v_mfma_f32_16x16x32_bf16 v[44:47], a[12:15], v[12:15], v[44:47]
ds_read_b128 v[12:15], v2 offset:32768
s_waitcnt lgkmcnt(5)
v_mfma_f32_16x16x32_bf16 v[32:35], a[16:19], v[16:19], v[32:35]
v_mfma_f32_16x16x32_bf16 v[36:39], a[20:23], v[16:19], v[36:39]
ds_read_b128 v[16:19], v2 offset:13312
s_waitcnt lgkmcnt(5)
v_mfma_f32_16x16x32_bf16 v[40:43], a[16:19], v[20:23], v[40:43]
buffer_load_dwordx4 v1, s[4:7], s3 offen offset:3072 sc1 lds
v_mfma_f32_16x16x32_bf16 v[44:47], a[20:23], v[20:23], v[44:47]
ds_read_b128 v[20:23], v2 offset:33792
s_waitcnt lgkmcnt(5)
v_mfma_f32_16x16x32_bf16 v[32:35], a[24:27], v[24:27], v[32:35]
v_mfma_f32_16x16x32_bf16 v[36:39], a[28:31], v[24:27], v[36:39]
ds_read_b128 v[24:27], v2 offset:14336
s_waitcnt lgkmcnt(5)
v_mfma_f32_16x16x32_bf16 v[40:43], a[24:27], v[28:31], v[40:43]
v_mfma_f32_16x16x32_bf16 v[44:47], a[28:31], v[28:31], v[44:47]
ds_read_b128 v[28:31], v2 offset:34816
s_waitcnt lgkmcnt(5)
v_mfma_f32_16x16x32_bf16 v[32:35], a[32:35], v[8:11], v[32:35]
s_add_u32 m0, s34, 8192
s_add_u32 s3, s33, 8192
buffer_load_dwordx4 v1, s[4:7], s3 offen offset:0 sc1 lds
v_mfma_f32_16x16x32_bf16 v[36:39], a[36:39], v[8:11], v[36:39]
ds_read_b128 v[8:11], v2 offset:15360
s_waitcnt lgkmcnt(5)
v_mfma_f32_16x16x32_bf16 v[40:43], a[32:35], v[12:15], v[40:43]
v_mfma_f32_16x16x32_bf16 v[44:47], a[36:39], v[12:15], v[44:47]
ds_read_b128 v[12:15], v2 offset:35840
s_waitcnt lgkmcnt(5)
v_mfma_f32_16x16x32_bf16 v[32:35], a[40:43], v[16:19], v[32:35]
v_mfma_f32_16x16x32_bf16 v[36:39], a[44:47], v[16:19], v[36:39]
ds_read_b128 v[16:19], v2 offset:16384
s_waitcnt lgkmcnt(5)
v_mfma_f32_16x16x32_bf16 v[40:43], a[40:43], v[20:23], v[40:43]
buffer_load_dwordx4 v1, s[4:7], s3 offen offset:1024 sc1 lds
s_add_u32 s33, s33, 40960
s_add_u32 s34, s34, 40960
s_cmp_ge_u32 s34, 163840
s_cselect_b32 s3, 163840, 0
s_sub_u32 s34, s34, s3
v_mfma_f32_16x16x32_bf16 v[44:47], a[44:47], v[20:23], v[44:47]
ds_read_b128 v[20:23], v2 offset:36864
s_waitcnt lgkmcnt(5)
v_mfma_f32_16x16x32_bf16 v[32:35], a[48:51], v[24:27], v[32:35]
v_mfma_f32_16x16x32_bf16 v[36:39], a[52:55], v[24:27], v[36:39]
ds_read_b128 v[24:27], v2 offset:17408
s_waitcnt lgkmcnt(5)
v_mfma_f32_16x16x32_bf16 v[40:43], a[48:51], v[28:31], v[40:43]
v_mfma_f32_16x16x32_bf16 v[44:47], a[52:55], v[28:31], v[44:47]
ds_read_b128 v[28:31], v2 offset:37888
s_waitcnt lgkmcnt(5)
v_mfma_f32_16x16x32_bf16 v[32:35], a[56:59], v[8:11], v[32:35]
v_mfma_f32_16x16x32_bf16 v[36:39], a[60:63], v[8:11], v[36:39]
ds_read_b128 v[8:11], v2 offset:18432
s_waitcnt lgkmcnt(5)
v_mfma_f32_16x16x32_bf16 v[40:43], a[56:59], v[12:15], v[40:43]
v_mfma_f32_16x16x32_bf16 v[44:47], a[60:63], v[12:15], v[44:47]
ds_read_b128 v[12:15], v2 offset:38912
s_waitcnt vmcnt(10)
buffer_store_dword v5, off, s[4:7], s37 sc1
s_waitcnt lgkmcnt(5)
v_mfma_f32_16x16x32_bf16 v[32:35], a[64:67], v[16:19], v[32:35]
v_mfma_f32_16x16x32_bf16 v[36:39], a[68:71], v[16:19], v[36:39]
ds_read_b128 v[16:19], v2 offset:19456
s_waitcnt lgkmcnt(5)
v_mfma_f32_16x16x32_bf16 v[40:43], a[64:67], v[20:23], v[40:43]
v_mfma_f32_16x16x32_bf16 v[44:47], a[68:71], v[20:23], v[44:47]
ds_read_b128 v[20:23], v2 offset:39936
s_waitcnt lgkmcnt(5)
v_mfma_f32_16x16x32_bf16 v[32:35], a[72:75], v[24:27], v[32:35]
v_mfma_f32_16x16x32_bf16 v[36:39], a[76:79], v[24:27], v[36:39]
s_waitcnt lgkmcnt(4)
v_mfma_f32_16x16x32_bf16 v[40:43], a[72:75], v[28:31], v[40:43]
v_mfma_f32_16x16x32_bf16 v[44:47], a[76:79], v[28:31], v[44:47]
s_waitcnt lgkmcnt(3)
v_mfma_f32_16x16x32_bf16 v[32:35], a[80:83], v[8:11], v[32:35]
v_mfma_f32_16x16x32_bf16 v[36:39], a[84:87], v[8:11], v[36:39]
s_waitcnt lgkmcnt(2)
v_mfma_f32_16x16x32_bf16 v[40:43], a[80:83], v[12:15], v[40:43]
v_mfma_f32_16x16x32_bf16 v[44:47], a[84:87], v[12:15], v[44:47]
s_waitcnt lgkmcnt(1)
v_mfma_f32_16x16x32_bf16 v[32:35], a[88:91], v[16:19], v[32:35]
v_mfma_f32_16x16x32_bf16 v[36:39], a[92:95], v[16:19], v[36:39]
s_waitcnt lgkmcnt(0)
v_mfma_f32_16x16x32_bf16 v[40:43], a[88:91], v[20:23], v[40:43]
v_mfma_f32_16x16x32_bf16 v[44:47], a[92:95], v[20:23], v[44:47]
s_nop 3
v_mul_f32 v32, s39, v32
v_mul_f32 v33, s39, v33
v_mul_f32 v34, s39, v34
v_mul_f32 v35, s39, v35
v_mul_f32 v36, s39, v36
v_mul_f32 v37, s39, v37
v_mul_f32 v38, s39, v38
v_mul_f32 v39, s39, v39
v_cvt_pk_bf16_f32 v64, v32, v33
v_cvt_pk_bf16_f32 v65, v34, v35
v_cvt_pk_bf16_f32 v66, v36, v37
v_cvt_pk_bf16_f32 v67, v38, v39
buffer_store_dwordx4 v[64:67], v1, s[4:7], s35 offen offset:0 sc1
v_mul_f32 v40, s39, v40
v_mul_f32 v41, s39, v41
v_mul_f32 v42, s39, v42
v_mul_f32 v43, s39, v43
v_mul_f32 v44, s39, v44
v_mul_f32 v45, s39, v45
v_mul_f32 v46, s39, v46
v_mul_f32 v47, s39, v47
v_cvt_pk_bf16_f32 v68, v40, v41
v_cvt_pk_bf16_f32 v69, v42, v43
v_cvt_pk_bf16_f32 v70, v44, v45
v_cvt_pk_bf16_f32 v71, v46, v47
buffer_store_dwordx4 v[68:71], v3, s[4:7], s35 offen offset:0 sc1
s_add_u32 s35, s35, 32768
s_add_u32 s36, s36, 32768
s_add_u32 s32, s32, 1
s_cmp_lt_u32 s32, 64
s_cbranch_scc1 L_ksegk_f
v_mov_b32 v5, 64
s_waitcnt vmcnt(0)
buffer_store_dword v5, off, s[4:7], s37 sc1
s_endpgm
L_role_v_f:
s_mov_b32 s8, s72
s_mov_b32 s9, s73
s_mov_b32 s10, 5242880
s_mov_b32 s11, 0x20000
s_mov_b32 s12, s68
s_mov_b32 s13, s69
s_mov_b32 s14, 5242880
s_mov_b32 s15, 0x20000
v_mbcnt_lo_u32_b32 v0, -1, 0
v_mbcnt_hi_u32_b32 v0, -1, v0
s_lshl_b32 s37, s25, 7
s_lshl_b32 s3, s26, 2
s_add_u32 s37, s37, s3
s_add_u32 s37, s37, 16
s_cmp_lg_u32 s26, 0
s_cbranch_scc1 L_arrv_f
s_mul_i32 s3, s24, 66
s_and_b32 s3, s3, 0xc8
s_add_u32 s3, s3, s76
v_mov_b32 v10, s3
s_lshl_b32 s3, 1, s25
v_mov_b32 v8, s3
s_add_u32 s3, s78, 0x10000
v_mov_b32 v9, s3
s_mov_b64 exec, 1
global_atomic_add_x2 v10, v[8:9], s[28:29] sc1
s_mov_b64 exec, -1
L_arrv_f:
s_lshl_b32 s30, s26, 15
s_lshl_b32 s31, s25, 8
s_add_u32 s31, s31, s30
s_lshl_b32 s38, s26, 10
v_lshrrev_b32 v8, 4, v0
v_and_b32 v9, 15, v0
v_lshlrev_b32 v5, 13, v8
v_lshl_add_u32 v5, v9, 4, v5
v_add_u32 v5, s31, v5
v_bfe_u32 v10, v0, 2, 2
v_and_b32 v9, 3, v0
v_lshlrev_b32 v6, 11, v8
v_lshl_add_u32 v6, v10, 8, v6
v_lshl_add_u32 v6, v9, 3, v6
s_lshl_b32 s30, s26, 6
v_add_u32 v6, s30, v6
v_lshlrev_b32 v1, 4, v0
v_add_u32 v3, 4096, v1
s_add_u32 m0, s38, 0
s_mov_b32 s3, 0
buffer_load_dwordx4 v5, s[8:11], s3 offen lds
s_add_u32 m0, s38, 4096
s_mov_b32 s3, 131072
buffer_load_dwordx4 v5, s[8:11], s3 offen lds
s_add_u32 m0, s38, 8192
s_mov_b32 s3, 262144
buffer_load_dwordx4 v5, s[8:11], s3 offen lds
s_add_u32 m0, s38, 12288
s_mov_b32 s3, 393216
buffer_load_dwordx4 v5, s[8:11], s3 offen lds
s_add_u32 m0, s38, 16384
s_mov_b32 s3, 524288
buffer_load_dwordx4 v5, s[8:11], s3 offen lds
s_add_u32 m0, s38, 20480
s_mov_b32 s3, 655360
buffer_load_dwordx4 v5, s[8:11], s3 offen lds
s_add_u32 m0, s38, 24576
s_mov_b32 s3, 786432
buffer_load_dwordx4 v5, s[8:11], s3 offen lds
s_add_u32 m0, s38, 28672
s_mov_b32 s3, 917504
buffer_load_dwordx4 v5, s[8:11], s3 offen lds
s_add_u32 m0, s38, 32768
s_mov_b32 s3, 1048576
buffer_load_dwordx4 v5, s[8:11], s3 offen lds
s_add_u32 m0, s38, 36864
s_mov_b32 s3, 1179648
buffer_load_dwordx4 v5, s[8:11], s3 offen lds
s_add_u32 m0, s38, 40960
s_mov_b32 s3, 1310720
buffer_load_dwordx4 v5, s[8:11], s3 offen lds
s_add_u32 m0, s38, 45056
s_mov_b32 s3, 1441792
buffer_load_dwordx4 v5, s[8:11], s3 offen lds
s_add_u32 m0, s38, 49152
s_mov_b32 s3, 1572864
buffer_load_dwordx4 v5, s[8:11], s3 offen lds
s_add_u32 m0, s38, 53248
s_mov_b32 s3, 1703936
buffer_load_dwordx4 v5, s[8:11], s3 offen lds
s_add_u32 m0, s38, 57344
s_mov_b32 s3, 1835008
buffer_load_dwordx4 v5, s[8:11], s3 offen lds
s_add_u32 m0, s38, 61440
s_mov_b32 s3, 1966080
buffer_load_dwordx4 v5, s[8:11], s3 offen lds
v_add_u32 v8, 0, v6
s_waitcnt vmcnt(12)
s_barrier
ds_read_b64_tr_b16 v[192:193], v8 offset:0
ds_read_b64_tr_b16 v[194:195], v8 offset:1024
ds_read_b64_tr_b16 v[196:197], v8 offset:32
ds_read_b64_tr_b16 v[198:199], v8 offset:1056
ds_read_b64_tr_b16 v[200:201], v8 offset:8192
ds_read_b64_tr_b16 v[202:203], v8 offset:9216
ds_read_b64_tr_b16 v[204:205], v8 offset:8224
ds_read_b64_tr_b16 v[206:207], v8 offset:9248
s_add_u32 m0, s38, 65536
s_mov_b32 s3, 2097152
buffer_load_dwordx4 v5, s[8:11], s3 offen lds
s_add_u32 m0, s38, 69632
s_mov_b32 s3, 2228224
buffer_load_dwordx4 v5, s[8:11], s3 offen lds
s_add_u32 m0, s38, 73728
s_mov_b32 s3, 2359296
buffer_load_dwordx4 v5, s[8:11], s3 offen lds
s_add_u32 m0, s38, 77824
s_mov_b32 s3, 2490368
buffer_load_dwordx4 v5, s[8:11], s3 offen lds
v_add_u32 v8, 16384, v6
s_waitcnt vmcnt(12)
s_waitcnt lgkmcnt(0)
s_barrier
ds_read_b64_tr_b16 v[208:209], v8 offset:0
ds_read_b64_tr_b16 v[210:211], v8 offset:1024
ds_read_b64_tr_b16 v[212:213], v8 offset:32
ds_read_b64_tr_b16 v[214:215], v8 offset:1056
ds_read_b64_tr_b16 v[216:217], v8 offset:8192
ds_read_b64_tr_b16 v[218:219], v8 offset:9216
ds_read_b64_tr_b16 v[220:221], v8 offset:8224
ds_read_b64_tr_b16 v[222:223], v8 offset:9248
s_add_u32 m0, s38, 81920
s_mov_b32 s3, 2621440
buffer_load_dwordx4 v5, s[8:11], s3 offen lds
s_add_u32 m0, s38, 86016
s_mov_b32 s3, 2752512
buffer_load_dwordx4 v5, s[8:11], s3 offen lds
s_add_u32 m0, s38, 90112
s_mov_b32 s3, 2883584
buffer_load_dwordx4 v5, s[8:11], s3 offen lds
s_add_u32 m0, s38, 94208
s_mov_b32 s3, 3014656
buffer_load_dwordx4 v5, s[8:11], s3 offen lds
v_add_u32 v8, 32768, v6
s_waitcnt vmcnt(12)
s_waitcnt lgkmcnt(0)
s_barrier
ds_read_b64_tr_b16 v[224:225], v8 offset:0
ds_read_b64_tr_b16 v[226:227], v8 offset:1024
ds_read_b64_tr_b16 v[228:229], v8 offset:32
ds_read_b64_tr_b16 v[230:231], v8 offset:1056
ds_read_b64_tr_b16 v[232:233], v8 offset:8192
ds_read_b64_tr_b16 v[234:235], v8 offset:9216
ds_read_b64_tr_b16 v[236:237], v8 offset:8224
ds_read_b64_tr_b16 v[238:239], v8 offset:9248
s_add_u32 m0, s38, 98304
s_mov_b32 s3, 3145728
buffer_load_dwordx4 v5, s[8:11], s3 offen lds
s_add_u32 m0, s38, 102400
s_mov_b32 s3, 3276800
buffer_load_dwordx4 v5, s[8:11], s3 offen lds
s_add_u32 m0, s38, 106496
s_mov_b32 s3, 3407872
buffer_load_dwordx4 v5, s[8:11], s3 offen lds
s_add_u32 m0, s38, 110592
s_mov_b32 s3, 3538944
buffer_load_dwordx4 v5, s[8:11], s3 offen lds
v_add_u32 v8, 49152, v6
s_waitcnt vmcnt(12)
s_waitcnt lgkmcnt(0)
s_barrier
ds_read_b64_tr_b16 v[240:241], v8 offset:0
ds_read_b64_tr_b16 v[242:243], v8 offset:1024
ds_read_b64_tr_b16 v[244:245], v8 offset:32
ds_read_b64_tr_b16 v[246:247], v8 offset:1056
ds_read_b64_tr_b16 v[248:249], v8 offset:8192
ds_read_b64_tr_b16 v[250:251], v8 offset:9216
ds_read_b64_tr_b16 v[252:253], v8 offset:8224
ds_read_b64_tr_b16 v[254:255], v8 offset:9248
s_add_u32 m0, s38, 114688
s_mov_b32 s3, 3670016
buffer_load_dwordx4 v5, s[8:11], s3 offen lds
s_add_u32 m0, s38, 118784
s_mov_b32 s3, 3801088
buffer_load_dwordx4 v5, s[8:11], s3 offen lds
s_add_u32 m0, s38, 122880
s_mov_b32 s3, 3932160
buffer_load_dwordx4 v5, s[8:11], s3 offen lds
s_add_u32 m0, s38, 126976
s_mov_b32 s3, 4063232
buffer_load_dwordx4 v5, s[8:11], s3 offen lds
v_add_u32 v8, 65536, v6
s_waitcnt vmcnt(12)
s_waitcnt lgkmcnt(0)
s_barrier
ds_read_b64_tr_b16 a[0:1], v8 offset:0
ds_read_b64_tr_b16 a[2:3], v8 offset:1024
ds_read_b64_tr_b16 a[4:5], v8 offset:32
ds_read_b64_tr_b16 a[6:7], v8 offset:1056
ds_read_b64_tr_b16 a[8:9], v8 offset:8192
ds_read_b64_tr_b16 a[10:11], v8 offset:9216
ds_read_b64_tr_b16 a[12:13], v8 offset:8224
ds_read_b64_tr_b16 a[14:15], v8 offset:9248
s_add_u32 m0, s38, 131072
s_mov_b32 s3, 4194304
buffer_load_dwordx4 v5, s[8:11], s3 offen lds
s_add_u32 m0, s38, 135168
s_mov_b32 s3, 4325376
buffer_load_dwordx4 v5, s[8:11], s3 offen lds
s_add_u32 m0, s38, 139264
s_mov_b32 s3, 4456448
buffer_load_dwordx4 v5, s[8:11], s3 offen lds
s_add_u32 m0, s38, 143360
s_mov_b32 s3, 4587520
buffer_load_dwordx4 v5, s[8:11], s3 offen lds
v_add_u32 v8, 81920, v6
s_waitcnt vmcnt(12)
s_waitcnt lgkmcnt(0)
s_barrier
ds_read_b64_tr_b16 a[16:17], v8 offset:0
ds_read_b64_tr_b16 a[18:19], v8 offset:1024
ds_read_b64_tr_b16 a[20:21], v8 offset:32
ds_read_b64_tr_b16 a[22:23], v8 offset:1056
ds_read_b64_tr_b16 a[24:25], v8 offset:8192
ds_read_b64_tr_b16 a[26:27], v8 offset:9216
ds_read_b64_tr_b16 a[28:29], v8 offset:8224
ds_read_b64_tr_b16 a[30:31], v8 offset:9248
s_add_u32 m0, s38, 147456
s_mov_b32 s3, 4718592
buffer_load_dwordx4 v5, s[8:11], s3 offen lds
s_add_u32 m0, s38, 151552
s_mov_b32 s3, 4849664
buffer_load_dwordx4 v5, s[8:11], s3 offen lds
s_add_u32 m0, s38, 155648
s_mov_b32 s3, 4980736
buffer_load_dwordx4 v5, s[8:11], s3 offen lds
s_add_u32 m0, s38, 159744
s_mov_b32 s3, 5111808
buffer_load_dwordx4 v5, s[8:11], s3 offen lds
v_add_u32 v8, 98304, v6
s_waitcnt vmcnt(12)
s_waitcnt lgkmcnt(0)
s_barrier
ds_read_b64_tr_b16 a[32:33], v8 offset:0
ds_read_b64_tr_b16 a[34:35], v8 offset:1024
ds_read_b64_tr_b16 a[36:37], v8 offset:32
ds_read_b64_tr_b16 a[38:39], v8 offset:1056
ds_read_b64_tr_b16 a[40:41], v8 offset:8192
ds_read_b64_tr_b16 a[42:43], v8 offset:9216
ds_read_b64_tr_b16 a[44:45], v8 offset:8224
ds_read_b64_tr_b16 a[46:47], v8 offset:9248
s_add_u32 m0, s38, 0
s_mov_b32 s3, 2621440
buffer_load_dwordx4 v5, s[12:15], s3 offen lds
s_add_u32 m0, s38, 4096
s_mov_b32 s3, 2752512
buffer_load_dwordx4 v5, s[12:15], s3 offen lds
s_add_u32 m0, s38, 8192
s_mov_b32 s3, 2883584
buffer_load_dwordx4 v5, s[12:15], s3 offen lds
s_add_u32 m0, s38, 12288
s_mov_b32 s3, 3014656
buffer_load_dwordx4 v5, s[12:15], s3 offen lds
v_add_u32 v8, 114688, v6
s_waitcnt vmcnt(12)
s_waitcnt lgkmcnt(0)
s_barrier
ds_read_b64_tr_b16 a[48:49], v8 offset:0
ds_read_b64_tr_b16 a[50:51], v8 offset:1024
ds_read_b64_tr_b16 a[52:53], v8 offset:32
ds_read_b64_tr_b16 a[54:55], v8 offset:1056
ds_read_b64_tr_b16 a[56:57], v8 offset:8192
ds_read_b64_tr_b16 a[58:59], v8 offset:9216
ds_read_b64_tr_b16 a[60:61], v8 offset:8224
ds_read_b64_tr_b16 a[62:63], v8 offset:9248
s_add_u32 m0, s38, 16384
s_mov_b32 s3, 3145728
buffer_load_dwordx4 v5, s[12:15], s3 offen lds
s_add_u32 m0, s38, 20480
s_mov_b32 s3, 3276800
buffer_load_dwordx4 v5, s[12:15], s3 offen lds
s_add_u32 m0, s38, 24576
s_mov_b32 s3, 3407872
buffer_load_dwordx4 v5, s[12:15], s3 offen lds
s_add_u32 m0, s38, 28672
s_mov_b32 s3, 3538944
buffer_load_dwordx4 v5, s[12:15], s3 offen lds
v_add_u32 v8, 131072, v6
s_waitcnt vmcnt(12)
s_waitcnt lgkmcnt(0)
s_barrier
ds_read_b64_tr_b16 a[64:65], v8 offset:0
ds_read_b64_tr_b16 a[66:67], v8 offset:1024
ds_read_b64_tr_b16 a[68:69], v8 offset:32
ds_read_b64_tr_b16 a[70:71], v8 offset:1056
ds_read_b64_tr_b16 a[72:73], v8 offset:8192
ds_read_b64_tr_b16 a[74:75], v8 offset:9216
ds_read_b64_tr_b16 a[76:77], v8 offset:8224
ds_read_b64_tr_b16 a[78:79], v8 offset:9248
s_add_u32 m0, s38, 32768
s_mov_b32 s3, 3670016
buffer_load_dwordx4 v5, s[12:15], s3 offen lds
s_add_u32 m0, s38, 36864
s_mov_b32 s3, 3801088
buffer_load_dwordx4 v5, s[12:15], s3 offen lds
s_add_u32 m0, s38, 40960
s_mov_b32 s3, 3932160
buffer_load_dwordx4 v5, s[12:15], s3 offen lds
s_add_u32 m0, s38, 45056
s_mov_b32 s3, 4063232
buffer_load_dwordx4 v5, s[12:15], s3 offen lds
v_add_u32 v8, 147456, v6
s_waitcnt vmcnt(12)
s_waitcnt lgkmcnt(0)
s_barrier
ds_read_b64_tr_b16 a[80:81], v8 offset:0
ds_read_b64_tr_b16 a[82:83], v8 offset:1024
ds_read_b64_tr_b16 a[84:85], v8 offset:32
ds_read_b64_tr_b16 a[86:87], v8 offset:1056
ds_read_b64_tr_b16 a[88:89], v8 offset:8192
ds_read_b64_tr_b16 a[90:91], v8 offset:9216
ds_read_b64_tr_b16 a[92:93], v8 offset:8224
ds_read_b64_tr_b16 a[94:95], v8 offset:9248
s_add_u32 m0, s38, 49152
s_mov_b32 s3, 4194304
buffer_load_dwordx4 v5, s[12:15], s3 offen lds
s_add_u32 m0, s38, 53248
s_mov_b32 s3, 4325376
buffer_load_dwordx4 v5, s[12:15], s3 offen lds
s_add_u32 m0, s38, 57344
s_mov_b32 s3, 4456448
buffer_load_dwordx4 v5, s[12:15], s3 offen lds
s_add_u32 m0, s38, 61440
s_mov_b32 s3, 4587520
buffer_load_dwordx4 v5, s[12:15], s3 offen lds
v_add_u32 v8, 0, v6
s_waitcnt vmcnt(12)
s_waitcnt lgkmcnt(0)
s_barrier
ds_read_b64_tr_b16 a[176:177], v8 offset:0
ds_read_b64_tr_b16 a[178:179], v8 offset:1024
ds_read_b64_tr_b16 a[180:181], v8 offset:32
ds_read_b64_tr_b16 a[182:183], v8 offset:1056
ds_read_b64_tr_b16 a[184:185], v8 offset:8192
ds_read_b64_tr_b16 a[186:187], v8 offset:9216
ds_read_b64_tr_b16 a[188:189], v8 offset:8224
ds_read_b64_tr_b16 a[190:191], v8 offset:9248
s_add_u32 m0, s38, 65536
s_mov_b32 s3, 4718592
buffer_load_dwordx4 v5, s[12:15], s3 offen lds
s_add_u32 m0, s38, 69632
s_mov_b32 s3, 4849664
buffer_load_dwordx4 v5, s[12:15], s3 offen lds
s_add_u32 m0, s38, 73728
s_mov_b32 s3, 4980736
buffer_load_dwordx4 v5, s[12:15], s3 offen lds
s_add_u32 m0, s38, 77824
s_mov_b32 s3, 5111808
buffer_load_dwordx4 v5, s[12:15], s3 offen lds
v_add_u32 v8, 16384, v6
s_waitcnt vmcnt(12)
s_waitcnt lgkmcnt(0)
s_barrier
ds_read_b64_tr_b16 a[192:193], v8 offset:0
ds_read_b64_tr_b16 a[194:195], v8 offset:1024
ds_read_b64_tr_b16 a[196:197], v8 offset:32
ds_read_b64_tr_b16 a[198:199], v8 offset:1056
ds_read_b64_tr_b16 a[200:201], v8 offset:8192
ds_read_b64_tr_b16 a[202:203], v8 offset:9216
ds_read_b64_tr_b16 a[204:205], v8 offset:8224
ds_read_b64_tr_b16 a[206:207], v8 offset:9248
s_add_u32 m0, s38, 81920
s_mov_b32 s3, 0
buffer_load_dwordx4 v5, s[12:15], s3 offen lds
s_add_u32 m0, s38, 86016
s_mov_b32 s3, 131072
buffer_load_dwordx4 v5, s[12:15], s3 offen lds
s_add_u32 m0, s38, 90112
s_mov_b32 s3, 262144
buffer_load_dwordx4 v5, s[12:15], s3 offen lds
s_add_u32 m0, s38, 94208
s_mov_b32 s3, 393216
buffer_load_dwordx4 v5, s[12:15], s3 offen lds
v_add_u32 v8, 32768, v6
s_waitcnt vmcnt(12)
s_waitcnt lgkmcnt(0)
s_barrier
ds_read_b64_tr_b16 a[208:209], v8 offset:0
ds_read_b64_tr_b16 a[210:211], v8 offset:1024
ds_read_b64_tr_b16 a[212:213], v8 offset:32
ds_read_b64_tr_b16 a[214:215], v8 offset:1056
ds_read_b64_tr_b16 a[216:217], v8 offset:8192
ds_read_b64_tr_b16 a[218:219], v8 offset:9216
ds_read_b64_tr_b16 a[220:221], v8 offset:8224
ds_read_b64_tr_b16 a[222:223], v8 offset:9248
s_add_u32 m0, s38, 98304
s_mov_b32 s3, 524288
buffer_load_dwordx4 v5, s[12:15], s3 offen lds
s_add_u32 m0, s38, 102400
s_mov_b32 s3, 655360
buffer_load_dwordx4 v5, s[12:15], s3 offen lds
s_add_u32 m0, s38, 106496
s_mov_b32 s3, 786432
buffer_load_dwordx4 v5, s[12:15], s3 offen lds
s_add_u32 m0, s38, 110592
s_mov_b32 s3, 917504
buffer_load_dwordx4 v5, s[12:15], s3 offen lds
v_add_u32 v8, 49152, v6
s_waitcnt vmcnt(12)
s_waitcnt lgkmcnt(0)
s_barrier
ds_read_b64_tr_b16 a[224:225], v8 offset:0
ds_read_b64_tr_b16 a[226:227], v8 offset:1024
ds_read_b64_tr_b16 a[228:229], v8 offset:32
ds_read_b64_tr_b16 a[230:231], v8 offset:1056
ds_read_b64_tr_b16 a[232:233], v8 offset:8192
ds_read_b64_tr_b16 a[234:235], v8 offset:9216
ds_read_b64_tr_b16 a[236:237], v8 offset:8224
ds_read_b64_tr_b16 a[238:239], v8 offset:9248
s_add_u32 m0, s38, 114688
s_mov_b32 s3, 1048576
buffer_load_dwordx4 v5, s[12:15], s3 offen lds
s_add_u32 m0, s38, 118784
s_mov_b32 s3, 1179648
buffer_load_dwordx4 v5, s[12:15], s3 offen lds
s_add_u32 m0, s38, 122880
s_mov_b32 s3, 1310720
buffer_load_dwordx4 v5, s[12:15], s3 offen lds
s_add_u32 m0, s38, 126976
s_mov_b32 s3, 1441792
buffer_load_dwordx4 v5, s[12:15], s3 offen lds
v_add_u32 v8, 65536, v6
s_waitcnt vmcnt(12)
s_waitcnt lgkmcnt(0)
s_barrier
ds_read_b64_tr_b16 a[240:241], v8 offset:0
ds_read_b64_tr_b16 a[242:243], v8 offset:1024
ds_read_b64_tr_b16 a[244:245], v8 offset:32
ds_read_b64_tr_b16 a[246:247], v8 offset:1056
ds_read_b64_tr_b16 a[248:249], v8 offset:8192
ds_read_b64_tr_b16 a[250:251], v8 offset:9216
ds_read_b64_tr_b16 a[252:253], v8 offset:8224
ds_read_b64_tr_b16 a[254:255], v8 offset:9248
s_add_u32 m0, s38, 131072
s_mov_b32 s3, 1572864
buffer_load_dwordx4 v5, s[12:15], s3 offen lds
s_add_u32 m0, s38, 135168
s_mov_b32 s3, 1703936
buffer_load_dwordx4 v5, s[12:15], s3 offen lds
s_add_u32 m0, s38, 139264
s_mov_b32 s3, 1835008
buffer_load_dwordx4 v5, s[12:15], s3 offen lds
s_add_u32 m0, s38, 143360
s_mov_b32 s3, 1966080
buffer_load_dwordx4 v5, s[12:15], s3 offen lds
v_add_u32 v8, 81920, v6
s_waitcnt vmcnt(12)
s_waitcnt lgkmcnt(0)
s_barrier
ds_read_b64_tr_b16 a[96:97], v8 offset:0
ds_read_b64_tr_b16 a[98:99], v8 offset:1024
ds_read_b64_tr_b16 a[100:101], v8 offset:32
ds_read_b64_tr_b16 a[102:103], v8 offset:1056
ds_read_b64_tr_b16 a[104:105], v8 offset:8192
ds_read_b64_tr_b16 a[106:107], v8 offset:9216
ds_read_b64_tr_b16 a[108:109], v8 offset:8224
ds_read_b64_tr_b16 a[110:111], v8 offset:9248
s_add_u32 m0, s38, 147456
s_mov_b32 s3, 2097152
buffer_load_dwordx4 v5, s[12:15], s3 offen lds
s_add_u32 m0, s38, 151552
s_mov_b32 s3, 2228224
buffer_load_dwordx4 v5, s[12:15], s3 offen lds
s_add_u32 m0, s38, 155648
s_mov_b32 s3, 2359296
buffer_load_dwordx4 v5, s[12:15], s3 offen lds
s_add_u32 m0, s38, 159744
s_mov_b32 s3, 2490368
buffer_load_dwordx4 v5, s[12:15], s3 offen lds
v_lshlrev_b32 v82, 2, v0
global_load_dword v83, v82, s[28:29] sc1
v_add_u32 v8, 98304, v6
s_waitcnt vmcnt(13)
s_waitcnt lgkmcnt(0)
s_barrier
ds_read_b64_tr_b16 a[112:113], v8 offset:0
ds_read_b64_tr_b16 a[114:115], v8 offset:1024
ds_read_b64_tr_b16 a[116:117], v8 offset:32
ds_read_b64_tr_b16 a[118:119], v8 offset:1056
ds_read_b64_tr_b16 a[120:121], v8 offset:8192
ds_read_b64_tr_b16 a[122:123], v8 offset:9216
ds_read_b64_tr_b16 a[124:125], v8 offset:8224
ds_read_b64_tr_b16 a[126:127], v8 offset:9248
v_add_u32 v8, 114688, v6
s_waitcnt vmcnt(9)
s_waitcnt lgkmcnt(0)
s_barrier
ds_read_b64_tr_b16 a[128:129], v8 offset:0
ds_read_b64_tr_b16 a[130:131], v8 offset:1024
ds_read_b64_tr_b16 a[132:133], v8 offset:32
ds_read_b64_tr_b16 a[134:135], v8 offset:1056
ds_read_b64_tr_b16 a[136:137], v8 offset:8192
ds_read_b64_tr_b16 a[138:139], v8 offset:9216
ds_read_b64_tr_b16 a[140:141], v8 offset:8224
ds_read_b64_tr_b16 a[142:143], v8 offset:9248
v_add_u32 v8, 131072, v6
s_waitcnt vmcnt(5)
s_waitcnt lgkmcnt(0)
s_barrier
ds_read_b64_tr_b16 a[144:145], v8 offset:0
ds_read_b64_tr_b16 a[146:147], v8 offset:1024
ds_read_b64_tr_b16 a[148:149], v8 offset:32
ds_read_b64_tr_b16 a[150:151], v8 offset:1056
ds_read_b64_tr_b16 a[152:153], v8 offset:8192
ds_read_b64_tr_b16 a[154:155], v8 offset:9216
ds_read_b64_tr_b16 a[156:157], v8 offset:8224
ds_read_b64_tr_b16 a[158:159], v8 offset:9248
v_add_u32 v8, 147456, v6
s_waitcnt vmcnt(1)
s_waitcnt lgkmcnt(0)
s_barrier
ds_read_b64_tr_b16 a[160:161], v8 offset:0
ds_read_b64_tr_b16 a[162:163], v8 offset:1024
ds_read_b64_tr_b16 a[164:165], v8 offset:32
ds_read_b64_tr_b16 a[166:167], v8 offset:1056
ds_read_b64_tr_b16 a[168:169], v8 offset:8192
ds_read_b64_tr_b16 a[170:171], v8 offset:9216
ds_read_b64_tr_b16 a[172:173], v8 offset:8224
ds_read_b64_tr_b16 a[174:175], v8 offset:9248
s_waitcnt lgkmcnt(0)
s_barrier
s_branch L_kc1v_f
L_kc0v_f:
global_load_dword v83, v82, s[28:29] sc1
s_add_u32 s27, s27, 1
s_cmp_gt_u32 s27, 262144
s_cbranch_scc1 L_fail_f
L_kc1v_f:
s_lshl_b32 s3, s77, 4
s_add_u32 s3, s3, 14
s_waitcnt vmcnt(0)
v_readlane_b32 s3, v83, s3
s_cmp_lt_u32 s3, 0x400000
s_cbranch_scc1 L_kc0v_f
s_and_b32 s31, s3, 0xff
s_cmp_ge_u32 s31, 32
s_cselect_b32 s30, 8192, 0
s_bfe_u32 s31, s3, 0x80008
s_cmp_ge_u32 s31, 32
s_cselect_b32 s31, 0, 16384
s_add_u32 s30, s30, s31
s_mul_i32 s35, s25, 2097152
s_add_u32 s35, s35, 50331648
s_lshr_b32 s3, s35, 8
s_xor_b32 s3, s3, s30
s_and_b32 s3, s3, 8192
s_add_u32 s35, s35, s3
s_lshl_b32 s3, s26, 10
s_xor_b32 s36, s35, 8192
s_add_u32 s36, s36, s3
s_lshl_b32 s3, s26, 11
s_add_u32 s35, s35, s3
s_add_u32 s35, s35, 16384
s_mul_i32 s38, s26, 10240
s_add_u32 s33, s38, 6291456
s_mov_b32 s34, s38
s_mov_b32 s40, 0
s_mov_b32 s32, 0
s_mov_b32 s39, 1040356334
v_mov_b32 v11, 0
s_cmp_lg_u32 s26, 0
s_cbranch_scc1 L_cenwv_f
v_mbcnt_lo_u32_b32 v10, -1, 0
v_mbcnt_hi_u32_b32 v10, -1, v10
v_and_b32 v10, 7, v10
v_mul_u32_u24 v10, 66, v10
v_and_b32 v10, 0xc8, v10
v_add_u32 v10, s76, v10
L_cenv_f:
global_load_dwordx2 v[8:9], v10, s[28:29] sc1
s_add_u32 s27, s27, 1
s_cmp_gt_u32 s27, 262144
s_cbranch_scc1 L_fail_f
s_waitcnt vmcnt(0)
v_cmp_eq_u32 s[30:31], -1, v8
v_cmp_eq_u32 vcc, 0x200000, v9
s_and_b64 s[30:31], s[30:31], vcc
v_lshrrev_b32 v9, 16, v9
s_nop 1
v_add_u32_dpp v9, v9, v9 row_ror:4 row_mask:0xf bank_mask:0xf
s_nop 1
v_add_u32_dpp v9, v9, v9 row_ror:2 row_mask:0xf bank_mask:0xf
s_nop 1
v_add_u32_dpp v9, v9, v9 row_ror:1 row_mask:0xf bank_mask:0xf
v_cmp_lt_u32 vcc, 255, v9
s_cbranch_vccnz L_cendv_f
s_sleep 12
s_branch L_cenv_f
L_cendv_f:
v_mov_b32 v8, s30
ds_write_b32 v11, v8
s_waitcnt lgkmcnt(0)
L_cenwv_f:
s_barrier
ds_read_b32 v8, v11
s_waitcnt lgkmcnt(0)
v_cmp_ne_u32 vcc, -1, v8
s_cbranch_vccnz L_next
s_cmp_lg_u32 s26, 0
s_cbranch_scc1 L_khwv_f
v_min_u32 v80, 11, v0
v_lshlrev_b32 v80, 2, v80
s_mov_b32 s3, 9216
L_kh0v_f:
buffer_load_dword v81, v80, s[4:7], s3 offen sc1
s_add_u32 s27, s27, 1
s_cmp_gt_u32 s27, 262144
s_cbranch_scc1 L_fail_f
s_waitcnt vmcnt(0)
v_cmp_ne_u32 vcc, 1, v81
s_cbranch_vccz L_khok0v_f
s_sleep 2
s_branch L_kh0v_f
L_khok0v_f:
L_khwv_f:
s_barrier
s_add_u32 m0, s34, 0
s_add_u32 s3, s33, 0
buffer_load_dwordx4 v1, s[4:7], s3 offen offset:0 sc1 lds
buffer_load_dwordx4 v1, s[4:7], s3 offen offset:1024 sc1 lds
buffer_load_dwordx4 v1, s[4:7], s3 offen offset:2048 sc1 lds
buffer_load_dwordx4 v1, s[4:7], s3 offen offset:3072 sc1 lds
s_add_u32 m0, s34, 4096
s_add_u32 s3, s33, 4096
buffer_load_dwordx4 v1, s[4:7], s3 offen offset:0 sc1 lds
buffer_load_dwordx4 v1, s[4:7], s3 offen offset:1024 sc1 lds
buffer_load_dwordx4 v1, s[4:7], s3 offen offset:2048 sc1 lds
buffer_load_dwordx4 v1, s[4:7], s3 offen offset:3072 sc1 lds
s_add_u32 m0, s34, 8192
s_add_u32 s3, s33, 8192
buffer_load_dwordx4 v1, s[4:7], s3 offen offset:0 sc1 lds
buffer_load_dwordx4 v1, s[4:7], s3 offen offset:1024 sc1 lds
s_add_u32 s33, s33, 40960
s_add_u32 s34, s34, 40960
s_cmp_ge_u32 s34, 163840
s_cselect_b32 s3, 163840, 0
s_sub_u32 s34, s34, s3
s_add_u32 m0, s34, 0
s_add_u32 s3, s33, 0
buffer_load_dwordx4 v1, s[4:7], s3 offen offset:0 sc1 lds
buffer_load_dwordx4 v1, s[4:7], s3 offen offset:1024 sc1 lds
buffer_load_dwordx4 v1, s[4:7], s3 offen offset:2048 sc1 lds
buffer_load_dwordx4 v1, s[4:7], s3 offen offset:3072 sc1 lds
s_add_u32 m0, s34, 4096
s_add_u32 s3, s33, 4096
buffer_load_dwordx4 v1, s[4:7], s3 offen offset:0 sc1 lds
buffer_load_dwordx4 v1, s[4:7], s3 offen offset:1024 sc1 lds
buffer_load_dwordx4 v1, s[4:7], s3 offen offset:2048 sc1 lds
buffer_load_dwordx4 v1, s[4:7], s3 offen offset:3072 sc1 lds
s_add_u32 m0, s34, 8192
s_add_u32 s3, s33, 8192
buffer_load_dwordx4 v1, s[4:7], s3 offen offset:0 sc1 lds
buffer_load_dwordx4 v1, s[4:7], s3 offen offset:1024 sc1 lds
s_add_u32 s33, s33, 40960
s_add_u32 s34, s34, 40960
s_cmp_ge_u32 s34, 163840
s_cselect_b32 s3, 163840, 0
s_sub_u32 s34, s34, s3
L_ksegv_f:
s_cmp_lg_u32 s32, 4
s_cbranch_scc1 L_kno1v_f
v_min_u32 v80, 63, v0
v_lshlrev_b32 v80, 2, v80
s_mov_b32 s3, 9216
L_kh1v_f:
buffer_load_dword v81, v80, s[4:7], s3 offen sc1
s_add_u32 s27, s27, 1
s_cmp_gt_u32 s27, 262144
s_cbranch_scc1 L_fail_f
s_waitcnt vmcnt(0)
v_cmp_ne_u32 vcc, 1, v81
s_cbranch_vccz L_khok1v_f
s_sleep 2
s_branch L_kh1v_f
L_khok1v_f:
L_kno1v_f:
s_cmp_lg_u32 s32, 30
s_cbranch_scc1 L_kno2v_f
v_min_u32 v80, 63, v0
v_lshlrev_b32 v80, 2, v80
s_mov_b32 s3, 9472
L_kh2v_f:
buffer_load_dword v81, v80, s[4:7], s3 offen sc1
s_add_u32 s27, s27, 1
s_cmp_gt_u32 s27, 262144
s_cbranch_scc1 L_fail_f
s_waitcnt vmcnt(0)
v_cmp_ne_u32 vcc, 1, v81
s_cbranch_vccz L_khok2v_f
s_sleep 2
s_branch L_kh2v_f
L_khok2v_f:
L_kno2v_f:
s_waitcnt vmcnt(10)
s_barrier
v_add_u32 v2, s40, v1
ds_read_b128 v[8:11], v2 offset:0
ds_read_b128 v[12:15], v2 offset:20480
ds_read_b128 v[16:19], v2 offset:1024
ds_read_b128 v[20:23], v2 offset:21504
ds_read_b128 v[24:27], v2 offset:2048
ds_read_b128 v[28:31], v2 offset:22528
s_add_u32 s40, s40, 40960
s_cmp_ge_u32 s40, 163840
s_cselect_b32 s40, 0, s40
v_mov_b32 v5, s32
s_waitcnt lgkmcnt(5)
v_mfma_f32_16x16x32_bf16 v[32:35], v[8:11], v[192:195], 0
s_add_u32 m0, s34, 0
s_add_u32 s3, s33, 0
buffer_load_dwordx4 v1, s[4:7], s3 offen offset:0 sc1 lds
v_mfma_f32_16x16x32_bf16 v[40:43], v[8:11], v[196:199], 0
ds_read_b128 v[8:11], v2 offset:3072
s_waitcnt lgkmcnt(5)
v_mfma_f32_16x16x32_bf16 v[36:39], v[12:15], v[192:195], 0
v_mfma_f32_16x16x32_bf16 v[44:47], v[12:15], v[196:199], 0
ds_read_b128 v[12:15], v2 offset:23552
s_waitcnt lgkmcnt(5)
v_mfma_f32_16x16x32_bf16 v[32:35], v[16:19], v[200:203], v[32:35]
v_mfma_f32_16x16x32_bf16 v[40:43], v[16:19], v[204:207], v[40:43]
ds_read_b128 v[16:19], v2 offset:4096
s_waitcnt lgkmcnt(5)
v_mfma_f32_16x16x32_bf16 v[36:39], v[20:23], v[200:203], v[36:39]
buffer_load_dwordx4 v1, s[4:7], s3 offen offset:1024 sc1 lds
v_mfma_f32_16x16x32_bf16 v[44:47], v[20:23], v[204:207], v[44:47]
ds_read_b128 v[20:23], v2 offset:24576
s_waitcnt lgkmcnt(5)
v_mfma_f32_16x16x32_bf16 v[32:35], v[24:27], v[208:211], v[32:35]
v_mfma_f32_16x16x32_bf16 v[40:43], v[24:27], v[212:215], v[40:43]
ds_read_b128 v[24:27], v2 offset:5120
s_waitcnt lgkmcnt(5)
v_mfma_f32_16x16x32_bf16 v[36:39], v[28:31], v[208:211], v[36:39]
v_mfma_f32_16x16x32_bf16 v[44:47], v[28:31], v[212:215], v[44:47]
ds_read_b128 v[28:31], v2 offset:25600
s_waitcnt lgkmcnt(5)
v_mfma_f32_16x16x32_bf16 v[32:35], v[8:11], v[216:219], v[32:35]
buffer_load_dwordx4 v1, s[4:7], s3 offen offset:2048 sc1 lds
v_mfma_f32_16x16x32_bf16 v[40:43], v[8:11], v[220:223], v[40:43]
ds_read_b128 v[8:11], v2 offset:6144
s_waitcnt lgkmcnt(5)
v_mfma_f32_16x16x32_bf16 v[36:39], v[12:15], v[216:219], v[36:39]
v_mfma_f32_16x16x32_bf16 v[44:47], v[12:15], v[220:223], v[44:47]
ds_read_b128 v[12:15], v2 offset:26624
s_waitcnt lgkmcnt(5)
v_mfma_f32_16x16x32_bf16 v[32:35], v[16:19], v[224:227], v[32:35]
v_mfma_f32_16x16x32_bf16 v[40:43], v[16:19], v[228:231], v[40:43]
ds_read_b128 v[16:19], v2 offset:7168
s_waitcnt lgkmcnt(5)
v_mfma_f32_16x16x32_bf16 v[36:39], v[20:23], v[224:227], v[36:39]
buffer_load_dwordx4 v1, s[4:7], s3 offen offset:3072 sc1 lds
v_mfma_f32_16x16x32_bf16 v[44:47], v[20:23], v[228:231], v[44:47]
ds_read_b128 v[20:23], v2 offset:27648
s_waitcnt lgkmcnt(5)
v_mfma_f32_16x16x32_bf16 v[32:35], v[24:27], v[232:235], v[32:35]
v_mfma_f32_16x16x32_bf16 v[40:43], v[24:27], v[236:239], v[40:43]
ds_read_b128 v[24:27], v2 offset:8192
s_waitcnt lgkmcnt(5)
v_mfma_f32_16x16x32_bf16 v[36:39], v[28:31], v[232:235], v[36:39]
v_mfma_f32_16x16x32_bf16 v[44:47], v[28:31], v[236:239], v[44:47]
ds_read_b128 v[28:31], v2 offset:28672
s_waitcnt lgkmcnt(5)
v_mfma_f32_16x16x32_bf16 v[32:35], v[8:11], v[240:243], v[32:35]
s_add_u32 m0, s34, 4096
s_add_u32 s3, s33, 4096
buffer_load_dwordx4 v1, s[4:7], s3 offen offset:0 sc1 lds
v_mfma_f32_16x16x32_bf16 v[40:43], v[8:11], v[244:247], v[40:43]
ds_read_b128 v[8:11], v2 offset:9216
s_waitcnt lgkmcnt(5)
v_mfma_f32_16x16x32_bf16 v[36:39], v[12:15], v[240:243], v[36:39]
v_mfma_f32_16x16x32_bf16 v[44:47], v[12:15], v[244:247], v[44:47]
ds_read_b128 v[12:15], v2 offset:29696
s_waitcnt lgkmcnt(5)
v_mfma_f32_16x16x32_bf16 v[32:35], v[16:19], v[248:251], v[32:35]
v_mfma_f32_16x16x32_bf16 v[40:43], v[16:19], v[252:255], v[40:43]
ds_read_b128 v[16:19], v2 offset:10240
s_waitcnt lgkmcnt(5)
v_mfma_f32_16x16x32_bf16 v[36:39], v[20:23], v[248:251], v[36:39]
buffer_load_dwordx4 v1, s[4:7], s3 offen offset:1024 sc1 lds
v_mfma_f32_16x16x32_bf16 v[44:47], v[20:23], v[252:255], v[44:47]
ds_read_b128 v[20:23], v2 offset:30720
s_waitcnt lgkmcnt(5)
v_mfma_f32_16x16x32_bf16 v[32:35], v[24:27], a[0:3], v[32:35]
v_mfma_f32_16x16x32_bf16 v[40:43], v[24:27], a[4:7], v[40:43]
ds_read_b128 v[24:27], v2 offset:11264
s_waitcnt lgkmcnt(5)
v_mfma_f32_16x16x32_bf16 v[36:39], v[28:31], a[0:3], v[36:39]
v_mfma_f32_16x16x32_bf16 v[44:47], v[28:31], a[4:7], v[44:47]
ds_read_b128 v[28:31], v2 offset:31744
s_waitcnt lgkmcnt(5)
v_mfma_f32_16x16x32_bf16 v[32:35], v[8:11], a[8:11], v[32:35]
buffer_load_dwordx4 v1, s[4:7], s3 offen offset:2048 sc1 lds
v_mfma_f32_16x16x32_bf16 v[40:43], v[8:11], a[12:15], v[40:43]
ds_read_b128 v[8:11], v2 offset:12288
s_waitcnt lgkmcnt(5)
v_mfma_f32_16x16x32_bf16 v[36:39], v[12:15], a[8:11], v[36:39]
v_mfma_f32_16x16x32_bf16 v[44:47], v[12:15], a[12:15], v[44:47]
ds_read_b128 v[12:15], v2 offset:32768
s_waitcnt lgkmcnt(5)
v_mfma_f32_16x16x32_bf16 v[32:35], v[16:19], a[16:19], v[32:35]
v_mfma_f32_16x16x32_bf16 v[40:43], v[16:19], a[20:23], v[40:43]
ds_read_b128 v[16:19], v2 offset:13312
s_waitcnt lgkmcnt(5)
v_mfma_f32_16x16x32_bf16 v[36:39], v[20:23], a[16:19], v[36:39]
buffer_load_dwordx4 v1, s[4:7], s3 offen offset:3072 sc1 lds
v_mfma_f32_16x16x32_bf16 v[44:47], v[20:23], a[20:23], v[44:47]
ds_read_b128 v[20:23], v2 offset:33792
s_waitcnt lgkmcnt(5)
v_mfma_f32_16x16x32_bf16 v[32:35], v[24:27], a[24:27], v[32:35]
v_mfma_f32_16x16x32_bf16 v[40:43], v[24:27], a[28:31], v[40:43]
ds_read_b128 v[24:27], v2 offset:14336
s_waitcnt lgkmcnt(5)
v_mfma_f32_16x16x32_bf16 v[36:39], v[28:31], a[24:27], v[36:39]
v_mfma_f32_16x16x32_bf16 v[44:47], v[28:31], a[28:31], v[44:47]
ds_read_b128 v[28:31], v2 offset:34816
s_waitcnt lgkmcnt(5)
v_mfma_f32_16x16x32_bf16 v[32:35], v[8:11], a[32:35], v[32:35]
s_add_u32 m0, s34, 8192
s_add_u32 s3, s33, 8192
buffer_load_dwordx4 v1, s[4:7], s3 offen offset:0 sc1 lds
v_mfma_f32_16x16x32_bf16 v[40:43], v[8:11], a[36:39], v[40:43]
ds_read_b128 v[8:11], v2 offset:15360
s_waitcnt lgkmcnt(5)
v_mfma_f32_16x16x32_bf16 v[36:39], v[12:15], a[32:35], v[36:39]
v_mfma_f32_16x16x32_bf16 v[44:47], v[12:15], a[36:39], v[44:47]
ds_read_b128 v[12:15], v2 offset:35840
s_waitcnt lgkmcnt(5)
v_mfma_f32_16x16x32_bf16 v[32:35], v[16:19], a[40:43], v[32:35]
v_mfma_f32_16x16x32_bf16 v[40:43], v[16:19], a[44:47], v[40:43]
ds_read_b128 v[16:19], v2 offset:16384
s_waitcnt lgkmcnt(5)
v_mfma_f32_16x16x32_bf16 v[36:39], v[20:23], a[40:43], v[36:39]
buffer_load_dwordx4 v1, s[4:7], s3 offen offset:1024 sc1 lds
s_add_u32 s33, s33, 40960
s_add_u32 s34, s34, 40960
s_cmp_ge_u32 s34, 163840
s_cselect_b32 s3, 163840, 0
s_sub_u32 s34, s34, s3
v_mfma_f32_16x16x32_bf16 v[44:47], v[20:23], a[44:47], v[44:47]
ds_read_b128 v[20:23], v2 offset:36864
s_waitcnt lgkmcnt(5)
v_mfma_f32_16x16x32_bf16 v[32:35], v[24:27], a[48:51], v[32:35]
v_mfma_f32_16x16x32_bf16 v[40:43], v[24:27], a[52:55], v[40:43]
ds_read_b128 v[24:27], v2 offset:17408
s_waitcnt lgkmcnt(5)
v_mfma_f32_16x16x32_bf16 v[36:39], v[28:31], a[48:51], v[36:39]
v_mfma_f32_16x16x32_bf16 v[44:47], v[28:31], a[52:55], v[44:47]
ds_read_b128 v[28:31], v2 offset:37888
s_waitcnt lgkmcnt(5)
v_mfma_f32_16x16x32_bf16 v[32:35], v[8:11], a[56:59], v[32:35]
v_mfma_f32_16x16x32_bf16 v[40:43], v[8:11], a[60:63], v[40:43]
ds_read_b128 v[8:11], v2 offset:18432
s_waitcnt lgkmcnt(5)
v_mfma_f32_16x16x32_bf16 v[36:39], v[12:15], a[56:59], v[36:39]
v_mfma_f32_16x16x32_bf16 v[44:47], v[12:15], a[60:63], v[44:47]
ds_read_b128 v[12:15], v2 offset:38912
s_waitcnt vmcnt(10)
buffer_store_dword v5, off, s[4:7], s37 sc1
s_waitcnt lgkmcnt(5)
v_mfma_f32_16x16x32_bf16 v[32:35], v[16:19], a[64:67], v[32:35]
v_mfma_f32_16x16x32_bf16 v[40:43], v[16:19], a[68:71], v[40:43]
ds_read_b128 v[16:19], v2 offset:19456
s_waitcnt lgkmcnt(5)
v_mfma_f32_16x16x32_bf16 v[36:39], v[20:23], a[64:67], v[36:39]
v_mfma_f32_16x16x32_bf16 v[44:47], v[20:23], a[68:71], v[44:47]
ds_read_b128 v[20:23], v2 offset:39936
s_waitcnt lgkmcnt(5)
v_mfma_f32_16x16x32_bf16 v[32:35], v[24:27], a[72:75], v[32:35]
v_mfma_f32_16x16x32_bf16 v[40:43], v[24:27], a[76:79], v[40:43]
s_waitcnt lgkmcnt(4)
v_mfma_f32_16x16x32_bf16 v[36:39], v[28:31], a[72:75], v[36:39]
v_mfma_f32_16x16x32_bf16 v[44:47], v[28:31], a[76:79], v[44:47]
s_waitcnt lgkmcnt(3)
v_mfma_f32_16x16x32_bf16 v[32:35], v[8:11], a[80:83], v[32:35]
v_mfma_f32_16x16x32_bf16 v[40:43], v[8:11], a[84:87], v[40:43]
s_waitcnt lgkmcnt(2)
v_mfma_f32_16x16x32_bf16 v[36:39], v[12:15], a[80:83], v[36:39]
v_mfma_f32_16x16x32_bf16 v[44:47], v[12:15], a[84:87], v[44:47]
s_waitcnt lgkmcnt(1)
v_mfma_f32_16x16x32_bf16 v[32:35], v[16:19], a[88:91], v[32:35]
v_mfma_f32_16x16x32_bf16 v[40:43], v[16:19], a[92:95], v[40:43]
s_waitcnt lgkmcnt(0)
v_mfma_f32_16x16x32_bf16 v[36:39], v[20:23], a[88:91], v[36:39]
v_mfma_f32_16x16x32_bf16 v[44:47], v[20:23], a[92:95], v[44:47]
s_nop 3
v_cvt_pk_bf16_f32 v64, v32, v33
v_cvt_pk_bf16_f32 v65, v34, v35
s_nop 0
v_cvt_pk_bf16_f32 v66, v36, v37
v_cvt_pk_bf16_f32 v67, v38, v39
buffer_store_dwordx4 v[64:67], v1, s[4:7], s35 offen offset:0 sc1
v_cvt_pk_bf16_f32 v68, v40, v41
v_cvt_pk_bf16_f32 v69, v42, v43
v_cvt_pk_bf16_f32 v70, v44, v45
v_cvt_pk_bf16_f32 v71, v46, v47
buffer_store_dwordx4 v[68:71], v1, s[4:7], s35 offen offset:1024 sc1
s_add_u32 s35, s35, 32768
s_add_u32 s36, s36, 32768
s_add_u32 s32, s32, 1
s_barrier
v_add_u32 v2, s40, v1
ds_read_b128 v[8:11], v2 offset:0
ds_read_b128 v[12:15], v2 offset:20480
ds_read_b128 v[16:19], v2 offset:1024
ds_read_b128 v[20:23], v2 offset:21504
ds_read_b128 v[24:27], v2 offset:2048
ds_read_b128 v[28:31], v2 offset:22528
s_add_u32 s40, s40, 40960
s_cmp_ge_u32 s40, 163840
s_cselect_b32 s40, 0, s40
v_mov_b32 v5, s32
s_waitcnt lgkmcnt(5)
v_mfma_f32_16x16x32_bf16 v[32:35], v[8:11], v[192:195], 0
s_add_u32 m0, s34, 0
s_add_u32 s3, s33, 0
buffer_load_dwordx4 v1, s[4:7], s3 offen offset:0 sc1 lds
v_mfma_f32_16x16x32_bf16 v[40:43], v[8:11], v[196:199], 0
v_mfma_f32_16x16x32_bf16 v[48:51], a[96:99], v[8:11], 0
v_mfma_f32_16x16x32_bf16 v[52:55], a[100:103], v[8:11], 0
ds_read_b128 v[8:11], v2 offset:3072
s_waitcnt lgkmcnt(5)
v_mfma_f32_16x16x32_bf16 v[36:39], v[12:15], v[192:195], 0
v_mfma_f32_16x16x32_bf16 v[44:47], v[12:15], v[196:199], 0
v_mfma_f32_16x16x32_bf16 v[56:59], a[96:99], v[12:15], 0
v_mfma_f32_16x16x32_bf16 v[60:63], a[100:103], v[12:15], 0
ds_read_b128 v[12:15], v2 offset:23552
s_waitcnt lgkmcnt(5)
v_mfma_f32_16x16x32_bf16 v[32:35], v[16:19], v[200:203], v[32:35]
v_mfma_f32_16x16x32_bf16 v[40:43], v[16:19], v[204:207], v[40:43]
v_mfma_f32_16x16x32_bf16 v[48:51], a[104:107], v[16:19], v[48:51]
v_mfma_f32_16x16x32_bf16 v[52:55], a[108:111], v[16:19], v[52:55]
ds_read_b128 v[16:19], v2 offset:4096
s_waitcnt lgkmcnt(5)
v_mfma_f32_16x16x32_bf16 v[36:39], v[20:23], v[200:203], v[36:39]
buffer_load_dwordx4 v1, s[4:7], s3 offen offset:1024 sc1 lds
v_mfma_f32_16x16x32_bf16 v[44:47], v[20:23], v[204:207], v[44:47]
v_mfma_f32_16x16x32_bf16 v[56:59], a[104:107], v[20:23], v[56:59]
v_mfma_f32_16x16x32_bf16 v[60:63], a[108:111], v[20:23], v[60:63]
ds_read_b128 v[20:23], v2 offset:24576
s_waitcnt lgkmcnt(5)
v_mfma_f32_16x16x32_bf16 v[32:35], v[24:27], v[208:211], v[32:35]
v_mfma_f32_16x16x32_bf16 v[40:43], v[24:27], v[212:215], v[40:43]
v_mfma_f32_16x16x32_bf16 v[48:51], a[112:115], v[24:27], v[48:51]
v_mfma_f32_16x16x32_bf16 v[52:55], a[116:119], v[24:27], v[52:55]
ds_read_b128 v[24:27], v2 offset:5120
s_waitcnt lgkmcnt(5)
v_mfma_f32_16x16x32_bf16 v[36:39], v[28:31], v[208:211], v[36:39]
v_mfma_f32_16x16x32_bf16 v[44:47], v[28:31], v[212:215], v[44:47]
v_mfma_f32_16x16x32_bf16 v[56:59], a[112:115], v[28:31], v[56:59]
v_mfma_f32_16x16x32_bf16 v[60:63], a[116:119], v[28:31], v[60:63]
ds_read_b128 v[28:31], v2 offset:25600
s_waitcnt lgkmcnt(5)
v_mfma_f32_16x16x32_bf16 v[32:35], v[8:11], v[216:219], v[32:35]
buffer_load_dwordx4 v1, s[4:7], s3 offen offset:2048 sc1 lds
v_mfma_f32_16x16x32_bf16 v[40:43], v[8:11], v[220:223], v[40:43]
v_mfma_f32_16x16x32_bf16 v[48:51], a[120:123], v[8:11], v[48:51]
v_mfma_f32_16x16x32_bf16 v[52:55], a[124:127], v[8:11], v[52:55]
ds_read_b128 v[8:11], v2 offset:6144
s_waitcnt lgkmcnt(5)
v_mfma_f32_16x16x32_bf16 v[36:39], v[12:15], v[216:219], v[36:39]
v_mfma_f32_16x16x32_bf16 v[44:47], v[12:15], v[220:223], v[44:47]
v_mfma_f32_16x16x32_bf16 v[56:59], a[120:123], v[12:15], v[56:59]
v_mfma_f32_16x16x32_bf16 v[60:63], a[124:127], v[12:15], v[60:63]
ds_read_b128 v[12:15], v2 offset:26624
s_waitcnt lgkmcnt(5)
v_mfma_f32_16x16x32_bf16 v[32:35], v[16:19], v[224:227], v[32:35]
v_mfma_f32_16x16x32_bf16 v[40:43], v[16:19], v[228:231], v[40:43]
v_mfma_f32_16x16x32_bf16 v[48:51], a[128:131], v[16:19], v[48:51]
v_mfma_f32_16x16x32_bf16 v[52:55], a[132:135], v[16:19], v[52:55]
ds_read_b128 v[16:19], v2 offset:7168
s_waitcnt lgkmcnt(5)
v_mfma_f32_16x16x32_bf16 v[36:39], v[20:23], v[224:227], v[36:39]
buffer_load_dwordx4 v1, s[4:7], s3 offen offset:3072 sc1 lds
v_mfma_f32_16x16x32_bf16 v[44:47], v[20:23], v[228:231], v[44:47]
v_mfma_f32_16x16x32_bf16 v[56:59], a[128:131], v[20:23], v[56:59]
v_mfma_f32_16x16x32_bf16 v[60:63], a[132:135], v[20:23], v[60:63]
ds_read_b128 v[20:23], v2 offset:27648
s_waitcnt lgkmcnt(5)
v_mfma_f32_16x16x32_bf16 v[32:35], v[24:27], v[232:235], v[32:35]
v_mfma_f32_16x16x32_bf16 v[40:43], v[24:27], v[236:239], v[40:43]
v_mfma_f32_16x16x32_bf16 v[48:51], a[136:139], v[24:27], v[48:51]
v_mfma_f32_16x16x32_bf16 v[52:55], a[140:143], v[24:27], v[52:55]
ds_read_b128 v[24:27], v2 offset:8192
s_waitcnt lgkmcnt(5)
v_mfma_f32_16x16x32_bf16 v[36:39], v[28:31], v[232:235], v[36:39]
v_mfma_f32_16x16x32_bf16 v[44:47], v[28:31], v[236:239], v[44:47]
v_mfma_f32_16x16x32_bf16 v[56:59], a[136:139], v[28:31], v[56:59]
v_mfma_f32_16x16x32_bf16 v[60:63], a[140:143], v[28:31], v[60:63]
ds_read_b128 v[28:31], v2 offset:28672
s_waitcnt lgkmcnt(5)
v_mfma_f32_16x16x32_bf16 v[32:35], v[8:11], v[240:243], v[32:35]
s_add_u32 m0, s34, 4096
s_add_u32 s3, s33, 4096
buffer_load_dwordx4 v1, s[4:7], s3 offen offset:0 sc1 lds
v_mfma_f32_16x16x32_bf16 v[40:43], v[8:11], v[244:247], v[40:43]
v_mfma_f32_16x16x32_bf16 v[48:51], a[144:147], v[8:11], v[48:51]
v_mfma_f32_16x16x32_bf16 v[52:55], a[148:151], v[8:11], v[52:55]
ds_read_b128 v[8:11], v2 offset:9216
s_waitcnt lgkmcnt(5)
v_mfma_f32_16x16x32_bf16 v[36:39], v[12:15], v[240:243], v[36:39]
v_mfma_f32_16x16x32_bf16 v[44:47], v[12:15], v[244:247], v[44:47]
v_mfma_f32_16x16x32_bf16 v[56:59], a[144:147], v[12:15], v[56:59]
v_mfma_f32_16x16x32_bf16 v[60:63], a[148:151], v[12:15], v[60:63]
ds_read_b128 v[12:15], v2 offset:29696
s_waitcnt lgkmcnt(5)
v_mfma_f32_16x16x32_bf16 v[32:35], v[16:19], v[248:251], v[32:35]
v_mfma_f32_16x16x32_bf16 v[40:43], v[16:19], v[252:255], v[40:43]
v_mfma_f32_16x16x32_bf16 v[48:51], a[152:155], v[16:19], v[48:51]
v_mfma_f32_16x16x32_bf16 v[52:55], a[156:159], v[16:19], v[52:55]
ds_read_b128 v[16:19], v2 offset:10240
s_waitcnt lgkmcnt(5)
v_mfma_f32_16x16x32_bf16 v[36:39], v[20:23], v[248:251], v[36:39]
buffer_load_dwordx4 v1, s[4:7], s3 offen offset:1024 sc1 lds
v_mfma_f32_16x16x32_bf16 v[44:47], v[20:23], v[252:255], v[44:47]
v_mfma_f32_16x16x32_bf16 v[56:59], a[152:155], v[20:23], v[56:59]
v_mfma_f32_16x16x32_bf16 v[60:63], a[156:159], v[20:23], v[60:63]
ds_read_b128 v[20:23], v2 offset:30720
s_waitcnt lgkmcnt(5)
v_mfma_f32_16x16x32_bf16 v[32:35], v[24:27], a[0:3], v[32:35]
v_mfma_f32_16x16x32_bf16 v[40:43], v[24:27], a[4:7], v[40:43]
v_mfma_f32_16x16x32_bf16 v[48:51], a[160:163], v[24:27], v[48:51]
v_mfma_f32_16x16x32_bf16 v[52:55], a[164:167], v[24:27], v[52:55]
ds_read_b128 v[24:27], v2 offset:11264
s_waitcnt lgkmcnt(5)
v_mfma_f32_16x16x32_bf16 v[36:39], v[28:31], a[0:3], v[36:39]
v_mfma_f32_16x16x32_bf16 v[44:47], v[28:31], a[4:7], v[44:47]
v_mfma_f32_16x16x32_bf16 v[56:59], a[160:163], v[28:31], v[56:59]
v_mfma_f32_16x16x32_bf16 v[60:63], a[164:167], v[28:31], v[60:63]
ds_read_b128 v[28:31], v2 offset:31744
s_waitcnt vmcnt(6)
buffer_store_dword v5, off, s[4:7], s37 sc1
s_waitcnt lgkmcnt(5)
v_mfma_f32_16x16x32_bf16 v[32:35], v[8:11], a[8:11], v[32:35]
buffer_load_dwordx4 v1, s[4:7], s3 offen offset:2048 sc1 lds
v_mfma_f32_16x16x32_bf16 v[40:43], v[8:11], a[12:15], v[40:43]
v_mfma_f32_16x16x32_bf16 v[48:51], a[168:171], v[8:11], v[48:51]
v_mfma_f32_16x16x32_bf16 v[52:55], a[172:175], v[8:11], v[52:55]
ds_read_b128 v[8:11], v2 offset:12288
s_waitcnt lgkmcnt(5)
v_mfma_f32_16x16x32_bf16 v[36:39], v[12:15], a[8:11], v[36:39]
v_mfma_f32_16x16x32_bf16 v[44:47], v[12:15], a[12:15], v[44:47]
v_mfma_f32_16x16x32_bf16 v[56:59], a[168:171], v[12:15], v[56:59]
v_mfma_f32_16x16x32_bf16 v[60:63], a[172:175], v[12:15], v[60:63]
ds_read_b128 v[12:15], v2 offset:32768
s_waitcnt lgkmcnt(5)
v_mfma_f32_16x16x32_bf16 v[32:35], v[16:19], a[16:19], v[32:35]
v_mfma_f32_16x16x32_bf16 v[40:43], v[16:19], a[20:23], v[40:43]
v_mfma_f32_16x16x32_bf16 v[48:51], a[176:179], v[16:19], v[48:51]
v_mfma_f32_16x16x32_bf16 v[52:55], a[180:183], v[16:19], v[52:55]
ds_read_b128 v[16:19], v2 offset:13312
s_waitcnt lgkmcnt(5)
v_mfma_f32_16x16x32_bf16 v[36:39], v[20:23], a[16:19], v[36:39]
buffer_load_dwordx4 v1, s[4:7], s3 offen offset:3072 sc1 lds
v_mfma_f32_16x16x32_bf16 v[44:47], v[20:23], a[20:23], v[44:47]
v_mfma_f32_16x16x32_bf16 v[56:59], a[176:179], v[20:23], v[56:59]
v_mfma_f32_16x16x32_bf16 v[60:63], a[180:183], v[20:23], v[60:63]
ds_read_b128 v[20:23], v2 offset:33792
s_waitcnt lgkmcnt(5)
v_mfma_f32_16x16x32_bf16 v[32:35], v[24:27], a[24:27], v[32:35]
v_mfma_f32_16x16x32_bf16 v[40:43], v[24:27], a[28:31], v[40:43]
v_mfma_f32_16x16x32_bf16 v[48:51], a[184:187], v[24:27], v[48:51]
v_mfma_f32_16x16x32_bf16 v[52:55], a[188:191], v[24:27], v[52:55]
ds_read_b128 v[24:27], v2 offset:14336
s_waitcnt lgkmcnt(5)
v_mfma_f32_16x16x32_bf16 v[36:39], v[28:31], a[24:27], v[36:39]
v_mfma_f32_16x16x32_bf16 v[44:47], v[28:31], a[28:31], v[44:47]
v_mfma_f32_16x16x32_bf16 v[56:59], a[184:187], v[28:31], v[56:59]
v_mfma_f32_16x16x32_bf16 v[60:63], a[188:191], v[28:31], v[60:63]
ds_read_b128 v[28:31], v2 offset:34816
s_waitcnt lgkmcnt(5)
v_mfma_f32_16x16x32_bf16 v[32:35], v[8:11], a[32:35], v[32:35]
s_add_u32 m0, s34, 8192
s_add_u32 s3, s33, 8192
buffer_load_dwordx4 v1, s[4:7], s3 offen offset:0 sc1 lds
v_mfma_f32_16x16x32_bf16 v[40:43], v[8:11], a[36:39], v[40:43]
v_mfma_f32_16x16x32_bf16 v[48:51], a[192:195], v[8:11], v[48:51]
v_mfma_f32_16x16x32_bf16 v[52:55], a[196:199], v[8:11], v[52:55]
ds_read_b128 v[8:11], v2 offset:15360
s_waitcnt lgkmcnt(5)
v_mfma_f32_16x16x32_bf16 v[36:39], v[12:15], a[32:35], v[36:39]
v_mfma_f32_16x16x32_bf16 v[44:47], v[12:15], a[36:39], v[44:47]
v_mfma_f32_16x16x32_bf16 v[56:59], a[192:195], v[12:15], v[56:59]
v_mfma_f32_16x16x32_bf16 v[60:63], a[196:199], v[12:15], v[60:63]
ds_read_b128 v[12:15], v2 offset:35840
s_waitcnt lgkmcnt(5)
v_mfma_f32_16x16x32_bf16 v[32:35], v[16:19], a[40:43], v[32:35]
v_mfma_f32_16x16x32_bf16 v[40:43], v[16:19], a[44:47], v[40:43]
v_mfma_f32_16x16x32_bf16 v[48:51], a[200:203], v[16:19], v[48:51]
v_mfma_f32_16x16x32_bf16 v[52:55], a[204:207], v[16:19], v[52:55]
ds_read_b128 v[16:19], v2 offset:16384
s_waitcnt lgkmcnt(5)
v_mfma_f32_16x16x32_bf16 v[36:39], v[20:23], a[40:43], v[36:39]
buffer_load_dwordx4 v1, s[4:7], s3 offen offset:1024 sc1 lds
s_add_u32 s33, s33, 40960
s_add_u32 s34, s34, 40960
s_cmp_ge_u32 s34, 163840
s_cselect_b32 s3, 163840, 0
s_sub_u32 s34, s34, s3
v_mfma_f32_16x16x32_bf16 v[44:47], v[20:23], a[44:47], v[44:47]
v_mfma_f32_16x16x32_bf16 v[56:59], a[200:203], v[20:23], v[56:59]
v_mfma_f32_16x16x32_bf16 v[60:63], a[204:207], v[20:23], v[60:63]
ds_read_b128 v[20:23], v2 offset:36864
s_waitcnt lgkmcnt(5)
v_mfma_f32_16x16x32_bf16 v[32:35], v[24:27], a[48:51], v[32:35]
v_mfma_f32_16x16x32_bf16 v[40:43], v[24:27], a[52:55], v[40:43]
v_mfma_f32_16x16x32_bf16 v[48:51], a[208:211], v[24:27], v[48:51]
v_mfma_f32_16x16x32_bf16 v[52:55], a[212:215], v[24:27], v[52:55]
ds_read_b128 v[24:27], v2 offset:17408
s_waitcnt lgkmcnt(5)
v_mfma_f32_16x16x32_bf16 v[36:39], v[28:31], a[48:51], v[36:39]
v_mfma_f32_16x16x32_bf16 v[44:47], v[28:31], a[52:55], v[44:47]
v_mfma_f32_16x16x32_bf16 v[56:59], a[208:211], v[28:31], v[56:59]
v_mfma_f32_16x16x32_bf16 v[60:63], a[212:215], v[28:31], v[60:63]
ds_read_b128 v[28:31], v2 offset:37888
s_waitcnt lgkmcnt(5)
v_mfma_f32_16x16x32_bf16 v[32:35], v[8:11], a[56:59], v[32:35]
v_mfma_f32_16x16x32_bf16 v[40:43], v[8:11], a[60:63], v[40:43]
v_mfma_f32_16x16x32_bf16 v[48:51], a[216:219], v[8:11], v[48:51]
v_mfma_f32_16x16x32_bf16 v[52:55], a[220:223], v[8:11], v[52:55]
ds_read_b128 v[8:11], v2 offset:18432
s_waitcnt lgkmcnt(5)
v_mfma_f32_16x16x32_bf16 v[36:39], v[12:15], a[56:59], v[36:39]
v_mfma_f32_16x16x32_bf16 v[44:47], v[12:15], a[60:63], v[44:47]
v_mfma_f32_16x16x32_bf16 v[56:59], a[216:219], v[12:15], v[56:59]
v_mfma_f32_16x16x32_bf16 v[60:63], a[220:223], v[12:15], v[60:63]
ds_read_b128 v[12:15], v2 offset:38912
s_waitcnt lgkmcnt(5)
v_mfma_f32_16x16x32_bf16 v[32:35], v[16:19], a[64:67], v[32:35]
v_mfma_f32_16x16x32_bf16 v[40:43], v[16:19], a[68:71], v[40:43]
v_mfma_f32_16x16x32_bf16 v[48:51], a[224:227], v[16:19], v[48:51]
v_mfma_f32_16x16x32_bf16 v[52:55], a[228:231], v[16:19], v[52:55]
ds_read_b128 v[16:19], v2 offset:19456
s_waitcnt lgkmcnt(5)
v_mfma_f32_16x16x32_bf16 v[36:39], v[20:23], a[64:67], v[36:39]
v_mfma_f32_16x16x32_bf16 v[44:47], v[20:23], a[68:71], v[44:47]
v_mfma_f32_16x16x32_bf16 v[56:59], a[224:227], v[20:23], v[56:59]
v_mfma_f32_16x16x32_bf16 v[60:63], a[228:231], v[20:23], v[60:63]
ds_read_b128 v[20:23], v2 offset:39936
s_waitcnt lgkmcnt(5)
v_mfma_f32_16x16x32_bf16 v[32:35], v[24:27], a[72:75], v[32:35]
v_mfma_f32_16x16x32_bf16 v[40:43], v[24:27], a[76:79], v[40:43]
v_mfma_f32_16x16x32_bf16 v[48:51], a[232:235], v[24:27], v[48:51]
v_mfma_f32_16x16x32_bf16 v[52:55], a[236:239], v[24:27], v[52:55]
s_waitcnt lgkmcnt(4)
v_mfma_f32_16x16x32_bf16 v[36:39], v[28:31], a[72:75], v[36:39]
v_mfma_f32_16x16x32_bf16 v[44:47], v[28:31], a[76:79], v[44:47]
v_mfma_f32_16x16x32_bf16 v[56:59], a[232:235], v[28:31], v[56:59]
v_mfma_f32_16x16x32_bf16 v[60:63], a[236:239], v[28:31], v[60:63]
s_waitcnt lgkmcnt(3)
v_mfma_f32_16x16x32_bf16 v[32:35], v[8:11], a[80:83], v[32:35]
v_mfma_f32_16x16x32_bf16 v[40:43], v[8:11], a[84:87], v[40:43]
v_mfma_f32_16x16x32_bf16 v[48:51], a[240:243], v[8:11], v[48:51]
v_mfma_f32_16x16x32_bf16 v[52:55], a[244:247], v[8:11], v[52:55]
s_waitcnt lgkmcnt(2)
v_mfma_f32_16x16x32_bf16 v[36:39], v[12:15], a[80:83], v[36:39]
v_mfma_f32_16x16x32_bf16 v[44:47], v[12:15], a[84:87], v[44:47]
v_mfma_f32_16x16x32_bf16 v[56:59], a[240:243], v[12:15], v[56:59]
v_mfma_f32_16x16x32_bf16 v[60:63], a[244:247], v[12:15], v[60:63]
s_waitcnt lgkmcnt(1)
v_mfma_f32_16x16x32_bf16 v[32:35], v[16:19], a[88:91], v[32:35]
v_mfma_f32_16x16x32_bf16 v[40:43], v[16:19], a[92:95], v[40:43]
v_mfma_f32_16x16x32_bf16 v[48:51], a[248:251], v[16:19], v[48:51]
v_mfma_f32_16x16x32_bf16 v[52:55], a[252:255], v[16:19], v[52:55]
s_waitcnt lgkmcnt(0)
v_mfma_f32_16x16x32_bf16 v[36:39], v[20:23], a[88:91], v[36:39]
v_mfma_f32_16x16x32_bf16 v[44:47], v[20:23], a[92:95], v[44:47]
v_mfma_f32_16x16x32_bf16 v[56:59], a[248:251], v[20:23], v[56:59]
v_mfma_f32_16x16x32_bf16 v[60:63], a[252:255], v[20:23], v[60:63]
v_cvt_pk_bf16_f32 v64, v32, v33
v_cvt_pk_bf16_f32 v65, v34, v35
s_nop 2
v_cvt_pk_bf16_f32 v66, v36, v37
v_cvt_pk_bf16_f32 v67, v38, v39
buffer_store_dwordx4 v[64:67], v1, s[4:7], s35 offen offset:0 sc1
v_cvt_pk_bf16_f32 v68, v40, v41
v_cvt_pk_bf16_f32 v69, v42, v43
v_cvt_pk_bf16_f32 v70, v44, v45
v_cvt_pk_bf16_f32 v71, v46, v47
buffer_store_dwordx4 v[68:71], v1, s[4:7], s35 offen offset:1024 sc1
v_cvt_pk_bf16_f32 v72, v48, v49
v_cvt_pk_bf16_f32 v73, v50, v51
v_cvt_pk_bf16_f32 v74, v52, v53
v_cvt_pk_bf16_f32 v75, v54, v55
buffer_store_dwordx4 v[72:75], v1, s[4:7], s36 offen offset:0 sc1
v_cvt_pk_bf16_f32 v76, v56, v57
v_cvt_pk_bf16_f32 v77, v58, v59
v_cvt_pk_bf16_f32 v78, v60, v61
v_cvt_pk_bf16_f32 v79, v62, v63
buffer_store_dwordx4 v[76:79], v3, s[4:7], s36 offen offset:0 sc1
s_add_u32 s35, s35, 32768
s_add_u32 s36, s36, 32768
s_add_u32 s32, s32, 1
s_cmp_lt_u32 s32, 64
s_cbranch_scc1 L_ksegv_f
v_mov_b32 v5, 64
s_waitcnt vmcnt(0)
buffer_store_dword v5, off, s[4:7], s37 sc1
s_endpgm
L_fail_f:
s_mov_b64 exec, 1
v_mov_b32 v1, 252
v_mov_b32 v2, 1
global_atomic_add v1, v2, s[28:29] sc1
s_endpgm
L_exit:
s_endpgm
L_next:
s_waitcnt vmcnt(0) lgkmcnt(0)
s_mov_b64 exec, -1
s_barrier
s_add_u32 s3, s77, 1
s_branch L_start
L_again:
s_cmp_eq_u32 s3, 1
s_cbranch_scc0 L_safe
s_mov_b32 s76, 16
s_cmp_lg_u32 s26, 0
s_cbranch_scc1 L_notick
s_mul_i32 s30, s24, 65
s_and_b32 s30, s30, 0xc4
s_add_u32 s30, s30, 48
v_mov_b32 v1, s30
v_mov_b32 v2, 1
v_mov_b32 v3, 0
s_mov_b64 exec, 1
global_atomic_add v2, v1, v2, s[28:29] sc0 sc1
s_waitcnt vmcnt(0)
ds_write_b32 v3, v2
s_mov_b64 exec, -1
s_waitcnt lgkmcnt(0)
L_notick:
s_barrier
v_mov_b32 v3, 0
ds_read_b32 v2, v3
s_waitcnt lgkmcnt(0)
v_readfirstlane_b32 s25, v2
s_barrier
s_and_b32 s25, s25, 31
s_branch L_roles_f
L_safe:
s_lshr_b32 s24, s2, 5
s_and_b32 s25, s2, 31
s_mov_b32 s76, 32
s_mov_b32 s78, 0
L_roles_s:
s_cmp_ge_u32 s24, 4
s_cbranch_scc1 L_role_p_s
s_cmp_ge_u32 s24, 2
s_cbranch_scc1 L_role_k_s
L_role_r_s:
s_cmp_lg_u32 s26, 0
s_cbranch_scc1 L_arrr_s
s_mul_i32 s3, s24, 66
s_and_b32 s3, s3, 0xc8
s_add_u32 s3, s3, s76
v_mov_b32 v18, s3
s_lshl_b32 s3, 1, s25
v_mov_b32 v16, s3
s_add_u32 s3, s78, 0x10000
v_mov_b32 v17, s3
s_mov_b64 exec, 1
global_atomic_add_x2 v18, v[16:17], s[28:29] sc1
s_mov_b64 exec, -1
L_arrr_s:
s_mov_b32 s8, s68
s_mov_b32 s9, s69
s_mov_b32 s10, 5242880
s_mov_b32 s11, 0x20000
s_mov_b32 s12, s70
s_mov_b32 s13, s71
s_mov_b32 s14, 5242880
s_mov_b32 s15, 0x20000
s_mov_b32 s16, s72
s_mov_b32 s17, s73
s_mov_b32 s18, 5242880
s_mov_b32 s19, 0x20000
s_mov_b32 s20, s74
s_mov_b32 s21, s75
s_mov_b32 s22, 5242880
s_mov_b32 s23, 0x20000
v_mbcnt_lo_u32_b32 v6, -1, 0
v_mbcnt_hi_u32_b32 v6, -1, v6
s_lshl_b32 s32, s26, 6
s_lshl_b32 s3, s25, 8
s_add_u32 s3, s3, s32
s_mul_i32 s33, s24, 2621440
s_sub_u32 s34, 2621440, s33
s_lshl_b32 s35, s26, 10
v_lshrrev_b32 v7, 2, v6
v_and_b32 v4, 3, v6
v_lshlrev_b32 v0, 13, v7
v_lshl_add_u32 v0, v4, 4, v0
v_add_u32 v0, s3, v0
s_mul_i32 s3, s25, 163840
s_mul_i32 s30, s24, 640
s_add_u32 s3, s3, s30
v_mul_u32_u24 v1, 1280, v7
v_lshl_add_u32 v1, v4, 4, v1
v_add_u32 v1, s3, v1
s_and_b32 s37, s32, 64
s_lshr_b32 s30, s26, 1
s_mul_i32 s30, s30, 81920
s_add_u32 s37, s37, s30
s_add_u32 s37, s37, 512
s_add_u32 m0, s35, 40960
s_add_u32 s36, s33, 0
buffer_load_dwordx4 v0, s[16:19], s36 offen lds
s_add_u32 m0, s35, 45056
s_add_u32 s36, s33, 131072
buffer_load_dwordx4 v0, s[16:19], s36 offen lds
s_add_u32 m0, s35, 49152
s_add_u32 s36, s33, 262144
buffer_load_dwordx4 v0, s[16:19], s36 offen lds
s_add_u32 m0, s35, 53248
s_add_u32 s36, s33, 393216
buffer_load_dwordx4 v0, s[16:19], s36 offen lds
s_barrier
s_add_u32 m0, s35, 57344
s_add_u32 s36, s33, 524288
buffer_load_dwordx4 v0, s[12:15], s36 offen lds
s_add_u32 m0, s35, 61440
s_add_u32 s36, s33, 655360
buffer_load_dwordx4 v0, s[12:15], s36 offen lds
s_add_u32 m0, s35, 65536
s_add_u32 s36, s33, 786432
buffer_load_dwordx4 v0, s[12:15], s36 offen lds
s_add_u32 m0, s35, 69632
s_add_u32 s36, s33, 917504
buffer_load_dwordx4 v0, s[12:15], s36 offen lds
s_barrier
s_add_u32 m0, s35, 73728
s_add_u32 s36, s33, 524288
buffer_load_dwordx4 v0, s[16:19], s36 offen lds
s_add_u32 m0, s35, 77824
s_add_u32 s36, s33, 655360
buffer_load_dwordx4 v0, s[16:19], s36 offen lds
s_add_u32 m0, s35, 81920
s_add_u32 s36, s33, 786432
buffer_load_dwordx4 v0, s[16:19], s36 offen lds
s_add_u32 m0, s35, 86016
s_add_u32 s36, s33, 917504
buffer_load_dwordx4 v0, s[16:19], s36 offen lds
s_barrier
s_add_u32 m0, s35, 90112
s_add_u32 s36, s33, 1048576
buffer_load_dwordx4 v0, s[16:19], s36 offen lds
s_add_u32 m0, s35, 94208
s_add_u32 s36, s33, 1179648
buffer_load_dwordx4 v0, s[16:19], s36 offen lds
s_add_u32 m0, s35, 98304
s_add_u32 s36, s33, 1310720
buffer_load_dwordx4 v0, s[16:19], s36 offen lds
s_add_u32 m0, s35, 102400
s_add_u32 s36, s33, 1441792
buffer_load_dwordx4 v0, s[16:19], s36 offen lds
s_barrier
v_bfe_u32 v8, v6, 5, 1
v_bfe_u32 v9, v6, 4, 1
v_bfe_u32 v10, v6, 3, 1
v_bfe_u32 v11, v6, 2, 1
s_min_u32 s41, s26, 1
s_lshr_b32 s38, s25, s41
s_lshl_b32 s3, s26, 5
s_add_u32 s38, s38, s3
s_and_b32 s42, s25, s41
s_mul_i32 s30, s24, 262144
s_add_u32 s30, s30, 1048576
s_lshl_b32 s46, s38, 12
s_add_u32 s46, s46, s30
s_lshl_b32 s3, s42, 6
s_add_u32 s46, s46, s3
s_add_u32 s47, s46, 32768
s_lshr_b32 s39, s38, 2
s_lshl_b32 s53, s39, 9
s_and_b32 s40, s38, 3
s_lshl_b32 s3, s40, 6
s_add_u32 s53, s53, s3
s_lshl_b32 s3, s26, 14
s_lshl_b32 s55, s25, 7
s_add_u32 s43, s3, s55
s_add_u32 s43, s43, s30
s_add_u32 s44, s43, 65536
s_add_u32 s45, s43, 131072
s_add_u32 s54, s55, 0
s_lshl_b32 s3, s24, 2
s_add_u32 s55, s55, s3
s_add_u32 s55, s55, 524288
s_lshl_b32 s60, s24, 15
s_add_u32 s60, s60, 65536
s_mul_i32 s61, s24, 131072
s_sub_u32 s62, 393216, s61
s_add_u32 s61, s61, 262144
v_lshrrev_b32 v12, 4, v6
v_and_b32 v13, 15, v6
v_lshlrev_b32 v14, 12, v12
v_lshl_add_u32 v14, v13, 3, v14
v_mov_b32 v16, 1
v_mov_b32 v17, 1
v_mov_b32 v18, 0
buffer_store_dwordx2 v[16:17], v14, s[4:7], s43 offen sc1
buffer_store_dwordx2 v[16:17], v14, s[4:7], s44 offen sc1
buffer_store_dwordx2 v[16:17], v14, s[4:7], s45 offen sc1
s_mov_b32 s96, s66
s_mov_b32 s97, s67
s_mov_b32 s98, 10240
s_mov_b32 s99, 0x20000
s_mul_i32 s40, s40, 2560
s_lshl_b32 s39, s39, 6
s_add_u32 s39, s39, s40
s_mul_i32 s3, s24, 640
s_add_u32 s101, s39, s3
v_and_b32 v15, 1, v6
v_bfe_u32 v20, v6, 1, 1
v_lshlrev_b32 v23, 8, v20
v_lshl_add_u32 v23, v11, 5, v23
v_lshl_add_u32 v23, v15, 4, v23
s_xor_b32 s3, s41, 1
v_and_b32 v25, s3, v12
v_add_u32 v25, s42, v25
v_lshl_add_u32 v25, v25, 1, v8
v_lshl_add_u32 v23, v25, 2, v23
v_add_u32 v23, s53, v23
v_mov_b32 v24, -1
v_mul_u32_u24 v19, 1280, v15
v_lshl_add_u32 v19, v20, 5, v19
v_lshl_add_u32 v19, v25, 3, v19
v_lshl_add_u32 v19, v11, 1, v19
buffer_load_ushort v200, v19, s[96:99], s101 offen
buffer_load_ushort v201, v19, s[96:99], s101 offen offset:4
v_mov_b32 v26, 2147483632
s_cmp_lt_u32 s38, 40
s_cselect_b64 vcc, -1, 0
v_cndmask_b32 v202, v26, v23, vcc
s_cbranch_scc0 L_rinit_s
s_add_u32 s3, s60, 5120
buffer_store_dword v24, v202, s[4:7], s3 offen sc1
s_add_u32 s3, s61, 32768
buffer_store_dword v24, v202, s[4:7], s3 offen sc1
s_add_u32 s3, s61, 40960
buffer_store_dword v24, v202, s[4:7], s3 offen sc1
s_add_u32 s3, s61, 49152
buffer_store_dword v24, v202, s[4:7], s3 offen sc1
s_add_u32 s3, s61, 57344
buffer_store_dword v24, v202, s[4:7], s3 offen sc1
s_add_u32 s3, s60, 10240
buffer_store_dword v24, v202, s[4:7], s3 offen sc1
s_add_u32 s3, s61, 65536
buffer_store_dword v24, v202, s[4:7], s3 offen sc1
s_add_u32 s3, s61, 73728
buffer_store_dword v24, v202, s[4:7], s3 offen sc1
s_add_u32 s3, s61, 81920
buffer_store_dword v24, v202, s[4:7], s3 offen sc1
s_add_u32 s3, s61, 90112
buffer_store_dword v24, v202, s[4:7], s3 offen sc1
s_add_u32 s3, s60, 15360
buffer_store_dword v24, v202, s[4:7], s3 offen sc1
s_add_u32 s3, s61, 98304
buffer_store_dword v24, v202, s[4:7], s3 offen sc1
s_add_u32 s3, s61, 106496
buffer_store_dword v24, v202, s[4:7], s3 offen sc1
s_add_u32 s3, s61, 114688
buffer_store_dword v24, v202, s[4:7], s3 offen sc1
s_add_u32 s3, s61, 122880
buffer_store_dword v24, v202, s[4:7], s3 offen sc1
L_rinit_s:
v_lshlrev_b32 v19, 13, v6
v_mov_b32 v20, 2147483632
s_cmp_eq_u32 s26, 3
s_cselect_b32 s3, 4, 0
v_cmp_gt_u32 vcc, s3, v6
s_nop 1
v_cndmask_b32 v19, v20, v19, vcc
buffer_store_dword v18, v19, s[4:7], s55 offen sc1
v_and_b32 v19, 7, v6
v_lshlrev_b32 v19, 7, v19
s_lshl_b32 s3, s24, 10
s_lshl_b32 s30, s25, 2
s_add_u32 s3, s3, s30
s_add_u32 s3, s3, 49152
buffer_store_dword v18, v19, s[4:7], s3 offen sc1
v_lshlrev_b32 v5, 4, v6
v_add_u32 v5, s35, v5
v_lshlrev_b32 v4, 3, v4
v_add_u32 v4, s35, v4
v_lshl_add_u32 v2, v8, 12, v4
v_lshl_add_u32 v2, v9, 9, v2
v_lshl_add_u32 v2, v11, 7, v2
v_lshl_add_u32 v2, v10, 6, v2
v_lshl_add_u32 v3, v9, 12, v4
v_lshl_add_u32 v3, v10, 5, v3
v_lshl_add_u32 v3, v8, 8, v3
v_lshl_add_u32 v3, v11, 6, v3
s_waitcnt vmcnt(19)
v_add_u32 v4, 40960, v2
ds_read_b64_tr_b16 a[64:65], v4 offset:0
ds_read_b64_tr_b16 a[66:67], v4 offset:256
ds_read_b64_tr_b16 a[68:69], v4 offset:8192
ds_read_b64_tr_b16 a[70:71], v4 offset:8448
ds_read_b64_tr_b16 a[72:73], v4 offset:32
ds_read_b64_tr_b16 a[74:75], v4 offset:288
ds_read_b64_tr_b16 a[76:77], v4 offset:8224
ds_read_b64_tr_b16 a[78:79], v4 offset:8480
s_waitcnt lgkmcnt(0)
s_barrier
s_add_u32 m0, s35, 106496
s_add_u32 s36, s33, 1572864
buffer_load_dwordx4 v0, s[12:15], s36 offen lds
s_add_u32 m0, s35, 110592
s_add_u32 s36, s33, 1703936
buffer_load_dwordx4 v0, s[12:15], s36 offen lds
s_add_u32 m0, s35, 114688
s_add_u32 s36, s33, 1835008
buffer_load_dwordx4 v0, s[12:15], s36 offen lds
s_add_u32 m0, s35, 118784
s_add_u32 s36, s33, 1966080
buffer_load_dwordx4 v0, s[12:15], s36 offen lds
s_waitcnt vmcnt(19)
v_add_u32 v4, 57344, v2
ds_read_b64_tr_b16 v[208:209], v4 offset:0
ds_read_b64_tr_b16 v[210:211], v4 offset:256
ds_read_b64_tr_b16 v[212:213], v4 offset:8192
ds_read_b64_tr_b16 v[214:215], v4 offset:8448
ds_read_b64_tr_b16 v[216:217], v4 offset:32
ds_read_b64_tr_b16 v[218:219], v4 offset:288
ds_read_b64_tr_b16 v[220:221], v4 offset:8224
ds_read_b64_tr_b16 v[222:223], v4 offset:8480
s_waitcnt lgkmcnt(0)
s_barrier
s_add_u32 m0, s35, 122880
s_add_u32 s36, s33, 1572864
buffer_load_dwordx4 v0, s[16:19], s36 offen lds
s_add_u32 m0, s35, 126976
s_add_u32 s36, s33, 1703936
buffer_load_dwordx4 v0, s[16:19], s36 offen lds
s_add_u32 m0, s35, 131072
s_add_u32 s36, s33, 1835008
buffer_load_dwordx4 v0, s[16:19], s36 offen lds
s_add_u32 m0, s35, 135168
s_add_u32 s36, s33, 1966080
buffer_load_dwordx4 v0, s[16:19], s36 offen lds
s_waitcnt vmcnt(19)
v_add_u32 v4, 73728, v2
ds_read_b64_tr_b16 a[80:81], v4 offset:0
ds_read_b64_tr_b16 a[82:83], v4 offset:256
ds_read_b64_tr_b16 a[84:85], v4 offset:8192
ds_read_b64_tr_b16 a[86:87], v4 offset:8448
ds_read_b64_tr_b16 a[88:89], v4 offset:32
ds_read_b64_tr_b16 a[90:91], v4 offset:288
ds_read_b64_tr_b16 a[92:93], v4 offset:8224
ds_read_b64_tr_b16 a[94:95], v4 offset:8480
s_waitcnt lgkmcnt(0)
s_barrier
s_add_u32 m0, s35, 139264
s_add_u32 s36, s33, 2097152
buffer_load_dwordx4 v0, s[12:15], s36 offen lds
s_add_u32 m0, s35, 143360
s_add_u32 s36, s33, 2228224
buffer_load_dwordx4 v0, s[12:15], s36 offen lds
s_add_u32 m0, s35, 147456
s_add_u32 s36, s33, 2359296
buffer_load_dwordx4 v0, s[12:15], s36 offen lds
s_add_u32 m0, s35, 151552
s_add_u32 s36, s33, 2490368
buffer_load_dwordx4 v0, s[12:15], s36 offen lds
s_waitcnt vmcnt(19)
v_add_u32 v4, 90112, v2
ds_read_b64_tr_b16 a[96:97], v4 offset:0
ds_read_b64_tr_b16 a[98:99], v4 offset:256
ds_read_b64_tr_b16 a[100:101], v4 offset:8192
ds_read_b64_tr_b16 a[102:103], v4 offset:8448
ds_read_b64_tr_b16 a[104:105], v4 offset:32
ds_read_b64_tr_b16 a[106:107], v4 offset:288
ds_read_b64_tr_b16 a[108:109], v4 offset:8224
ds_read_b64_tr_b16 a[110:111], v4 offset:8480
s_waitcnt lgkmcnt(0)
s_barrier
s_add_u32 m0, s35, 40960
s_add_u32 s36, s33, 2097152
buffer_load_dwordx4 v0, s[16:19], s36 offen lds
s_add_u32 m0, s35, 45056
s_add_u32 s36, s33, 2228224
buffer_load_dwordx4 v0, s[16:19], s36 offen lds
s_add_u32 m0, s35, 49152
s_add_u32 s36, s33, 2359296
buffer_load_dwordx4 v0, s[16:19], s36 offen lds
s_add_u32 m0, s35, 53248
s_add_u32 s36, s33, 2490368
buffer_load_dwordx4 v0, s[16:19], s36 offen lds
s_waitcnt vmcnt(12)
v_add_u32 v4, 106496, v2
ds_read_b64_tr_b16 v[224:225], v4 offset:0
ds_read_b64_tr_b16 v[226:227], v4 offset:256
ds_read_b64_tr_b16 v[228:229], v4 offset:8192
ds_read_b64_tr_b16 v[230:231], v4 offset:8448
ds_read_b64_tr_b16 v[232:233], v4 offset:32
ds_read_b64_tr_b16 v[234:235], v4 offset:288
ds_read_b64_tr_b16 v[236:237], v4 offset:8224
ds_read_b64_tr_b16 v[238:239], v4 offset:8480
s_waitcnt lgkmcnt(0)
s_barrier
s_add_u32 m0, s35, 57344
s_add_u32 s36, s34, 0
buffer_load_dwordx4 v0, s[12:15], s36 offen lds
s_add_u32 m0, s35, 61440
s_add_u32 s36, s34, 131072
buffer_load_dwordx4 v0, s[12:15], s36 offen lds
s_add_u32 m0, s35, 65536
s_add_u32 s36, s34, 262144
buffer_load_dwordx4 v0, s[12:15], s36 offen lds
s_add_u32 m0, s35, 69632
s_add_u32 s36, s34, 393216
buffer_load_dwordx4 v0, s[12:15], s36 offen lds
v_lshl_or_b32 v200, v201, 16, v200
v_min_u32 v200, -2, v200
s_add_u32 s3, s60, 0
buffer_store_dword v200, v202, s[4:7], s3 offen sc1
s_add_u32 s3, s61, 0
buffer_store_dword v200, v202, s[4:7], s3 offen sc1
s_add_u32 s3, s61, 8192
buffer_store_dword v200, v202, s[4:7], s3 offen sc1
s_add_u32 s3, s61, 16384
buffer_store_dword v200, v202, s[4:7], s3 offen sc1
s_add_u32 s3, s61, 24576
buffer_store_dword v200, v202, s[4:7], s3 offen sc1
s_waitcnt vmcnt(17)
v_add_u32 v4, 122880, v2
ds_read_b64_tr_b16 v[32:33], v4 offset:0
ds_read_b64_tr_b16 v[34:35], v4 offset:256
ds_read_b64_tr_b16 v[36:37], v4 offset:8192
ds_read_b64_tr_b16 v[38:39], v4 offset:8448
ds_read_b64_tr_b16 a[112:113], v4 offset:32
ds_read_b64_tr_b16 a[114:115], v4 offset:288
ds_read_b64_tr_b16 a[116:117], v4 offset:8224
ds_read_b64_tr_b16 a[118:119], v4 offset:8480
s_waitcnt lgkmcnt(0)
s_barrier
s_add_u32 m0, s35, 73728
s_add_u32 s36, s34, 0
buffer_load_dwordx4 v0, s[16:19], s36 offen lds
s_add_u32 m0, s35, 77824
s_add_u32 s36, s34, 131072
buffer_load_dwordx4 v0, s[16:19], s36 offen lds
s_add_u32 m0, s35, 81920
s_add_u32 s36, s34, 262144
buffer_load_dwordx4 v0, s[16:19], s36 offen lds
s_add_u32 m0, s35, 86016
s_add_u32 s36, s34, 393216
buffer_load_dwordx4 v0, s[16:19], s36 offen lds
s_waitcnt vmcnt(17)
v_add_u32 v4, 139264, v2
ds_read_b64_tr_b16 v[240:241], v4 offset:0
ds_read_b64_tr_b16 v[242:243], v4 offset:256
ds_read_b64_tr_b16 v[244:245], v4 offset:8192
ds_read_b64_tr_b16 v[246:247], v4 offset:8448
ds_read_b64_tr_b16 v[248:249], v4 offset:32
ds_read_b64_tr_b16 v[250:251], v4 offset:288
ds_read_b64_tr_b16 v[252:253], v4 offset:8224
ds_read_b64_tr_b16 v[254:255], v4 offset:8480
s_waitcnt lgkmcnt(0)
s_barrier
s_add_u32 m0, s35, 90112
s_add_u32 s36, s34, 524288
buffer_load_dwordx4 v0, s[12:15], s36 offen lds
s_add_u32 m0, s35, 94208
s_add_u32 s36, s34, 655360
buffer_load_dwordx4 v0, s[12:15], s36 offen lds
s_add_u32 m0, s35, 98304
s_add_u32 s36, s34, 786432
buffer_load_dwordx4 v0, s[12:15], s36 offen lds
s_add_u32 m0, s35, 102400
s_add_u32 s36, s34, 917504
buffer_load_dwordx4 v0, s[12:15], s36 offen lds
s_waitcnt vmcnt(17)
v_add_u32 v4, 40960, v2
ds_read_b64_tr_b16 a[120:121], v4 offset:0
ds_read_b64_tr_b16 a[122:123], v4 offset:256
ds_read_b64_tr_b16 a[124:125], v4 offset:8192
ds_read_b64_tr_b16 a[126:127], v4 offset:8448
ds_read_b64_tr_b16 a[128:129], v4 offset:32
ds_read_b64_tr_b16 a[130:131], v4 offset:288
ds_read_b64_tr_b16 a[132:133], v4 offset:8224
ds_read_b64_tr_b16 a[134:135], v4 offset:8480
s_waitcnt lgkmcnt(0)
s_barrier
s_add_u32 m0, s35, 106496
s_add_u32 s36, s34, 524288
buffer_load_dwordx4 v0, s[16:19], s36 offen lds
s_add_u32 m0, s35, 110592
s_add_u32 s36, s34, 655360
buffer_load_dwordx4 v0, s[16:19], s36 offen lds
s_add_u32 m0, s35, 114688
s_add_u32 s36, s34, 786432
buffer_load_dwordx4 v0, s[16:19], s36 offen lds
s_add_u32 m0, s35, 118784
s_add_u32 s36, s34, 917504
buffer_load_dwordx4 v0, s[16:19], s36 offen lds
s_waitcnt vmcnt(17)
v_add_u32 v4, 57344, v2
ds_read_b64_tr_b16 a[0:1], v4 offset:0
ds_read_b64_tr_b16 a[2:3], v4 offset:256
ds_read_b64_tr_b16 a[4:5], v4 offset:8192
ds_read_b64_tr_b16 a[6:7], v4 offset:8448
ds_read_b64_tr_b16 a[8:9], v4 offset:32
ds_read_b64_tr_b16 a[10:11], v4 offset:288
ds_read_b64_tr_b16 a[12:13], v4 offset:8224
ds_read_b64_tr_b16 a[14:15], v4 offset:8480
s_waitcnt lgkmcnt(0)
s_barrier
s_add_u32 m0, s35, 122880
s_add_u32 s36, s34, 1048576
buffer_load_dwordx4 v0, s[12:15], s36 offen lds
s_add_u32 m0, s35, 126976
s_add_u32 s36, s34, 1179648
buffer_load_dwordx4 v0, s[12:15], s36 offen lds
s_add_u32 m0, s35, 131072
s_add_u32 s36, s34, 1310720
buffer_load_dwordx4 v0, s[12:15], s36 offen lds
s_add_u32 m0, s35, 135168
s_add_u32 s36, s34, 1441792
buffer_load_dwordx4 v0, s[12:15], s36 offen lds
s_waitcnt vmcnt(12)
v_add_u32 v4, 73728, v2
ds_read_b64_tr_b16 a[136:137], v4 offset:0
ds_read_b64_tr_b16 a[138:139], v4 offset:256
ds_read_b64_tr_b16 a[140:141], v4 offset:8192
ds_read_b64_tr_b16 a[142:143], v4 offset:8448
ds_read_b64_tr_b16 a[144:145], v4 offset:32
ds_read_b64_tr_b16 a[146:147], v4 offset:288
ds_read_b64_tr_b16 a[148:149], v4 offset:8224
ds_read_b64_tr_b16 a[150:151], v4 offset:8480
s_waitcnt lgkmcnt(0)
s_barrier
s_add_u32 m0, s35, 139264
s_add_u32 s36, s34, 1048576
buffer_load_dwordx4 v0, s[16:19], s36 offen lds
s_add_u32 m0, s35, 143360
s_add_u32 s36, s34, 1179648
buffer_load_dwordx4 v0, s[16:19], s36 offen lds
s_add_u32 m0, s35, 147456
s_add_u32 s36, s34, 1310720
buffer_load_dwordx4 v0, s[16:19], s36 offen lds
s_add_u32 m0, s35, 151552
s_add_u32 s36, s34, 1441792
buffer_load_dwordx4 v0, s[16:19], s36 offen lds
s_barrier
s_cmp_lg_u32 s26, 0
s_cbranch_scc1 L_rrr_s
s_lshl_b32 s3, s77, 6
s_add_u32 s3, s3, 60
v_mov_b32 v200, s3
v_mov_b32 v201, 1
s_mov_b64 exec, 1
global_atomic_add v200, v201, s[28:29] sc1
s_mov_b64 exec, -1
L_rrr_s:
s_waitcnt vmcnt(12)
v_add_u32 v4, 90112, v2
ds_read_b64_tr_b16 v[48:49], v4 offset:0
ds_read_b64_tr_b16 v[50:51], v4 offset:256
ds_read_b64_tr_b16 v[52:53], v4 offset:8192
ds_read_b64_tr_b16 v[54:55], v4 offset:8448
ds_read_b64_tr_b16 a[16:17], v4 offset:32
ds_read_b64_tr_b16 a[18:19], v4 offset:288
ds_read_b64_tr_b16 a[20:21], v4 offset:8224
ds_read_b64_tr_b16 a[22:23], v4 offset:8480
s_waitcnt lgkmcnt(0)
s_barrier
s_add_u32 m0, s35, 40960
s_add_u32 s36, s34, 1572864
buffer_load_dwordx4 v0, s[12:15], s36 offen lds
s_add_u32 m0, s35, 45056
s_add_u32 s36, s34, 1703936
buffer_load_dwordx4 v0, s[12:15], s36 offen lds
s_add_u32 m0, s35, 49152
s_add_u32 s36, s34, 1835008
buffer_load_dwordx4 v0, s[12:15], s36 offen lds
s_add_u32 m0, s35, 53248
s_add_u32 s36, s34, 1966080
buffer_load_dwordx4 v0, s[12:15], s36 offen lds
s_waitcnt vmcnt(12)
v_add_u32 v4, 106496, v2
ds_read_b64_tr_b16 a[152:153], v4 offset:0
ds_read_b64_tr_b16 a[154:155], v4 offset:256
ds_read_b64_tr_b16 a[156:157], v4 offset:8192
ds_read_b64_tr_b16 a[158:159], v4 offset:8448
ds_read_b64_tr_b16 a[160:161], v4 offset:32
ds_read_b64_tr_b16 a[162:163], v4 offset:288
ds_read_b64_tr_b16 a[164:165], v4 offset:8224
ds_read_b64_tr_b16 a[166:167], v4 offset:8480
s_waitcnt lgkmcnt(0)
s_barrier
s_add_u32 m0, s35, 57344
s_add_u32 s36, s34, 1572864
buffer_load_dwordx4 v0, s[16:19], s36 offen lds
s_add_u32 m0, s35, 61440
s_add_u32 s36, s34, 1703936
buffer_load_dwordx4 v0, s[16:19], s36 offen lds
s_add_u32 m0, s35, 65536
s_add_u32 s36, s34, 1835008
buffer_load_dwordx4 v0, s[16:19], s36 offen lds
s_add_u32 m0, s35, 69632
s_add_u32 s36, s34, 1966080
buffer_load_dwordx4 v0, s[16:19], s36 offen lds
s_waitcnt vmcnt(12)
v_add_u32 v4, 122880, v2
ds_read_b64_tr_b16 a[24:25], v4 offset:0
ds_read_b64_tr_b16 a[26:27], v4 offset:256
ds_read_b64_tr_b16 a[28:29], v4 offset:8192
ds_read_b64_tr_b16 a[30:31], v4 offset:8448
ds_read_b64_tr_b16 v[56:57], v4 offset:32
ds_read_b64_tr_b16 v[58:59], v4 offset:288
ds_read_b64_tr_b16 v[60:61], v4 offset:8224
ds_read_b64_tr_b16 v[62:63], v4 offset:8480
s_waitcnt lgkmcnt(0)
s_barrier
s_add_u32 m0, s35, 73728
s_add_u32 s36, s34, 2097152
buffer_load_dwordx4 v0, s[12:15], s36 offen lds
s_add_u32 m0, s35, 77824
s_add_u32 s36, s34, 2228224
buffer_load_dwordx4 v0, s[12:15], s36 offen lds
s_add_u32 m0, s35, 81920
s_add_u32 s36, s34, 2359296
buffer_load_dwordx4 v0, s[12:15], s36 offen lds
s_add_u32 m0, s35, 86016
s_add_u32 s36, s34, 2490368
buffer_load_dwordx4 v0, s[12:15], s36 offen lds
s_waitcnt vmcnt(12)
v_add_u32 v4, 139264, v2
ds_read_b64_tr_b16 a[168:169], v4 offset:0
ds_read_b64_tr_b16 a[170:171], v4 offset:256
ds_read_b64_tr_b16 a[172:173], v4 offset:8192
ds_read_b64_tr_b16 a[174:175], v4 offset:8448
ds_read_b64_tr_b16 a[176:177], v4 offset:32
ds_read_b64_tr_b16 a[178:179], v4 offset:288
ds_read_b64_tr_b16 a[180:181], v4 offset:8224
ds_read_b64_tr_b16 a[182:183], v4 offset:8480
s_waitcnt lgkmcnt(0)
s_barrier
s_add_u32 m0, s35, 90112
s_add_u32 s36, s34, 2097152
buffer_load_dwordx4 v0, s[16:19], s36 offen lds
s_add_u32 m0, s35, 94208
s_add_u32 s36, s34, 2228224
buffer_load_dwordx4 v0, s[16:19], s36 offen lds
s_add_u32 m0, s35, 98304
s_add_u32 s36, s34, 2359296
buffer_load_dwordx4 v0, s[16:19], s36 offen lds
s_add_u32 m0, s35, 102400
s_add_u32 s36, s34, 2490368
buffer_load_dwordx4 v0, s[16:19], s36 offen lds
s_waitcnt vmcnt(12)
v_add_u32 v4, 40960, v2
ds_read_b64_tr_b16 a[32:33], v4 offset:0
ds_read_b64_tr_b16 a[34:35], v4 offset:256
ds_read_b64_tr_b16 a[36:37], v4 offset:8192
ds_read_b64_tr_b16 a[38:39], v4 offset:8448
ds_read_b64_tr_b16 a[40:41], v4 offset:32
ds_read_b64_tr_b16 a[42:43], v4 offset:288
ds_read_b64_tr_b16 a[44:45], v4 offset:8224
ds_read_b64_tr_b16 a[46:47], v4 offset:8480
s_waitcnt lgkmcnt(0)
s_barrier
s_add_u32 m0, s35, 106496
s_add_u32 s36, s33, 0
buffer_load_dwordx4 v0, s[8:11], s36 offen lds
s_add_u32 m0, s35, 110592
s_add_u32 s36, s33, 131072
buffer_load_dwordx4 v0, s[8:11], s36 offen lds
s_add_u32 m0, s35, 114688
s_add_u32 s36, s33, 262144
buffer_load_dwordx4 v0, s[8:11], s36 offen lds
s_add_u32 m0, s35, 118784
s_add_u32 s36, s33, 393216
buffer_load_dwordx4 v0, s[8:11], s36 offen lds
s_waitcnt vmcnt(12)
v_add_u32 v4, 57344, v2
ds_read_b64_tr_b16 a[184:185], v4 offset:0
ds_read_b64_tr_b16 a[186:187], v4 offset:256
ds_read_b64_tr_b16 a[188:189], v4 offset:8192
ds_read_b64_tr_b16 a[190:191], v4 offset:8448
ds_read_b64_tr_b16 a[192:193], v4 offset:32
ds_read_b64_tr_b16 a[194:195], v4 offset:288
ds_read_b64_tr_b16 a[196:197], v4 offset:8224
ds_read_b64_tr_b16 a[198:199], v4 offset:8480
s_waitcnt lgkmcnt(0)
s_barrier
s_add_u32 m0, s35, 122880
s_add_u32 s36, s33, 524288
buffer_load_dwordx4 v0, s[8:11], s36 offen lds
s_add_u32 m0, s35, 126976
s_add_u32 s36, s33, 655360
buffer_load_dwordx4 v0, s[8:11], s36 offen lds
s_add_u32 m0, s35, 131072
s_add_u32 s36, s33, 786432
buffer_load_dwordx4 v0, s[8:11], s36 offen lds
s_add_u32 m0, s35, 135168
s_add_u32 s36, s33, 917504
buffer_load_dwordx4 v0, s[8:11], s36 offen lds
s_waitcnt vmcnt(12)
v_add_u32 v4, 73728, v2
ds_read_b64_tr_b16 a[48:49], v4 offset:0
ds_read_b64_tr_b16 a[50:51], v4 offset:256
ds_read_b64_tr_b16 a[52:53], v4 offset:8192
ds_read_b64_tr_b16 a[54:55], v4 offset:8448
ds_read_b64_tr_b16 a[56:57], v4 offset:32
ds_read_b64_tr_b16 a[58:59], v4 offset:288
ds_read_b64_tr_b16 a[60:61], v4 offset:8224
ds_read_b64_tr_b16 a[62:63], v4 offset:8480
s_waitcnt lgkmcnt(0)
s_barrier
s_add_u32 m0, s35, 139264
s_add_u32 s36, s33, 1048576
buffer_load_dwordx4 v0, s[8:11], s36 offen lds
s_add_u32 m0, s35, 143360
s_add_u32 s36, s33, 1179648
buffer_load_dwordx4 v0, s[8:11], s36 offen lds
s_add_u32 m0, s35, 147456
s_add_u32 s36, s33, 1310720
buffer_load_dwordx4 v0, s[8:11], s36 offen lds
s_add_u32 m0, s35, 151552
s_add_u32 s36, s33, 1441792
buffer_load_dwordx4 v0, s[8:11], s36 offen lds
s_waitcnt vmcnt(12)
v_add_u32 v4, 90112, v2
ds_read_b64_tr_b16 a[200:201], v4 offset:0
ds_read_b64_tr_b16 a[202:203], v4 offset:256
ds_read_b64_tr_b16 a[204:205], v4 offset:8192
ds_read_b64_tr_b16 a[206:207], v4 offset:8448
ds_read_b64_tr_b16 a[208:209], v4 offset:32
ds_read_b64_tr_b16 a[210:211], v4 offset:288
ds_read_b64_tr_b16 a[212:213], v4 offset:8224
ds_read_b64_tr_b16 a[214:215], v4 offset:8480
s_waitcnt lgkmcnt(0)
s_barrier
s_add_u32 m0, s35, 40960
s_add_u32 s36, s33, 1572864
buffer_load_dwordx4 v0, s[8:11], s36 offen lds
s_add_u32 m0, s35, 45056
s_add_u32 s36, s33, 1703936
buffer_load_dwordx4 v0, s[8:11], s36 offen lds
s_add_u32 m0, s35, 49152
s_add_u32 s36, s33, 1835008
buffer_load_dwordx4 v0, s[8:11], s36 offen lds
s_add_u32 m0, s35, 53248
s_add_u32 s36, s33, 1966080
buffer_load_dwordx4 v0, s[8:11], s36 offen lds
s_waitcnt vmcnt(12)
v_add_u32 v4, 106496, v2
ds_read_b64_tr_b16 v[72:73], v4 offset:0
ds_read_b64_tr_b16 v[74:75], v4 offset:256
ds_read_b64_tr_b16 v[76:77], v4 offset:8192
ds_read_b64_tr_b16 v[78:79], v4 offset:8448
ds_read_b64_tr_b16 v[80:81], v4 offset:32
ds_read_b64_tr_b16 v[82:83], v4 offset:288
ds_read_b64_tr_b16 v[84:85], v4 offset:8224
ds_read_b64_tr_b16 v[86:87], v4 offset:8480
s_waitcnt lgkmcnt(0)
s_barrier
s_add_u32 m0, s35, 57344
s_add_u32 s36, s33, 2097152
buffer_load_dwordx4 v0, s[8:11], s36 offen lds
s_add_u32 m0, s35, 61440
s_add_u32 s36, s33, 2228224
buffer_load_dwordx4 v0, s[8:11], s36 offen lds
s_add_u32 m0, s35, 65536
s_add_u32 s36, s33, 2359296
buffer_load_dwordx4 v0, s[8:11], s36 offen lds
s_add_u32 m0, s35, 69632
s_add_u32 s36, s33, 2490368
buffer_load_dwordx4 v0, s[8:11], s36 offen lds
s_waitcnt vmcnt(12)
v_add_u32 v4, 122880, v2
ds_read_b64_tr_b16 v[88:89], v4 offset:0
ds_read_b64_tr_b16 v[90:91], v4 offset:256
ds_read_b64_tr_b16 v[92:93], v4 offset:8192
ds_read_b64_tr_b16 v[94:95], v4 offset:8448
ds_read_b64_tr_b16 v[96:97], v4 offset:32
ds_read_b64_tr_b16 v[98:99], v4 offset:288
ds_read_b64_tr_b16 v[100:101], v4 offset:8224
ds_read_b64_tr_b16 v[102:103], v4 offset:8480
s_waitcnt lgkmcnt(0)
s_barrier
s_add_u32 m0, s35, 73728
s_add_u32 s36, s34, 0
buffer_load_dwordx4 v0, s[8:11], s36 offen lds
s_add_u32 m0, s35, 77824
s_add_u32 s36, s34, 131072
buffer_load_dwordx4 v0, s[8:11], s36 offen lds
s_add_u32 m0, s35, 81920
s_add_u32 s36, s34, 262144
buffer_load_dwordx4 v0, s[8:11], s36 offen lds
s_add_u32 m0, s35, 86016
s_add_u32 s36, s34, 393216
buffer_load_dwordx4 v0, s[8:11], s36 offen lds
s_waitcnt vmcnt(12)
v_add_u32 v4, 139264, v2
ds_read_b64_tr_b16 v[104:105], v4 offset:0
ds_read_b64_tr_b16 v[106:107], v4 offset:256
ds_read_b64_tr_b16 v[108:109], v4 offset:8192
ds_read_b64_tr_b16 v[110:111], v4 offset:8448
ds_read_b64_tr_b16 v[112:113], v4 offset:32
ds_read_b64_tr_b16 v[114:115], v4 offset:288
ds_read_b64_tr_b16 v[116:117], v4 offset:8224
ds_read_b64_tr_b16 v[118:119], v4 offset:8480
s_waitcnt lgkmcnt(0)
s_barrier
s_add_u32 m0, s35, 90112
s_add_u32 s36, s34, 524288
buffer_load_dwordx4 v0, s[8:11], s36 offen lds
s_add_u32 m0, s35, 94208
s_add_u32 s36, s34, 655360
buffer_load_dwordx4 v0, s[8:11], s36 offen lds
s_add_u32 m0, s35, 98304
s_add_u32 s36, s34, 786432
buffer_load_dwordx4 v0, s[8:11], s36 offen lds
s_add_u32 m0, s35, 102400
s_add_u32 s36, s34, 917504
buffer_load_dwordx4 v0, s[8:11], s36 offen lds
s_waitcnt vmcnt(12)
v_add_u32 v4, 40960, v2
ds_read_b64_tr_b16 v[120:121], v4 offset:0
ds_read_b64_tr_b16 v[122:123], v4 offset:256
ds_read_b64_tr_b16 v[124:125], v4 offset:8192
ds_read_b64_tr_b16 v[126:127], v4 offset:8448
ds_read_b64_tr_b16 v[128:129], v4 offset:32
ds_read_b64_tr_b16 v[130:131], v4 offset:288
ds_read_b64_tr_b16 v[132:133], v4 offset:8224
ds_read_b64_tr_b16 v[134:135], v4 offset:8480
s_waitcnt lgkmcnt(0)
s_barrier
s_add_u32 m0, s35, 106496
s_add_u32 s36, s34, 1048576
buffer_load_dwordx4 v0, s[8:11], s36 offen lds
s_add_u32 m0, s35, 110592
s_add_u32 s36, s34, 1179648
buffer_load_dwordx4 v0, s[8:11], s36 offen lds
s_add_u32 m0, s35, 114688
s_add_u32 s36, s34, 1310720
buffer_load_dwordx4 v0, s[8:11], s36 offen lds
s_add_u32 m0, s35, 118784
s_add_u32 s36, s34, 1441792
buffer_load_dwordx4 v0, s[8:11], s36 offen lds
s_waitcnt vmcnt(12)
v_add_u32 v4, 57344, v2
ds_read_b64_tr_b16 v[136:137], v4 offset:0
ds_read_b64_tr_b16 v[138:139], v4 offset:256
ds_read_b64_tr_b16 v[140:141], v4 offset:8192
ds_read_b64_tr_b16 v[142:143], v4 offset:8448
ds_read_b64_tr_b16 v[40:41], v4 offset:32
ds_read_b64_tr_b16 v[42:43], v4 offset:288
ds_read_b64_tr_b16 v[44:45], v4 offset:8224
ds_read_b64_tr_b16 v[46:47], v4 offset:8480
s_waitcnt lgkmcnt(0)
s_barrier
s_add_u32 m0, s35, 122880
s_add_u32 s36, s34, 1572864
buffer_load_dwordx4 v0, s[8:11], s36 offen lds
s_add_u32 m0, s35, 126976
s_add_u32 s36, s34, 1703936
buffer_load_dwordx4 v0, s[8:11], s36 offen lds
s_add_u32 m0, s35, 131072
s_add_u32 s36, s34, 1835008
buffer_load_dwordx4 v0, s[8:11], s36 offen lds
s_add_u32 m0, s35, 135168
s_add_u32 s36, s34, 1966080
buffer_load_dwordx4 v0, s[8:11], s36 offen lds
s_waitcnt vmcnt(12)
v_add_u32 v4, 73728, v2
ds_read_b64_tr_b16 v[144:145], v4 offset:0
ds_read_b64_tr_b16 v[146:147], v4 offset:256
ds_read_b64_tr_b16 v[148:149], v4 offset:8192
ds_read_b64_tr_b16 v[150:151], v4 offset:8448
ds_read_b64_tr_b16 v[152:153], v4 offset:32
ds_read_b64_tr_b16 v[154:155], v4 offset:288
ds_read_b64_tr_b16 v[156:157], v4 offset:8224
ds_read_b64_tr_b16 v[158:159], v4 offset:8480
s_waitcnt lgkmcnt(0)
s_barrier
s_add_u32 m0, s35, 139264
s_add_u32 s36, s34, 2097152
buffer_load_dwordx4 v0, s[8:11], s36 offen lds
s_add_u32 m0, s35, 143360
s_add_u32 s36, s34, 2228224
buffer_load_dwordx4 v0, s[8:11], s36 offen lds
s_add_u32 m0, s35, 147456
s_add_u32 s36, s34, 2359296
buffer_load_dwordx4 v0, s[8:11], s36 offen lds
s_add_u32 m0, s35, 151552
s_add_u32 s36, s34, 2490368
buffer_load_dwordx4 v0, s[8:11], s36 offen lds
s_mov_b32 m0, s35
v_lshlrev_b32 v7, 2, v6
global_load_lds_dword v7, s[28:29] sc1
s_waitcnt vmcnt(13)
v_add_u32 v4, 90112, v2
ds_read_b64_tr_b16 v[160:161], v4 offset:0
ds_read_b64_tr_b16 v[162:163], v4 offset:256
ds_read_b64_tr_b16 v[164:165], v4 offset:8192
ds_read_b64_tr_b16 v[166:167], v4 offset:8448
ds_read_b64_tr_b16 v[168:169], v4 offset:32
ds_read_b64_tr_b16 v[170:171], v4 offset:288
ds_read_b64_tr_b16 v[172:173], v4 offset:8224
ds_read_b64_tr_b16 v[174:175], v4 offset:8480
s_waitcnt lgkmcnt(0)
s_barrier
s_add_u32 m0, s35, 40960
s_add_u32 s36, s32, 0
buffer_load_dwordx4 v1, s[20:23], s36 offen lds
s_add_u32 m0, s35, 45056
s_add_u32 s36, s32, 20480
buffer_load_dwordx4 v1, s[20:23], s36 offen lds
s_add_u32 m0, s35, 49152
s_add_u32 s36, s32, 40960
buffer_load_dwordx4 v1, s[20:23], s36 offen lds
s_add_u32 m0, s35, 53248
s_add_u32 s36, s32, 61440
buffer_load_dwordx4 v1, s[20:23], s36 offen lds
s_waitcnt vmcnt(13)
v_add_u32 v4, 106496, v2
ds_read_b64_tr_b16 v[64:65], v4 offset:0
ds_read_b64_tr_b16 v[66:67], v4 offset:256
ds_read_b64_tr_b16 v[68:69], v4 offset:8192
ds_read_b64_tr_b16 v[70:71], v4 offset:8448
ds_read_b64_tr_b16 v[16:17], v4 offset:32
ds_read_b64_tr_b16 v[18:19], v4 offset:288
ds_read_b64_tr_b16 v[20:21], v4 offset:8224
ds_read_b64_tr_b16 v[22:23], v4 offset:8480
s_waitcnt lgkmcnt(0)
s_barrier
s_add_u32 m0, s35, 57344
s_add_u32 s36, s32, 82176
buffer_load_dwordx4 v1, s[20:23], s36 offen lds
s_add_u32 m0, s35, 61440
s_add_u32 s36, s32, 102656
buffer_load_dwordx4 v1, s[20:23], s36 offen lds
s_add_u32 m0, s35, 65536
s_add_u32 s36, s32, 123136
buffer_load_dwordx4 v1, s[20:23], s36 offen lds
s_add_u32 m0, s35, 69632
s_add_u32 s36, s32, 143616
buffer_load_dwordx4 v1, s[20:23], s36 offen lds
v_add_u32 v7, 155648, v5
ds_write_b128 v7, v[16:19] offset:0
ds_write_b128 v7, v[20:23] offset:4096
s_waitcnt vmcnt(13)
v_add_u32 v4, 122880, v2
ds_read_b64_tr_b16 v[176:177], v4 offset:0
ds_read_b64_tr_b16 v[178:179], v4 offset:256
ds_read_b64_tr_b16 v[180:181], v4 offset:8192
ds_read_b64_tr_b16 v[182:183], v4 offset:8448
ds_read_b64_tr_b16 v[184:185], v4 offset:32
ds_read_b64_tr_b16 v[186:187], v4 offset:288
ds_read_b64_tr_b16 v[188:189], v4 offset:8224
ds_read_b64_tr_b16 v[190:191], v4 offset:8480
s_waitcnt lgkmcnt(0)
s_barrier
s_add_u32 m0, s35, 73728
s_add_u32 s36, s33, 0
buffer_load_dwordx4 v0, s[12:15], s36 offen lds
s_add_u32 m0, s35, 77824
s_add_u32 s36, s33, 131072
buffer_load_dwordx4 v0, s[12:15], s36 offen lds
s_add_u32 m0, s35, 81920
s_add_u32 s36, s33, 262144
buffer_load_dwordx4 v0, s[12:15], s36 offen lds
s_add_u32 m0, s35, 86016
s_add_u32 s36, s33, 393216
buffer_load_dwordx4 v0, s[12:15], s36 offen lds
s_waitcnt vmcnt(13)
v_add_u32 v4, 139264, v2
ds_read_b64_tr_b16 v[192:193], v4 offset:0
ds_read_b64_tr_b16 v[194:195], v4 offset:256
ds_read_b64_tr_b16 v[196:197], v4 offset:8192
ds_read_b64_tr_b16 v[198:199], v4 offset:8448
ds_read_b64_tr_b16 v[200:201], v4 offset:32
ds_read_b64_tr_b16 v[202:203], v4 offset:288
ds_read_b64_tr_b16 v[204:205], v4 offset:8224
ds_read_b64_tr_b16 v[206:207], v4 offset:8480
s_waitcnt lgkmcnt(0)
s_barrier
s_add_u32 m0, s35, 90112
s_add_u32 s36, s33, 1048576
buffer_load_dwordx4 v0, s[12:15], s36 offen lds
s_add_u32 m0, s35, 94208
s_add_u32 s36, s33, 1179648
buffer_load_dwordx4 v0, s[12:15], s36 offen lds
s_add_u32 m0, s35, 98304
s_add_u32 s36, s33, 1310720
buffer_load_dwordx4 v0, s[12:15], s36 offen lds
s_add_u32 m0, s35, 102400
s_add_u32 s36, s33, 1441792
buffer_load_dwordx4 v0, s[12:15], s36 offen lds
s_waitcnt vmcnt(12)
v_add_u32 v4, 40960, v3
ds_read_b64_tr_b16 v[8:9], v4 offset:0
ds_read_b64_tr_b16 v[10:11], v4 offset:128
ds_read_b64_tr_b16 v[12:13], v4 offset:512
ds_read_b64_tr_b16 v[14:15], v4 offset:640
ds_read_b64_tr_b16 v[16:17], v4 offset:8192
ds_read_b64_tr_b16 v[18:19], v4 offset:8320
ds_read_b64_tr_b16 v[20:21], v4 offset:8704
ds_read_b64_tr_b16 v[22:23], v4 offset:8832
s_waitcnt lgkmcnt(0)
s_barrier
s_add_u32 m0, s35, 106496
s_add_u32 s36, s32, 81920
buffer_load_dwordx4 v1, s[20:23], s36 offen lds
s_add_u32 m0, s35, 110592
s_add_u32 s36, s32, 102400
buffer_load_dwordx4 v1, s[20:23], s36 offen lds
s_add_u32 m0, s35, 114688
s_add_u32 s36, s32, 122880
buffer_load_dwordx4 v1, s[20:23], s36 offen lds
s_add_u32 m0, s35, 118784
s_add_u32 s36, s32, 143360
buffer_load_dwordx4 v1, s[20:23], s36 offen lds
v_add_u32 v7, 40960, v5
ds_write_b128 v7, v[8:11] offset:0
ds_write_b128 v7, v[12:15] offset:4096
v_add_u32 v7, 49152, v5
ds_write_b128 v7, v[16:19] offset:0
ds_write_b128 v7, v[20:23] offset:4096
s_branch L_rce_s
L_rca_s:
s_sleep 8
s_add_u32 s27, s27, 1
s_cmp_gt_u32 s27, 262144
s_cbranch_scc1 L_fail_s
s_mov_b32 m0, s35
v_lshlrev_b32 v7, 2, v6
global_load_lds_dword v7, s[28:29] sc1
s_waitcnt vmcnt(0) lgkmcnt(0)
L_rce_s:
v_lshlrev_b32 v7, 2, v6
v_add_u32 v7, s35, v7
ds_read_b32 v7, v7
s_lshr_b32 s3, s76, 2
s_lshl_b32 s80, 0x50005, s3
s_mov_b32 s81, s80
s_waitcnt lgkmcnt(0)
v_cmp_eq_u32 s[82:83], -1, v7
v_cmp_eq_u32 vcc, 0x200000, v7
s_lshr_b64 s[30:31], vcc, 1
s_and_b64 s[30:31], s[30:31], s[82:83]
s_and_b64 s[30:31], s[30:31], s[80:81]
s_cmp_eq_u64 s[30:31], s[80:81]
s_cbranch_scc1 L_ceokL_rca_s
s_mov_b32 s31, 0
s_add_u32 s80, s3, 1
v_readlane_b32 s30, v7, s80
s_lshr_b32 s30, s30, 16
s_add_u32 s31, s31, s30
s_add_u32 s80, s3, 3
v_readlane_b32 s30, v7, s80
s_lshr_b32 s30, s30, 16
s_add_u32 s31, s31, s30
s_add_u32 s80, s3, 17
v_readlane_b32 s30, v7, s80
s_lshr_b32 s30, s30, 16
s_add_u32 s31, s31, s30
s_add_u32 s80, s3, 19
v_readlane_b32 s30, v7, s80
s_lshr_b32 s30, s30, 16
s_add_u32 s31, s31, s30
s_add_u32 s80, s3, 33
v_readlane_b32 s30, v7, s80
s_lshr_b32 s30, s30, 16
s_add_u32 s31, s31, s30
s_add_u32 s80, s3, 35
v_readlane_b32 s30, v7, s80
s_lshr_b32 s30, s30, 16
s_add_u32 s31, s31, s30
s_add_u32 s80, s3, 49
v_readlane_b32 s30, v7, s80
s_lshr_b32 s30, s30, 16
s_add_u32 s31, s31, s30
s_add_u32 s80, s3, 51
v_readlane_b32 s30, v7, s80
s_lshr_b32 s30, s30, 16
s_add_u32 s31, s31, s30
s_cmp_lt_u32 s31, 256
s_cbranch_scc1 L_rca_s
s_branch L_fail_s
L_ceokL_rca_s:
s_lshl_b32 s3, s77, 4
s_add_u32 s3, s3, 15
v_readlane_b32 s3, v7, s3
s_cmp_lt_u32 s3, 64
s_cbranch_scc1 L_rca_s
s_lshl_b32 s3, s77, 4
s_add_u32 s3, s3, 14
v_readlane_b32 s3, v7, s3
s_cmp_lt_u32 s3, 0x400000
s_cbranch_scc1 L_rca_s
s_and_b32 s31, s3, 0xff
s_cmp_ge_u32 s31, 32
s_cselect_b32 s30, 8192, 0
s_bfe_u32 s31, s3, 0x80008
s_cmp_ge_u32 s31, 32
s_cselect_b32 s31, 0, 16384
s_add_u32 s30, s30, s31
s_add_u32 s61, s61, s30
s_add_u32 s62, s62, s30
s_add_u32 s55, s55, s30
s_mul_i32 s48, s25, 2097152
s_add_u32 s48, s48, 50331648
s_mul_i32 s50, s25, 1048576
s_add_u32 s50, s50, 16777216
s_lshr_b32 s3, s48, 8
s_xor_b32 s3, s3, s30
s_and_b32 s3, s3, 8192
s_add_u32 s48, s48, s3
s_lshr_b32 s3, s50, 8
s_xor_b32 s3, s3, s30
s_and_b32 s3, s3, 8192
s_add_u32 s50, s50, s3
s_lshl_b32 s30, s26, 11
s_add_u32 s48, s48, s30
s_add_u32 s49, s48, 16384
s_add_u32 s59, s30, 24576
s_add_u32 m0, s35, 256
v_and_b32 v7, 7, v6
v_lshlrev_b32 v7, 2, v7
buffer_load_dword v7, s[4:7], s54 offen sc1 lds
s_waitcnt vmcnt(13)
v_add_u32 v4, 57344, v3
ds_read_b64_tr_b16 v[8:9], v4 offset:0
ds_read_b64_tr_b16 v[10:11], v4 offset:128
ds_read_b64_tr_b16 v[12:13], v4 offset:512
ds_read_b64_tr_b16 v[14:15], v4 offset:640
ds_read_b64_tr_b16 v[16:17], v4 offset:8192
ds_read_b64_tr_b16 v[18:19], v4 offset:8320
ds_read_b64_tr_b16 v[20:21], v4 offset:8704
ds_read_b64_tr_b16 v[22:23], v4 offset:8832
s_waitcnt lgkmcnt(0)
s_barrier
s_add_u32 m0, s35, 122880
s_add_u32 s36, s32, 256
buffer_load_dwordx4 v1, s[20:23], s36 offen lds
s_add_u32 m0, s35, 126976
s_add_u32 s36, s32, 20736
buffer_load_dwordx4 v1, s[20:23], s36 offen lds
s_add_u32 m0, s35, 131072
s_add_u32 s36, s32, 41216
buffer_load_dwordx4 v1, s[20:23], s36 offen lds
s_add_u32 m0, s35, 135168
s_add_u32 s36, s32, 61696
buffer_load_dwordx4 v1, s[20:23], s36 offen lds
v_add_u32 v7, 57344, v5
ds_write_b128 v7, v[8:11] offset:0
ds_write_b128 v7, v[12:15] offset:4096
v_add_u32 v7, 65536, v5
ds_write_b128 v7, v[16:19] offset:0
ds_write_b128 v7, v[20:23] offset:4096
s_waitcnt vmcnt(13)
v_add_u32 v4, 73728, v2
ds_read_b64_tr_b16 v[8:9], v4 offset:0
ds_read_b64_tr_b16 v[10:11], v4 offset:256
ds_read_b64_tr_b16 v[12:13], v4 offset:8192
ds_read_b64_tr_b16 v[14:15], v4 offset:8448
ds_read_b64_tr_b16 v[16:17], v4 offset:32
ds_read_b64_tr_b16 v[18:19], v4 offset:288
ds_read_b64_tr_b16 v[20:21], v4 offset:8224
ds_read_b64_tr_b16 v[22:23], v4 offset:8480
s_waitcnt lgkmcnt(0)
s_barrier
s_add_u32 m0, s35, 139264
s_add_u32 s36, s37, 0
buffer_load_dwordx4 v1, s[20:23], s36 offen lds
s_add_u32 m0, s35, 143360
s_add_u32 s36, s37, 20480
buffer_load_dwordx4 v1, s[20:23], s36 offen lds
s_add_u32 m0, s35, 147456
s_add_u32 s36, s37, 40960
buffer_load_dwordx4 v1, s[20:23], s36 offen lds
s_add_u32 m0, s35, 151552
s_add_u32 s36, s37, 61440
buffer_load_dwordx4 v1, s[20:23], s36 offen lds
v_add_u32 v7, 73728, v5
ds_write_b128 v7, v[8:11] offset:0
ds_write_b128 v7, v[12:15] offset:4096
v_add_u32 v7, 81920, v5
ds_write_b128 v7, v[16:19] offset:0
ds_write_b128 v7, v[20:23] offset:4096
s_waitcnt vmcnt(13)
v_add_u32 v4, 90112, v2
ds_read_b64_tr_b16 v[8:9], v4 offset:0
ds_read_b64_tr_b16 v[10:11], v4 offset:256
ds_read_b64_tr_b16 v[12:13], v4 offset:8192
ds_read_b64_tr_b16 v[14:15], v4 offset:8448
ds_read_b64_tr_b16 v[16:17], v4 offset:32
ds_read_b64_tr_b16 v[18:19], v4 offset:288
ds_read_b64_tr_b16 v[20:21], v4 offset:8224
ds_read_b64_tr_b16 v[22:23], v4 offset:8480
s_waitcnt lgkmcnt(0)
v_add_u32 v7, 90112, v5
ds_write_b128 v7, v[8:11] offset:0
ds_write_b128 v7, v[12:15] offset:4096
v_add_u32 v7, 98304, v5
ds_write_b128 v7, v[16:19] offset:0
ds_write_b128 v7, v[20:23] offset:4096
s_waitcnt vmcnt(9)
v_add_u32 v4, 106496, v3
ds_read_b64_tr_b16 a[216:217], v4 offset:0
ds_read_b64_tr_b16 a[218:219], v4 offset:128
ds_read_b64_tr_b16 a[220:221], v4 offset:512
ds_read_b64_tr_b16 a[222:223], v4 offset:640
ds_read_b64_tr_b16 a[224:225], v4 offset:8192
ds_read_b64_tr_b16 a[226:227], v4 offset:8320
ds_read_b64_tr_b16 a[228:229], v4 offset:8704
ds_read_b64_tr_b16 a[230:231], v4 offset:8832
s_waitcnt lgkmcnt(0)
s_waitcnt vmcnt(4)
v_add_u32 v4, 122880, v3
ds_read_b64_tr_b16 a[232:233], v4 offset:0
ds_read_b64_tr_b16 a[234:235], v4 offset:128
ds_read_b64_tr_b16 a[236:237], v4 offset:512
ds_read_b64_tr_b16 a[238:239], v4 offset:640
ds_read_b64_tr_b16 a[240:241], v4 offset:8192
ds_read_b64_tr_b16 a[242:243], v4 offset:8320
ds_read_b64_tr_b16 a[244:245], v4 offset:8704
ds_read_b64_tr_b16 a[246:247], v4 offset:8832
s_waitcnt lgkmcnt(0)
v_lshlrev_b32 v7, 2, v6
v_add_u32 v7, s35, v7
ds_read_b32 v7, v7 offset:256
s_waitcnt lgkmcnt(0)
v_cmp_gt_u32 s[84:85], 2, v7
v_cmp_gt_u32 vcc, 1, v7
s_cbranch_vccz L_rk1_s
v_and_b32 v8, 7, v6
v_lshlrev_b32 v8, 2, v8
L_rkv1_s:
buffer_load_dword v9, v8, s[4:7], s54 offen sc1
s_add_u32 s27, s27, 1
s_cmp_gt_u32 s27, 262144
s_cbranch_scc1 L_fail_s
s_waitcnt vmcnt(0)
v_cmp_gt_u32 vcc, 1, v9
s_cbranch_vccz L_rkvok1_s
s_sleep 2
s_branch L_rkv1_s
L_rkvok1_s:
L_rk1_s:
s_lshl_b32 s30, s26, 11
s_add_u32 m0, s30, 16384
v_lshlrev_b32 v7, 4, v6
buffer_load_dwordx4 v7, s[4:7], s48 offen sc1 lds
buffer_load_dwordx4 v7, s[4:7], s48 offen offset:1024 sc1 lds
s_add_u32 m0, s30, 32768
s_add_u32 s48, s48, 32768
buffer_load_dwordx4 v7, s[4:7], s49 offen sc1 lds
buffer_load_dwordx4 v7, s[4:7], s49 offen offset:1024 sc1 lds
s_add_u32 s49, s49, 32768
s_waitcnt vmcnt(4)
v_add_u32 v4, 139264, v3
ds_read_b64_tr_b16 v[24:25], v4 offset:0
ds_read_b64_tr_b16 v[26:27], v4 offset:128
ds_read_b64_tr_b16 v[28:29], v4 offset:512
ds_read_b64_tr_b16 v[30:31], v4 offset:640
ds_read_b64_tr_b16 a[248:249], v4 offset:8192
ds_read_b64_tr_b16 a[250:251], v4 offset:8320
ds_read_b64_tr_b16 a[252:253], v4 offset:8704
ds_read_b64_tr_b16 a[254:255], v4 offset:8832
s_waitcnt lgkmcnt(0)
v_add_u32 v7, 114688, v5
ds_write_b128 v7, v[32:35] offset:0
ds_write_b128 v7, v[36:39] offset:4096
v_add_u32 v7, 131072, v5
ds_write_b128 v7, v[48:51] offset:0
ds_write_b128 v7, v[52:55] offset:4096
v_add_u32 v7, 139264, v5
ds_write_b128 v7, v[56:59] offset:0
ds_write_b128 v7, v[60:63] offset:4096
v_add_u32 v7, 122880, v5
ds_write_b128 v7, v[40:43] offset:0
ds_write_b128 v7, v[44:47] offset:4096
v_add_u32 v7, 147456, v5
ds_write_b128 v7, v[64:67] offset:0
ds_write_b128 v7, v[68:71] offset:4096
v_add_u32 v7, 106496, v5
ds_write_b128 v7, v[24:27] offset:0
ds_write_b128 v7, v[28:31] offset:4096
s_waitcnt lgkmcnt(0)
v_mov_b32 v8, v6
v_lshrrev_b32 v9, 4, v8
v_and_b32 v10, 15, v8
v_lshlrev_b32 v1, 4, v8
v_add_u32 v2, 0x10000, v1
v_lshrrev_b32 v11, 5, v8
v_lshlrev_b32 v11, 6, v11
v_lshlrev_b32 v12, 3, v10
v_xor_b32 v11, v11, v12
v_lshl_add_u32 v3, v9, 7, v11
v_lshrrev_b32 v11, 2, v8
v_lshlrev_b32 v11, 3, v11
v_bfe_u32 v13, v8, 1, 1
v_lshlrev_b32 v14, 6, v13
v_xor_b32 v11, v11, v14
v_and_b32 v14, 3, v8
v_lshl_add_u32 v4, v14, 7, v11
v_lshl_add_u32 v5, v9, 12, v12
v_lshrrev_b32 v6, 2, v8
v_lshlrev_b32 v6, 7, v6
v_lshl_add_u32 v6, v14, 4, v6
v_and_b32 v15, 1, v8
v_mul_u32_u24 v0, 0xaaaa, v13
v_add_u32 v0, 0x4444, v0
v_bfe_u32 v11, v8, 2, 1
v_lshlrev_b32 v7, 8, v13
v_lshl_add_u32 v7, v11, 5, v7
v_lshl_add_u32 v7, v15, 4, v7
s_xor_b32 s3, s41, 1
v_and_b32 v25, s3, v9
v_add_u32 v25, s42, v25
v_lshrrev_b32 v26, 5, v8
v_lshl_add_u32 v25, v25, 1, v26
v_lshl_add_u32 v7, v25, 2, v7
v_add_u32 v7, s53, v7
s_mov_b32 s64, 50529027
s_mov_b32 s65, 50529027
s_mov_b32 s66, 202116108
s_mov_b32 s67, 202116108
s_mov_b32 s68, 808464432
s_mov_b32 s69, 808464432
s_mov_b32 s70, 3233857728
s_mov_b32 s71, 3233857728
s_mov_b32 s56, 1040356334
s_mov_b32 s57, 0x3f80
s_mov_b32 s74, 0x3f803f80
s_mov_b32 s75, 0x3f803f80
s_mov_b32 s63, 1006632960
s_mov_b32 s32, 0
s_mov_b32 s33, 0
s_mov_b32 s34, 0
s_mov_b32 s52, 0
s_mov_b32 s100, 0
s_sub_u32 s50, s50, 16384
s_add_u32 s51, s50, 4096
s_cmp_eq_u32 s24, 0
s_cselect_b32 s30, 0, 0x40000000
s_cselect_b32 s31, 0x40000000, 0
s_add_u32 s50, s50, s30
s_add_u32 s51, s51, s31
s_lshl_b32 s3, s26, 10
s_add_u32 s35, s60, s3
s_add_u32 s37, s62, s3
s_lshr_b32 s3, s3, 2
s_add_u32 s3, s3, 4096
s_add_u32 s36, s60, s3
s_add_u32 s38, s62, s3
s_and_b32 s3, s25, 7
s_lshl_b32 s3, s3, 7
s_lshl_b32 s30, s25, 2
s_cmp_eq_u32 s26, 2
s_cselect_b32 s3, s30, s3
s_lshl_b32 s8, s24, 10
s_add_u32 s8, s8, s3
s_add_u32 s8, s8, 49152
s_mov_b32 s53, s8
s_mov_b32 s9, 0x40000000
s_mov_b32 s12, 32768
s_cmp_eq_u32 s26, 0
s_cselect_b32 s10, s61, s62
s_add_u32 s10, s10, 5376
s_cmp_eq_u32 s25, 31
s_cselect_b32 s10, s10, 0x40000000
s_cmp_eq_u64 s[84:85], 0
s_cbranch_scc1 L_rk2_s
v_and_b32 v16, 7, v8
v_lshlrev_b32 v16, 2, v16
L_rkv2_s:
buffer_load_dword v17, v16, s[4:7], s54 offen sc1
s_add_u32 s27, s27, 1
s_cmp_gt_u32 s27, 262144
s_cbranch_scc1 L_fail_s
s_waitcnt vmcnt(0)
v_cmp_gt_u32 vcc, 2, v17
s_cbranch_vccz L_rkvok2_s
s_sleep 2
s_branch L_rkv2_s
L_rkvok2_s:
L_rk2_s:
s_waitcnt vmcnt(0) lgkmcnt(0)
s_cmp_eq_u32 s26, 2
s_cbranch_scc1 L_rw2_s
s_cmp_eq_u32 s26, 3
s_cbranch_scc1 L_rw3_s
s_cmp_eq_u32 s26, 0
s_cbranch_scc1 L_rw0_s
s_cmp_lt_u32 s25, 16
s_cbranch_scc1 L_rw1_s
v_lshrrev_b32 v6, 2, v1
ds_read_b128 v[56:59], v1 offset:34816
ds_read_b128 v[60:63], v1 offset:35840
ds_read_b128 v[64:67], v2 offset:9216
ds_read_b128 v[68:71], v2 offset:13312
v_mov_b64 v[8:9], 0
v_mov_b64 v[10:11], 0
v_mov_b64 v[12:13], 0
v_mov_b64 v[14:15], 0
v_mov_b64 v[16:17], 0
v_mov_b64 v[18:19], 0
v_mov_b64 v[20:21], 0
v_mov_b64 v[22:23], 0
v_mov_b64 v[24:25], 0
v_mov_b64 v[26:27], 0
v_mov_b64 v[28:29], 0
v_mov_b64 v[30:31], 0
s_mov_b32 s41, 0x40000000
.p2align 6
L_step10_s:
buffer_load_dwordx4 v[48:51], v1, s[4:7], s35 offen sc1
s_nop 15
s_nop 0
buffer_load_dwordx4 v[52:55], v1, s[4:7], s35 offen sc1
s_nop 15
s_nop 0
buffer_load_dwordx4 v[44:47], v1, s[4:7], s35 offen sc1
s_nop 15
s_nop 0
buffer_load_dwordx4 v[40:43], v1, s[4:7], s35 offen sc1
s_waitcnt vmcnt(3)
ds_write_b128 v1, v[48:51] offset:1024
v_max3_u32 v32, v48, v49, v50
v_max_u32 v32, v32, v51
v_cmp_eq_u32 vcc, -1, v32
s_cbranch_vccnz L_aretry10_s
L_aback10_s:
buffer_load_dword v44, v6, s[4:7], s36 offen sc1
s_waitcnt lgkmcnt(0)
s_barrier
ds_read_b128 v[32:35], v1 offset:0
buffer_load_dwordx4 v[48:51], v1, s[4:7], s37 offen sc1
buffer_load_dword v52, v6, s[4:7], s38 offen sc1
ds_read_b128 v[36:39], v1 offset:1024
s_waitcnt lgkmcnt(1)
v_smfmac_f32_16x16x64_bf16 v[8:11], v[32:35], v[64:71], v0
ds_read_b128 v[64:67], v2 offset:17408
ds_read_b128 v[68:71], v2 offset:21504
v_smfmac_f32_16x16x64_bf16 v[16:19], v[32:35], v[72:79], v0
s_mul_i32 s3, s52, 5120
s_add_u32 s40, s60, s3
s_add_u32 s52, s52, 1
v_smfmac_f32_16x16x64_bf16 v[20:23], v[32:35], v[80:87], v0
v_smfmac_f32_16x16x64_bf16 v[24:27], v[32:35], a[64:71], v0
v_smfmac_f32_16x16x64_bf16 v[28:31], v[32:35], a[72:79], v0
s_waitcnt lgkmcnt(0)
v_smfmac_f32_16x16x64_bf16 v[12:15], v[32:35], v[64:71], v0
ds_read_b128 v[64:67], v2 offset:25600
ds_read_b128 v[68:71], v2 offset:29696
v_smfmac_f32_16x16x64_bf16 v[8:11], v[36:39], v[208:215], v0
s_and_b32 s52, s52, 3
s_xor_b32 s30, s52, 2
s_lshl_b32 s30, s30, 15
v_smfmac_f32_16x16x64_bf16 v[12:15], v[36:39], v[216:223], v0
s_waitcnt vmcnt(3)
ds_read_b128 v[40:43], v1 offset:2048
v_smfmac_f32_16x16x64_bf16 v[16:19], v[36:39], v[88:95], v0
s_mul_i32 s3, s52, 5120
s_add_u32 s39, s60, s3
s_lshl_b32 s31, s52, 15
v_smfmac_f32_16x16x64_bf16 v[20:23], v[36:39], v[96:103], v0
ds_read_b128 v[32:35], v1 offset:3072
s_add_u32 s42, s61, s30
v_smfmac_f32_16x16x64_bf16 v[24:27], v[36:39], a[80:87], v0
s_waitcnt vmcnt(2)
ds_write_b32 v6, v44 offset:4352
v_cmp_eq_u32 vcc, -1, v44
v_smfmac_f32_16x16x64_bf16 v[28:31], v[36:39], a[88:95], v0
s_waitcnt lgkmcnt(2)
v_smfmac_f32_16x16x64_bf16 v[8:11], v[40:43], v[64:71], v0
ds_read_b128 v[64:67], v2 offset:33792
ds_read_b128 v[68:71], v2 offset:37888
s_cbranch_vccnz L_fretry10_s
L_fback10_s:
v_smfmac_f32_16x16x64_bf16 v[16:19], v[40:43], v[104:111], v0
v_smfmac_f32_16x16x64_bf16 v[20:23], v[40:43], v[112:119], v0
s_add_u32 s41, s61, s31
s_add_u32 s31, s31, s62
s_add_u32 s35, s39, 1024
v_smfmac_f32_16x16x64_bf16 v[24:27], v[40:43], a[96:103], v0
s_waitcnt lgkmcnt(2)
s_barrier
v_smfmac_f32_16x16x64_bf16 v[28:31], v[40:43], a[104:111], v0
s_waitcnt lgkmcnt(0)
v_smfmac_f32_16x16x64_bf16 v[12:15], v[40:43], v[64:71], v0
ds_read_b128 v[64:67], v2 offset:50176
ds_read_b128 v[68:71], v2 offset:54272
v_smfmac_f32_16x16x64_bf16 v[8:11], v[32:35], v[224:231], v0
ds_read_b128 v[36:39], v1 offset:4096
v_smfmac_f32_16x16x64_bf16 v[12:15], v[32:35], v[232:239], v0
s_add_u32 s36, s39, 4352
v_smfmac_f32_16x16x64_bf16 v[16:19], v[32:35], v[120:127], v0
s_waitcnt vmcnt(1)
ds_write_b128 v1, v[48:51] offset:6144
s_add_u32 s58, s32, 3
s_min_u32 s58, s58, 64
v_max3_u32 v53, v48, v49, v50
v_smfmac_f32_16x16x64_bf16 v[20:23], v[32:35], v[128:135], v0
s_waitcnt vmcnt(0)
ds_write_b32 v6, v52 offset:9472
s_mov_b32 m0, s59
s_xor_b32 s59, s59, 8192
v_max3_u32 v53, v53, v51, v52
s_waitcnt lgkmcnt(3)
v_smfmac_f32_16x16x64_bf16 v[24:27], v[32:35], v[64:71], v0
ds_read_b128 v[64:67], v2 offset:58368
ds_read_b128 v[68:71], v2 offset:62464
v_cmp_eq_u32 vcc, -1, v53
v_smfmac_f32_16x16x64_bf16 v[28:31], v[32:35], a[112:119], v0
s_waitcnt lgkmcnt(4)
v_smfmac_f32_16x16x64_bf16 v[8:11], v[36:39], v[240:247], v0
s_cbranch_vccnz L_bretry10_s
L_bback10_s:
v_add_u32 v2, 0x10000, v2
v_smfmac_f32_16x16x64_bf16 v[12:15], v[36:39], v[248:255], v0
s_waitcnt lgkmcnt(2)
s_barrier
ds_read_b128 v[40:43], v1 offset:5120
v_smfmac_f32_16x16x64_bf16 v[16:19], v[36:39], v[136:143], v0
ds_read_b128 v[44:47], v1 offset:6144
buffer_load_dwordx4 v1, s[4:7], s48 offen sc1 lds
s_waitcnt lgkmcnt(2)
v_smfmac_f32_16x16x64_bf16 v[20:23], v[36:39], v[64:71], v0
ds_read_b128 v[64:67], v2 offset:1024
ds_read_b128 v[68:71], v2 offset:5120
v_smfmac_f32_16x16x64_bf16 v[24:27], v[36:39], a[120:127], v0
ds_read_b128 v[32:35], v1 offset:7168
buffer_load_dwordx4 v1, s[4:7], s48 offen offset:1024 sc1 lds
s_mov_b32 m0, 34816
v_smfmac_f32_16x16x64_bf16 v[28:31], v[36:39], a[128:135], v0
ds_read_b128 v[48:51], v1 offset:8192
s_waitcnt lgkmcnt(5)
v_smfmac_f32_16x16x64_bf16 v[8:11], v[40:43], a[0:7], v0
ds_read_b128 v[36:39], v1 offset:9216
v_smfmac_f32_16x16x64_bf16 v[12:15], v[40:43], a[8:15], v0
buffer_load_dwordx4 v1, s[4:7], s49 offen sc1 lds
s_waitcnt lgkmcnt(3)
v_smfmac_f32_16x16x64_bf16 v[8:11], v[44:47], v[64:71], v0
ds_read_b128 v[64:67], v2 offset:9216
ds_read_b128 v[68:71], v2 offset:13312
v_smfmac_f32_16x16x64_bf16 v[12:15], v[44:47], a[16:23], v0
buffer_load_dwordx4 v1, s[4:7], s49 offen offset:1024 sc1 lds
s_waitcnt lgkmcnt(4)
v_smfmac_f32_16x16x64_bf16 v[8:11], v[32:35], a[24:31], v0
s_cmp_eq_u32 s32, 62
s_cselect_b32 s11, 0x40000000, s12
s_waitcnt lgkmcnt(3)
v_smfmac_f32_16x16x64_bf16 v[8:11], v[48:51], a[32:39], v0
s_waitcnt lgkmcnt(2)
v_smfmac_f32_16x16x64_bf16 v[8:11], v[36:39], a[48:55], v0
s_add_u32 s37, s31, 1024
s_add_u32 s38, s31, 4352
s_waitcnt lgkmcnt(0)
v_smfmac_f32_16x16x64_bf16 v[12:15], v[32:35], v[64:71], v0
ds_read_b128 v[64:67], v2 offset:17408
ds_read_b128 v[68:71], v2 offset:21504
v_smfmac_f32_16x16x64_bf16 v[12:15], v[48:51], a[40:47], v0
s_sub_u32 s3, s59, 2048
v_add_u32 v6, s3, v1
v_smfmac_f32_16x16x64_bf16 v[12:15], v[36:39], a[56:63], v0
s_add_u32 s48, s48, s11
s_add_u32 s49, s49, s11
v_add_f32 v8, v8, v10
v_smfmac_f32_16x16x64_bf16 v[16:19], v[40:43], v[144:151], v0
v_add_f32 v9, v9, v11
v_smfmac_f32_16x16x64_bf16 v[16:19], v[44:47], v[160:167], v0
v_mul_f32 v8, s56, v8
s_waitcnt lgkmcnt(0)
v_smfmac_f32_16x16x64_bf16 v[16:19], v[32:35], v[64:71], v0
ds_read_b128 v[64:67], v2 offset:25600
ds_read_b128 v[68:71], v2 offset:29696
v_mul_f32 v9, s56, v9
v_smfmac_f32_16x16x64_bf16 v[16:19], v[48:51], v[176:183], v0
s_add_u32 s50, s50, 16384
s_add_u32 s51, s51, 16384
v_add_f32 v12, v12, v14
v_smfmac_f32_16x16x64_bf16 v[16:19], v[36:39], v[192:199], v0
s_nop 1
v_add_f32 v13, v13, v15
v_smfmac_f32_16x16x64_bf16 v[20:23], v[40:43], v[152:159], v0
s_nop 1
v_mul_f32 v12, s56, v12
v_smfmac_f32_16x16x64_bf16 v[20:23], v[44:47], v[168:175], v0
v_mul_f32 v13, s56, v13
s_waitcnt lgkmcnt(0)
v_smfmac_f32_16x16x64_bf16 v[20:23], v[32:35], v[64:71], v0
ds_read_b128 v[64:67], v6 offset:0
v_add_f32 v16, v16, v18
v_smfmac_f32_16x16x64_bf16 v[20:23], v[48:51], v[184:191], v0
s_cmp_eq_u32 s32, 63
ds_read_b128 v[68:71], v6 offset:1024
v_add_f32 v17, v17, v19
v_smfmac_f32_16x16x64_bf16 v[20:23], v[36:39], v[200:207], v0
s_nop 1
v_cvt_pk_bf16_f32 v53, v8, v9
v_cvt_pk_bf16_f32 v52, v16, v17
v_smfmac_f32_16x16x64_bf16 v[24:27], v[32:35], a[168:175], v0
s_nop 0
ds_write_b64 v3, v[52:53] offset:10752
v_cvt_pk_bf16_f32 v55, v12, v13
v_add_f32 v20, v20, v22
v_add_f32 v21, v21, v23
v_cvt_pk_bf16_f32 v54, v20, v21
ds_write_b64 v3, v[54:55] offset:12800
v_smfmac_f32_16x16x64_bf16 v[28:31], v[32:35], a[176:183], v0
v_smfmac_f32_16x16x64_bf16 v[24:27], v[36:39], a[200:207], v0
ds_read_b128 v[32:35], v6 offset:2048
v_add_u32 v2, 0x10000, v1
v_smfmac_f32_16x16x64_bf16 v[28:31], v[36:39], a[208:215], v0
v_smfmac_f32_16x16x64_bf16 v[24:27], v[44:47], a[152:159], v0
s_waitcnt lgkmcnt(1)
s_barrier
ds_read_b64_tr_b16 v[8:9], v4 offset:10240
ds_read_b64_tr_b16 v[10:11], v4 offset:12288
v_smfmac_f32_16x16x64_bf16 v[28:31], v[44:47], a[160:167], v0
ds_read_b64_tr_b16 v[12:13], v4 offset:10752
ds_read_b64_tr_b16 v[14:15], v4 offset:12800
v_smfmac_f32_16x16x64_bf16 v[24:27], v[40:43], a[136:143], v0
ds_read_b64_tr_b16 v[16:17], v4 offset:11264
ds_read_b64_tr_b16 v[18:19], v4 offset:13312
v_smfmac_f32_16x16x64_bf16 v[28:31], v[40:43], a[144:151], v0
ds_read_b64_tr_b16 v[20:21], v4 offset:11776
ds_read_b64_tr_b16 v[22:23], v4 offset:13824
v_smfmac_f32_16x16x64_bf16 v[24:27], v[48:51], a[184:191], v0
ds_read_b128 v[36:39], v6 offset:3072
ds_read_b128 v[44:47], v6 offset:4096
v_smfmac_f32_16x16x64_bf16 v[28:31], v[48:51], a[192:199], v0
ds_read_b128 v[40:43], v6 offset:5120
s_waitcnt lgkmcnt(9)
v_mfma_f32_16x16x32_bf16 v[52:55], v[8:11], v[8:11], 0
s_waitcnt lgkmcnt(7)
v_mfma_f32_16x16x32_bf16 v[52:55], v[12:15], v[12:15], v[52:55]
buffer_store_dwordx4 v[12:15], v1, s[4:7], s50 offen offset:1024 sc1
s_waitcnt lgkmcnt(5)
v_add_f32 v24, v24, v26
v_add_f32 v25, v25, v27
v_mfma_f32_16x16x32_bf16 v[52:55], v[16:19], v[16:19], v[52:55]
s_waitcnt lgkmcnt(3)
v_add_f32 v28, v28, v30
v_add_f32 v29, v29, v31
v_mfma_f32_16x16x32_bf16 v[52:55], v[20:23], v[20:23], v[52:55]
v_cvt_pk_bf16_f32 v24, v24, v25
v_cvt_pk_bf16_f32 v25, v28, v29
v_mfma_f32_16x16x32_bf16 v[48:51], v[64:67], v[8:11], 0
ds_read_b128 v[64:67], v6 offset:6144
v_mov_b64 v[26:27], s[74:75]
v_mfma_f32_16x16x32_bf16 v[48:51], v[68:71], v[12:15], v[48:51]
ds_read_b128 v[68:71], v6 offset:7168
buffer_store_dwordx2 v[24:25], v3, s[4:7], s51 offen offset:512 sc1
v_mov_b32 v29, 0
v_mfma_f32_16x16x32_bf16 v[48:51], v[32:35], v[16:19], v[48:51]
s_cbranch_scc1 L_last10_s
s_waitcnt lgkmcnt(4)
v_exp_f32 v54, v54
v_mfma_f32_16x16x32_bf16 v[48:51], v[36:39], v[20:23], v[48:51]
s_waitcnt lgkmcnt(3)
v_exp_f32 v55, v55
v_mfma_f32_16x16x32_bf16 v[32:35], v[44:47], v[8:11], 0
s_waitcnt lgkmcnt(2)
v_cvt_pk_bf16_f32 v28, v54, v55
v_cvt_pk_bf16_f32 v31, v54, v55
v_mfma_f32_16x16x32_bf16 v[32:35], v[40:43], v[12:15], v[32:35]
s_waitcnt lgkmcnt(1)
v_mov_b32 v30, 0
v_mfma_f32_16x16x32_bf16 v[32:35], v[64:67], v[16:19], v[32:35]
s_waitcnt lgkmcnt(0)
v_exp_f32 v48, v48
v_mfma_f32_16x16x32_bf16 v[32:35], v[68:71], v[20:23], v[32:35]
s_add_u32 s32, s32, 1
v_exp_f32 v49, v49
v_mfma_f32_16x16x16_bf16 v[52:55], v[28:29], v[26:27], 0
ds_read_b128 v[8:11], v2 offset:41984
v_exp_f32 v50, v50
v_mfma_f32_16x16x16_bf16 v[44:47], v[28:29], v[24:25], 0
ds_read_b128 v[12:15], v2 offset:46080
v_exp_f32 v51, v51
v_mfma_f32_16x16x16_bf16 v[40:43], v[30:31], v[24:25], 0
v_exp_f32 v32, v32
v_cvt_pk_bf16_f32 v36, v48, v49
v_cvt_pk_bf16_f32 v37, v50, v51
v_exp_f32 v33, v33
v_exp_f32 v34, v34
v_mfma_f32_16x16x16_bf16 v[52:55], v[36:37], v[26:27], v[52:55]
v_exp_f32 v35, v35
v_cvt_pk_bf16_f32 v38, v32, v33
v_cvt_pk_bf16_f32 v39, v34, v35
s_nop 1
v_mfma_f32_16x16x16_bf16 v[52:55], v[38:39], v[26:27], v[52:55]
ds_read_b128 v[16:19], v1 offset:41984
ds_read_b128 v[20:23], v1 offset:46080
v_mfma_f32_16x16x32_bf16 v[44:47], v[36:39], v[56:59], v[44:47]
ds_read_b128 v[64:67], v1 offset:50176
ds_read_b128 v[68:71], v1 offset:54272
v_mfma_f32_16x16x32_bf16 v[40:43], v[36:39], v[60:63], v[40:43]
s_nop 1
v_rcp_f32 v52, v52
v_rcp_f32 v53, v53
v_subrev_u32 v54, 562036736, v52
v_mul_f32 v44, v44, v52
v_mul_f32 v45, v45, v53
v_cvt_pk_bf16_f32 v48, v44, v45
v_cvt_pk_bf16_f32 v49, v44, v45
ds_write_b64 v3, v[48:49] offset:5632
v_pk_mul_f32 v[40:41], v[40:41], v[52:53]
v_cvt_pk_bf16_f32 v50, v40, v41
v_cvt_pk_bf16_f32 v51, v40, v41
ds_write_b64 v3, v[50:51] offset:7680
v_subrev_u32 v53, 562036736, v53
v_max_u32 v52, v54, v53
v_cmp_le_u32 vcc, s63, v52
v_mov_b64 v[52:53], 0
v_mov_b64 v[54:55], 0
v_mov_b64 v[40:41], 0
v_mov_b64 v[42:43], 0
s_cbranch_vccnz L_sretry10_s
L_sback10_s:
s_waitcnt lgkmcnt(0)
s_barrier
ds_read_b64_tr_b16 v[24:25], v4 offset:5120
ds_read_b64_tr_b16 v[26:27], v4 offset:7168
ds_read_b64_tr_b16 v[28:29], v4 offset:5632
ds_read_b64_tr_b16 v[30:31], v4 offset:7680
ds_read_b64_tr_b16 v[32:33], v4 offset:6144
ds_read_b64_tr_b16 v[34:35], v4 offset:8192
s_waitcnt lgkmcnt(4)
v_smfmac_f32_16x16x64_bf16 v[52:55], v[24:27], v[8:15], v0
ds_read_b64_tr_b16 v[36:37], v4 offset:6656
ds_read_b64_tr_b16 v[38:39], v4 offset:8704
s_waitcnt lgkmcnt(4)
v_mov_b64 v[44:45], 0
v_smfmac_f32_16x16x64_bf16 v[52:55], v[28:31], a[248:255], v0
v_mov_b64 v[46:47], 0
v_smfmac_f32_16x16x64_bf16 v[40:43], v[24:27], v[16:23], v0
ds_read_b128 v[56:59], v1 offset:58368
ds_read_b128 v[60:63], v1 offset:62464
v_smfmac_f32_16x16x64_bf16 v[40:43], v[28:31], v[64:71], v0
ds_read_b128 v[8:11], v2 offset:1024
ds_read_b128 v[12:15], v2 offset:5120
s_waitcnt lgkmcnt(6)
v_cvt_pk_bf16_f32 v52, v52, v53
v_smfmac_f32_16x16x64_bf16 v[40:43], v[32:35], a[216:223], v0
s_waitcnt lgkmcnt(4)
v_cvt_pk_bf16_f32 v53, v54, v55
v_and_or_b32 v52, v52, -2, s33
v_smfmac_f32_16x16x64_bf16 v[40:43], v[36:39], a[224:231], v0
buffer_store_dwordx2 v[52:53], v5, s[4:7], s45 offen sc1
s_nop 0
v_smfmac_f32_16x16x64_bf16 v[44:47], v[24:27], a[232:239], v0
s_nop 1
v_smfmac_f32_16x16x64_bf16 v[44:47], v[28:31], a[240:247], v0
s_waitcnt lgkmcnt(2)
s_nop 0
v_cvt_pk_bf16_f32 v40, v40, v41
v_smfmac_f32_16x16x64_bf16 v[44:47], v[32:35], v[56:63], v0
s_waitcnt lgkmcnt(0)
v_cvt_pk_bf16_f32 v41, v42, v43
v_and_or_b32 v40, v40, -2, s33
v_smfmac_f32_16x16x64_bf16 v[44:47], v[36:39], v[8:15], v0
buffer_store_dwordx2 v[40:41], v5, s[4:7], s43 offen sc1
s_nop 6
v_cvt_pk_bf16_f32 v44, v44, v45
v_cvt_pk_bf16_f32 v45, v46, v47
v_and_or_b32 v44, v44, -2, s33
buffer_store_dwordx2 v[44:45], v5, s[4:7], s44 offen sc1
s_xor_b32 s33, s33, 1
s_barrier
s_waitcnt vmcnt(0)
ds_read_b128 v[56:59], v1 offset:34816
ds_read_b128 v[60:63], v1 offset:35840
ds_read_b128 v[64:67], v2 offset:9216
ds_read_b128 v[68:71], v2 offset:13312
v_mov_b64 v[8:9], 0
v_mov_b64 v[10:11], 0
v_mov_b64 v[12:13], 0
v_mov_b64 v[14:15], 0
v_mov_b64 v[16:17], 0
v_mov_b64 v[18:19], 0
v_mov_b64 v[20:21], 0
v_mov_b64 v[22:23], 0
v_mov_b64 v[24:25], 0
v_mov_b64 v[26:27], 0
v_mov_b64 v[28:29], 0
v_mov_b64 v[30:31], 0
s_barrier
v_lshrrev_b32 v6, 2, v1
s_nop 15
s_nop 15
s_nop 9
s_branch L_step10_s
L_aretry10_s:
buffer_load_dwordx4 v[48:51], v1, s[4:7], s35 offen sc1
s_waitcnt vmcnt(3)
v_max3_u32 v32, v52, v53, v54
v_max_u32 v32, v32, v55
v_cmp_eq_u32 vcc, -1, v32
s_cbranch_vccz L_aw010_s
buffer_load_dwordx4 v[52:55], v1, s[4:7], s35 offen sc1
s_waitcnt vmcnt(3)
v_max3_u32 v32, v44, v45, v46
v_max_u32 v32, v32, v47
v_cmp_eq_u32 vcc, -1, v32
s_cbranch_vccz L_aw110_s
buffer_load_dwordx4 v[44:47], v1, s[4:7], s35 offen sc1
s_waitcnt vmcnt(3)
v_max3_u32 v32, v40, v41, v42
v_max_u32 v32, v32, v43
v_cmp_eq_u32 vcc, -1, v32
s_cbranch_vccz L_aw210_s
buffer_load_dwordx4 v[40:43], v1, s[4:7], s35 offen sc1
s_waitcnt vmcnt(3)
v_max3_u32 v32, v48, v49, v50
v_max_u32 v32, v32, v51
v_cmp_eq_u32 vcc, -1, v32
s_cbranch_vccz L_aw310_s
s_add_u32 s27, s27, 1
s_cmp_gt_u32 s27, 262144
s_cbranch_scc0 L_aretry10_s
s_branch L_fail_s
L_aw010_s:
ds_write_b128 v1, v[52:55] offset:1024
s_branch L_aback10_s
L_aw110_s:
ds_write_b128 v1, v[44:47] offset:1024
s_branch L_aback10_s
L_aw210_s:
ds_write_b128 v1, v[40:43] offset:1024
s_branch L_aback10_s
L_aw310_s:
ds_write_b128 v1, v[48:51] offset:1024
s_branch L_aback10_s
L_fretry10_s:
s_waitcnt lgkmcnt(0)
buffer_load_dword v44, v6, s[4:7], s36 offen sc1
s_add_u32 s27, s27, 1
s_cmp_gt_u32 s27, 262144
s_cbranch_scc1 L_fail_s
s_waitcnt vmcnt(0)
ds_write_b32 v6, v44 offset:4352
v_cmp_eq_u32 vcc, -1, v44
s_waitcnt lgkmcnt(0)
s_cbranch_vccnz L_fretry10_s
s_branch L_fback10_s
L_bretry10_s:
s_waitcnt lgkmcnt(0)
buffer_load_dwordx4 v[48:51], v1, s[4:7], s37 offen sc1
buffer_load_dword v52, v6, s[4:7], s38 offen sc1
s_add_u32 s27, s27, 1
s_cmp_gt_u32 s27, 262144
s_cbranch_scc1 L_fail_s
s_waitcnt vmcnt(0)
ds_write_b128 v1, v[48:51] offset:6144
ds_write_b32 v6, v52 offset:9472
v_max3_u32 v53, v48, v49, v50
v_max3_u32 v53, v53, v51, v52
v_cmp_eq_u32 vcc, -1, v53
s_waitcnt lgkmcnt(0)
s_cbranch_vccnz L_bretry10_s
s_branch L_bback10_s
L_last10_s:
s_waitcnt vmcnt(0) lgkmcnt(0)
s_barrier
s_endpgm
L_sretry10_s:
s_waitcnt lgkmcnt(0)
s_sub_u32 s3, s59, 2048
v_add_u32 v6, s3, v1
ds_read_b64_tr_b16 v[8:9], v4 offset:10240
ds_read_b64_tr_b16 v[10:11], v4 offset:12288
ds_read_b64_tr_b16 v[12:13], v4 offset:10752
ds_read_b64_tr_b16 v[14:15], v4 offset:12800
ds_read_b64_tr_b16 v[16:17], v4 offset:11264
ds_read_b64_tr_b16 v[18:19], v4 offset:13312
ds_read_b64_tr_b16 v[20:21], v4 offset:11776
ds_read_b64_tr_b16 v[22:23], v4 offset:13824
s_waitcnt lgkmcnt(6)
v_mfma_f32_16x16x32_bf16 v[52:55], v[8:11], v[8:11], 0
s_waitcnt lgkmcnt(4)
v_mfma_f32_16x16x32_bf16 v[52:55], v[12:15], v[12:15], v[52:55]
s_waitcnt lgkmcnt(2)
v_mfma_f32_16x16x32_bf16 v[52:55], v[16:19], v[16:19], v[52:55]
s_waitcnt lgkmcnt(0)
v_mfma_f32_16x16x32_bf16 v[52:55], v[20:23], v[20:23], v[52:55]
ds_read_b128 v[64:67], v6 offset:0
ds_read_b128 v[68:71], v6 offset:1024
ds_read_b128 v[40:43], v6 offset:2048
ds_read_b128 v[44:47], v6 offset:3072
s_waitcnt lgkmcnt(3)
v_mfma_f32_16x16x32_bf16 v[48:51], v[64:67], v[8:11], 0
s_waitcnt lgkmcnt(2)
v_mfma_f32_16x16x32_bf16 v[48:51], v[68:71], v[12:15], v[48:51]
s_waitcnt lgkmcnt(1)
v_mfma_f32_16x16x32_bf16 v[48:51], v[40:43], v[16:19], v[48:51]
s_waitcnt lgkmcnt(0)
v_mfma_f32_16x16x32_bf16 v[48:51], v[44:47], v[20:23], v[48:51]
ds_read_b128 v[64:67], v6 offset:4096
ds_read_b128 v[68:71], v6 offset:5120
ds_read_b128 v[40:43], v6 offset:6144
ds_read_b128 v[44:47], v6 offset:7168
s_waitcnt lgkmcnt(3)
v_mfma_f32_16x16x32_bf16 v[32:35], v[64:67], v[8:11], 0
s_waitcnt lgkmcnt(2)
v_mfma_f32_16x16x32_bf16 v[32:35], v[68:71], v[12:15], v[32:35]
s_waitcnt lgkmcnt(1)
v_mfma_f32_16x16x32_bf16 v[32:35], v[40:43], v[16:19], v[32:35]
s_waitcnt lgkmcnt(0)
v_mfma_f32_16x16x32_bf16 v[32:35], v[44:47], v[20:23], v[32:35]
v_max3_f32 v52, v54, v55, v48
v_max3_f32 v52, v52, v49, v50
s_nop 5
v_max3_f32 v52, v52, v51, v32
v_max3_f32 v52, v52, v33, v34
v_max_f32 v52, v52, v35
v_mov_b32 v53, v52
s_nop 1
v_permlane32_swap_b32 v52, v53
v_max_f32 v52, v52, v53
v_mov_b32 v53, v52
s_nop 1
v_permlane16_swap_b32 v52, v53
v_max_f32 v52, v52, v53
v_sub_f32 v54, v54, v52
v_sub_f32 v55, v55, v52
v_sub_f32 v48, v48, v52
v_sub_f32 v49, v49, v52
v_sub_f32 v50, v50, v52
v_sub_f32 v51, v51, v52
v_sub_f32 v32, v32, v52
v_sub_f32 v33, v33, v52
v_sub_f32 v34, v34, v52
v_sub_f32 v35, v35, v52
v_exp_f32 v54, v54
v_exp_f32 v55, v55
v_exp_f32 v48, v48
v_exp_f32 v49, v49
v_exp_f32 v50, v50
v_exp_f32 v51, v51
v_exp_f32 v32, v32
v_exp_f32 v33, v33
v_exp_f32 v34, v34
v_exp_f32 v35, v35
v_cvt_pk_bf16_f32 v28, v54, v55
v_cvt_pk_bf16_f32 v31, v54, v55
v_cvt_pk_bf16_f32 v36, v48, v49
v_cvt_pk_bf16_f32 v37, v50, v51
v_cvt_pk_bf16_f32 v38, v32, v33
v_cvt_pk_bf16_f32 v39, v34, v35
v_mfma_f32_16x16x16_bf16 v[52:55], v[28:29], v[26:27], 0
v_mfma_f32_16x16x16_bf16 v[44:47], v[28:29], v[24:25], 0
v_mfma_f32_16x16x16_bf16 v[40:43], v[30:31], v[24:25], 0
v_mfma_f32_16x16x16_bf16 v[52:55], v[36:37], v[26:27], v[52:55]
v_mfma_f32_16x16x16_bf16 v[52:55], v[38:39], v[26:27], v[52:55]
v_mfma_f32_16x16x32_bf16 v[44:47], v[36:39], v[56:59], v[44:47]
v_mfma_f32_16x16x32_bf16 v[40:43], v[36:39], v[60:63], v[40:43]
ds_read_b128 v[8:11], v2 offset:41984
ds_read_b128 v[12:15], v2 offset:46080
ds_read_b128 v[16:19], v1 offset:41984
ds_read_b128 v[20:23], v1 offset:46080
ds_read_b128 v[64:67], v1 offset:50176
ds_read_b128 v[68:71], v1 offset:54272
v_rcp_f32 v52, v52
v_rcp_f32 v53, v53
v_subrev_u32 v54, 562036736, v52
v_mul_f32 v44, v44, v52
v_mul_f32 v45, v45, v53
v_cvt_pk_bf16_f32 v48, v44, v45
v_cvt_pk_bf16_f32 v49, v44, v45
ds_write_b64 v3, v[48:49] offset:5632
v_pk_mul_f32 v[40:41], v[40:41], v[52:53]
v_cvt_pk_bf16_f32 v50, v40, v41
v_cvt_pk_bf16_f32 v51, v40, v41
ds_write_b64 v3, v[50:51] offset:7680
v_mov_b64 v[40:41], 0
v_mov_b64 v[42:43], 0
v_mov_b64 v[44:45], 0
v_mov_b64 v[46:47], 0
v_mov_b64 v[52:53], 0
v_mov_b64 v[54:55], 0
s_waitcnt lgkmcnt(0)
s_branch L_sback10_s
L_rw0_s:
v_lshrrev_b32 v6, 2, v1
s_mov_b32 s41, 0x40000000
.p2align 6
L_step01_s:
buffer_load_dwordx4 v[48:51], v1, s[4:7], s35 offen sc1
s_nop 15
s_nop 0
buffer_load_dwordx4 v[52:55], v1, s[4:7], s35 offen sc1
s_nop 15
s_nop 0
buffer_load_dwordx4 v[44:47], v1, s[4:7], s35 offen sc1
s_waitcnt vmcnt(7)
ds_read_b128 v[56:59], v1 offset:32768
s_waitcnt vmcnt(6)
ds_read_b128 v[60:63], v1 offset:33792
ds_read_b128 v[64:67], v2 offset:8192
ds_read_b128 v[68:71], v2 offset:12288
v_mov_b64 v[8:9], 0
v_mov_b64 v[10:11], 0
v_mov_b64 v[12:13], 0
v_mov_b64 v[14:15], 0
v_mov_b64 v[16:17], 0
v_mov_b64 v[18:19], 0
v_mov_b64 v[20:21], 0
v_mov_b64 v[22:23], 0
v_mov_b64 v[24:25], 0
v_mov_b64 v[26:27], 0
v_mov_b64 v[28:29], 0
v_mov_b64 v[30:31], 0
s_nop 0
buffer_load_dwordx4 v[40:43], v1, s[4:7], s35 offen sc1
s_waitcnt vmcnt(3)
ds_write_b128 v1, v[48:51] offset:0
v_max3_u32 v32, v48, v49, v50
v_max_u32 v32, v32, v51
v_cmp_eq_u32 vcc, -1, v32
s_cbranch_vccnz L_aretry01_s
L_aback01_s:
buffer_load_dword v44, v6, s[4:7], s36 offen sc1
s_waitcnt lgkmcnt(0)
s_barrier
ds_read_b128 v[32:35], v1 offset:0
buffer_load_dwordx4 v[48:51], v1, s[4:7], s37 offen sc1
buffer_load_dword v52, v6, s[4:7], s38 offen sc1
ds_read_b128 v[36:39], v1 offset:1024
s_waitcnt lgkmcnt(1)
v_smfmac_f32_16x16x64_bf16 v[8:11], v[32:35], v[64:71], v0
ds_read_b128 v[64:67], v2 offset:16384
ds_read_b128 v[68:71], v2 offset:20480
v_smfmac_f32_16x16x64_bf16 v[16:19], v[32:35], v[72:79], v0
s_mul_i32 s3, s52, 5120
s_add_u32 s40, s60, s3
s_add_u32 s52, s52, 1
v_smfmac_f32_16x16x64_bf16 v[20:23], v[32:35], v[80:87], v0
v_smfmac_f32_16x16x64_bf16 v[24:27], v[32:35], a[64:71], v0
v_smfmac_f32_16x16x64_bf16 v[28:31], v[32:35], a[72:79], v0
s_waitcnt lgkmcnt(0)
v_smfmac_f32_16x16x64_bf16 v[12:15], v[32:35], v[64:71], v0
ds_read_b128 v[64:67], v2 offset:24576
ds_read_b128 v[68:71], v2 offset:28672
v_smfmac_f32_16x16x64_bf16 v[8:11], v[36:39], v[208:215], v0
s_and_b32 s52, s52, 3
s_xor_b32 s30, s52, 2
s_lshl_b32 s30, s30, 15
v_smfmac_f32_16x16x64_bf16 v[12:15], v[36:39], v[216:223], v0
s_waitcnt vmcnt(3)
ds_read_b128 v[40:43], v1 offset:2048
v_smfmac_f32_16x16x64_bf16 v[16:19], v[36:39], v[88:95], v0
s_mul_i32 s3, s52, 5120
s_add_u32 s39, s60, s3
s_lshl_b32 s31, s52, 15
v_smfmac_f32_16x16x64_bf16 v[20:23], v[36:39], v[96:103], v0
ds_read_b128 v[32:35], v1 offset:3072
s_add_u32 s42, s61, s30
v_smfmac_f32_16x16x64_bf16 v[24:27], v[36:39], a[80:87], v0
s_waitcnt vmcnt(2)
ds_write_b32 v6, v44 offset:4096
v_cmp_eq_u32 vcc, -1, v44
v_smfmac_f32_16x16x64_bf16 v[28:31], v[36:39], a[88:95], v0
s_waitcnt lgkmcnt(2)
v_smfmac_f32_16x16x64_bf16 v[8:11], v[40:43], v[64:71], v0
ds_read_b128 v[64:67], v2 offset:32768
ds_read_b128 v[68:71], v2 offset:36864
s_cbranch_vccnz L_fretry01_s
L_fback01_s:
v_smfmac_f32_16x16x64_bf16 v[16:19], v[40:43], v[104:111], v0
v_smfmac_f32_16x16x64_bf16 v[20:23], v[40:43], v[112:119], v0
s_add_u32 s41, s61, s31
s_add_u32 s31, s31, s62
s_add_u32 s35, s39, 0
v_smfmac_f32_16x16x64_bf16 v[24:27], v[40:43], a[96:103], v0
s_waitcnt lgkmcnt(2)
s_barrier
v_smfmac_f32_16x16x64_bf16 v[28:31], v[40:43], a[104:111], v0
s_waitcnt lgkmcnt(0)
v_smfmac_f32_16x16x64_bf16 v[12:15], v[40:43], v[64:71], v0
ds_read_b128 v[64:67], v2 offset:49152
ds_read_b128 v[68:71], v2 offset:53248
v_smfmac_f32_16x16x64_bf16 v[8:11], v[32:35], v[224:231], v0
ds_read_b128 v[36:39], v1 offset:4096
v_smfmac_f32_16x16x64_bf16 v[12:15], v[32:35], v[232:239], v0
s_add_u32 s36, s39, 4096
v_smfmac_f32_16x16x64_bf16 v[16:19], v[32:35], v[120:127], v0
s_waitcnt vmcnt(1)
ds_write_b128 v1, v[48:51] offset:5120
s_add_u32 s58, s32, 3
s_min_u32 s58, s58, 64
v_max3_u32 v53, v48, v49, v50
v_smfmac_f32_16x16x64_bf16 v[20:23], v[32:35], v[128:135], v0
s_waitcnt vmcnt(0)
ds_write_b32 v6, v52 offset:9216
s_mov_b32 m0, s59
s_xor_b32 s59, s59, 8192
v_max3_u32 v53, v53, v51, v52
s_waitcnt lgkmcnt(3)
v_smfmac_f32_16x16x64_bf16 v[24:27], v[32:35], v[64:71], v0
ds_read_b128 v[64:67], v2 offset:57344
ds_read_b128 v[68:71], v2 offset:61440
v_cmp_eq_u32 vcc, -1, v53
v_smfmac_f32_16x16x64_bf16 v[28:31], v[32:35], a[112:119], v0
s_waitcnt lgkmcnt(4)
v_smfmac_f32_16x16x64_bf16 v[8:11], v[36:39], v[240:247], v0
s_cbranch_vccnz L_bretry01_s
L_bback01_s:
v_add_u32 v2, 0x10000, v2
v_smfmac_f32_16x16x64_bf16 v[12:15], v[36:39], v[248:255], v0
s_waitcnt lgkmcnt(2)
s_barrier
ds_read_b128 v[40:43], v1 offset:5120
v_smfmac_f32_16x16x64_bf16 v[16:19], v[36:39], v[136:143], v0
ds_read_b128 v[44:47], v1 offset:6144
buffer_load_dwordx4 v1, s[4:7], s48 offen sc1 lds
s_waitcnt lgkmcnt(2)
v_smfmac_f32_16x16x64_bf16 v[20:23], v[36:39], v[64:71], v0
ds_read_b128 v[64:67], v2 offset:0
ds_read_b128 v[68:71], v2 offset:4096
v_smfmac_f32_16x16x64_bf16 v[24:27], v[36:39], a[120:127], v0
ds_read_b128 v[32:35], v1 offset:7168
buffer_load_dwordx4 v1, s[4:7], s48 offen offset:1024 sc1 lds
s_mov_b32 m0, 32768
v_smfmac_f32_16x16x64_bf16 v[28:31], v[36:39], a[128:135], v0
ds_read_b128 v[48:51], v1 offset:8192
s_waitcnt lgkmcnt(5)
v_smfmac_f32_16x16x64_bf16 v[8:11], v[40:43], a[0:7], v0
ds_read_b128 v[36:39], v1 offset:9216
v_smfmac_f32_16x16x64_bf16 v[12:15], v[40:43], a[8:15], v0
buffer_load_dwordx4 v1, s[4:7], s49 offen sc1 lds
v_mov_b32 v54, -1
s_waitcnt lgkmcnt(3)
v_smfmac_f32_16x16x64_bf16 v[8:11], v[44:47], v[64:71], v0
ds_read_b128 v[64:67], v2 offset:8192
ds_read_b128 v[68:71], v2 offset:12288
v_smfmac_f32_16x16x64_bf16 v[12:15], v[44:47], a[16:23], v0
buffer_load_dwordx4 v1, s[4:7], s49 offen offset:1024 sc1 lds
s_waitcnt lgkmcnt(4)
v_smfmac_f32_16x16x64_bf16 v[8:11], v[32:35], a[24:31], v0
s_cmp_eq_u32 s32, 62
s_cselect_b32 s11, 0x40000000, s12
s_waitcnt lgkmcnt(3)
v_smfmac_f32_16x16x64_bf16 v[8:11], v[48:51], a[32:39], v0
s_waitcnt lgkmcnt(2)
v_smfmac_f32_16x16x64_bf16 v[8:11], v[36:39], a[48:55], v0
s_add_u32 s37, s31, 0
s_add_u32 s38, s31, 4096
s_waitcnt lgkmcnt(0)
v_smfmac_f32_16x16x64_bf16 v[12:15], v[32:35], v[64:71], v0
ds_read_b128 v[64:67], v2 offset:16384
ds_read_b128 v[68:71], v2 offset:20480
v_smfmac_f32_16x16x64_bf16 v[12:15], v[48:51], a[40:47], v0
buffer_store_dword v54, v7, s[4:7], s42 offen sc1
s_sub_u32 s3, s59, 0
v_add_u32 v6, s3, v1
v_smfmac_f32_16x16x64_bf16 v[12:15], v[36:39], a[56:63], v0
s_add_u32 s48, s48, s11
s_add_u32 s49, s49, s11
v_add_f32 v8, v8, v10
v_smfmac_f32_16x16x64_bf16 v[16:19], v[40:43], v[144:151], v0
v_add_f32 v9, v9, v11
v_smfmac_f32_16x16x64_bf16 v[16:19], v[44:47], v[160:167], v0
v_mul_f32 v8, s56, v8
s_waitcnt lgkmcnt(0)
v_smfmac_f32_16x16x64_bf16 v[16:19], v[32:35], v[64:71], v0
ds_read_b128 v[64:67], v2 offset:24576
ds_read_b128 v[68:71], v2 offset:28672
v_mul_f32 v9, s56, v9
v_smfmac_f32_16x16x64_bf16 v[16:19], v[48:51], v[176:183], v0
s_add_u32 s50, s50, 16384
s_add_u32 s51, s51, 16384
v_add_f32 v12, v12, v14
v_smfmac_f32_16x16x64_bf16 v[16:19], v[36:39], v[192:199], v0
s_nop 1
v_add_f32 v13, v13, v15
v_smfmac_f32_16x16x64_bf16 v[20:23], v[40:43], v[152:159], v0
s_nop 1
v_mul_f32 v12, s56, v12
v_smfmac_f32_16x16x64_bf16 v[20:23], v[44:47], v[168:175], v0
v_mul_f32 v13, s56, v13
s_waitcnt lgkmcnt(0)
v_smfmac_f32_16x16x64_bf16 v[20:23], v[32:35], v[64:71], v0
ds_read_b128 v[64:67], v6 offset:0
v_add_f32 v16, v16, v18
v_smfmac_f32_16x16x64_bf16 v[20:23], v[48:51], v[184:191], v0
s_cmp_eq_u32 s32, 63
ds_read_b128 v[68:71], v6 offset:1024
v_add_f32 v17, v17, v19
v_smfmac_f32_16x16x64_bf16 v[20:23], v[36:39], v[200:207], v0
s_nop 1
v_cvt_pk_bf16_f32 v53, v8, v9
v_cvt_pk_bf16_f32 v52, v16, v17
v_smfmac_f32_16x16x64_bf16 v[24:27], v[32:35], a[168:175], v0
s_nop 0
ds_write_b64 v3, v[52:53] offset:10240
v_cvt_pk_bf16_f32 v55, v12, v13
v_add_f32 v20, v20, v22
v_add_f32 v21, v21, v23
v_cvt_pk_bf16_f32 v54, v20, v21
ds_write_b64 v3, v[54:55] offset:12288
v_smfmac_f32_16x16x64_bf16 v[28:31], v[32:35], a[176:183], v0
v_smfmac_f32_16x16x64_bf16 v[24:27], v[36:39], a[200:207], v0
ds_read_b128 v[32:35], v6 offset:2048
v_add_u32 v2, 0x10000, v1
v_smfmac_f32_16x16x64_bf16 v[28:31], v[36:39], a[208:215], v0
v_smfmac_f32_16x16x64_bf16 v[24:27], v[44:47], a[152:159], v0
s_waitcnt lgkmcnt(1)
s_barrier
ds_read_b64_tr_b16 v[8:9], v4 offset:10240
ds_read_b64_tr_b16 v[10:11], v4 offset:12288
v_smfmac_f32_16x16x64_bf16 v[28:31], v[44:47], a[160:167], v0
ds_read_b64_tr_b16 v[12:13], v4 offset:10752
ds_read_b64_tr_b16 v[14:15], v4 offset:12800
v_smfmac_f32_16x16x64_bf16 v[24:27], v[40:43], a[136:143], v0
ds_read_b64_tr_b16 v[16:17], v4 offset:11264
ds_read_b64_tr_b16 v[18:19], v4 offset:13312
v_smfmac_f32_16x16x64_bf16 v[28:31], v[40:43], a[144:151], v0
ds_read_b64_tr_b16 v[20:21], v4 offset:11776
ds_read_b64_tr_b16 v[22:23], v4 offset:13824
v_smfmac_f32_16x16x64_bf16 v[24:27], v[48:51], a[184:191], v0
ds_read_b128 v[36:39], v6 offset:3072
ds_read_b128 v[44:47], v6 offset:4096
v_smfmac_f32_16x16x64_bf16 v[28:31], v[48:51], a[192:199], v0
ds_read_b128 v[40:43], v6 offset:5120
s_waitcnt lgkmcnt(9)
v_mfma_f32_16x16x32_bf16 v[52:55], v[8:11], v[8:11], 0
buffer_store_dwordx4 v[8:11], v1, s[4:7], s50 offen offset:0 sc1
s_waitcnt lgkmcnt(7)
v_mfma_f32_16x16x32_bf16 v[52:55], v[12:15], v[12:15], v[52:55]
s_waitcnt lgkmcnt(5)
v_add_f32 v24, v24, v26
v_add_f32 v25, v25, v27
v_mfma_f32_16x16x32_bf16 v[52:55], v[16:19], v[16:19], v[52:55]
s_waitcnt lgkmcnt(3)
v_add_f32 v28, v28, v30
v_add_f32 v29, v29, v31
v_mfma_f32_16x16x32_bf16 v[52:55], v[20:23], v[20:23], v[52:55]
v_cvt_pk_bf16_f32 v24, v24, v25
v_cvt_pk_bf16_f32 v25, v28, v29
v_mfma_f32_16x16x32_bf16 v[48:51], v[64:67], v[8:11], 0
ds_read_b128 v[64:67], v6 offset:6144
v_mov_b64 v[26:27], s[74:75]
v_mfma_f32_16x16x32_bf16 v[48:51], v[68:71], v[12:15], v[48:51]
ds_read_b128 v[68:71], v6 offset:7168
buffer_store_dwordx2 v[24:25], v3, s[4:7], s51 offen offset:0 sc1
v_mov_b32 v29, 0
v_mfma_f32_16x16x32_bf16 v[48:51], v[32:35], v[16:19], v[48:51]
s_cbranch_scc1 L_last01_s
s_waitcnt lgkmcnt(4)
v_exp_f32 v54, v54
v_mfma_f32_16x16x32_bf16 v[48:51], v[36:39], v[20:23], v[48:51]
s_waitcnt lgkmcnt(3)
v_exp_f32 v55, v55
v_mfma_f32_16x16x32_bf16 v[32:35], v[44:47], v[8:11], 0
s_waitcnt lgkmcnt(2)
v_cvt_pk_bf16_f32 v28, v54, v55
v_cvt_pk_bf16_f32 v31, v54, v55
v_mfma_f32_16x16x32_bf16 v[32:35], v[40:43], v[12:15], v[32:35]
s_waitcnt lgkmcnt(1)
v_mov_b32 v30, 0
v_bfe_u32 v6, v1, 2, 7
v_mfma_f32_16x16x32_bf16 v[32:35], v[64:67], v[16:19], v[32:35]
s_waitcnt lgkmcnt(0)
v_exp_f32 v48, v48
v_mfma_f32_16x16x32_bf16 v[32:35], v[68:71], v[20:23], v[32:35]
s_add_u32 s32, s32, 1
v_exp_f32 v49, v49
v_mfma_f32_16x16x16_bf16 v[52:55], v[28:29], v[26:27], 0
ds_read_b128 v[8:11], v2 offset:40960
v_exp_f32 v50, v50
v_mfma_f32_16x16x16_bf16 v[44:47], v[28:29], v[24:25], 0
ds_read_b128 v[12:15], v2 offset:45056
v_exp_f32 v51, v51
v_mfma_f32_16x16x16_bf16 v[40:43], v[30:31], v[24:25], 0
v_exp_f32 v32, v32
v_cvt_pk_bf16_f32 v36, v48, v49
v_cvt_pk_bf16_f32 v37, v50, v51
v_exp_f32 v33, v33
v_exp_f32 v34, v34
v_mfma_f32_16x16x16_bf16 v[52:55], v[36:37], v[26:27], v[52:55]
v_exp_f32 v35, v35
v_cvt_pk_bf16_f32 v38, v32, v33
v_cvt_pk_bf16_f32 v39, v34, v35
s_nop 1
v_mfma_f32_16x16x16_bf16 v[52:55], v[38:39], v[26:27], v[52:55]
ds_read_b128 v[16:19], v1 offset:40960
ds_read_b128 v[20:23], v1 offset:45056
v_mfma_f32_16x16x32_bf16 v[44:47], v[36:39], v[56:59], v[44:47]
ds_read_b128 v[64:67], v1 offset:49152
ds_read_b128 v[68:71], v1 offset:53248
v_mfma_f32_16x16x32_bf16 v[40:43], v[36:39], v[60:63], v[40:43]
s_nop 1
v_rcp_f32 v52, v52
v_rcp_f32 v53, v53
v_subrev_u32 v54, 562036736, v52
v_mul_f32 v44, v44, v52
v_mul_f32 v45, v45, v53
v_cvt_pk_bf16_f32 v48, v44, v45
v_cvt_pk_bf16_f32 v49, v44, v45
ds_write_b64 v3, v[48:49] offset:5120
v_pk_mul_f32 v[40:41], v[40:41], v[52:53]
v_cvt_pk_bf16_f32 v50, v40, v41
v_cvt_pk_bf16_f32 v51, v40, v41
ds_write_b64 v3, v[50:51] offset:7168
v_subrev_u32 v53, 562036736, v53
v_max_u32 v52, v54, v53
v_cmp_le_u32 vcc, s63, v52
v_mov_b64 v[52:53], 0
v_mov_b64 v[54:55], 0
v_mov_b64 v[40:41], 0
v_mov_b64 v[42:43], 0
s_cbranch_vccnz L_sretry01_s
L_sback01_s:
s_waitcnt lgkmcnt(0)
s_barrier
ds_read_b64_tr_b16 v[24:25], v4 offset:5120
ds_read_b64_tr_b16 v[26:27], v4 offset:7168
ds_read_b64_tr_b16 v[28:29], v4 offset:5632
ds_read_b64_tr_b16 v[30:31], v4 offset:7680
ds_read_b64_tr_b16 v[32:33], v4 offset:6144
ds_read_b64_tr_b16 v[34:35], v4 offset:8192
s_waitcnt lgkmcnt(4)
v_smfmac_f32_16x16x64_bf16 v[52:55], v[24:27], v[8:15], v0
ds_read_b64_tr_b16 v[36:37], v4 offset:6656
ds_read_b64_tr_b16 v[38:39], v4 offset:8704
s_waitcnt lgkmcnt(4)
v_mov_b64 v[44:45], 0
v_smfmac_f32_16x16x64_bf16 v[52:55], v[28:31], a[248:255], v0
v_mov_b64 v[46:47], 0
v_smfmac_f32_16x16x64_bf16 v[40:43], v[24:27], v[16:23], v0
ds_read_b128 v[56:59], v1 offset:57344
ds_read_b128 v[60:63], v1 offset:61440
v_smfmac_f32_16x16x64_bf16 v[40:43], v[28:31], v[64:71], v0
ds_read_b128 v[8:11], v2 offset:0
ds_read_b128 v[12:15], v2 offset:4096
s_waitcnt lgkmcnt(6)
v_cvt_pk_bf16_f32 v52, v52, v53
v_smfmac_f32_16x16x64_bf16 v[40:43], v[32:35], a[216:223], v0
buffer_load_dword v16, v6, s[4:7], s8 offen sc1
s_waitcnt lgkmcnt(4)
v_cvt_pk_bf16_f32 v53, v54, v55
v_and_or_b32 v52, v52, -2, s33
v_smfmac_f32_16x16x64_bf16 v[40:43], v[36:39], a[224:231], v0
buffer_store_dwordx2 v[52:53], v5, s[4:7], s45 offen sc1
s_nop 0
v_smfmac_f32_16x16x64_bf16 v[44:47], v[24:27], a[232:239], v0
buffer_load_dword v17, v6, s[4:7], s8 offen sc1
s_nop 1
v_smfmac_f32_16x16x64_bf16 v[44:47], v[28:31], a[240:247], v0
s_waitcnt lgkmcnt(2)
v_cvt_pk_bf16_f32 v40, v40, v41
v_smfmac_f32_16x16x64_bf16 v[44:47], v[32:35], v[56:63], v0
buffer_load_dword v18, v6, s[4:7], s8 offen sc1
s_waitcnt lgkmcnt(0)
v_cvt_pk_bf16_f32 v41, v42, v43
v_and_or_b32 v40, v40, -2, s33
v_smfmac_f32_16x16x64_bf16 v[44:47], v[36:39], v[8:15], v0
buffer_store_dwordx2 v[40:41], v5, s[4:7], s43 offen sc1
buffer_load_dword v19, v6, s[4:7], s8 offen sc1
s_nop 5
v_cvt_pk_bf16_f32 v44, v44, v45
v_cvt_pk_bf16_f32 v45, v46, v47
v_and_or_b32 v44, v44, -2, s33
buffer_store_dwordx2 v[44:45], v5, s[4:7], s44 offen sc1
s_xor_b32 s33, s33, 1
buffer_load_dword v20, v6, s[4:7], s8 offen sc1
s_nop 6
buffer_load_dword v21, v6, s[4:7], s8 offen sc1
s_waitcnt vmcnt(8)
v_cmp_gt_u32 vcc, s32, v16
buffer_load_dword v16, v6, s[4:7], s8 offen sc1
s_cbranch_vccz L_mok01_s
s_waitcnt vmcnt(7)
v_cmp_gt_u32 vcc, s32, v17
buffer_load_dword v17, v6, s[4:7], s8 offen sc1
s_cbranch_vccz L_mok01_s
s_waitcnt vmcnt(7)
v_cmp_gt_u32 vcc, s32, v18
buffer_load_dword v18, v6, s[4:7], s8 offen sc1
s_cbranch_vccz L_mok01_s
s_waitcnt vmcnt(6)
v_cmp_gt_u32 vcc, s32, v19
buffer_load_dword v19, v6, s[4:7], s8 offen sc1
s_cbranch_vccz L_mok01_s
s_waitcnt vmcnt(5)
v_cmp_gt_u32 vcc, s32, v20
buffer_load_dword v20, v6, s[4:7], s8 offen sc1
s_cbranch_vccz L_mok01_s
s_waitcnt vmcnt(5)
v_cmp_gt_u32 vcc, s32, v21
buffer_load_dword v21, v6, s[4:7], s8 offen sc1
s_cbranch_vccz L_mok01_s
L_mk01_s:
s_waitcnt vmcnt(5)
v_cmp_gt_u32 vcc, s32, v16
buffer_load_dword v16, v6, s[4:7], s8 offen sc1
s_cbranch_vccz L_mok01_s
s_waitcnt vmcnt(5)
v_cmp_gt_u32 vcc, s32, v17
buffer_load_dword v17, v6, s[4:7], s8 offen sc1
s_cbranch_vccz L_mok01_s
s_waitcnt vmcnt(5)
v_cmp_gt_u32 vcc, s32, v18
buffer_load_dword v18, v6, s[4:7], s8 offen sc1
s_cbranch_vccz L_mok01_s
s_waitcnt vmcnt(5)
v_cmp_gt_u32 vcc, s32, v19
buffer_load_dword v19, v6, s[4:7], s8 offen sc1
s_cbranch_vccz L_mok01_s
s_waitcnt vmcnt(5)
v_cmp_gt_u32 vcc, s32, v20
buffer_load_dword v20, v6, s[4:7], s8 offen sc1
s_cbranch_vccz L_mok01_s
s_waitcnt vmcnt(5)
v_cmp_gt_u32 vcc, s32, v21
buffer_load_dword v21, v6, s[4:7], s8 offen sc1
s_cbranch_vccz L_mok01_s
s_add_u32 s27, s27, 1
s_cmp_gt_u32 s27, 262144
s_cbranch_scc0 L_mk01_s
s_branch L_fail_s
L_mok01_s:
s_barrier
s_cmp_lt_u32 s25, 16
s_cbranch_scc1 L_glo01_s
s_nop 4
L_glo01_s:
s_nop 9
buffer_load_dwordx4 v[8:11], v1, s[4:7], s46 offen offset:0 sc1
buffer_load_dwordx4 v[12:15], v1, s[4:7], s46 offen offset:1024 sc1
buffer_load_dwordx4 v[16:19], v1, s[4:7], s46 offen offset:2048 sc1
buffer_load_dwordx4 v[20:23], v1, s[4:7], s46 offen offset:3072 sc1
v_and_b32 v32, 16, v1
v_lshlrev_b32 v32, v32, s57
v_cndmask_b32 v24, 0, v32, s[64:65]
v_cndmask_b32 v25, 0, v32, s[66:67]
v_cndmask_b32 v26, 0, v32, s[68:69]
v_cndmask_b32 v27, 0, v32, s[70:71]
v_mov_b32 v37, -1
v_mov_b32 v38, s32
s_nop 14
buffer_load_dwordx4 v[64:67], v1, s[4:7], s46 offen offset:0 sc1
buffer_load_dwordx4 v[68:71], v1, s[4:7], s46 offen offset:1024 sc1
buffer_load_dwordx4 v[56:59], v1, s[4:7], s46 offen offset:2048 sc1
buffer_load_dwordx4 v[60:63], v1, s[4:7], s46 offen offset:3072 sc1
s_waitcnt vmcnt(7)
v_mfma_f32_16x16x32_bf16 v[28:31], v[8:11], v[24:27], 0
v_bitop3_b32 v32, v8, v10, s34 bitop3:0x7e
s_waitcnt vmcnt(6)
v_mfma_f32_16x16x32_bf16 v[28:31], v[12:15], v[24:27], v[28:31]
v_bitop3_b32 v33, v12, v14, s34 bitop3:0x7e
v_or_b32 v32, v32, v33
s_waitcnt vmcnt(5)
v_mfma_f32_16x16x32_bf16 v[28:31], v[16:19], v[24:27], v[28:31]
v_bitop3_b32 v33, v16, v18, s34 bitop3:0x7e
v_or_b32 v32, v32, v33
s_waitcnt vmcnt(4)
v_mfma_f32_16x16x32_bf16 v[28:31], v[20:23], v[24:27], v[28:31]
v_bitop3_b32 v33, v20, v22, s34 bitop3:0x7e
v_bitop3_b32 v32, v32, v33, 1 bitop3:0xa8
v_cmp_ne_u32 vcc, 0, v32
s_nop 3
s_cbranch_vccnz L_gretry01_s
L_gback01_s:
v_permlane32_swap_b32 v28, v30
v_permlane32_swap_b32 v29, v31
v_pk_add_f32 v[28:29], v[28:29], v[30:31]
v_cvt_pk_bf16_f32 v28, v28, v29
v_min_u32 v28, -2, v28
buffer_store_dword v28, v7, s[4:7], s39 offen sc1
s_barrier
buffer_store_dword v28, v7, s[4:7], s41 offen sc1
buffer_store_dword v37, v7, s[4:7], s40 offen sc1
s_not_b32 s34, s34
v_lshrrev_b32 v6, 2, v1
s_nop 15
s_nop 15
s_nop 7
s_branch L_step01_s
L_aretry01_s:
buffer_load_dwordx4 v[48:51], v1, s[4:7], s35 offen sc1
s_waitcnt vmcnt(3)
v_max3_u32 v32, v52, v53, v54
v_max_u32 v32, v32, v55
v_cmp_eq_u32 vcc, -1, v32
s_cbranch_vccz L_aw001_s
buffer_load_dwordx4 v[52:55], v1, s[4:7], s35 offen sc1
s_waitcnt vmcnt(3)
v_max3_u32 v32, v44, v45, v46
v_max_u32 v32, v32, v47
v_cmp_eq_u32 vcc, -1, v32
s_cbranch_vccz L_aw101_s
buffer_load_dwordx4 v[44:47], v1, s[4:7], s35 offen sc1
s_waitcnt vmcnt(3)
v_max3_u32 v32, v40, v41, v42
v_max_u32 v32, v32, v43
v_cmp_eq_u32 vcc, -1, v32
s_cbranch_vccz L_aw201_s
buffer_load_dwordx4 v[40:43], v1, s[4:7], s35 offen sc1
s_waitcnt vmcnt(3)
v_max3_u32 v32, v48, v49, v50
v_max_u32 v32, v32, v51
v_cmp_eq_u32 vcc, -1, v32
s_cbranch_vccz L_aw301_s
s_add_u32 s27, s27, 1
s_cmp_gt_u32 s27, 262144
s_cbranch_scc0 L_aretry01_s
s_branch L_fail_s
L_aw001_s:
ds_write_b128 v1, v[52:55] offset:0
s_branch L_aback01_s
L_aw101_s:
ds_write_b128 v1, v[44:47] offset:0
s_branch L_aback01_s
L_aw201_s:
ds_write_b128 v1, v[40:43] offset:0
s_branch L_aback01_s
L_aw301_s:
ds_write_b128 v1, v[48:51] offset:0
s_branch L_aback01_s
L_fretry01_s:
s_waitcnt lgkmcnt(0)
buffer_load_dword v44, v6, s[4:7], s36 offen sc1
s_add_u32 s27, s27, 1
s_cmp_gt_u32 s27, 262144
s_cbranch_scc1 L_fail_s
s_waitcnt vmcnt(0)
ds_write_b32 v6, v44 offset:4096
v_cmp_eq_u32 vcc, -1, v44
s_waitcnt lgkmcnt(0)
s_cbranch_vccnz L_fretry01_s
s_branch L_fback01_s
L_bretry01_s:
s_waitcnt lgkmcnt(0)
buffer_load_dwordx4 v[48:51], v1, s[4:7], s37 offen sc1
buffer_load_dword v52, v6, s[4:7], s38 offen sc1
s_add_u32 s27, s27, 1
s_cmp_gt_u32 s27, 262144
s_cbranch_scc1 L_fail_s
s_waitcnt vmcnt(0)
ds_write_b128 v1, v[48:51] offset:5120
ds_write_b32 v6, v52 offset:9216
v_max3_u32 v53, v48, v49, v50
v_max3_u32 v53, v53, v51, v52
v_cmp_eq_u32 vcc, -1, v53
s_waitcnt lgkmcnt(0)
s_cbranch_vccnz L_bretry01_s
s_branch L_bback01_s
L_last01_s:
s_waitcnt vmcnt(0) lgkmcnt(0)
s_barrier
s_endpgm
L_sretry01_s:
s_waitcnt lgkmcnt(0)
s_sub_u32 s3, s59, 0
v_add_u32 v6, s3, v1
ds_read_b64_tr_b16 v[8:9], v4 offset:10240
ds_read_b64_tr_b16 v[10:11], v4 offset:12288
ds_read_b64_tr_b16 v[12:13], v4 offset:10752
ds_read_b64_tr_b16 v[14:15], v4 offset:12800
ds_read_b64_tr_b16 v[16:17], v4 offset:11264
ds_read_b64_tr_b16 v[18:19], v4 offset:13312
ds_read_b64_tr_b16 v[20:21], v4 offset:11776
ds_read_b64_tr_b16 v[22:23], v4 offset:13824
s_waitcnt lgkmcnt(6)
v_mfma_f32_16x16x32_bf16 v[52:55], v[8:11], v[8:11], 0
s_waitcnt lgkmcnt(4)
v_mfma_f32_16x16x32_bf16 v[52:55], v[12:15], v[12:15], v[52:55]
s_waitcnt lgkmcnt(2)
v_mfma_f32_16x16x32_bf16 v[52:55], v[16:19], v[16:19], v[52:55]
s_waitcnt lgkmcnt(0)
v_mfma_f32_16x16x32_bf16 v[52:55], v[20:23], v[20:23], v[52:55]
ds_read_b128 v[64:67], v6 offset:0
ds_read_b128 v[68:71], v6 offset:1024
ds_read_b128 v[40:43], v6 offset:2048
ds_read_b128 v[44:47], v6 offset:3072
s_waitcnt lgkmcnt(3)
v_mfma_f32_16x16x32_bf16 v[48:51], v[64:67], v[8:11], 0
s_waitcnt lgkmcnt(2)
v_mfma_f32_16x16x32_bf16 v[48:51], v[68:71], v[12:15], v[48:51]
s_waitcnt lgkmcnt(1)
v_mfma_f32_16x16x32_bf16 v[48:51], v[40:43], v[16:19], v[48:51]
s_waitcnt lgkmcnt(0)
v_mfma_f32_16x16x32_bf16 v[48:51], v[44:47], v[20:23], v[48:51]
ds_read_b128 v[64:67], v6 offset:4096
ds_read_b128 v[68:71], v6 offset:5120
ds_read_b128 v[40:43], v6 offset:6144
ds_read_b128 v[44:47], v6 offset:7168
s_waitcnt lgkmcnt(3)
v_mfma_f32_16x16x32_bf16 v[32:35], v[64:67], v[8:11], 0
s_waitcnt lgkmcnt(2)
v_mfma_f32_16x16x32_bf16 v[32:35], v[68:71], v[12:15], v[32:35]
s_waitcnt lgkmcnt(1)
v_mfma_f32_16x16x32_bf16 v[32:35], v[40:43], v[16:19], v[32:35]
s_waitcnt lgkmcnt(0)
v_mfma_f32_16x16x32_bf16 v[32:35], v[44:47], v[20:23], v[32:35]
v_max3_f32 v52, v54, v55, v48
v_max3_f32 v52, v52, v49, v50
s_nop 5
v_max3_f32 v52, v52, v51, v32
v_max3_f32 v52, v52, v33, v34
v_max_f32 v52, v52, v35
v_mov_b32 v53, v52
s_nop 1
v_permlane32_swap_b32 v52, v53
v_max_f32 v52, v52, v53
v_mov_b32 v53, v52
s_nop 1
v_permlane16_swap_b32 v52, v53
v_max_f32 v52, v52, v53
v_sub_f32 v54, v54, v52
v_sub_f32 v55, v55, v52
v_sub_f32 v48, v48, v52
v_sub_f32 v49, v49, v52
v_sub_f32 v50, v50, v52
v_sub_f32 v51, v51, v52
v_sub_f32 v32, v32, v52
v_sub_f32 v33, v33, v52
v_sub_f32 v34, v34, v52
v_sub_f32 v35, v35, v52
v_exp_f32 v54, v54
v_exp_f32 v55, v55
v_exp_f32 v48, v48
v_exp_f32 v49, v49
v_exp_f32 v50, v50
v_exp_f32 v51, v51
v_exp_f32 v32, v32
v_exp_f32 v33, v33
v_exp_f32 v34, v34
v_exp_f32 v35, v35
v_cvt_pk_bf16_f32 v28, v54, v55
v_cvt_pk_bf16_f32 v31, v54, v55
v_cvt_pk_bf16_f32 v36, v48, v49
v_cvt_pk_bf16_f32 v37, v50, v51
v_cvt_pk_bf16_f32 v38, v32, v33
v_cvt_pk_bf16_f32 v39, v34, v35
v_mfma_f32_16x16x16_bf16 v[52:55], v[28:29], v[26:27], 0
v_mfma_f32_16x16x16_bf16 v[44:47], v[28:29], v[24:25], 0
v_mfma_f32_16x16x16_bf16 v[40:43], v[30:31], v[24:25], 0
v_mfma_f32_16x16x16_bf16 v[52:55], v[36:37], v[26:27], v[52:55]
v_mfma_f32_16x16x16_bf16 v[52:55], v[38:39], v[26:27], v[52:55]
v_mfma_f32_16x16x32_bf16 v[44:47], v[36:39], v[56:59], v[44:47]
v_mfma_f32_16x16x32_bf16 v[40:43], v[36:39], v[60:63], v[40:43]
ds_read_b128 v[8:11], v2 offset:40960
ds_read_b128 v[12:15], v2 offset:45056
ds_read_b128 v[16:19], v1 offset:40960
ds_read_b128 v[20:23], v1 offset:45056
ds_read_b128 v[64:67], v1 offset:49152
ds_read_b128 v[68:71], v1 offset:53248
v_bfe_u32 v6, v1, 2, 7
v_rcp_f32 v52, v52
v_rcp_f32 v53, v53
v_subrev_u32 v54, 562036736, v52
v_mul_f32 v44, v44, v52
v_mul_f32 v45, v45, v53
v_cvt_pk_bf16_f32 v48, v44, v45
v_cvt_pk_bf16_f32 v49, v44, v45
ds_write_b64 v3, v[48:49] offset:5120
v_pk_mul_f32 v[40:41], v[40:41], v[52:53]
v_cvt_pk_bf16_f32 v50, v40, v41
v_cvt_pk_bf16_f32 v51, v40, v41
ds_write_b64 v3, v[50:51] offset:7168
v_mov_b64 v[40:41], 0
v_mov_b64 v[42:43], 0
v_mov_b64 v[44:45], 0
v_mov_b64 v[46:47], 0
v_mov_b64 v[52:53], 0
v_mov_b64 v[54:55], 0
s_waitcnt lgkmcnt(0)
s_branch L_sback01_s
L_gretry01_s:
L_gloop01_s:
buffer_load_dwordx4 v[8:11], v1, s[4:7], s46 offen offset:0 sc1
buffer_load_dwordx4 v[12:15], v1, s[4:7], s46 offen offset:1024 sc1
buffer_load_dwordx4 v[16:19], v1, s[4:7], s46 offen offset:2048 sc1
buffer_load_dwordx4 v[20:23], v1, s[4:7], s46 offen offset:3072 sc1
s_add_u32 s27, s27, 1
s_waitcnt vmcnt(7)
v_mfma_f32_16x16x32_bf16 v[28:31], v[64:67], v[24:27], 0
v_bitop3_b32 v32, v64, v66, s34 bitop3:0x7e
s_waitcnt vmcnt(6)
v_mfma_f32_16x16x32_bf16 v[28:31], v[68:71], v[24:27], v[28:31]
v_bitop3_b32 v33, v68, v70, s34 bitop3:0x7e
v_or_b32 v32, v32, v33
s_waitcnt vmcnt(5)
v_mfma_f32_16x16x32_bf16 v[28:31], v[56:59], v[24:27], v[28:31]
v_bitop3_b32 v33, v56, v58, s34 bitop3:0x7e
v_or_b32 v32, v32, v33
s_waitcnt vmcnt(4)
v_mfma_f32_16x16x32_bf16 v[28:31], v[60:63], v[24:27], v[28:31]
v_bitop3_b32 v33, v60, v62, s34 bitop3:0x7e
v_bitop3_b32 v32, v32, v33, 1 bitop3:0xa8
v_cmp_ne_u32 vcc, 0, v32
s_nop 3
s_cbranch_vccz L_gback01_s
buffer_load_dwordx4 v[64:67], v1, s[4:7], s46 offen offset:0 sc1
buffer_load_dwordx4 v[68:71], v1, s[4:7], s46 offen offset:1024 sc1
buffer_load_dwordx4 v[56:59], v1, s[4:7], s46 offen offset:2048 sc1
buffer_load_dwordx4 v[60:63], v1, s[4:7], s46 offen offset:3072 sc1
s_add_u32 s27, s27, 1
s_waitcnt vmcnt(7)
v_mfma_f32_16x16x32_bf16 v[28:31], v[8:11], v[24:27], 0
v_bitop3_b32 v32, v8, v10, s34 bitop3:0x7e
s_waitcnt vmcnt(6)
v_mfma_f32_16x16x32_bf16 v[28:31], v[12:15], v[24:27], v[28:31]
v_bitop3_b32 v33, v12, v14, s34 bitop3:0x7e
v_or_b32 v32, v32, v33
s_waitcnt vmcnt(5)
v_mfma_f32_16x16x32_bf16 v[28:31], v[16:19], v[24:27], v[28:31]
v_bitop3_b32 v33, v16, v18, s34 bitop3:0x7e
v_or_b32 v32, v32, v33
s_waitcnt vmcnt(4)
v_mfma_f32_16x16x32_bf16 v[28:31], v[20:23], v[24:27], v[28:31]
v_bitop3_b32 v33, v20, v22, s34 bitop3:0x7e
v_bitop3_b32 v32, v32, v33, 1 bitop3:0xa8
v_cmp_ne_u32 vcc, 0, v32
s_nop 3
s_cbranch_vccz L_gback01_s
s_cmp_gt_u32 s27, 262144
s_cbranch_scc0 L_gloop01_s
s_branch L_fail_s
L_rw1_s:
v_lshrrev_b32 v6, 2, v1
s_mov_b32 s41, 0x40000000
.p2align 6
L_step12_s:
buffer_load_dwordx4 v[48:51], v1, s[4:7], s35 offen sc1
s_nop 15
s_nop 0
buffer_load_dwordx4 v[52:55], v1, s[4:7], s35 offen sc1
s_nop 15
s_nop 0
buffer_load_dwordx4 v[44:47], v1, s[4:7], s35 offen sc1
s_waitcnt vmcnt(7)
ds_read_b128 v[56:59], v1 offset:34816
s_waitcnt vmcnt(6)
ds_read_b128 v[60:63], v1 offset:35840
ds_read_b128 v[64:67], v2 offset:9216
ds_read_b128 v[68:71], v2 offset:13312
v_mov_b64 v[8:9], 0
v_mov_b64 v[10:11], 0
v_mov_b64 v[12:13], 0
v_mov_b64 v[14:15], 0
v_mov_b64 v[16:17], 0
v_mov_b64 v[18:19], 0
v_mov_b64 v[20:21], 0
v_mov_b64 v[22:23], 0
v_mov_b64 v[24:25], 0
v_mov_b64 v[26:27], 0
v_mov_b64 v[28:29], 0
v_mov_b64 v[30:31], 0
s_nop 0
buffer_load_dwordx4 v[40:43], v1, s[4:7], s35 offen sc1
s_waitcnt vmcnt(3)
ds_write_b128 v1, v[48:51] offset:1024
v_max3_u32 v32, v48, v49, v50
v_max_u32 v32, v32, v51
v_cmp_eq_u32 vcc, -1, v32
s_cbranch_vccnz L_aretry12_s
L_aback12_s:
buffer_load_dword v44, v6, s[4:7], s36 offen sc1
s_waitcnt lgkmcnt(0)
s_barrier
ds_read_b128 v[32:35], v1 offset:0
buffer_load_dwordx4 v[48:51], v1, s[4:7], s37 offen sc1
buffer_load_dword v52, v6, s[4:7], s38 offen sc1
ds_read_b128 v[36:39], v1 offset:1024
s_waitcnt lgkmcnt(1)
v_smfmac_f32_16x16x64_bf16 v[8:11], v[32:35], v[64:71], v0
ds_read_b128 v[64:67], v2 offset:17408
ds_read_b128 v[68:71], v2 offset:21504
v_smfmac_f32_16x16x64_bf16 v[16:19], v[32:35], v[72:79], v0
s_mul_i32 s3, s52, 5120
s_add_u32 s40, s60, s3
s_add_u32 s52, s52, 1
v_smfmac_f32_16x16x64_bf16 v[20:23], v[32:35], v[80:87], v0
v_smfmac_f32_16x16x64_bf16 v[24:27], v[32:35], a[64:71], v0
v_smfmac_f32_16x16x64_bf16 v[28:31], v[32:35], a[72:79], v0
s_waitcnt lgkmcnt(0)
v_smfmac_f32_16x16x64_bf16 v[12:15], v[32:35], v[64:71], v0
ds_read_b128 v[64:67], v2 offset:25600
ds_read_b128 v[68:71], v2 offset:29696
v_smfmac_f32_16x16x64_bf16 v[8:11], v[36:39], v[208:215], v0
s_and_b32 s52, s52, 3
s_xor_b32 s30, s52, 2
s_lshl_b32 s30, s30, 15
v_smfmac_f32_16x16x64_bf16 v[12:15], v[36:39], v[216:223], v0
s_waitcnt vmcnt(3)
ds_read_b128 v[40:43], v1 offset:2048
v_smfmac_f32_16x16x64_bf16 v[16:19], v[36:39], v[88:95], v0
s_mul_i32 s3, s52, 5120
s_add_u32 s39, s60, s3
s_lshl_b32 s31, s52, 15
v_smfmac_f32_16x16x64_bf16 v[20:23], v[36:39], v[96:103], v0
ds_read_b128 v[32:35], v1 offset:3072
s_add_u32 s42, s61, s30
v_smfmac_f32_16x16x64_bf16 v[24:27], v[36:39], a[80:87], v0
s_waitcnt vmcnt(2)
ds_write_b32 v6, v44 offset:4352
v_cmp_eq_u32 vcc, -1, v44
v_smfmac_f32_16x16x64_bf16 v[28:31], v[36:39], a[88:95], v0
s_waitcnt lgkmcnt(2)
v_smfmac_f32_16x16x64_bf16 v[8:11], v[40:43], v[64:71], v0
ds_read_b128 v[64:67], v2 offset:33792
ds_read_b128 v[68:71], v2 offset:37888
s_cbranch_vccnz L_fretry12_s
L_fback12_s:
v_smfmac_f32_16x16x64_bf16 v[16:19], v[40:43], v[104:111], v0
v_smfmac_f32_16x16x64_bf16 v[20:23], v[40:43], v[112:119], v0
s_add_u32 s41, s61, s31
s_add_u32 s31, s31, s62
s_add_u32 s35, s39, 1024
v_smfmac_f32_16x16x64_bf16 v[24:27], v[40:43], a[96:103], v0
s_waitcnt lgkmcnt(2)
s_barrier
v_smfmac_f32_16x16x64_bf16 v[28:31], v[40:43], a[104:111], v0
s_waitcnt lgkmcnt(0)
v_smfmac_f32_16x16x64_bf16 v[12:15], v[40:43], v[64:71], v0
ds_read_b128 v[64:67], v2 offset:50176
ds_read_b128 v[68:71], v2 offset:54272
v_smfmac_f32_16x16x64_bf16 v[8:11], v[32:35], v[224:231], v0
ds_read_b128 v[36:39], v1 offset:4096
v_smfmac_f32_16x16x64_bf16 v[12:15], v[32:35], v[232:239], v0
s_add_u32 s36, s39, 4352
v_smfmac_f32_16x16x64_bf16 v[16:19], v[32:35], v[120:127], v0
s_waitcnt vmcnt(1)
ds_write_b128 v1, v[48:51] offset:6144
s_add_u32 s58, s32, 3
s_min_u32 s58, s58, 64
v_max3_u32 v53, v48, v49, v50
v_smfmac_f32_16x16x64_bf16 v[20:23], v[32:35], v[128:135], v0
s_waitcnt vmcnt(0)
ds_write_b32 v6, v52 offset:9472
s_mov_b32 m0, s59
s_xor_b32 s59, s59, 8192
v_max3_u32 v53, v53, v51, v52
s_waitcnt lgkmcnt(3)
v_smfmac_f32_16x16x64_bf16 v[24:27], v[32:35], v[64:71], v0
ds_read_b128 v[64:67], v2 offset:58368
ds_read_b128 v[68:71], v2 offset:62464
v_cmp_eq_u32 vcc, -1, v53
v_smfmac_f32_16x16x64_bf16 v[28:31], v[32:35], a[112:119], v0
s_waitcnt lgkmcnt(4)
v_smfmac_f32_16x16x64_bf16 v[8:11], v[36:39], v[240:247], v0
s_cbranch_vccnz L_bretry12_s
L_bback12_s:
v_add_u32 v2, 0x10000, v2
v_smfmac_f32_16x16x64_bf16 v[12:15], v[36:39], v[248:255], v0
s_waitcnt lgkmcnt(2)
s_barrier
ds_read_b128 v[40:43], v1 offset:5120
v_smfmac_f32_16x16x64_bf16 v[16:19], v[36:39], v[136:143], v0
ds_read_b128 v[44:47], v1 offset:6144
buffer_load_dwordx4 v1, s[4:7], s48 offen sc1 lds
s_waitcnt lgkmcnt(2)
v_smfmac_f32_16x16x64_bf16 v[20:23], v[36:39], v[64:71], v0
ds_read_b128 v[64:67], v2 offset:1024
ds_read_b128 v[68:71], v2 offset:5120
v_smfmac_f32_16x16x64_bf16 v[24:27], v[36:39], a[120:127], v0
ds_read_b128 v[32:35], v1 offset:7168
buffer_load_dwordx4 v1, s[4:7], s48 offen offset:1024 sc1 lds
s_mov_b32 m0, 34816
v_smfmac_f32_16x16x64_bf16 v[28:31], v[36:39], a[128:135], v0
ds_read_b128 v[48:51], v1 offset:8192
s_waitcnt lgkmcnt(5)
v_smfmac_f32_16x16x64_bf16 v[8:11], v[40:43], a[0:7], v0
ds_read_b128 v[36:39], v1 offset:9216
v_smfmac_f32_16x16x64_bf16 v[12:15], v[40:43], a[8:15], v0
buffer_load_dwordx4 v1, s[4:7], s49 offen sc1 lds
v_mov_b32 v54, -1
s_waitcnt lgkmcnt(3)
v_smfmac_f32_16x16x64_bf16 v[8:11], v[44:47], v[64:71], v0
ds_read_b128 v[64:67], v2 offset:9216
ds_read_b128 v[68:71], v2 offset:13312
v_smfmac_f32_16x16x64_bf16 v[12:15], v[44:47], a[16:23], v0
buffer_load_dwordx4 v1, s[4:7], s49 offen offset:1024 sc1 lds
s_waitcnt lgkmcnt(4)
v_smfmac_f32_16x16x64_bf16 v[8:11], v[32:35], a[24:31], v0
s_cmp_eq_u32 s32, 62
s_cselect_b32 s11, 0x40000000, s12
s_waitcnt lgkmcnt(3)
v_smfmac_f32_16x16x64_bf16 v[8:11], v[48:51], a[32:39], v0
s_waitcnt lgkmcnt(2)
v_smfmac_f32_16x16x64_bf16 v[8:11], v[36:39], a[48:55], v0
s_add_u32 s37, s31, 1024
s_add_u32 s38, s31, 4352
s_waitcnt lgkmcnt(0)
v_smfmac_f32_16x16x64_bf16 v[12:15], v[32:35], v[64:71], v0
ds_read_b128 v[64:67], v2 offset:17408
ds_read_b128 v[68:71], v2 offset:21504
v_smfmac_f32_16x16x64_bf16 v[12:15], v[48:51], a[40:47], v0
buffer_store_dword v54, v7, s[4:7], s42 offen sc1
s_sub_u32 s3, s59, 2048
v_add_u32 v6, s3, v1
v_smfmac_f32_16x16x64_bf16 v[12:15], v[36:39], a[56:63], v0
s_add_u32 s48, s48, s11
s_add_u32 s49, s49, s11
v_add_f32 v8, v8, v10
v_smfmac_f32_16x16x64_bf16 v[16:19], v[40:43], v[144:151], v0
v_add_f32 v9, v9, v11
v_smfmac_f32_16x16x64_bf16 v[16:19], v[44:47], v[160:167], v0
v_mul_f32 v8, s56, v8
s_waitcnt lgkmcnt(0)
v_smfmac_f32_16x16x64_bf16 v[16:19], v[32:35], v[64:71], v0
ds_read_b128 v[64:67], v2 offset:25600
ds_read_b128 v[68:71], v2 offset:29696
v_mul_f32 v9, s56, v9
v_smfmac_f32_16x16x64_bf16 v[16:19], v[48:51], v[176:183], v0
s_add_u32 s50, s50, 16384
s_add_u32 s51, s51, 16384
v_add_f32 v12, v12, v14
v_smfmac_f32_16x16x64_bf16 v[16:19], v[36:39], v[192:199], v0
s_nop 1
v_add_f32 v13, v13, v15
v_smfmac_f32_16x16x64_bf16 v[20:23], v[40:43], v[152:159], v0
s_nop 1
v_mul_f32 v12, s56, v12
v_smfmac_f32_16x16x64_bf16 v[20:23], v[44:47], v[168:175], v0
v_mul_f32 v13, s56, v13
s_waitcnt lgkmcnt(0)
v_smfmac_f32_16x16x64_bf16 v[20:23], v[32:35], v[64:71], v0
ds_read_b128 v[64:67], v6 offset:0
v_add_f32 v16, v16, v18
v_smfmac_f32_16x16x64_bf16 v[20:23], v[48:51], v[184:191], v0
s_cmp_eq_u32 s32, 63
ds_read_b128 v[68:71], v6 offset:1024
v_add_f32 v17, v17, v19
v_smfmac_f32_16x16x64_bf16 v[20:23], v[36:39], v[200:207], v0
s_nop 1
v_cvt_pk_bf16_f32 v53, v8, v9
v_cvt_pk_bf16_f32 v52, v16, v17
v_smfmac_f32_16x16x64_bf16 v[24:27], v[32:35], a[168:175], v0
s_nop 0
ds_write_b64 v3, v[52:53] offset:10752
v_cvt_pk_bf16_f32 v55, v12, v13
v_add_f32 v20, v20, v22
v_add_f32 v21, v21, v23
v_cvt_pk_bf16_f32 v54, v20, v21
ds_write_b64 v3, v[54:55] offset:12800
v_smfmac_f32_16x16x64_bf16 v[28:31], v[32:35], a[176:183], v0
v_smfmac_f32_16x16x64_bf16 v[24:27], v[36:39], a[200:207], v0
ds_read_b128 v[32:35], v6 offset:2048
v_add_u32 v2, 0x10000, v1
v_smfmac_f32_16x16x64_bf16 v[28:31], v[36:39], a[208:215], v0
v_smfmac_f32_16x16x64_bf16 v[24:27], v[44:47], a[152:159], v0
s_waitcnt lgkmcnt(1)
s_barrier
ds_read_b64_tr_b16 v[8:9], v4 offset:10240
ds_read_b64_tr_b16 v[10:11], v4 offset:12288
v_smfmac_f32_16x16x64_bf16 v[28:31], v[44:47], a[160:167], v0
ds_read_b64_tr_b16 v[12:13], v4 offset:10752
ds_read_b64_tr_b16 v[14:15], v4 offset:12800
v_smfmac_f32_16x16x64_bf16 v[24:27], v[40:43], a[136:143], v0
ds_read_b64_tr_b16 v[16:17], v4 offset:11264
ds_read_b64_tr_b16 v[18:19], v4 offset:13312
v_smfmac_f32_16x16x64_bf16 v[28:31], v[40:43], a[144:151], v0
ds_read_b64_tr_b16 v[20:21], v4 offset:11776
ds_read_b64_tr_b16 v[22:23], v4 offset:13824
v_smfmac_f32_16x16x64_bf16 v[24:27], v[48:51], a[184:191], v0
ds_read_b128 v[36:39], v6 offset:3072
ds_read_b128 v[44:47], v6 offset:4096
v_smfmac_f32_16x16x64_bf16 v[28:31], v[48:51], a[192:199], v0
ds_read_b128 v[40:43], v6 offset:5120
s_waitcnt lgkmcnt(9)
v_mfma_f32_16x16x32_bf16 v[52:55], v[8:11], v[8:11], 0
s_waitcnt lgkmcnt(7)
v_mfma_f32_16x16x32_bf16 v[52:55], v[12:15], v[12:15], v[52:55]
buffer_store_dwordx4 v[12:15], v1, s[4:7], s50 offen offset:1024 sc1
s_waitcnt lgkmcnt(5)
v_add_f32 v24, v24, v26
v_add_f32 v25, v25, v27
v_mfma_f32_16x16x32_bf16 v[52:55], v[16:19], v[16:19], v[52:55]
s_waitcnt lgkmcnt(3)
v_add_f32 v28, v28, v30
v_add_f32 v29, v29, v31
v_mfma_f32_16x16x32_bf16 v[52:55], v[20:23], v[20:23], v[52:55]
v_cvt_pk_bf16_f32 v24, v24, v25
v_cvt_pk_bf16_f32 v25, v28, v29
v_mfma_f32_16x16x32_bf16 v[48:51], v[64:67], v[8:11], 0
ds_read_b128 v[64:67], v6 offset:6144
v_mov_b64 v[26:27], s[74:75]
v_mfma_f32_16x16x32_bf16 v[48:51], v[68:71], v[12:15], v[48:51]
ds_read_b128 v[68:71], v6 offset:7168
buffer_store_dwordx2 v[24:25], v3, s[4:7], s51 offen offset:512 sc1
v_mov_b32 v29, 0
v_mfma_f32_16x16x32_bf16 v[48:51], v[32:35], v[16:19], v[48:51]
s_cbranch_scc1 L_last12_s
s_waitcnt lgkmcnt(4)
v_exp_f32 v54, v54
v_mfma_f32_16x16x32_bf16 v[48:51], v[36:39], v[20:23], v[48:51]
s_waitcnt lgkmcnt(3)
v_exp_f32 v55, v55
v_mfma_f32_16x16x32_bf16 v[32:35], v[44:47], v[8:11], 0
s_waitcnt lgkmcnt(2)
v_cvt_pk_bf16_f32 v28, v54, v55
v_cvt_pk_bf16_f32 v31, v54, v55
v_mfma_f32_16x16x32_bf16 v[32:35], v[40:43], v[12:15], v[32:35]
s_waitcnt lgkmcnt(1)
v_mov_b32 v30, 0
v_mfma_f32_16x16x32_bf16 v[32:35], v[64:67], v[16:19], v[32:35]
s_waitcnt lgkmcnt(0)
v_exp_f32 v48, v48
v_mfma_f32_16x16x32_bf16 v[32:35], v[68:71], v[20:23], v[32:35]
s_add_u32 s32, s32, 1
v_exp_f32 v49, v49
v_mfma_f32_16x16x16_bf16 v[52:55], v[28:29], v[26:27], 0
ds_read_b128 v[8:11], v2 offset:41984
v_exp_f32 v50, v50
v_mfma_f32_16x16x16_bf16 v[44:47], v[28:29], v[24:25], 0
ds_read_b128 v[12:15], v2 offset:46080
v_exp_f32 v51, v51
v_mfma_f32_16x16x16_bf16 v[40:43], v[30:31], v[24:25], 0
v_exp_f32 v32, v32
v_cvt_pk_bf16_f32 v36, v48, v49
v_cvt_pk_bf16_f32 v37, v50, v51
v_exp_f32 v33, v33
v_exp_f32 v34, v34
v_mfma_f32_16x16x16_bf16 v[52:55], v[36:37], v[26:27], v[52:55]
v_exp_f32 v35, v35
v_cvt_pk_bf16_f32 v38, v32, v33
v_cvt_pk_bf16_f32 v39, v34, v35
s_nop 1
v_mfma_f32_16x16x16_bf16 v[52:55], v[38:39], v[26:27], v[52:55]
ds_read_b128 v[16:19], v1 offset:41984
ds_read_b128 v[20:23], v1 offset:46080
v_mfma_f32_16x16x32_bf16 v[44:47], v[36:39], v[56:59], v[44:47]
ds_read_b128 v[64:67], v1 offset:50176
ds_read_b128 v[68:71], v1 offset:54272
v_mfma_f32_16x16x32_bf16 v[40:43], v[36:39], v[60:63], v[40:43]
s_nop 1
v_rcp_f32 v52, v52
v_rcp_f32 v53, v53
v_subrev_u32 v54, 562036736, v52
v_mul_f32 v44, v44, v52
v_mul_f32 v45, v45, v53
v_cvt_pk_bf16_f32 v48, v44, v45
v_cvt_pk_bf16_f32 v49, v44, v45
ds_write_b64 v3, v[48:49] offset:5632
v_pk_mul_f32 v[40:41], v[40:41], v[52:53]
v_cvt_pk_bf16_f32 v50, v40, v41
v_cvt_pk_bf16_f32 v51, v40, v41
ds_write_b64 v3, v[50:51] offset:7680
v_subrev_u32 v53, 562036736, v53
v_max_u32 v52, v54, v53
v_cmp_le_u32 vcc, s63, v52
v_mov_b64 v[52:53], 0
v_mov_b64 v[54:55], 0
v_mov_b64 v[40:41], 0
v_mov_b64 v[42:43], 0
s_cbranch_vccnz L_sretry12_s
L_sback12_s:
s_waitcnt lgkmcnt(0)
s_barrier
ds_read_b64_tr_b16 v[24:25], v4 offset:5120
ds_read_b64_tr_b16 v[26:27], v4 offset:7168
ds_read_b64_tr_b16 v[28:29], v4 offset:5632
ds_read_b64_tr_b16 v[30:31], v4 offset:7680
ds_read_b64_tr_b16 v[32:33], v4 offset:6144
ds_read_b64_tr_b16 v[34:35], v4 offset:8192
s_waitcnt lgkmcnt(4)
v_smfmac_f32_16x16x64_bf16 v[52:55], v[24:27], v[8:15], v0
ds_read_b64_tr_b16 v[36:37], v4 offset:6656
ds_read_b64_tr_b16 v[38:39], v4 offset:8704
s_waitcnt lgkmcnt(4)
v_mov_b64 v[44:45], 0
v_smfmac_f32_16x16x64_bf16 v[52:55], v[28:31], a[248:255], v0
v_mov_b64 v[46:47], 0
v_smfmac_f32_16x16x64_bf16 v[40:43], v[24:27], v[16:23], v0
ds_read_b128 v[56:59], v1 offset:58368
ds_read_b128 v[60:63], v1 offset:62464
v_smfmac_f32_16x16x64_bf16 v[40:43], v[28:31], v[64:71], v0
ds_read_b128 v[8:11], v2 offset:1024
ds_read_b128 v[12:15], v2 offset:5120
s_waitcnt lgkmcnt(6)
v_cvt_pk_bf16_f32 v52, v52, v53
v_smfmac_f32_16x16x64_bf16 v[40:43], v[32:35], a[216:223], v0
s_waitcnt lgkmcnt(4)
v_cvt_pk_bf16_f32 v53, v54, v55
v_and_or_b32 v52, v52, -2, s33
v_smfmac_f32_16x16x64_bf16 v[40:43], v[36:39], a[224:231], v0
buffer_store_dwordx2 v[52:53], v5, s[4:7], s45 offen sc1
s_nop 0
v_smfmac_f32_16x16x64_bf16 v[44:47], v[24:27], a[232:239], v0
s_nop 1
v_smfmac_f32_16x16x64_bf16 v[44:47], v[28:31], a[240:247], v0
s_waitcnt lgkmcnt(2)
s_nop 0
v_cvt_pk_bf16_f32 v40, v40, v41
v_smfmac_f32_16x16x64_bf16 v[44:47], v[32:35], v[56:63], v0
s_waitcnt lgkmcnt(0)
v_cvt_pk_bf16_f32 v41, v42, v43
v_and_or_b32 v40, v40, -2, s33
v_smfmac_f32_16x16x64_bf16 v[44:47], v[36:39], v[8:15], v0
buffer_store_dwordx2 v[40:41], v5, s[4:7], s43 offen sc1
s_nop 6
v_cvt_pk_bf16_f32 v44, v44, v45
v_cvt_pk_bf16_f32 v45, v46, v47
v_and_or_b32 v44, v44, -2, s33
buffer_store_dwordx2 v[44:45], v5, s[4:7], s44 offen sc1
s_xor_b32 s33, s33, 1
s_barrier
v_and_b32 v6, 0x3c0, v1
v_add_u32 v6, v6, v1
buffer_load_dwordx4 v[8:11], v6, s[4:7], s46 offen offset:0 sc1
buffer_load_dwordx4 v[12:15], v6, s[4:7], s46 offen offset:2048 sc1
buffer_load_dwordx4 v[16:19], v6, s[4:7], s47 offen offset:0 sc1
buffer_load_dwordx4 v[20:23], v6, s[4:7], s47 offen offset:2048 sc1
v_and_b32 v32, 16, v1
v_lshlrev_b32 v32, v32, s57
v_cndmask_b32 v24, 0, v32, s[64:65]
v_cndmask_b32 v25, 0, v32, s[66:67]
v_cndmask_b32 v26, 0, v32, s[68:69]
v_cndmask_b32 v27, 0, v32, s[70:71]
v_mov_b32 v37, -1
v_mov_b32 v38, s32
s_waitcnt vmcnt(3)
v_mfma_f32_16x16x32_bf16 v[28:31], v[8:11], v[24:27], 0
v_bitop3_b32 v32, v8, v10, s34 bitop3:0x7e
s_waitcnt vmcnt(2)
v_mfma_f32_16x16x32_bf16 v[28:31], v[12:15], v[24:27], v[28:31]
v_bitop3_b32 v33, v12, v14, s34 bitop3:0x7e
v_or_b32 v32, v32, v33
s_waitcnt vmcnt(1)
v_mfma_f32_16x16x32_bf16 v[28:31], v[16:19], v[24:27], v[28:31]
v_bitop3_b32 v33, v16, v18, s34 bitop3:0x7e
v_or_b32 v32, v32, v33
s_waitcnt vmcnt(0)
v_mfma_f32_16x16x32_bf16 v[28:31], v[20:23], v[24:27], v[28:31]
v_bitop3_b32 v33, v20, v22, s34 bitop3:0x7e
v_bitop3_b32 v32, v32, v33, 1 bitop3:0xa8
v_cmp_ne_u32 vcc, 0, v32
s_nop 3
s_cbranch_vccnz L_gretry12_s
L_gback12_s:
v_permlane32_swap_b32 v28, v30
v_permlane32_swap_b32 v29, v31
v_pk_add_f32 v[28:29], v[28:29], v[30:31]
v_mov_b64 v[30:31], v[28:29]
s_nop 1
v_permlane16_swap_b32 v28, v30
v_permlane16_swap_b32 v29, v31
v_pk_add_f32 v[28:29], v[28:29], v[30:31]
v_cvt_pk_bf16_f32 v28, v28, v29
v_min_u32 v28, -2, v28
buffer_store_dword v28, v7, s[4:7], s39 offen sc1
s_barrier
buffer_store_dword v28, v7, s[4:7], s41 offen sc1
buffer_store_dword v37, v7, s[4:7], s40 offen sc1
s_not_b32 s34, s34
v_lshrrev_b32 v6, 2, v1
s_nop 15
s_nop 15
s_nop 7
s_branch L_step12_s
L_aretry12_s:
buffer_load_dwordx4 v[48:51], v1, s[4:7], s35 offen sc1
s_waitcnt vmcnt(3)
v_max3_u32 v32, v52, v53, v54
v_max_u32 v32, v32, v55
v_cmp_eq_u32 vcc, -1, v32
s_cbranch_vccz L_aw012_s
buffer_load_dwordx4 v[52:55], v1, s[4:7], s35 offen sc1
s_waitcnt vmcnt(3)
v_max3_u32 v32, v44, v45, v46
v_max_u32 v32, v32, v47
v_cmp_eq_u32 vcc, -1, v32
s_cbranch_vccz L_aw112_s
buffer_load_dwordx4 v[44:47], v1, s[4:7], s35 offen sc1
s_waitcnt vmcnt(3)
v_max3_u32 v32, v40, v41, v42
v_max_u32 v32, v32, v43
v_cmp_eq_u32 vcc, -1, v32
s_cbranch_vccz L_aw212_s
buffer_load_dwordx4 v[40:43], v1, s[4:7], s35 offen sc1
s_waitcnt vmcnt(3)
v_max3_u32 v32, v48, v49, v50
v_max_u32 v32, v32, v51
v_cmp_eq_u32 vcc, -1, v32
s_cbranch_vccz L_aw312_s
s_add_u32 s27, s27, 1
s_cmp_gt_u32 s27, 262144
s_cbranch_scc0 L_aretry12_s
s_branch L_fail_s
L_aw012_s:
ds_write_b128 v1, v[52:55] offset:1024
s_branch L_aback12_s
L_aw112_s:
ds_write_b128 v1, v[44:47] offset:1024
s_branch L_aback12_s
L_aw212_s:
ds_write_b128 v1, v[40:43] offset:1024
s_branch L_aback12_s
L_aw312_s:
ds_write_b128 v1, v[48:51] offset:1024
s_branch L_aback12_s
L_fretry12_s:
s_waitcnt lgkmcnt(0)
buffer_load_dword v44, v6, s[4:7], s36 offen sc1
s_add_u32 s27, s27, 1
s_cmp_gt_u32 s27, 262144
s_cbranch_scc1 L_fail_s
s_waitcnt vmcnt(0)
ds_write_b32 v6, v44 offset:4352
v_cmp_eq_u32 vcc, -1, v44
s_waitcnt lgkmcnt(0)
s_cbranch_vccnz L_fretry12_s
s_branch L_fback12_s
L_bretry12_s:
s_waitcnt lgkmcnt(0)
buffer_load_dwordx4 v[48:51], v1, s[4:7], s37 offen sc1
buffer_load_dword v52, v6, s[4:7], s38 offen sc1
s_add_u32 s27, s27, 1
s_cmp_gt_u32 s27, 262144
s_cbranch_scc1 L_fail_s
s_waitcnt vmcnt(0)
ds_write_b128 v1, v[48:51] offset:6144
ds_write_b32 v6, v52 offset:9472
v_max3_u32 v53, v48, v49, v50
v_max3_u32 v53, v53, v51, v52
v_cmp_eq_u32 vcc, -1, v53
s_waitcnt lgkmcnt(0)
s_cbranch_vccnz L_bretry12_s
s_branch L_bback12_s
L_last12_s:
s_waitcnt vmcnt(0) lgkmcnt(0)
s_barrier
s_endpgm
L_sretry12_s:
s_waitcnt lgkmcnt(0)
s_sub_u32 s3, s59, 2048
v_add_u32 v6, s3, v1
ds_read_b64_tr_b16 v[8:9], v4 offset:10240
ds_read_b64_tr_b16 v[10:11], v4 offset:12288
ds_read_b64_tr_b16 v[12:13], v4 offset:10752
ds_read_b64_tr_b16 v[14:15], v4 offset:12800
ds_read_b64_tr_b16 v[16:17], v4 offset:11264
ds_read_b64_tr_b16 v[18:19], v4 offset:13312
ds_read_b64_tr_b16 v[20:21], v4 offset:11776
ds_read_b64_tr_b16 v[22:23], v4 offset:13824
s_waitcnt lgkmcnt(6)
v_mfma_f32_16x16x32_bf16 v[52:55], v[8:11], v[8:11], 0
s_waitcnt lgkmcnt(4)
v_mfma_f32_16x16x32_bf16 v[52:55], v[12:15], v[12:15], v[52:55]
s_waitcnt lgkmcnt(2)
v_mfma_f32_16x16x32_bf16 v[52:55], v[16:19], v[16:19], v[52:55]
s_waitcnt lgkmcnt(0)
v_mfma_f32_16x16x32_bf16 v[52:55], v[20:23], v[20:23], v[52:55]
ds_read_b128 v[64:67], v6 offset:0
ds_read_b128 v[68:71], v6 offset:1024
ds_read_b128 v[40:43], v6 offset:2048
ds_read_b128 v[44:47], v6 offset:3072
s_waitcnt lgkmcnt(3)
v_mfma_f32_16x16x32_bf16 v[48:51], v[64:67], v[8:11], 0
s_waitcnt lgkmcnt(2)
v_mfma_f32_16x16x32_bf16 v[48:51], v[68:71], v[12:15], v[48:51]
s_waitcnt lgkmcnt(1)
v_mfma_f32_16x16x32_bf16 v[48:51], v[40:43], v[16:19], v[48:51]
s_waitcnt lgkmcnt(0)
v_mfma_f32_16x16x32_bf16 v[48:51], v[44:47], v[20:23], v[48:51]
ds_read_b128 v[64:67], v6 offset:4096
ds_read_b128 v[68:71], v6 offset:5120
ds_read_b128 v[40:43], v6 offset:6144
ds_read_b128 v[44:47], v6 offset:7168
s_waitcnt lgkmcnt(3)
v_mfma_f32_16x16x32_bf16 v[32:35], v[64:67], v[8:11], 0
s_waitcnt lgkmcnt(2)
v_mfma_f32_16x16x32_bf16 v[32:35], v[68:71], v[12:15], v[32:35]
s_waitcnt lgkmcnt(1)
v_mfma_f32_16x16x32_bf16 v[32:35], v[40:43], v[16:19], v[32:35]
s_waitcnt lgkmcnt(0)
v_mfma_f32_16x16x32_bf16 v[32:35], v[44:47], v[20:23], v[32:35]
v_max3_f32 v52, v54, v55, v48
v_max3_f32 v52, v52, v49, v50
s_nop 5
v_max3_f32 v52, v52, v51, v32
v_max3_f32 v52, v52, v33, v34
v_max_f32 v52, v52, v35
v_mov_b32 v53, v52
s_nop 1
v_permlane32_swap_b32 v52, v53
v_max_f32 v52, v52, v53
v_mov_b32 v53, v52
s_nop 1
v_permlane16_swap_b32 v52, v53
v_max_f32 v52, v52, v53
v_sub_f32 v54, v54, v52
v_sub_f32 v55, v55, v52
v_sub_f32 v48, v48, v52
v_sub_f32 v49, v49, v52
v_sub_f32 v50, v50, v52
v_sub_f32 v51, v51, v52
v_sub_f32 v32, v32, v52
v_sub_f32 v33, v33, v52
v_sub_f32 v34, v34, v52
v_sub_f32 v35, v35, v52
v_exp_f32 v54, v54
v_exp_f32 v55, v55
v_exp_f32 v48, v48
v_exp_f32 v49, v49
v_exp_f32 v50, v50
v_exp_f32 v51, v51
v_exp_f32 v32, v32
v_exp_f32 v33, v33
v_exp_f32 v34, v34
v_exp_f32 v35, v35
v_cvt_pk_bf16_f32 v28, v54, v55
v_cvt_pk_bf16_f32 v31, v54, v55
v_cvt_pk_bf16_f32 v36, v48, v49
v_cvt_pk_bf16_f32 v37, v50, v51
v_cvt_pk_bf16_f32 v38, v32, v33
v_cvt_pk_bf16_f32 v39, v34, v35
v_mfma_f32_16x16x16_bf16 v[52:55], v[28:29], v[26:27], 0
v_mfma_f32_16x16x16_bf16 v[44:47], v[28:29], v[24:25], 0
v_mfma_f32_16x16x16_bf16 v[40:43], v[30:31], v[24:25], 0
v_mfma_f32_16x16x16_bf16 v[52:55], v[36:37], v[26:27], v[52:55]
v_mfma_f32_16x16x16_bf16 v[52:55], v[38:39], v[26:27], v[52:55]
v_mfma_f32_16x16x32_bf16 v[44:47], v[36:39], v[56:59], v[44:47]
v_mfma_f32_16x16x32_bf16 v[40:43], v[36:39], v[60:63], v[40:43]
ds_read_b128 v[8:11], v2 offset:41984
ds_read_b128 v[12:15], v2 offset:46080
ds_read_b128 v[16:19], v1 offset:41984
ds_read_b128 v[20:23], v1 offset:46080
ds_read_b128 v[64:67], v1 offset:50176
ds_read_b128 v[68:71], v1 offset:54272
v_rcp_f32 v52, v52
v_rcp_f32 v53, v53
v_subrev_u32 v54, 562036736, v52
v_mul_f32 v44, v44, v52
v_mul_f32 v45, v45, v53
v_cvt_pk_bf16_f32 v48, v44, v45
v_cvt_pk_bf16_f32 v49, v44, v45
ds_write_b64 v3, v[48:49] offset:5632
v_pk_mul_f32 v[40:41], v[40:41], v[52:53]
v_cvt_pk_bf16_f32 v50, v40, v41
v_cvt_pk_bf16_f32 v51, v40, v41
ds_write_b64 v3, v[50:51] offset:7680
v_mov_b64 v[40:41], 0
v_mov_b64 v[42:43], 0
v_mov_b64 v[44:45], 0
v_mov_b64 v[46:47], 0
v_mov_b64 v[52:53], 0
v_mov_b64 v[54:55], 0
s_waitcnt lgkmcnt(0)
s_branch L_sback12_s
L_gretry12_s:
buffer_load_dwordx4 v[64:67], v6, s[4:7], s46 offen offset:0 sc1
buffer_load_dwordx4 v[68:71], v6, s[4:7], s46 offen offset:2048 sc1
buffer_load_dwordx4 v[56:59], v6, s[4:7], s47 offen offset:0 sc1
buffer_load_dwordx4 v[60:63], v6, s[4:7], s47 offen offset:2048 sc1
s_nop 15
s_nop 8
L_gloop12_s:
buffer_load_dwordx4 v[8:11], v6, s[4:7], s46 offen offset:0 sc1
buffer_load_dwordx4 v[12:15], v6, s[4:7], s46 offen offset:2048 sc1
buffer_load_dwordx4 v[16:19], v6, s[4:7], s47 offen offset:0 sc1
buffer_load_dwordx4 v[20:23], v6, s[4:7], s47 offen offset:2048 sc1
s_add_u32 s27, s27, 1
s_waitcnt vmcnt(7)
v_mfma_f32_16x16x32_bf16 v[28:31], v[64:67], v[24:27], 0
v_bitop3_b32 v32, v64, v66, s34 bitop3:0x7e
s_waitcnt vmcnt(6)
v_mfma_f32_16x16x32_bf16 v[28:31], v[68:71], v[24:27], v[28:31]
v_bitop3_b32 v33, v68, v70, s34 bitop3:0x7e
v_or_b32 v32, v32, v33
s_waitcnt vmcnt(5)
v_mfma_f32_16x16x32_bf16 v[28:31], v[56:59], v[24:27], v[28:31]
v_bitop3_b32 v33, v56, v58, s34 bitop3:0x7e
v_or_b32 v32, v32, v33
s_waitcnt vmcnt(4)
v_mfma_f32_16x16x32_bf16 v[28:31], v[60:63], v[24:27], v[28:31]
v_bitop3_b32 v33, v60, v62, s34 bitop3:0x7e
v_bitop3_b32 v32, v32, v33, 1 bitop3:0xa8
v_cmp_ne_u32 vcc, 0, v32
s_nop 3
s_cbranch_vccz L_gback12_s
buffer_load_dwordx4 v[64:67], v6, s[4:7], s46 offen offset:0 sc1
buffer_load_dwordx4 v[68:71], v6, s[4:7], s46 offen offset:2048 sc1
buffer_load_dwordx4 v[56:59], v6, s[4:7], s47 offen offset:0 sc1
buffer_load_dwordx4 v[60:63], v6, s[4:7], s47 offen offset:2048 sc1
s_add_u32 s27, s27, 1
s_waitcnt vmcnt(7)
v_mfma_f32_16x16x32_bf16 v[28:31], v[8:11], v[24:27], 0
v_bitop3_b32 v32, v8, v10, s34 bitop3:0x7e
s_waitcnt vmcnt(6)
v_mfma_f32_16x16x32_bf16 v[28:31], v[12:15], v[24:27], v[28:31]
v_bitop3_b32 v33, v12, v14, s34 bitop3:0x7e
v_or_b32 v32, v32, v33
s_waitcnt vmcnt(5)
v_mfma_f32_16x16x32_bf16 v[28:31], v[16:19], v[24:27], v[28:31]
v_bitop3_b32 v33, v16, v18, s34 bitop3:0x7e
v_or_b32 v32, v32, v33
s_waitcnt vmcnt(4)
v_mfma_f32_16x16x32_bf16 v[28:31], v[20:23], v[24:27], v[28:31]
v_bitop3_b32 v33, v20, v22, s34 bitop3:0x7e
v_bitop3_b32 v32, v32, v33, 1 bitop3:0xa8
v_cmp_ne_u32 vcc, 0, v32
s_nop 3
s_cbranch_vccz L_gback12_s
s_cmp_gt_u32 s27, 262144
s_cbranch_scc0 L_gloop12_s
s_branch L_fail_s
L_rw2_s:
v_lshrrev_b32 v6, 2, v1
ds_read_b128 v[56:59], v1 offset:36864
ds_read_b128 v[60:63], v1 offset:37888
ds_read_b128 v[64:67], v2 offset:10240
ds_read_b128 v[68:71], v2 offset:14336
v_mov_b64 v[8:9], 0
v_mov_b64 v[10:11], 0
v_mov_b64 v[12:13], 0
v_mov_b64 v[14:15], 0
v_mov_b64 v[16:17], 0
v_mov_b64 v[18:19], 0
v_mov_b64 v[20:21], 0
v_mov_b64 v[22:23], 0
v_mov_b64 v[24:25], 0
v_mov_b64 v[26:27], 0
v_mov_b64 v[28:29], 0
v_mov_b64 v[30:31], 0
v_mov_b32 v7, 0
s_mov_b32 s41, 0x40000000
.p2align 6
L_step20_s:
buffer_load_dwordx4 v[48:51], v1, s[4:7], s35 offen sc1
s_nop 15
s_nop 0
buffer_load_dwordx4 v[52:55], v1, s[4:7], s35 offen sc1
s_nop 15
s_nop 0
buffer_load_dwordx4 v[44:47], v1, s[4:7], s35 offen sc1
s_nop 15
s_nop 0
buffer_load_dwordx4 v[40:43], v1, s[4:7], s35 offen sc1
s_waitcnt vmcnt(3)
ds_write_b128 v1, v[48:51] offset:2048
v_max3_u32 v32, v48, v49, v50
v_max_u32 v32, v32, v51
v_cmp_eq_u32 vcc, -1, v32
s_cbranch_vccnz L_aretry20_s
L_aback20_s:
buffer_load_dword v44, v6, s[4:7], s36 offen sc1
s_waitcnt lgkmcnt(0)
s_barrier
ds_read_b128 v[32:35], v1 offset:0
buffer_load_dwordx4 v[48:51], v1, s[4:7], s37 offen sc1
buffer_load_dword v52, v6, s[4:7], s38 offen sc1
ds_read_b128 v[36:39], v1 offset:1024
s_waitcnt lgkmcnt(1)
v_smfmac_f32_16x16x64_bf16 v[8:11], v[32:35], v[64:71], v0
ds_read_b128 v[64:67], v2 offset:18432
ds_read_b128 v[68:71], v2 offset:22528
v_smfmac_f32_16x16x64_bf16 v[16:19], v[32:35], v[72:79], v0
s_mul_i32 s3, s52, 5120
s_add_u32 s40, s60, s3
s_add_u32 s52, s52, 1
v_smfmac_f32_16x16x64_bf16 v[20:23], v[32:35], v[80:87], v0
v_smfmac_f32_16x16x64_bf16 v[24:27], v[32:35], a[64:71], v0
v_smfmac_f32_16x16x64_bf16 v[28:31], v[32:35], a[72:79], v0
s_waitcnt lgkmcnt(0)
v_smfmac_f32_16x16x64_bf16 v[12:15], v[32:35], v[64:71], v0
ds_read_b128 v[64:67], v2 offset:26624
ds_read_b128 v[68:71], v2 offset:30720
v_smfmac_f32_16x16x64_bf16 v[8:11], v[36:39], v[208:215], v0
s_and_b32 s52, s52, 3
s_xor_b32 s30, s52, 2
s_lshl_b32 s30, s30, 15
v_smfmac_f32_16x16x64_bf16 v[12:15], v[36:39], v[216:223], v0
s_waitcnt vmcnt(3)
ds_read_b128 v[40:43], v1 offset:2048
v_smfmac_f32_16x16x64_bf16 v[16:19], v[36:39], v[88:95], v0
s_mul_i32 s3, s52, 5120
s_add_u32 s39, s60, s3
s_lshl_b32 s31, s52, 15
v_smfmac_f32_16x16x64_bf16 v[20:23], v[36:39], v[96:103], v0
ds_read_b128 v[32:35], v1 offset:3072
s_add_u32 s42, s61, s30
v_smfmac_f32_16x16x64_bf16 v[24:27], v[36:39], a[80:87], v0
s_waitcnt vmcnt(2)
ds_write_b32 v6, v44 offset:4608
v_cmp_eq_u32 vcc, -1, v44
v_smfmac_f32_16x16x64_bf16 v[28:31], v[36:39], a[88:95], v0
buffer_store_dword v7, off, s[4:7], s55 sc1
s_waitcnt lgkmcnt(2)
v_smfmac_f32_16x16x64_bf16 v[8:11], v[40:43], v[64:71], v0
ds_read_b128 v[64:67], v2 offset:34816
ds_read_b128 v[68:71], v2 offset:38912
s_cbranch_vccnz L_fretry20_s
L_fback20_s:
v_smfmac_f32_16x16x64_bf16 v[16:19], v[40:43], v[104:111], v0
v_smfmac_f32_16x16x64_bf16 v[20:23], v[40:43], v[112:119], v0
s_add_u32 s41, s61, s31
s_add_u32 s31, s31, s62
s_add_u32 s35, s39, 2048
v_smfmac_f32_16x16x64_bf16 v[24:27], v[40:43], a[96:103], v0
s_waitcnt lgkmcnt(2)
s_barrier
v_smfmac_f32_16x16x64_bf16 v[28:31], v[40:43], a[104:111], v0
s_waitcnt lgkmcnt(0)
v_smfmac_f32_16x16x64_bf16 v[12:15], v[40:43], v[64:71], v0
ds_read_b128 v[64:67], v2 offset:51200
ds_read_b128 v[68:71], v2 offset:55296
v_smfmac_f32_16x16x64_bf16 v[8:11], v[32:35], v[224:231], v0
ds_read_b128 v[36:39], v1 offset:4096
v_smfmac_f32_16x16x64_bf16 v[12:15], v[32:35], v[232:239], v0
s_add_u32 s36, s39, 4608
v_smfmac_f32_16x16x64_bf16 v[16:19], v[32:35], v[120:127], v0
s_waitcnt vmcnt(2)
ds_write_b128 v1, v[48:51] offset:7168
s_add_u32 s58, s32, 3
s_min_u32 s58, s58, 64
v_max3_u32 v53, v48, v49, v50
v_smfmac_f32_16x16x64_bf16 v[20:23], v[32:35], v[128:135], v0
s_waitcnt vmcnt(1)
ds_write_b32 v6, v52 offset:9728
s_mov_b32 m0, s59
s_xor_b32 s59, s59, 8192
v_max3_u32 v53, v53, v51, v52
s_waitcnt lgkmcnt(3)
v_smfmac_f32_16x16x64_bf16 v[24:27], v[32:35], v[64:71], v0
ds_read_b128 v[64:67], v2 offset:59392
ds_read_b128 v[68:71], v2 offset:63488
v_cmp_eq_u32 vcc, -1, v53
v_smfmac_f32_16x16x64_bf16 v[28:31], v[32:35], a[112:119], v0
s_waitcnt lgkmcnt(4)
v_smfmac_f32_16x16x64_bf16 v[8:11], v[36:39], v[240:247], v0
s_cbranch_vccnz L_bretry20_s
L_bback20_s:
v_add_u32 v2, 0x10000, v2
v_smfmac_f32_16x16x64_bf16 v[12:15], v[36:39], v[248:255], v0
s_waitcnt lgkmcnt(2)
s_barrier
ds_read_b128 v[40:43], v1 offset:5120
v_smfmac_f32_16x16x64_bf16 v[16:19], v[36:39], v[136:143], v0
ds_read_b128 v[44:47], v1 offset:6144
buffer_load_dwordx4 v1, s[4:7], s48 offen sc1 lds
s_waitcnt lgkmcnt(2)
v_smfmac_f32_16x16x64_bf16 v[20:23], v[36:39], v[64:71], v0
ds_read_b128 v[64:67], v2 offset:2048
ds_read_b128 v[68:71], v2 offset:6144
v_smfmac_f32_16x16x64_bf16 v[24:27], v[36:39], a[120:127], v0
ds_read_b128 v[32:35], v1 offset:7168
buffer_load_dwordx4 v1, s[4:7], s48 offen offset:1024 sc1 lds
s_mov_b32 m0, 36864
v_smfmac_f32_16x16x64_bf16 v[28:31], v[36:39], a[128:135], v0
ds_read_b128 v[48:51], v1 offset:8192
s_waitcnt lgkmcnt(5)
v_smfmac_f32_16x16x64_bf16 v[8:11], v[40:43], a[0:7], v0
ds_read_b128 v[36:39], v1 offset:9216
v_smfmac_f32_16x16x64_bf16 v[12:15], v[40:43], a[8:15], v0
buffer_load_dwordx4 v1, s[4:7], s49 offen sc1 lds
s_waitcnt lgkmcnt(3)
v_smfmac_f32_16x16x64_bf16 v[8:11], v[44:47], v[64:71], v0
ds_read_b128 v[64:67], v2 offset:10240
ds_read_b128 v[68:71], v2 offset:14336
v_smfmac_f32_16x16x64_bf16 v[12:15], v[44:47], a[16:23], v0
buffer_load_dwordx4 v1, s[4:7], s49 offen offset:1024 sc1 lds
s_waitcnt lgkmcnt(4)
v_smfmac_f32_16x16x64_bf16 v[8:11], v[32:35], a[24:31], v0
s_cmp_eq_u32 s32, 62
s_cselect_b32 s11, 0x40000000, s12
s_waitcnt lgkmcnt(3)
v_smfmac_f32_16x16x64_bf16 v[8:11], v[48:51], a[32:39], v0
s_waitcnt lgkmcnt(2)
v_smfmac_f32_16x16x64_bf16 v[8:11], v[36:39], a[48:55], v0
s_add_u32 s37, s31, 2048
s_add_u32 s38, s31, 4608
s_waitcnt lgkmcnt(0)
v_smfmac_f32_16x16x64_bf16 v[12:15], v[32:35], v[64:71], v0
ds_read_b128 v[64:67], v2 offset:18432
ds_read_b128 v[68:71], v2 offset:22528
v_smfmac_f32_16x16x64_bf16 v[12:15], v[48:51], a[40:47], v0
s_sub_u32 s3, s59, 4096
v_add_u32 v6, s3, v1
v_smfmac_f32_16x16x64_bf16 v[12:15], v[36:39], a[56:63], v0
s_add_u32 s48, s48, s11
s_add_u32 s49, s49, s11
v_add_f32 v8, v8, v10
v_smfmac_f32_16x16x64_bf16 v[16:19], v[40:43], v[144:151], v0
v_add_f32 v9, v9, v11
v_smfmac_f32_16x16x64_bf16 v[16:19], v[44:47], v[160:167], v0
v_mul_f32 v8, s56, v8
s_waitcnt lgkmcnt(0)
v_smfmac_f32_16x16x64_bf16 v[16:19], v[32:35], v[64:71], v0
ds_read_b128 v[64:67], v2 offset:26624
ds_read_b128 v[68:71], v2 offset:30720
v_mul_f32 v9, s56, v9
v_smfmac_f32_16x16x64_bf16 v[16:19], v[48:51], v[176:183], v0
s_add_u32 s50, s50, 16384
s_add_u32 s51, s51, 16384
v_add_f32 v12, v12, v14
v_smfmac_f32_16x16x64_bf16 v[16:19], v[36:39], v[192:199], v0
s_nop 1
v_add_f32 v13, v13, v15
v_smfmac_f32_16x16x64_bf16 v[20:23], v[40:43], v[152:159], v0
s_nop 1
v_mul_f32 v12, s56, v12
v_smfmac_f32_16x16x64_bf16 v[20:23], v[44:47], v[168:175], v0
v_mul_f32 v13, s56, v13
s_waitcnt lgkmcnt(0)
v_smfmac_f32_16x16x64_bf16 v[20:23], v[32:35], v[64:71], v0
ds_read_b128 v[64:67], v6 offset:0
v_add_f32 v16, v16, v18
v_smfmac_f32_16x16x64_bf16 v[20:23], v[48:51], v[184:191], v0
s_cmp_eq_u32 s32, 63
ds_read_b128 v[68:71], v6 offset:1024
v_add_f32 v17, v17, v19
v_smfmac_f32_16x16x64_bf16 v[20:23], v[36:39], v[200:207], v0
s_nop 1
v_cvt_pk_bf16_f32 v53, v8, v9
v_cvt_pk_bf16_f32 v52, v16, v17
v_smfmac_f32_16x16x64_bf16 v[24:27], v[32:35], a[168:175], v0
s_nop 0
ds_write_b64 v3, v[52:53] offset:11264
v_cvt_pk_bf16_f32 v55, v12, v13
v_add_f32 v20, v20, v22
v_add_f32 v21, v21, v23
v_cvt_pk_bf16_f32 v54, v20, v21
ds_write_b64 v3, v[54:55] offset:13312
v_smfmac_f32_16x16x64_bf16 v[28:31], v[32:35], a[176:183], v0
v_smfmac_f32_16x16x64_bf16 v[24:27], v[36:39], a[200:207], v0
ds_read_b128 v[32:35], v6 offset:2048
v_add_u32 v2, 0x10000, v1
v_smfmac_f32_16x16x64_bf16 v[28:31], v[36:39], a[208:215], v0
v_smfmac_f32_16x16x64_bf16 v[24:27], v[44:47], a[152:159], v0
s_waitcnt lgkmcnt(1)
s_barrier
ds_read_b64_tr_b16 v[8:9], v4 offset:10240
ds_read_b64_tr_b16 v[10:11], v4 offset:12288
v_smfmac_f32_16x16x64_bf16 v[28:31], v[44:47], a[160:167], v0
ds_read_b64_tr_b16 v[12:13], v4 offset:10752
ds_read_b64_tr_b16 v[14:15], v4 offset:12800
v_smfmac_f32_16x16x64_bf16 v[24:27], v[40:43], a[136:143], v0
ds_read_b64_tr_b16 v[16:17], v4 offset:11264
ds_read_b64_tr_b16 v[18:19], v4 offset:13312
v_smfmac_f32_16x16x64_bf16 v[28:31], v[40:43], a[144:151], v0
ds_read_b64_tr_b16 v[20:21], v4 offset:11776
ds_read_b64_tr_b16 v[22:23], v4 offset:13824
v_smfmac_f32_16x16x64_bf16 v[24:27], v[48:51], a[184:191], v0
ds_read_b128 v[36:39], v6 offset:3072
ds_read_b128 v[44:47], v6 offset:4096
v_smfmac_f32_16x16x64_bf16 v[28:31], v[48:51], a[192:199], v0
ds_read_b128 v[40:43], v6 offset:5120
s_waitcnt lgkmcnt(9)
v_mfma_f32_16x16x32_bf16 v[52:55], v[8:11], v[8:11], 0
s_waitcnt lgkmcnt(7)
v_mfma_f32_16x16x32_bf16 v[52:55], v[12:15], v[12:15], v[52:55]
s_waitcnt lgkmcnt(5)
v_add_f32 v24, v24, v26
v_add_f32 v25, v25, v27
v_mfma_f32_16x16x32_bf16 v[52:55], v[16:19], v[16:19], v[52:55]
buffer_store_dwordx4 v[16:19], v1, s[4:7], s50 offen offset:2048 sc1
s_waitcnt lgkmcnt(3)
v_add_f32 v28, v28, v30
v_add_f32 v29, v29, v31
v_mfma_f32_16x16x32_bf16 v[52:55], v[20:23], v[20:23], v[52:55]
v_cvt_pk_bf16_f32 v24, v24, v25
v_cvt_pk_bf16_f32 v25, v28, v29
v_mfma_f32_16x16x32_bf16 v[48:51], v[64:67], v[8:11], 0
ds_read_b128 v[64:67], v6 offset:6144
v_mov_b64 v[26:27], s[74:75]
v_mfma_f32_16x16x32_bf16 v[48:51], v[68:71], v[12:15], v[48:51]
ds_read_b128 v[68:71], v6 offset:7168
buffer_store_dwordx2 v[24:25], v3, s[4:7], s51 offen offset:1024 sc1
v_mov_b32 v29, 0
v_mfma_f32_16x16x32_bf16 v[48:51], v[32:35], v[16:19], v[48:51]
s_cbranch_scc1 L_last20_s
s_waitcnt lgkmcnt(4)
v_exp_f32 v54, v54
v_mfma_f32_16x16x32_bf16 v[48:51], v[36:39], v[20:23], v[48:51]
s_waitcnt lgkmcnt(3)
v_exp_f32 v55, v55
v_mfma_f32_16x16x32_bf16 v[32:35], v[44:47], v[8:11], 0
s_waitcnt lgkmcnt(2)
v_cvt_pk_bf16_f32 v28, v54, v55
v_cvt_pk_bf16_f32 v31, v54, v55
v_mfma_f32_16x16x32_bf16 v[32:35], v[40:43], v[12:15], v[32:35]
s_waitcnt lgkmcnt(1)
v_mov_b32 v30, 0
v_and_b32 v6, 0x70, v1
v_mfma_f32_16x16x32_bf16 v[32:35], v[64:67], v[16:19], v[32:35]
s_waitcnt lgkmcnt(0)
v_exp_f32 v48, v48
v_mfma_f32_16x16x32_bf16 v[32:35], v[68:71], v[20:23], v[32:35]
s_add_u32 s32, s32, 1
v_exp_f32 v49, v49
v_mfma_f32_16x16x16_bf16 v[52:55], v[28:29], v[26:27], 0
ds_read_b128 v[8:11], v2 offset:43008
v_exp_f32 v50, v50
v_mfma_f32_16x16x16_bf16 v[44:47], v[28:29], v[24:25], 0
ds_read_b128 v[12:15], v2 offset:47104
v_exp_f32 v51, v51
v_mfma_f32_16x16x16_bf16 v[40:43], v[30:31], v[24:25], 0
v_exp_f32 v32, v32
v_cvt_pk_bf16_f32 v36, v48, v49
v_cvt_pk_bf16_f32 v37, v50, v51
v_exp_f32 v33, v33
v_exp_f32 v34, v34
v_mfma_f32_16x16x16_bf16 v[52:55], v[36:37], v[26:27], v[52:55]
v_exp_f32 v35, v35
v_cvt_pk_bf16_f32 v38, v32, v33
v_cvt_pk_bf16_f32 v39, v34, v35
s_nop 1
v_mfma_f32_16x16x16_bf16 v[52:55], v[38:39], v[26:27], v[52:55]
ds_read_b128 v[16:19], v1 offset:43008
ds_read_b128 v[20:23], v1 offset:47104
v_lshlrev_b32 v6, 3, v6
v_mfma_f32_16x16x32_bf16 v[44:47], v[36:39], v[56:59], v[44:47]
ds_read_b128 v[64:67], v1 offset:51200
ds_read_b128 v[68:71], v1 offset:55296
v_mov_b32 v7, s32
v_mfma_f32_16x16x32_bf16 v[40:43], v[36:39], v[60:63], v[40:43]
v_rcp_f32 v52, v52
v_rcp_f32 v53, v53
v_subrev_u32 v54, 562036736, v52
s_nop 0
v_mul_f32 v44, v44, v52
v_mul_f32 v45, v45, v53
v_cvt_pk_bf16_f32 v48, v44, v45
v_cvt_pk_bf16_f32 v49, v44, v45
ds_write_b64 v3, v[48:49] offset:6144
v_pk_mul_f32 v[40:41], v[40:41], v[52:53]
v_cvt_pk_bf16_f32 v50, v40, v41
v_cvt_pk_bf16_f32 v51, v40, v41
ds_write_b64 v3, v[50:51] offset:8192
v_subrev_u32 v53, 562036736, v53
v_max_u32 v52, v54, v53
v_cmp_le_u32 vcc, s63, v52
v_mov_b64 v[52:53], 0
v_mov_b64 v[54:55], 0
v_mov_b64 v[40:41], 0
v_mov_b64 v[42:43], 0
s_cbranch_vccnz L_sretry20_s
L_sback20_s:
s_mov_b64 exec, 0xff
s_waitcnt lgkmcnt(0)
s_barrier
buffer_store_dword v7, v6, s[4:7], s8 offen sc1
s_mov_b64 exec, -1
ds_read_b64_tr_b16 v[32:33], v4 offset:6144
ds_read_b64_tr_b16 v[34:35], v4 offset:8192
ds_read_b64_tr_b16 v[36:37], v4 offset:6656
ds_read_b64_tr_b16 v[38:39], v4 offset:8704
ds_read_b64_tr_b16 v[24:25], v4 offset:5120
ds_read_b64_tr_b16 v[26:27], v4 offset:7168
s_waitcnt lgkmcnt(4)
v_smfmac_f32_16x16x64_bf16 v[52:55], v[32:35], v[8:15], v0
ds_read_b64_tr_b16 v[28:29], v4 offset:5632
ds_read_b64_tr_b16 v[30:31], v4 offset:7680
s_waitcnt lgkmcnt(4)
v_mov_b64 v[44:45], 0
v_smfmac_f32_16x16x64_bf16 v[52:55], v[36:39], a[248:255], v0
s_waitcnt lgkmcnt(2)
v_mov_b64 v[46:47], 0
v_smfmac_f32_16x16x64_bf16 v[40:43], v[24:27], v[16:23], v0
ds_read_b128 v[56:59], v1 offset:59392
ds_read_b128 v[60:63], v1 offset:63488
s_waitcnt lgkmcnt(2)
v_smfmac_f32_16x16x64_bf16 v[40:43], v[28:31], v[64:71], v0
ds_read_b128 v[8:11], v2 offset:2048
ds_read_b128 v[12:15], v2 offset:6144
v_cvt_pk_bf16_f32 v52, v52, v53
v_smfmac_f32_16x16x64_bf16 v[40:43], v[32:35], a[216:223], v0
v_cvt_pk_bf16_f32 v53, v54, v55
v_and_or_b32 v52, v52, -2, s33
v_smfmac_f32_16x16x64_bf16 v[40:43], v[36:39], a[224:231], v0
buffer_store_dwordx2 v[52:53], v5, s[4:7], s45 offen sc1
s_nop 0
v_smfmac_f32_16x16x64_bf16 v[44:47], v[24:27], a[232:239], v0
s_nop 1
v_smfmac_f32_16x16x64_bf16 v[44:47], v[28:31], a[240:247], v0
s_waitcnt lgkmcnt(2)
s_nop 0
v_cvt_pk_bf16_f32 v40, v40, v41
v_smfmac_f32_16x16x64_bf16 v[44:47], v[32:35], v[56:63], v0
s_waitcnt lgkmcnt(0)
v_cvt_pk_bf16_f32 v41, v42, v43
v_and_or_b32 v40, v40, -2, s33
v_smfmac_f32_16x16x64_bf16 v[44:47], v[36:39], v[8:15], v0
buffer_store_dwordx2 v[40:41], v5, s[4:7], s43 offen sc1
s_nop 6
v_cvt_pk_bf16_f32 v44, v44, v45
v_cvt_pk_bf16_f32 v45, v46, v47
v_and_or_b32 v44, v44, -2, s33
buffer_store_dwordx2 v[44:45], v5, s[4:7], s44 offen sc1
s_xor_b32 s33, s33, 1
s_barrier
s_waitcnt vmcnt(0)
ds_read_b128 v[56:59], v1 offset:36864
ds_read_b128 v[60:63], v1 offset:37888
ds_read_b128 v[64:67], v2 offset:10240
ds_read_b128 v[68:71], v2 offset:14336
v_mov_b64 v[8:9], 0
v_mov_b64 v[10:11], 0
v_mov_b64 v[12:13], 0
v_mov_b64 v[14:15], 0
v_mov_b64 v[16:17], 0
v_mov_b64 v[18:19], 0
v_mov_b64 v[20:21], 0
v_mov_b64 v[22:23], 0
v_mov_b64 v[24:25], 0
v_mov_b64 v[26:27], 0
v_mov_b64 v[28:29], 0
v_mov_b64 v[30:31], 0
v_mov_b32 v7, s32
s_barrier
v_lshrrev_b32 v6, 2, v1
s_nop 15
s_nop 15
s_nop 9
s_branch L_step20_s
L_aretry20_s:
buffer_load_dwordx4 v[48:51], v1, s[4:7], s35 offen sc1
s_waitcnt vmcnt(3)
v_max3_u32 v32, v52, v53, v54
v_max_u32 v32, v32, v55
v_cmp_eq_u32 vcc, -1, v32
s_cbranch_vccz L_aw020_s
buffer_load_dwordx4 v[52:55], v1, s[4:7], s35 offen sc1
s_waitcnt vmcnt(3)
v_max3_u32 v32, v44, v45, v46
v_max_u32 v32, v32, v47
v_cmp_eq_u32 vcc, -1, v32
s_cbranch_vccz L_aw120_s
buffer_load_dwordx4 v[44:47], v1, s[4:7], s35 offen sc1
s_waitcnt vmcnt(3)
v_max3_u32 v32, v40, v41, v42
v_max_u32 v32, v32, v43
v_cmp_eq_u32 vcc, -1, v32
s_cbranch_vccz L_aw220_s
buffer_load_dwordx4 v[40:43], v1, s[4:7], s35 offen sc1
s_waitcnt vmcnt(3)
v_max3_u32 v32, v48, v49, v50
v_max_u32 v32, v32, v51
v_cmp_eq_u32 vcc, -1, v32
s_cbranch_vccz L_aw320_s
s_add_u32 s27, s27, 1
s_cmp_gt_u32 s27, 262144
s_cbranch_scc0 L_aretry20_s
s_branch L_fail_s
L_aw020_s:
ds_write_b128 v1, v[52:55] offset:2048
s_branch L_aback20_s
L_aw120_s:
ds_write_b128 v1, v[44:47] offset:2048
s_branch L_aback20_s
L_aw220_s:
ds_write_b128 v1, v[40:43] offset:2048
s_branch L_aback20_s
L_aw320_s:
ds_write_b128 v1, v[48:51] offset:2048
s_branch L_aback20_s
L_fretry20_s:
s_waitcnt lgkmcnt(0)
buffer_load_dword v44, v6, s[4:7], s36 offen sc1
s_add_u32 s27, s27, 1
s_cmp_gt_u32 s27, 262144
s_cbranch_scc1 L_fail_s
s_waitcnt vmcnt(0)
ds_write_b32 v6, v44 offset:4608
v_cmp_eq_u32 vcc, -1, v44
s_waitcnt lgkmcnt(0)
s_cbranch_vccnz L_fretry20_s
s_branch L_fback20_s
L_bretry20_s:
s_waitcnt lgkmcnt(0)
buffer_load_dwordx4 v[48:51], v1, s[4:7], s37 offen sc1
buffer_load_dword v52, v6, s[4:7], s38 offen sc1
s_add_u32 s27, s27, 1
s_cmp_gt_u32 s27, 262144
s_cbranch_scc1 L_fail_s
s_waitcnt vmcnt(0)
ds_write_b128 v1, v[48:51] offset:7168
ds_write_b32 v6, v52 offset:9728
v_max3_u32 v53, v48, v49, v50
v_max3_u32 v53, v53, v51, v52
v_cmp_eq_u32 vcc, -1, v53
s_waitcnt lgkmcnt(0)
s_cbranch_vccnz L_bretry20_s
s_branch L_bback20_s
L_last20_s:
s_waitcnt vmcnt(0) lgkmcnt(0)
s_barrier
v_mov_b32 v7, 64
buffer_store_dword v7, off, s[4:7], s55 sc1
s_endpgm
L_sretry20_s:
s_waitcnt lgkmcnt(0)
s_sub_u32 s3, s59, 4096
v_add_u32 v6, s3, v1
ds_read_b64_tr_b16 v[8:9], v4 offset:10240
ds_read_b64_tr_b16 v[10:11], v4 offset:12288
ds_read_b64_tr_b16 v[12:13], v4 offset:10752
ds_read_b64_tr_b16 v[14:15], v4 offset:12800
ds_read_b64_tr_b16 v[16:17], v4 offset:11264
ds_read_b64_tr_b16 v[18:19], v4 offset:13312
ds_read_b64_tr_b16 v[20:21], v4 offset:11776
ds_read_b64_tr_b16 v[22:23], v4 offset:13824
s_waitcnt lgkmcnt(6)
v_mfma_f32_16x16x32_bf16 v[52:55], v[8:11], v[8:11], 0
s_waitcnt lgkmcnt(4)
v_mfma_f32_16x16x32_bf16 v[52:55], v[12:15], v[12:15], v[52:55]
s_waitcnt lgkmcnt(2)
v_mfma_f32_16x16x32_bf16 v[52:55], v[16:19], v[16:19], v[52:55]
s_waitcnt lgkmcnt(0)
v_mfma_f32_16x16x32_bf16 v[52:55], v[20:23], v[20:23], v[52:55]
ds_read_b128 v[64:67], v6 offset:0
ds_read_b128 v[68:71], v6 offset:1024
ds_read_b128 v[40:43], v6 offset:2048
ds_read_b128 v[44:47], v6 offset:3072
s_waitcnt lgkmcnt(3)
v_mfma_f32_16x16x32_bf16 v[48:51], v[64:67], v[8:11], 0
s_waitcnt lgkmcnt(2)
v_mfma_f32_16x16x32_bf16 v[48:51], v[68:71], v[12:15], v[48:51]
s_waitcnt lgkmcnt(1)
v_mfma_f32_16x16x32_bf16 v[48:51], v[40:43], v[16:19], v[48:51]
s_waitcnt lgkmcnt(0)
v_mfma_f32_16x16x32_bf16 v[48:51], v[44:47], v[20:23], v[48:51]
ds_read_b128 v[64:67], v6 offset:4096
ds_read_b128 v[68:71], v6 offset:5120
ds_read_b128 v[40:43], v6 offset:6144
ds_read_b128 v[44:47], v6 offset:7168
s_waitcnt lgkmcnt(3)
v_mfma_f32_16x16x32_bf16 v[32:35], v[64:67], v[8:11], 0
s_waitcnt lgkmcnt(2)
v_mfma_f32_16x16x32_bf16 v[32:35], v[68:71], v[12:15], v[32:35]
s_waitcnt lgkmcnt(1)
v_mfma_f32_16x16x32_bf16 v[32:35], v[40:43], v[16:19], v[32:35]
s_waitcnt lgkmcnt(0)
v_mfma_f32_16x16x32_bf16 v[32:35], v[44:47], v[20:23], v[32:35]
v_max3_f32 v52, v54, v55, v48
v_max3_f32 v52, v52, v49, v50
s_nop 5
v_max3_f32 v52, v52, v51, v32
v_max3_f32 v52, v52, v33, v34
v_max_f32 v52, v52, v35
v_mov_b32 v53, v52
s_nop 1
v_permlane32_swap_b32 v52, v53
v_max_f32 v52, v52, v53
v_mov_b32 v53, v52
s_nop 1
v_permlane16_swap_b32 v52, v53
v_max_f32 v52, v52, v53
v_sub_f32 v54, v54, v52
v_sub_f32 v55, v55, v52
v_sub_f32 v48, v48, v52
v_sub_f32 v49, v49, v52
v_sub_f32 v50, v50, v52
v_sub_f32 v51, v51, v52
v_sub_f32 v32, v32, v52
v_sub_f32 v33, v33, v52
v_sub_f32 v34, v34, v52
v_sub_f32 v35, v35, v52
v_exp_f32 v54, v54
v_exp_f32 v55, v55
v_exp_f32 v48, v48
v_exp_f32 v49, v49
v_exp_f32 v50, v50
v_exp_f32 v51, v51
v_exp_f32 v32, v32
v_exp_f32 v33, v33
v_exp_f32 v34, v34
v_exp_f32 v35, v35
v_cvt_pk_bf16_f32 v28, v54, v55
v_cvt_pk_bf16_f32 v31, v54, v55
v_cvt_pk_bf16_f32 v36, v48, v49
v_cvt_pk_bf16_f32 v37, v50, v51
v_cvt_pk_bf16_f32 v38, v32, v33
v_cvt_pk_bf16_f32 v39, v34, v35
v_mfma_f32_16x16x16_bf16 v[52:55], v[28:29], v[26:27], 0
v_mfma_f32_16x16x16_bf16 v[44:47], v[28:29], v[24:25], 0
v_mfma_f32_16x16x16_bf16 v[40:43], v[30:31], v[24:25], 0
v_mfma_f32_16x16x16_bf16 v[52:55], v[36:37], v[26:27], v[52:55]
v_mfma_f32_16x16x16_bf16 v[52:55], v[38:39], v[26:27], v[52:55]
v_mfma_f32_16x16x32_bf16 v[44:47], v[36:39], v[56:59], v[44:47]
v_mfma_f32_16x16x32_bf16 v[40:43], v[36:39], v[60:63], v[40:43]
ds_read_b128 v[8:11], v2 offset:43008
ds_read_b128 v[12:15], v2 offset:47104
ds_read_b128 v[16:19], v1 offset:43008
ds_read_b128 v[20:23], v1 offset:47104
ds_read_b128 v[64:67], v1 offset:51200
ds_read_b128 v[68:71], v1 offset:55296
v_and_b32 v6, 0x70, v1
v_lshlrev_b32 v6, 3, v6
v_mov_b32 v7, s32
v_rcp_f32 v52, v52
v_rcp_f32 v53, v53
v_subrev_u32 v54, 562036736, v52
v_mul_f32 v44, v44, v52
v_mul_f32 v45, v45, v53
v_cvt_pk_bf16_f32 v48, v44, v45
v_cvt_pk_bf16_f32 v49, v44, v45
ds_write_b64 v3, v[48:49] offset:6144
v_pk_mul_f32 v[40:41], v[40:41], v[52:53]
v_cvt_pk_bf16_f32 v50, v40, v41
v_cvt_pk_bf16_f32 v51, v40, v41
ds_write_b64 v3, v[50:51] offset:8192
v_mov_b64 v[40:41], 0
v_mov_b64 v[42:43], 0
v_mov_b64 v[44:45], 0
v_mov_b64 v[46:47], 0
v_mov_b64 v[52:53], 0
v_mov_b64 v[54:55], 0
s_waitcnt lgkmcnt(0)
s_branch L_sback20_s
L_rw3_s:
v_lshrrev_b32 v6, 2, v1
ds_read_b128 v[56:59], v1 offset:38912
ds_read_b128 v[60:63], v1 offset:39936
ds_read_b128 v[64:67], v2 offset:11264
ds_read_b128 v[68:71], v2 offset:15360
v_mov_b64 v[8:9], 0
v_mov_b64 v[10:11], 0
v_mov_b64 v[12:13], 0
v_mov_b64 v[14:15], 0
v_mov_b64 v[16:17], 0
v_mov_b64 v[18:19], 0
v_mov_b64 v[20:21], 0
v_mov_b64 v[22:23], 0
v_mov_b64 v[24:25], 0
v_mov_b64 v[26:27], 0
v_mov_b64 v[28:29], 0
v_mov_b64 v[30:31], 0
s_mov_b32 s41, 0x40000000
.p2align 6
L_step30_s:
buffer_load_dwordx4 v[48:51], v1, s[4:7], s35 offen sc1
s_nop 15
s_nop 0
buffer_load_dwordx4 v[52:55], v1, s[4:7], s35 offen sc1
s_nop 15
s_nop 0
buffer_load_dwordx4 v[44:47], v1, s[4:7], s35 offen sc1
s_nop 15
s_nop 0
buffer_load_dwordx4 v[40:43], v1, s[4:7], s35 offen sc1
s_waitcnt vmcnt(3)
ds_write_b128 v1, v[48:51] offset:3072
v_max3_u32 v32, v48, v49, v50
v_max_u32 v32, v32, v51
v_cmp_eq_u32 vcc, -1, v32
s_cbranch_vccnz L_aretry30_s
L_aback30_s:
buffer_load_dword v44, v6, s[4:7], s36 offen sc1
s_waitcnt lgkmcnt(0)
s_barrier
ds_read_b128 v[32:35], v1 offset:0
buffer_load_dwordx4 v[48:51], v1, s[4:7], s37 offen sc1
buffer_load_dword v52, v6, s[4:7], s38 offen sc1
ds_read_b128 v[36:39], v1 offset:1024
s_waitcnt lgkmcnt(1)
v_smfmac_f32_16x16x64_bf16 v[8:11], v[32:35], v[64:71], v0
ds_read_b128 v[64:67], v2 offset:19456
ds_read_b128 v[68:71], v2 offset:23552
v_smfmac_f32_16x16x64_bf16 v[16:19], v[32:35], v[72:79], v0
s_mul_i32 s3, s52, 5120
s_add_u32 s40, s60, s3
s_add_u32 s52, s52, 1
v_smfmac_f32_16x16x64_bf16 v[20:23], v[32:35], v[80:87], v0
v_smfmac_f32_16x16x64_bf16 v[24:27], v[32:35], a[64:71], v0
v_smfmac_f32_16x16x64_bf16 v[28:31], v[32:35], a[72:79], v0
s_waitcnt lgkmcnt(0)
v_smfmac_f32_16x16x64_bf16 v[12:15], v[32:35], v[64:71], v0
ds_read_b128 v[64:67], v2 offset:27648
ds_read_b128 v[68:71], v2 offset:31744
v_smfmac_f32_16x16x64_bf16 v[8:11], v[36:39], v[208:215], v0
s_and_b32 s52, s52, 3
s_xor_b32 s30, s52, 2
s_lshl_b32 s30, s30, 15
v_smfmac_f32_16x16x64_bf16 v[12:15], v[36:39], v[216:223], v0
s_waitcnt vmcnt(3)
ds_read_b128 v[40:43], v1 offset:2048
v_smfmac_f32_16x16x64_bf16 v[16:19], v[36:39], v[88:95], v0
s_mul_i32 s3, s52, 5120
s_add_u32 s39, s60, s3
s_lshl_b32 s31, s52, 15
v_smfmac_f32_16x16x64_bf16 v[20:23], v[36:39], v[96:103], v0
ds_read_b128 v[32:35], v1 offset:3072
s_add_u32 s42, s61, s30
v_smfmac_f32_16x16x64_bf16 v[24:27], v[36:39], a[80:87], v0
s_waitcnt vmcnt(2)
ds_write_b32 v6, v44 offset:4864
v_cmp_eq_u32 vcc, -1, v44
v_smfmac_f32_16x16x64_bf16 v[28:31], v[36:39], a[88:95], v0
s_waitcnt lgkmcnt(2)
v_smfmac_f32_16x16x64_bf16 v[8:11], v[40:43], v[64:71], v0
ds_read_b128 v[64:67], v2 offset:35840
ds_read_b128 v[68:71], v2 offset:39936
s_cbranch_vccnz L_fretry30_s
L_fback30_s:
v_smfmac_f32_16x16x64_bf16 v[16:19], v[40:43], v[104:111], v0
v_smfmac_f32_16x16x64_bf16 v[20:23], v[40:43], v[112:119], v0
s_add_u32 s41, s61, s31
s_add_u32 s31, s31, s62
s_add_u32 s35, s39, 3072
v_smfmac_f32_16x16x64_bf16 v[24:27], v[40:43], a[96:103], v0
s_waitcnt lgkmcnt(2)
s_barrier
v_smfmac_f32_16x16x64_bf16 v[28:31], v[40:43], a[104:111], v0
s_waitcnt lgkmcnt(0)
v_smfmac_f32_16x16x64_bf16 v[12:15], v[40:43], v[64:71], v0
ds_read_b128 v[64:67], v2 offset:52224
ds_read_b128 v[68:71], v2 offset:56320
v_smfmac_f32_16x16x64_bf16 v[8:11], v[32:35], v[224:231], v0
ds_read_b128 v[36:39], v1 offset:4096
v_bfe_u32 v7, v1, 2, 5
v_smfmac_f32_16x16x64_bf16 v[12:15], v[32:35], v[232:239], v0
s_add_u32 s36, s39, 4864
v_smfmac_f32_16x16x64_bf16 v[16:19], v[32:35], v[120:127], v0
s_waitcnt vmcnt(1)
ds_write_b128 v1, v[48:51] offset:8192
s_add_u32 s58, s32, 3
s_min_u32 s58, s58, 64
v_max3_u32 v53, v48, v49, v50
v_smfmac_f32_16x16x64_bf16 v[20:23], v[32:35], v[128:135], v0
s_waitcnt vmcnt(0)
ds_write_b32 v6, v52 offset:9984
s_mov_b32 m0, s59
s_xor_b32 s59, s59, 8192
v_max3_u32 v53, v53, v51, v52
s_waitcnt lgkmcnt(3)
v_smfmac_f32_16x16x64_bf16 v[24:27], v[32:35], v[64:71], v0
ds_read_b128 v[64:67], v2 offset:60416
ds_read_b128 v[68:71], v2 offset:64512
v_cmp_eq_u32 vcc, -1, v53
v_smfmac_f32_16x16x64_bf16 v[28:31], v[32:35], a[112:119], v0
s_waitcnt lgkmcnt(4)
v_smfmac_f32_16x16x64_bf16 v[8:11], v[36:39], v[240:247], v0
s_cbranch_vccnz L_bretry30_s
L_bback30_s:
v_add_u32 v2, 0x10000, v2
v_smfmac_f32_16x16x64_bf16 v[12:15], v[36:39], v[248:255], v0
s_waitcnt lgkmcnt(2)
s_barrier
ds_read_b128 v[40:43], v1 offset:5120
v_smfmac_f32_16x16x64_bf16 v[16:19], v[36:39], v[136:143], v0
ds_read_b128 v[44:47], v1 offset:6144
buffer_load_dwordx4 v1, s[4:7], s48 offen sc1 lds
s_waitcnt lgkmcnt(2)
v_smfmac_f32_16x16x64_bf16 v[20:23], v[36:39], v[64:71], v0
ds_read_b128 v[64:67], v2 offset:3072
ds_read_b128 v[68:71], v2 offset:7168
v_smfmac_f32_16x16x64_bf16 v[24:27], v[36:39], a[120:127], v0
ds_read_b128 v[32:35], v1 offset:7168
buffer_load_dwordx4 v1, s[4:7], s48 offen offset:1024 sc1 lds
s_mov_b32 m0, 38912
v_smfmac_f32_16x16x64_bf16 v[28:31], v[36:39], a[128:135], v0
ds_read_b128 v[48:51], v1 offset:8192
s_waitcnt lgkmcnt(5)
v_smfmac_f32_16x16x64_bf16 v[8:11], v[40:43], a[0:7], v0
ds_read_b128 v[36:39], v1 offset:9216
v_smfmac_f32_16x16x64_bf16 v[12:15], v[40:43], a[8:15], v0
buffer_load_dwordx4 v1, s[4:7], s49 offen sc1 lds
s_waitcnt lgkmcnt(3)
v_smfmac_f32_16x16x64_bf16 v[8:11], v[44:47], v[64:71], v0
ds_read_b128 v[64:67], v2 offset:11264
ds_read_b128 v[68:71], v2 offset:15360
v_smfmac_f32_16x16x64_bf16 v[12:15], v[44:47], a[16:23], v0
buffer_load_dwordx4 v1, s[4:7], s49 offen offset:1024 sc1 lds
s_waitcnt lgkmcnt(4)
v_smfmac_f32_16x16x64_bf16 v[8:11], v[32:35], a[24:31], v0
s_cmp_eq_u32 s32, 62
s_cselect_b32 s11, 0x40000000, s12
s_waitcnt lgkmcnt(3)
v_smfmac_f32_16x16x64_bf16 v[8:11], v[48:51], a[32:39], v0
s_waitcnt lgkmcnt(2)
v_smfmac_f32_16x16x64_bf16 v[8:11], v[36:39], a[48:55], v0
s_add_u32 s37, s31, 3072
s_add_u32 s38, s31, 4864
s_waitcnt lgkmcnt(0)
v_smfmac_f32_16x16x64_bf16 v[12:15], v[32:35], v[64:71], v0
ds_read_b128 v[64:67], v2 offset:19456
ds_read_b128 v[68:71], v2 offset:23552
v_smfmac_f32_16x16x64_bf16 v[12:15], v[48:51], a[40:47], v0
buffer_load_dword v7, v7, s[4:7], s54 offen sc1
s_sub_u32 s3, s59, 6144
v_add_u32 v6, s3, v1
v_smfmac_f32_16x16x64_bf16 v[12:15], v[36:39], a[56:63], v0
s_add_u32 s48, s48, s11
s_add_u32 s49, s49, s11
v_add_f32 v8, v8, v10
v_smfmac_f32_16x16x64_bf16 v[16:19], v[40:43], v[144:151], v0
v_add_f32 v9, v9, v11
v_smfmac_f32_16x16x64_bf16 v[16:19], v[44:47], v[160:167], v0
v_mul_f32 v8, s56, v8
s_waitcnt lgkmcnt(0)
v_smfmac_f32_16x16x64_bf16 v[16:19], v[32:35], v[64:71], v0
ds_read_b128 v[64:67], v2 offset:27648
ds_read_b128 v[68:71], v2 offset:31744
v_mul_f32 v9, s56, v9
v_smfmac_f32_16x16x64_bf16 v[16:19], v[48:51], v[176:183], v0
s_add_u32 s50, s50, 16384
s_add_u32 s51, s51, 16384
v_add_f32 v12, v12, v14
v_smfmac_f32_16x16x64_bf16 v[16:19], v[36:39], v[192:199], v0
s_nop 1
v_add_f32 v13, v13, v15
v_smfmac_f32_16x16x64_bf16 v[20:23], v[40:43], v[152:159], v0
s_nop 1
v_mul_f32 v12, s56, v12
v_smfmac_f32_16x16x64_bf16 v[20:23], v[44:47], v[168:175], v0
v_mul_f32 v13, s56, v13
s_waitcnt lgkmcnt(0)
v_smfmac_f32_16x16x64_bf16 v[20:23], v[32:35], v[64:71], v0
ds_read_b128 v[64:67], v6 offset:0
v_add_f32 v16, v16, v18
v_smfmac_f32_16x16x64_bf16 v[20:23], v[48:51], v[184:191], v0
s_cmp_eq_u32 s32, 63
ds_read_b128 v[68:71], v6 offset:1024
v_add_f32 v17, v17, v19
v_smfmac_f32_16x16x64_bf16 v[20:23], v[36:39], v[200:207], v0
s_nop 1
v_cvt_pk_bf16_f32 v53, v8, v9
v_cvt_pk_bf16_f32 v52, v16, v17
v_smfmac_f32_16x16x64_bf16 v[24:27], v[32:35], a[168:175], v0
s_nop 0
ds_write_b64 v3, v[52:53] offset:11776
v_cvt_pk_bf16_f32 v55, v12, v13
v_add_f32 v20, v20, v22
v_add_f32 v21, v21, v23
v_cvt_pk_bf16_f32 v54, v20, v21
ds_write_b64 v3, v[54:55] offset:13824
v_smfmac_f32_16x16x64_bf16 v[28:31], v[32:35], a[176:183], v0
v_smfmac_f32_16x16x64_bf16 v[24:27], v[36:39], a[200:207], v0
ds_read_b128 v[32:35], v6 offset:2048
v_add_u32 v2, 0x10000, v1
v_smfmac_f32_16x16x64_bf16 v[28:31], v[36:39], a[208:215], v0
v_smfmac_f32_16x16x64_bf16 v[24:27], v[44:47], a[152:159], v0
s_waitcnt lgkmcnt(1)
s_barrier
ds_read_b64_tr_b16 v[8:9], v4 offset:10240
ds_read_b64_tr_b16 v[10:11], v4 offset:12288
v_smfmac_f32_16x16x64_bf16 v[28:31], v[44:47], a[160:167], v0
ds_read_b64_tr_b16 v[12:13], v4 offset:10752
ds_read_b64_tr_b16 v[14:15], v4 offset:12800
v_smfmac_f32_16x16x64_bf16 v[24:27], v[40:43], a[136:143], v0
ds_read_b64_tr_b16 v[16:17], v4 offset:11264
ds_read_b64_tr_b16 v[18:19], v4 offset:13312
v_smfmac_f32_16x16x64_bf16 v[28:31], v[40:43], a[144:151], v0
ds_read_b64_tr_b16 v[20:21], v4 offset:11776
ds_read_b64_tr_b16 v[22:23], v4 offset:13824
v_smfmac_f32_16x16x64_bf16 v[24:27], v[48:51], a[184:191], v0
ds_read_b128 v[36:39], v6 offset:3072
ds_read_b128 v[44:47], v6 offset:4096
v_smfmac_f32_16x16x64_bf16 v[28:31], v[48:51], a[192:199], v0
ds_read_b128 v[40:43], v6 offset:5120
s_waitcnt lgkmcnt(9)
v_mfma_f32_16x16x32_bf16 v[52:55], v[8:11], v[8:11], 0
s_waitcnt lgkmcnt(7)
v_mfma_f32_16x16x32_bf16 v[52:55], v[12:15], v[12:15], v[52:55]
s_waitcnt lgkmcnt(5)
v_add_f32 v24, v24, v26
v_add_f32 v25, v25, v27
v_mfma_f32_16x16x32_bf16 v[52:55], v[16:19], v[16:19], v[52:55]
s_waitcnt lgkmcnt(3)
v_add_f32 v28, v28, v30
v_add_f32 v29, v29, v31
v_mfma_f32_16x16x32_bf16 v[52:55], v[20:23], v[20:23], v[52:55]
buffer_store_dwordx4 v[20:23], v1, s[4:7], s50 offen offset:3072 sc1
v_cvt_pk_bf16_f32 v24, v24, v25
v_cvt_pk_bf16_f32 v25, v28, v29
v_mfma_f32_16x16x32_bf16 v[48:51], v[64:67], v[8:11], 0
ds_read_b128 v[64:67], v6 offset:6144
v_mov_b64 v[26:27], s[74:75]
v_mfma_f32_16x16x32_bf16 v[48:51], v[68:71], v[12:15], v[48:51]
ds_read_b128 v[68:71], v6 offset:7168
buffer_store_dwordx2 v[24:25], v3, s[4:7], s51 offen offset:1536 sc1
v_mov_b32 v29, 0
v_mfma_f32_16x16x32_bf16 v[48:51], v[32:35], v[16:19], v[48:51]
s_cbranch_scc1 L_last30_s
s_waitcnt lgkmcnt(4)
v_exp_f32 v54, v54
v_mfma_f32_16x16x32_bf16 v[48:51], v[36:39], v[20:23], v[48:51]
s_waitcnt lgkmcnt(3)
v_exp_f32 v55, v55
v_mfma_f32_16x16x32_bf16 v[32:35], v[44:47], v[8:11], 0
s_waitcnt lgkmcnt(2)
v_cvt_pk_bf16_f32 v28, v54, v55
v_cvt_pk_bf16_f32 v31, v54, v55
v_mfma_f32_16x16x32_bf16 v[32:35], v[40:43], v[12:15], v[32:35]
s_waitcnt lgkmcnt(1)
v_mov_b32 v30, 0
v_mfma_f32_16x16x32_bf16 v[32:35], v[64:67], v[16:19], v[32:35]
s_waitcnt lgkmcnt(0)
v_exp_f32 v48, v48
v_mfma_f32_16x16x32_bf16 v[32:35], v[68:71], v[20:23], v[32:35]
s_add_u32 s32, s32, 1
v_exp_f32 v49, v49
v_mfma_f32_16x16x16_bf16 v[52:55], v[28:29], v[26:27], 0
ds_read_b128 v[8:11], v2 offset:44032
v_exp_f32 v50, v50
v_mfma_f32_16x16x16_bf16 v[44:47], v[28:29], v[24:25], 0
ds_read_b128 v[12:15], v2 offset:48128
v_exp_f32 v51, v51
v_mfma_f32_16x16x16_bf16 v[40:43], v[30:31], v[24:25], 0
v_exp_f32 v32, v32
v_cvt_pk_bf16_f32 v36, v48, v49
v_cvt_pk_bf16_f32 v37, v50, v51
v_exp_f32 v33, v33
v_exp_f32 v34, v34
v_mfma_f32_16x16x16_bf16 v[52:55], v[36:37], v[26:27], v[52:55]
v_exp_f32 v35, v35
v_cvt_pk_bf16_f32 v38, v32, v33
v_cvt_pk_bf16_f32 v39, v34, v35
s_nop 1
v_mfma_f32_16x16x16_bf16 v[52:55], v[38:39], v[26:27], v[52:55]
ds_read_b128 v[16:19], v1 offset:44032
ds_read_b128 v[20:23], v1 offset:48128
v_mfma_f32_16x16x32_bf16 v[44:47], v[36:39], v[56:59], v[44:47]
ds_read_b128 v[64:67], v1 offset:52224
ds_read_b128 v[68:71], v1 offset:56320
v_mfma_f32_16x16x32_bf16 v[40:43], v[36:39], v[60:63], v[40:43]
s_nop 1
v_rcp_f32 v52, v52
v_rcp_f32 v53, v53
v_subrev_u32 v54, 562036736, v52
v_mul_f32 v44, v44, v52
v_mul_f32 v45, v45, v53
v_cvt_pk_bf16_f32 v48, v44, v45
v_cvt_pk_bf16_f32 v49, v44, v45
ds_write_b64 v3, v[48:49] offset:6656
v_pk_mul_f32 v[40:41], v[40:41], v[52:53]
v_cvt_pk_bf16_f32 v50, v40, v41
v_cvt_pk_bf16_f32 v51, v40, v41
ds_write_b64 v3, v[50:51] offset:8704
v_subrev_u32 v53, 562036736, v53
v_max_u32 v52, v54, v53
v_cmp_le_u32 vcc, s63, v52
v_mov_b64 v[52:53], 0
v_mov_b64 v[54:55], 0
v_mov_b64 v[40:41], 0
v_mov_b64 v[42:43], 0
s_cbranch_vccnz L_sretry30_s
L_sback30_s:
s_waitcnt lgkmcnt(0)
s_barrier
ds_read_b64_tr_b16 v[32:33], v4 offset:6144
ds_read_b64_tr_b16 v[34:35], v4 offset:8192
ds_read_b64_tr_b16 v[36:37], v4 offset:6656
ds_read_b64_tr_b16 v[38:39], v4 offset:8704
ds_read_b64_tr_b16 v[24:25], v4 offset:5120
ds_read_b64_tr_b16 v[26:27], v4 offset:7168
s_waitcnt lgkmcnt(4)
v_smfmac_f32_16x16x64_bf16 v[52:55], v[32:35], v[8:15], v0
ds_read_b64_tr_b16 v[28:29], v4 offset:5632
ds_read_b64_tr_b16 v[30:31], v4 offset:7680
s_waitcnt lgkmcnt(4)
v_mov_b64 v[44:45], 0
v_smfmac_f32_16x16x64_bf16 v[52:55], v[36:39], a[248:255], v0
s_waitcnt lgkmcnt(2)
v_mov_b64 v[46:47], 0
v_smfmac_f32_16x16x64_bf16 v[40:43], v[24:27], v[16:23], v0
ds_read_b128 v[56:59], v1 offset:60416
ds_read_b128 v[60:63], v1 offset:64512
s_waitcnt lgkmcnt(2)
v_smfmac_f32_16x16x64_bf16 v[40:43], v[28:31], v[64:71], v0
ds_read_b128 v[8:11], v2 offset:3072
ds_read_b128 v[12:15], v2 offset:7168
v_cvt_pk_bf16_f32 v52, v52, v53
v_smfmac_f32_16x16x64_bf16 v[40:43], v[32:35], a[216:223], v0
v_cvt_pk_bf16_f32 v53, v54, v55
v_and_or_b32 v52, v52, -2, s33
v_smfmac_f32_16x16x64_bf16 v[40:43], v[36:39], a[224:231], v0
buffer_store_dwordx2 v[52:53], v5, s[4:7], s45 offen sc1
s_nop 0
v_smfmac_f32_16x16x64_bf16 v[44:47], v[24:27], a[232:239], v0
s_nop 1
v_smfmac_f32_16x16x64_bf16 v[44:47], v[28:31], a[240:247], v0
s_waitcnt lgkmcnt(2)
s_nop 0
v_cvt_pk_bf16_f32 v40, v40, v41
v_smfmac_f32_16x16x64_bf16 v[44:47], v[32:35], v[56:63], v0
s_waitcnt lgkmcnt(0)
v_cvt_pk_bf16_f32 v41, v42, v43
v_and_or_b32 v40, v40, -2, s33
v_smfmac_f32_16x16x64_bf16 v[44:47], v[36:39], v[8:15], v0
buffer_store_dwordx2 v[40:41], v5, s[4:7], s43 offen sc1
s_nop 6
v_cvt_pk_bf16_f32 v44, v44, v45
v_cvt_pk_bf16_f32 v45, v46, v47
v_and_or_b32 v44, v44, -2, s33
buffer_store_dwordx2 v[44:45], v5, s[4:7], s44 offen sc1
s_xor_b32 s33, s33, 1
s_barrier
s_waitcnt vmcnt(0)
ds_read_b128 v[56:59], v1 offset:38912
ds_read_b128 v[60:63], v1 offset:39936
ds_read_b128 v[64:67], v2 offset:11264
ds_read_b128 v[68:71], v2 offset:15360
v_mov_b64 v[8:9], 0
v_mov_b64 v[10:11], 0
v_mov_b64 v[12:13], 0
v_mov_b64 v[14:15], 0
v_mov_b64 v[16:17], 0
v_mov_b64 v[18:19], 0
v_mov_b64 v[20:21], 0
v_mov_b64 v[22:23], 0
v_mov_b64 v[24:25], 0
v_mov_b64 v[26:27], 0
v_mov_b64 v[28:29], 0
v_mov_b64 v[30:31], 0
v_cmp_gt_u32 vcc, s58, v7
s_cbranch_vccnz L_kretry30_s
L_kback30_s:
s_barrier
v_lshrrev_b32 v6, 2, v1
s_nop 15
s_nop 15
s_nop 9
s_branch L_step30_s
L_aretry30_s:
buffer_load_dwordx4 v[48:51], v1, s[4:7], s35 offen sc1
s_waitcnt vmcnt(3)
v_max3_u32 v32, v52, v53, v54
v_max_u32 v32, v32, v55
v_cmp_eq_u32 vcc, -1, v32
s_cbranch_vccz L_aw030_s
buffer_load_dwordx4 v[52:55], v1, s[4:7], s35 offen sc1
s_waitcnt vmcnt(3)
v_max3_u32 v32, v44, v45, v46
v_max_u32 v32, v32, v47
v_cmp_eq_u32 vcc, -1, v32
s_cbranch_vccz L_aw130_s
buffer_load_dwordx4 v[44:47], v1, s[4:7], s35 offen sc1
s_waitcnt vmcnt(3)
v_max3_u32 v32, v40, v41, v42
v_max_u32 v32, v32, v43
v_cmp_eq_u32 vcc, -1, v32
s_cbranch_vccz L_aw230_s
buffer_load_dwordx4 v[40:43], v1, s[4:7], s35 offen sc1
s_waitcnt vmcnt(3)
v_max3_u32 v32, v48, v49, v50
v_max_u32 v32, v32, v51
v_cmp_eq_u32 vcc, -1, v32
s_cbranch_vccz L_aw330_s
s_add_u32 s27, s27, 1
s_cmp_gt_u32 s27, 262144
s_cbranch_scc0 L_aretry30_s
s_branch L_fail_s
L_aw030_s:
ds_write_b128 v1, v[52:55] offset:3072
s_branch L_aback30_s
L_aw130_s:
ds_write_b128 v1, v[44:47] offset:3072
s_branch L_aback30_s
L_aw230_s:
ds_write_b128 v1, v[40:43] offset:3072
s_branch L_aback30_s
L_aw330_s:
ds_write_b128 v1, v[48:51] offset:3072
s_branch L_aback30_s
L_fretry30_s:
s_waitcnt lgkmcnt(0)
buffer_load_dword v44, v6, s[4:7], s36 offen sc1
s_add_u32 s27, s27, 1
s_cmp_gt_u32 s27, 262144
s_cbranch_scc1 L_fail_s
s_waitcnt vmcnt(0)
ds_write_b32 v6, v44 offset:4864
v_cmp_eq_u32 vcc, -1, v44
s_waitcnt lgkmcnt(0)
s_cbranch_vccnz L_fretry30_s
s_branch L_fback30_s
L_bretry30_s:
s_waitcnt lgkmcnt(0)
buffer_load_dwordx4 v[48:51], v1, s[4:7], s37 offen sc1
buffer_load_dword v52, v6, s[4:7], s38 offen sc1
s_add_u32 s27, s27, 1
s_cmp_gt_u32 s27, 262144
s_cbranch_scc1 L_fail_s
s_waitcnt vmcnt(0)
ds_write_b128 v1, v[48:51] offset:8192
ds_write_b32 v6, v52 offset:9984
v_max3_u32 v53, v48, v49, v50
v_max3_u32 v53, v53, v51, v52
v_cmp_eq_u32 vcc, -1, v53
s_waitcnt lgkmcnt(0)
s_cbranch_vccnz L_bretry30_s
s_branch L_bback30_s
L_last30_s:
s_waitcnt vmcnt(0) lgkmcnt(0)
s_barrier
s_endpgm
L_sretry30_s:
s_waitcnt lgkmcnt(0)
s_sub_u32 s3, s59, 6144
v_add_u32 v6, s3, v1
ds_read_b64_tr_b16 v[8:9], v4 offset:10240
ds_read_b64_tr_b16 v[10:11], v4 offset:12288
ds_read_b64_tr_b16 v[12:13], v4 offset:10752
ds_read_b64_tr_b16 v[14:15], v4 offset:12800
ds_read_b64_tr_b16 v[16:17], v4 offset:11264
ds_read_b64_tr_b16 v[18:19], v4 offset:13312
ds_read_b64_tr_b16 v[20:21], v4 offset:11776
ds_read_b64_tr_b16 v[22:23], v4 offset:13824
s_waitcnt lgkmcnt(6)
v_mfma_f32_16x16x32_bf16 v[52:55], v[8:11], v[8:11], 0
s_waitcnt lgkmcnt(4)
v_mfma_f32_16x16x32_bf16 v[52:55], v[12:15], v[12:15], v[52:55]
s_waitcnt lgkmcnt(2)
v_mfma_f32_16x16x32_bf16 v[52:55], v[16:19], v[16:19], v[52:55]
s_waitcnt lgkmcnt(0)
v_mfma_f32_16x16x32_bf16 v[52:55], v[20:23], v[20:23], v[52:55]
ds_read_b128 v[64:67], v6 offset:0
ds_read_b128 v[68:71], v6 offset:1024
ds_read_b128 v[40:43], v6 offset:2048
ds_read_b128 v[44:47], v6 offset:3072
s_waitcnt lgkmcnt(3)
v_mfma_f32_16x16x32_bf16 v[48:51], v[64:67], v[8:11], 0
s_waitcnt lgkmcnt(2)
v_mfma_f32_16x16x32_bf16 v[48:51], v[68:71], v[12:15], v[48:51]
s_waitcnt lgkmcnt(1)
v_mfma_f32_16x16x32_bf16 v[48:51], v[40:43], v[16:19], v[48:51]
s_waitcnt lgkmcnt(0)
v_mfma_f32_16x16x32_bf16 v[48:51], v[44:47], v[20:23], v[48:51]
ds_read_b128 v[64:67], v6 offset:4096
ds_read_b128 v[68:71], v6 offset:5120
ds_read_b128 v[40:43], v6 offset:6144
ds_read_b128 v[44:47], v6 offset:7168
s_waitcnt lgkmcnt(3)
v_mfma_f32_16x16x32_bf16 v[32:35], v[64:67], v[8:11], 0
s_waitcnt lgkmcnt(2)
v_mfma_f32_16x16x32_bf16 v[32:35], v[68:71], v[12:15], v[32:35]
s_waitcnt lgkmcnt(1)
v_mfma_f32_16x16x32_bf16 v[32:35], v[40:43], v[16:19], v[32:35]
s_waitcnt lgkmcnt(0)
v_mfma_f32_16x16x32_bf16 v[32:35], v[44:47], v[20:23], v[32:35]
v_max3_f32 v52, v54, v55, v48
v_max3_f32 v52, v52, v49, v50
s_nop 5
v_max3_f32 v52, v52, v51, v32
v_max3_f32 v52, v52, v33, v34
v_max_f32 v52, v52, v35
v_mov_b32 v53, v52
s_nop 1
v_permlane32_swap_b32 v52, v53
v_max_f32 v52, v52, v53
v_mov_b32 v53, v52
s_nop 1
v_permlane16_swap_b32 v52, v53
v_max_f32 v52, v52, v53
v_sub_f32 v54, v54, v52
v_sub_f32 v55, v55, v52
v_sub_f32 v48, v48, v52
v_sub_f32 v49, v49, v52
v_sub_f32 v50, v50, v52
v_sub_f32 v51, v51, v52
v_sub_f32 v32, v32, v52
v_sub_f32 v33, v33, v52
v_sub_f32 v34, v34, v52
v_sub_f32 v35, v35, v52
v_exp_f32 v54, v54
v_exp_f32 v55, v55
v_exp_f32 v48, v48
v_exp_f32 v49, v49
v_exp_f32 v50, v50
v_exp_f32 v51, v51
v_exp_f32 v32, v32
v_exp_f32 v33, v33
v_exp_f32 v34, v34
v_exp_f32 v35, v35
v_cvt_pk_bf16_f32 v28, v54, v55
v_cvt_pk_bf16_f32 v31, v54, v55
v_cvt_pk_bf16_f32 v36, v48, v49
v_cvt_pk_bf16_f32 v37, v50, v51
v_cvt_pk_bf16_f32 v38, v32, v33
v_cvt_pk_bf16_f32 v39, v34, v35
v_mfma_f32_16x16x16_bf16 v[52:55], v[28:29], v[26:27], 0
v_mfma_f32_16x16x16_bf16 v[44:47], v[28:29], v[24:25], 0
v_mfma_f32_16x16x16_bf16 v[40:43], v[30:31], v[24:25], 0
v_mfma_f32_16x16x16_bf16 v[52:55], v[36:37], v[26:27], v[52:55]
v_mfma_f32_16x16x16_bf16 v[52:55], v[38:39], v[26:27], v[52:55]
v_mfma_f32_16x16x32_bf16 v[44:47], v[36:39], v[56:59], v[44:47]
v_mfma_f32_16x16x32_bf16 v[40:43], v[36:39], v[60:63], v[40:43]
ds_read_b128 v[8:11], v2 offset:44032
ds_read_b128 v[12:15], v2 offset:48128
ds_read_b128 v[16:19], v1 offset:44032
ds_read_b128 v[20:23], v1 offset:48128
ds_read_b128 v[64:67], v1 offset:52224
ds_read_b128 v[68:71], v1 offset:56320
v_rcp_f32 v52, v52
v_rcp_f32 v53, v53
v_subrev_u32 v54, 562036736, v52
v_mul_f32 v44, v44, v52
v_mul_f32 v45, v45, v53
v_cvt_pk_bf16_f32 v48, v44, v45
v_cvt_pk_bf16_f32 v49, v44, v45
ds_write_b64 v3, v[48:49] offset:6656
v_pk_mul_f32 v[40:41], v[40:41], v[52:53]
v_cvt_pk_bf16_f32 v50, v40, v41
v_cvt_pk_bf16_f32 v51, v40, v41
ds_write_b64 v3, v[50:51] offset:8704
v_mov_b64 v[40:41], 0
v_mov_b64 v[42:43], 0
v_mov_b64 v[44:45], 0
v_mov_b64 v[46:47], 0
v_mov_b64 v[52:53], 0
v_mov_b64 v[54:55], 0
s_waitcnt lgkmcnt(0)
s_branch L_sback30_s
L_kretry30_s:
s_add_u32 s27, s27, 1
s_cmp_gt_u32 s27, 262144
s_cbranch_scc1 L_fail_s
v_bfe_u32 v7, v1, 2, 5
buffer_load_dword v7, v7, s[4:7], s54 offen sc1
s_waitcnt vmcnt(0)
v_cmp_gt_u32 vcc, s58, v7
s_cbranch_vccnz L_kretry30_s
s_branch L_kback30_s
L_role_p_s:
s_mov_b32 s8, s64
s_mov_b32 s9, s65
s_mov_b32 s10, 2621440
s_mov_b32 s11, 0x20000
s_mov_b32 s12, s88
s_mov_b32 s13, s89
s_mov_b32 s14, 4915200
s_mov_b32 s15, 0x20000
s_mov_b32 s16, s86
s_mov_b32 s17, s87
s_mov_b32 s18, 1280
s_mov_b32 s19, 0x20000
v_mbcnt_lo_u32_b32 v0, -1, 0
v_mbcnt_hi_u32_b32 v0, -1, v0
s_sub_u32 s3, s24, 4
s_lshl_b32 s32, s3, 5
s_add_u32 s32, s32, s25
s_mul_i32 s41, s3, 1536
s_add_u32 s41, s41, 12288
s_lshl_b32 s30, s25, 4
s_lshl_b32 s31, s26, 2
s_add_u32 s40, s41, s30
s_add_u32 s40, s40, s31
s_lshl_b32 s33, s32, 2
s_add_u32 s34, s33, 9216
s_add_u32 s33, s33, 8192
v_mov_b32 v2, 0
s_lshl_b32 s3, s26, 6
v_add_u32 v1, s3, v0
s_lshl_b32 s30, s25, 2
s_add_u32 s60, s41, s30
buffer_store_dword v2, off, s[4:7], s40 offset:0 sc1
buffer_store_dword v2, off, s[4:7], s60 offset:512 sc1
buffer_store_dword v2, off, s[4:7], s40 offset:1024 sc1
buffer_store_dword v2, off, s[4:7], s60 offset:640 sc1
v_mov_b32 v3, 0
v_mov_b32 v4, 0
v_mov_b32 v5, 0
v_lshlrev_b32 v6, 4, v1
s_cmp_eq_u32 s32, 126
s_cselect_b32 s3, 0, 0x40000000
s_cmp_eq_u32 s32, 127
s_cselect_b32 s3, 8192, s3
buffer_store_dwordx4 v[2:5], v6, s[4:7], s3 offen sc1
s_nop 1
v_lshrrev_b32 v3, 2, v1
v_and_b32 v4, 3, v1
v_mul_u32_u24 v5, 7680, v3
v_lshl_add_u32 v5, v4, 4, v5
v_lshlrev_b32 v6, 1, v3
s_lshl_b32 s35, s32, 6
s_cmp_lt_u32 s32, 120
s_cselect_b32 s35, s35, 0x40000000
s_waitcnt vmcnt(0)
s_barrier
s_cmp_lg_u32 s26, 0
s_cbranch_scc1 L_arrp_s
s_mul_i32 s3, s24, 66
s_and_b32 s3, s3, 0xc8
s_add_u32 s3, s3, s76
v_mov_b32 v92, s3
s_lshl_b32 s3, 1, s25
v_mov_b32 v90, s3
s_add_u32 s3, s78, 0x10000
v_mov_b32 v91, s3
s_mov_b64 exec, 1
global_atomic_add_x2 v92, v[90:91], s[28:29] sc1
s_mov_b64 exec, -1
L_arrp_s:
s_sub_u32 s3, s32, 120
s_cmp_ge_u32 s3, 3
s_cbranch_scc1 L_pmpf_s
s_getpc_b64 s[44:45]
L_ppc_s:
s_sub_u32 s44, s44, L_ppc_s-L_roles_s
s_subb_u32 s45, s45, 0
s_lshl_b32 s3, s3, 15
v_lshl_add_u32 v94, v1, 7, s3
v_min_u32 v94, L_fail_s-L_roles_s, v94
global_load_dword v94, v94, s[44:45]
L_pmpf_s:
s_cmp_lt_u32 s24, 6
s_cbranch_scc1 L_pearly_s
s_cmp_lg_u32 s26, 0
s_cbranch_scc1 L_plate_s
s_and_b32 s46, s32, 3
s_lshl_b32 s46, s46, 15
s_bfe_u32 s3, s32, 0x40002
s_lshl_b32 s3, s3, 7
s_add_u32 s46, s46, s3
s_add_u32 s46, s46, 267776
s_mov_b32 s48, -1
s_mov_b32 s49, 0
s_mov_b32 s50, 0
s_mov_b64 exec, 1
s_waitcnt vmcnt(0) lgkmcnt(0)
L_vote_s:
s_and_b32 s47, s50, 3
s_lshl_b32 s3, s47, 13
s_add_u32 s3, s3, s46
s_memtime s[30:31]
s_waitcnt lgkmcnt(0)
buffer_store_dword v90, off, s[4:7], s3 sc1
s_waitcnt vmcnt(0)
s_memtime s[44:45]
s_waitcnt lgkmcnt(0)
s_sub_u32 s3, s44, s30
s_cmp_lt_u32 s3, s48
s_cselect_b32 s48, s3, s48
s_cselect_b32 s49, s47, s49
s_add_u32 s50, s50, 1
s_cmp_lt_u32 s50, 12
s_cbranch_scc1 L_vote_s
s_mul_i32 s3, s49, 0x81
s_and_b32 s3, s3, 0x101
s_add_u32 s3, s3, 0x10000
v_mov_b32 v90, s3
s_lshl_b32 s3, s77, 6
s_add_u32 s3, s3, 56
v_mov_b32 v91, s3
global_atomic_add v91, v90, s[28:29] sc1
s_mov_b64 exec, -1
L_plate_s:
s_barrier
L_pearly_s:
buffer_load_ushort v48, v6, s[16:19], 0 offen offset:0
buffer_load_ushort v49, v6, s[16:19], 0 offen offset:128
buffer_load_ushort v50, v6, s[16:19], 0 offen offset:256
buffer_load_ushort v51, v6, s[16:19], 0 offen offset:384
buffer_load_ushort v52, v6, s[16:19], 0 offen offset:512
buffer_load_ushort v53, v6, s[16:19], 0 offen offset:640
buffer_load_ushort v54, v6, s[16:19], 0 offen offset:768
buffer_load_ushort v55, v6, s[16:19], 0 offen offset:896
buffer_load_ushort v56, v6, s[16:19], 0 offen offset:1024
buffer_load_ushort v57, v6, s[16:19], 0 offen offset:1152
s_add_u32 s3, s35, 0
buffer_load_dwordx4 v[8:11], v5, s[12:15], s3 offen
s_add_u32 s3, s35, 491520
buffer_load_dwordx4 v[12:15], v5, s[12:15], s3 offen
s_add_u32 s3, s35, 983040
buffer_load_dwordx4 v[16:19], v5, s[12:15], s3 offen
s_add_u32 s3, s35, 1474560
buffer_load_dwordx4 v[20:23], v5, s[12:15], s3 offen
s_add_u32 s3, s35, 1966080
buffer_load_dwordx4 v[24:27], v5, s[12:15], s3 offen
s_add_u32 s3, s35, 2457600
buffer_load_dwordx4 v[28:31], v5, s[12:15], s3 offen
s_add_u32 s3, s35, 2949120
buffer_load_dwordx4 v[32:35], v5, s[12:15], s3 offen
s_add_u32 s3, s35, 3440640
buffer_load_dwordx4 v[36:39], v5, s[12:15], s3 offen
s_add_u32 s3, s35, 3932160
buffer_load_dwordx4 v[40:43], v5, s[12:15], s3 offen
s_add_u32 s3, s35, 4423680
buffer_load_dwordx4 v[44:47], v5, s[12:15], s3 offen
v_lshrrev_b32 v7, 4, v1
v_and_b32 v2, 15, v1
v_mul_u32_u24 v5, 1280, v7
v_lshl_add_u32 v5, v2, 4, v5
s_mul_i32 s36, s32, 20480
buffer_load_dwordx4 v[60:63], v5, s[8:11], s36 offen offset:0
buffer_load_dwordx4 v[64:67], v5, s[8:11], s36 offen offset:256
buffer_load_dwordx4 v[68:71], v5, s[8:11], s36 offen offset:512
buffer_load_dwordx4 v[72:75], v5, s[8:11], s36 offen offset:768
buffer_load_dwordx4 v[76:79], v5, s[8:11], s36 offen offset:1024
s_waitcnt vmcnt(24)
v_lshlrev_b32 v48, 16, v48
v_mul_f32 v90, 3216550459, v48
v_exp_f32 v90, v90
s_nop 0
v_add_f32 v90, 1.0, v90
v_rcp_f32 v90, v90
s_nop 0
v_mul_f32 v48, v48, v90
v_cvt_pk_bf16_f32 v48, v48, v48
v_lshlrev_b32 v48, 16, v48
s_waitcnt vmcnt(23)
v_lshlrev_b32 v49, 16, v49
v_mul_f32 v90, 3216550459, v49
v_exp_f32 v90, v90
s_nop 0
v_add_f32 v90, 1.0, v90
v_rcp_f32 v90, v90
s_nop 0
v_mul_f32 v49, v49, v90
v_cvt_pk_bf16_f32 v49, v49, v49
v_lshlrev_b32 v49, 16, v49
s_waitcnt vmcnt(22)
v_lshlrev_b32 v50, 16, v50
v_mul_f32 v90, 3216550459, v50
v_exp_f32 v90, v90
s_nop 0
v_add_f32 v90, 1.0, v90
v_rcp_f32 v90, v90
s_nop 0
v_mul_f32 v50, v50, v90
v_cvt_pk_bf16_f32 v50, v50, v50
v_lshlrev_b32 v50, 16, v50
s_waitcnt vmcnt(21)
v_lshlrev_b32 v51, 16, v51
v_mul_f32 v90, 3216550459, v51
v_exp_f32 v90, v90
s_nop 0
v_add_f32 v90, 1.0, v90
v_rcp_f32 v90, v90
s_nop 0
v_mul_f32 v51, v51, v90
v_cvt_pk_bf16_f32 v51, v51, v51
v_lshlrev_b32 v51, 16, v51
s_waitcnt vmcnt(20)
v_lshlrev_b32 v52, 16, v52
v_mul_f32 v90, 3216550459, v52
v_exp_f32 v90, v90
s_nop 0
v_add_f32 v90, 1.0, v90
v_rcp_f32 v90, v90
s_nop 0
v_mul_f32 v52, v52, v90
v_cvt_pk_bf16_f32 v52, v52, v52
v_lshlrev_b32 v52, 16, v52
s_waitcnt vmcnt(19)
v_lshlrev_b32 v53, 16, v53
v_mul_f32 v90, 3216550459, v53
v_exp_f32 v90, v90
s_nop 0
v_add_f32 v90, 1.0, v90
v_rcp_f32 v90, v90
s_nop 0
v_mul_f32 v53, v53, v90
v_cvt_pk_bf16_f32 v53, v53, v53
v_lshlrev_b32 v53, 16, v53
s_waitcnt vmcnt(18)
v_lshlrev_b32 v54, 16, v54
v_mul_f32 v90, 3216550459, v54
v_exp_f32 v90, v90
s_nop 0
v_add_f32 v90, 1.0, v90
v_rcp_f32 v90, v90
s_nop 0
v_mul_f32 v54, v54, v90
v_cvt_pk_bf16_f32 v54, v54, v54
v_lshlrev_b32 v54, 16, v54
s_waitcnt vmcnt(17)
v_lshlrev_b32 v55, 16, v55
v_mul_f32 v90, 3216550459, v55
v_exp_f32 v90, v90
s_nop 0
v_add_f32 v90, 1.0, v90
v_rcp_f32 v90, v90
s_nop 0
v_mul_f32 v55, v55, v90
v_cvt_pk_bf16_f32 v55, v55, v55
v_lshlrev_b32 v55, 16, v55
s_waitcnt vmcnt(16)
v_lshlrev_b32 v56, 16, v56
v_mul_f32 v90, 3216550459, v56
v_exp_f32 v90, v90
s_nop 0
v_add_f32 v90, 1.0, v90
v_rcp_f32 v90, v90
s_nop 0
v_mul_f32 v56, v56, v90
v_cvt_pk_bf16_f32 v56, v56, v56
v_lshlrev_b32 v56, 16, v56
s_waitcnt vmcnt(15)
v_lshlrev_b32 v57, 16, v57
v_mul_f32 v90, 3216550459, v57
v_exp_f32 v90, v90
s_nop 0
v_add_f32 v90, 1.0, v90
v_rcp_f32 v90, v90
s_nop 0
v_mul_f32 v57, v57, v90
v_cvt_pk_bf16_f32 v57, v57, v57
v_lshlrev_b32 v57, 16, v57
s_waitcnt vmcnt(14)
v_lshlrev_b32 v90, 16, v8
v_and_b32 v91, 0xffff0000, v8
v_mul_f32 v80, v48, v90
v_mul_f32 v81, v48, v91
v_lshlrev_b32 v90, 16, v9
v_and_b32 v91, 0xffff0000, v9
v_mul_f32 v82, v48, v90
v_mul_f32 v83, v48, v91
v_lshlrev_b32 v90, 16, v10
v_and_b32 v91, 0xffff0000, v10
v_mul_f32 v84, v48, v90
v_mul_f32 v85, v48, v91
v_lshlrev_b32 v90, 16, v11
v_and_b32 v91, 0xffff0000, v11
v_mul_f32 v86, v48, v90
v_mul_f32 v87, v48, v91
s_waitcnt vmcnt(13)
v_lshlrev_b32 v90, 16, v12
v_and_b32 v91, 0xffff0000, v12
v_fmac_f32 v80, v49, v90
v_fmac_f32 v81, v49, v91
v_lshlrev_b32 v90, 16, v13
v_and_b32 v91, 0xffff0000, v13
v_fmac_f32 v82, v49, v90
v_fmac_f32 v83, v49, v91
v_lshlrev_b32 v90, 16, v14
v_and_b32 v91, 0xffff0000, v14
v_fmac_f32 v84, v49, v90
v_fmac_f32 v85, v49, v91
v_lshlrev_b32 v90, 16, v15
v_and_b32 v91, 0xffff0000, v15
v_fmac_f32 v86, v49, v90
v_fmac_f32 v87, v49, v91
s_waitcnt vmcnt(12)
v_lshlrev_b32 v90, 16, v16
v_and_b32 v91, 0xffff0000, v16
v_fmac_f32 v80, v50, v90
v_fmac_f32 v81, v50, v91
v_lshlrev_b32 v90, 16, v17
v_and_b32 v91, 0xffff0000, v17
v_fmac_f32 v82, v50, v90
v_fmac_f32 v83, v50, v91
v_lshlrev_b32 v90, 16, v18
v_and_b32 v91, 0xffff0000, v18
v_fmac_f32 v84, v50, v90
v_fmac_f32 v85, v50, v91
v_lshlrev_b32 v90, 16, v19
v_and_b32 v91, 0xffff0000, v19
v_fmac_f32 v86, v50, v90
v_fmac_f32 v87, v50, v91
s_waitcnt vmcnt(11)
v_lshlrev_b32 v90, 16, v20
v_and_b32 v91, 0xffff0000, v20
v_fmac_f32 v80, v51, v90
v_fmac_f32 v81, v51, v91
v_lshlrev_b32 v90, 16, v21
v_and_b32 v91, 0xffff0000, v21
v_fmac_f32 v82, v51, v90
v_fmac_f32 v83, v51, v91
v_lshlrev_b32 v90, 16, v22
v_and_b32 v91, 0xffff0000, v22
v_fmac_f32 v84, v51, v90
v_fmac_f32 v85, v51, v91
v_lshlrev_b32 v90, 16, v23
v_and_b32 v91, 0xffff0000, v23
v_fmac_f32 v86, v51, v90
v_fmac_f32 v87, v51, v91
s_waitcnt vmcnt(10)
v_lshlrev_b32 v90, 16, v24
v_and_b32 v91, 0xffff0000, v24
v_fmac_f32 v80, v52, v90
v_fmac_f32 v81, v52, v91
v_lshlrev_b32 v90, 16, v25
v_and_b32 v91, 0xffff0000, v25
v_fmac_f32 v82, v52, v90
v_fmac_f32 v83, v52, v91
v_lshlrev_b32 v90, 16, v26
v_and_b32 v91, 0xffff0000, v26
v_fmac_f32 v84, v52, v90
v_fmac_f32 v85, v52, v91
v_lshlrev_b32 v90, 16, v27
v_and_b32 v91, 0xffff0000, v27
v_fmac_f32 v86, v52, v90
v_fmac_f32 v87, v52, v91
s_waitcnt vmcnt(9)
v_lshlrev_b32 v90, 16, v28
v_and_b32 v91, 0xffff0000, v28
v_fmac_f32 v80, v53, v90
v_fmac_f32 v81, v53, v91
v_lshlrev_b32 v90, 16, v29
v_and_b32 v91, 0xffff0000, v29
v_fmac_f32 v82, v53, v90
v_fmac_f32 v83, v53, v91
v_lshlrev_b32 v90, 16, v30
v_and_b32 v91, 0xffff0000, v30
v_fmac_f32 v84, v53, v90
v_fmac_f32 v85, v53, v91
v_lshlrev_b32 v90, 16, v31
v_and_b32 v91, 0xffff0000, v31
v_fmac_f32 v86, v53, v90
v_fmac_f32 v87, v53, v91
s_waitcnt vmcnt(8)
v_lshlrev_b32 v90, 16, v32
v_and_b32 v91, 0xffff0000, v32
v_fmac_f32 v80, v54, v90
v_fmac_f32 v81, v54, v91
v_lshlrev_b32 v90, 16, v33
v_and_b32 v91, 0xffff0000, v33
v_fmac_f32 v82, v54, v90
v_fmac_f32 v83, v54, v91
v_lshlrev_b32 v90, 16, v34
v_and_b32 v91, 0xffff0000, v34
v_fmac_f32 v84, v54, v90
v_fmac_f32 v85, v54, v91
v_lshlrev_b32 v90, 16, v35
v_and_b32 v91, 0xffff0000, v35
v_fmac_f32 v86, v54, v90
v_fmac_f32 v87, v54, v91
s_waitcnt vmcnt(7)
v_lshlrev_b32 v90, 16, v36
v_and_b32 v91, 0xffff0000, v36
v_fmac_f32 v80, v55, v90
v_fmac_f32 v81, v55, v91
v_lshlrev_b32 v90, 16, v37
v_and_b32 v91, 0xffff0000, v37
v_fmac_f32 v82, v55, v90
v_fmac_f32 v83, v55, v91
v_lshlrev_b32 v90, 16, v38
v_and_b32 v91, 0xffff0000, v38
v_fmac_f32 v84, v55, v90
v_fmac_f32 v85, v55, v91
v_lshlrev_b32 v90, 16, v39
v_and_b32 v91, 0xffff0000, v39
v_fmac_f32 v86, v55, v90
v_fmac_f32 v87, v55, v91
s_waitcnt vmcnt(6)
v_lshlrev_b32 v90, 16, v40
v_and_b32 v91, 0xffff0000, v40
v_fmac_f32 v80, v56, v90
v_fmac_f32 v81, v56, v91
v_lshlrev_b32 v90, 16, v41
v_and_b32 v91, 0xffff0000, v41
v_fmac_f32 v82, v56, v90
v_fmac_f32 v83, v56, v91
v_lshlrev_b32 v90, 16, v42
v_and_b32 v91, 0xffff0000, v42
v_fmac_f32 v84, v56, v90
v_fmac_f32 v85, v56, v91
v_lshlrev_b32 v90, 16, v43
v_and_b32 v91, 0xffff0000, v43
v_fmac_f32 v86, v56, v90
v_fmac_f32 v87, v56, v91
s_waitcnt vmcnt(5)
v_lshlrev_b32 v90, 16, v44
v_and_b32 v91, 0xffff0000, v44
v_fmac_f32 v80, v57, v90
v_fmac_f32 v81, v57, v91
v_lshlrev_b32 v90, 16, v45
v_and_b32 v91, 0xffff0000, v45
v_fmac_f32 v82, v57, v90
v_fmac_f32 v83, v57, v91
v_lshlrev_b32 v90, 16, v46
v_and_b32 v91, 0xffff0000, v46
v_fmac_f32 v84, v57, v90
v_fmac_f32 v85, v57, v91
v_lshlrev_b32 v90, 16, v47
v_and_b32 v91, 0xffff0000, v47
v_fmac_f32 v86, v57, v90
v_fmac_f32 v87, v57, v91
v_lshlrev_b32 v5, 5, v1
ds_write_b128 v5, v[80:83]
ds_write_b128 v5, v[84:87] offset:16
v_and_b32 v3, 31, v1
v_lshrrev_b32 v4, 5, v1
v_lshlrev_b32 v6, 2, v3
v_lshl_add_u32 v5, v4, 10, v6
s_waitcnt lgkmcnt(0)
s_barrier
ds_read_b32 v8, v5 offset:0
ds_read_b32 v9, v5 offset:128
ds_read_b32 v10, v5 offset:256
ds_read_b32 v11, v5 offset:384
ds_read_b32 v12, v5 offset:512
ds_read_b32 v13, v5 offset:640
ds_read_b32 v14, v5 offset:768
ds_read_b32 v15, v5 offset:896
s_waitcnt lgkmcnt(6)
v_add_f32 v8, v8, v9
s_waitcnt lgkmcnt(5)
v_add_f32 v8, v8, v10
s_waitcnt lgkmcnt(4)
v_add_f32 v8, v8, v11
s_waitcnt lgkmcnt(3)
v_add_f32 v8, v8, v12
s_waitcnt lgkmcnt(2)
v_add_f32 v8, v8, v13
s_waitcnt lgkmcnt(1)
v_add_f32 v8, v8, v14
s_waitcnt lgkmcnt(0)
v_add_f32 v8, v8, v15
v_lshlrev_b32 v5, 2, v1
ds_write_b32 v5, v8 offset:8192
s_waitcnt lgkmcnt(0)
s_barrier
ds_read_b32 v8, v6 offset:8192
ds_read_b32 v9, v6 offset:8320
ds_read_b32 v10, v6 offset:8448
ds_read_b32 v11, v6 offset:8576
ds_read_b32 v12, v6 offset:8704
ds_read_b32 v13, v6 offset:8832
ds_read_b32 v14, v6 offset:8960
ds_read_b32 v15, v6 offset:9088
s_waitcnt lgkmcnt(6)
v_add_f32 v8, v8, v9
s_waitcnt lgkmcnt(5)
v_add_f32 v8, v8, v10
s_waitcnt lgkmcnt(4)
v_add_f32 v8, v8, v11
s_waitcnt lgkmcnt(3)
v_add_f32 v8, v8, v12
s_waitcnt lgkmcnt(2)
v_add_f32 v8, v8, v13
s_waitcnt lgkmcnt(1)
v_add_f32 v8, v8, v14
s_waitcnt lgkmcnt(0)
v_add_f32 v8, v8, v15
v_cvt_pk_bf16_f32 v8, v8, v8
v_lshlrev_b32 v9, 16, v8
v_add_f32 v9, 1.0, v9
v_cvt_pk_bf16_f32 v9, v9, v9
s_sub_u32 s3, s32, 20
s_cmp_lt_u32 s3, 20
s_cselect_b64 s[30:31], -1, 0
s_sub_u32 s3, s32, 80
s_cmp_lt_u32 s3, 20
s_cselect_b64 s[30:31], -1, s[30:31]
v_cndmask_b32 v8, v8, v9, s[30:31]
v_lshlrev_b32 v3, 1, v3
s_add_u32 s35, s35, 32768
s_cmp_lg_u32 s26, 0
s_cbranch_scc1 L_pm_s
buffer_store_short v8, v3, s[4:7], s35 offen sc1
L_pm_s:
v_mov_b32 v95, 65536
s_waitcnt vmcnt(0)
s_cmp_lg_u32 s26, 0
s_cbranch_scc1 L_cenwp_s
v_mbcnt_lo_u32_b32 v94, -1, 0
v_mbcnt_hi_u32_b32 v94, -1, v94
v_and_b32 v94, 7, v94
v_mul_u32_u24 v94, 66, v94
v_and_b32 v94, 0xc8, v94
v_add_u32 v94, s76, v94
L_cenp_s:
global_load_dwordx2 v[92:93], v94, s[28:29] sc1
s_add_u32 s27, s27, 1
s_cmp_gt_u32 s27, 262144
s_cbranch_scc1 L_fail_s
s_waitcnt vmcnt(0)
v_cmp_eq_u32 s[30:31], -1, v92
v_cmp_eq_u32 vcc, 0x200000, v93
s_and_b64 s[30:31], s[30:31], vcc
v_lshrrev_b32 v93, 16, v93
s_nop 1
v_add_u32_dpp v93, v93, v93 row_ror:4 row_mask:0xf bank_mask:0xf
s_nop 1
v_add_u32_dpp v93, v93, v93 row_ror:2 row_mask:0xf bank_mask:0xf
s_nop 1
v_add_u32_dpp v93, v93, v93 row_ror:1 row_mask:0xf bank_mask:0xf
v_cmp_lt_u32 vcc, 255, v93
s_cbranch_vccnz L_cendp_s
s_sleep 12
s_branch L_cenp_s
L_cendp_s:
v_mov_b32 v92, s30
ds_write_b32 v95, v92
s_waitcnt lgkmcnt(0)
L_cenwp_s:
s_barrier
ds_read_b32 v92, v95
s_waitcnt lgkmcnt(0)
v_cmp_ne_u32 vcc, -1, v92
s_cbranch_vccnz L_fail_s
s_cmp_eq_u32 s26, 0
s_cselect_b32 s3, s33, 0x40000000
v_mov_b32 v9, 1
buffer_store_dword v9, off, s[4:7], s3 sc1
v_lshlrev_b32 v8, 16, v60
v_and_b32 v9, 0xffff0000, v60
v_lshlrev_b32 v10, 16, v61
v_and_b32 v11, 0xffff0000, v61
v_lshlrev_b32 v12, 16, v62
v_and_b32 v13, 0xffff0000, v62
v_lshlrev_b32 v14, 16, v63
v_and_b32 v15, 0xffff0000, v63
v_lshlrev_b32 v16, 16, v64
v_and_b32 v17, 0xffff0000, v64
v_lshlrev_b32 v18, 16, v65
v_and_b32 v19, 0xffff0000, v65
v_lshlrev_b32 v20, 16, v66
v_and_b32 v21, 0xffff0000, v66
v_lshlrev_b32 v22, 16, v67
v_and_b32 v23, 0xffff0000, v67
v_lshlrev_b32 v24, 16, v68
v_and_b32 v25, 0xffff0000, v68
v_lshlrev_b32 v26, 16, v69
v_and_b32 v27, 0xffff0000, v69
v_lshlrev_b32 v28, 16, v70
v_and_b32 v29, 0xffff0000, v70
v_lshlrev_b32 v30, 16, v71
v_and_b32 v31, 0xffff0000, v71
v_lshlrev_b32 v32, 16, v72
v_and_b32 v33, 0xffff0000, v72
v_lshlrev_b32 v34, 16, v73
v_and_b32 v35, 0xffff0000, v73
v_lshlrev_b32 v36, 16, v74
v_and_b32 v37, 0xffff0000, v74
v_lshlrev_b32 v38, 16, v75
v_and_b32 v39, 0xffff0000, v75
v_lshlrev_b32 v40, 16, v76
v_and_b32 v41, 0xffff0000, v76
v_lshlrev_b32 v42, 16, v77
v_and_b32 v43, 0xffff0000, v77
v_lshlrev_b32 v44, 16, v78
v_and_b32 v45, 0xffff0000, v78
v_lshlrev_b32 v46, 16, v79
v_and_b32 v47, 0xffff0000, v79
v_add_f32 v90, v8, v9
v_add_f32 v90, v90, v10
v_add_f32 v90, v90, v11
v_add_f32 v90, v90, v12
v_add_f32 v90, v90, v13
v_add_f32 v90, v90, v14
v_add_f32 v90, v90, v15
v_add_f32 v90, v90, v16
v_add_f32 v90, v90, v17
v_add_f32 v90, v90, v18
v_add_f32 v90, v90, v19
v_add_f32 v90, v90, v20
v_add_f32 v90, v90, v21
v_add_f32 v90, v90, v22
v_add_f32 v90, v90, v23
v_add_f32 v90, v90, v24
v_add_f32 v90, v90, v25
v_add_f32 v90, v90, v26
v_add_f32 v90, v90, v27
v_add_f32 v90, v90, v28
v_add_f32 v90, v90, v29
v_add_f32 v90, v90, v30
v_add_f32 v90, v90, v31
v_add_f32 v90, v90, v32
v_add_f32 v90, v90, v33
v_add_f32 v90, v90, v34
v_add_f32 v90, v90, v35
v_add_f32 v90, v90, v36
v_add_f32 v90, v90, v37
v_add_f32 v90, v90, v38
v_add_f32 v90, v90, v39
v_add_f32 v90, v90, v40
v_add_f32 v90, v90, v41
v_add_f32 v90, v90, v42
v_add_f32 v90, v90, v43
v_add_f32 v90, v90, v44
v_add_f32 v90, v90, v45
v_add_f32 v90, v90, v46
v_add_f32 v90, v90, v47
s_nop 1
v_add_f32_dpp v90, v90, v90 row_ror:8 row_mask:0xf bank_mask:0xf
s_nop 1
v_add_f32_dpp v90, v90, v90 row_ror:4 row_mask:0xf bank_mask:0xf
s_nop 1
v_add_f32_dpp v90, v90, v90 row_ror:2 row_mask:0xf bank_mask:0xf
s_nop 1
v_add_f32_dpp v90, v90, v90 row_ror:1 row_mask:0xf bank_mask:0xf
v_mul_f32 v90, 986500301, v90
v_sub_f32 v8, v8, v90
v_sub_f32 v9, v9, v90
v_sub_f32 v10, v10, v90
v_sub_f32 v11, v11, v90
v_sub_f32 v12, v12, v90
v_sub_f32 v13, v13, v90
v_sub_f32 v14, v14, v90
v_sub_f32 v15, v15, v90
v_sub_f32 v16, v16, v90
v_sub_f32 v17, v17, v90
v_sub_f32 v18, v18, v90
v_sub_f32 v19, v19, v90
v_sub_f32 v20, v20, v90
v_sub_f32 v21, v21, v90
v_sub_f32 v22, v22, v90
v_sub_f32 v23, v23, v90
v_sub_f32 v24, v24, v90
v_sub_f32 v25, v25, v90
v_sub_f32 v26, v26, v90
v_sub_f32 v27, v27, v90
v_sub_f32 v28, v28, v90
v_sub_f32 v29, v29, v90
v_sub_f32 v30, v30, v90
v_sub_f32 v31, v31, v90
v_sub_f32 v32, v32, v90
v_sub_f32 v33, v33, v90
v_sub_f32 v34, v34, v90
v_sub_f32 v35, v35, v90
v_sub_f32 v36, v36, v90
v_sub_f32 v37, v37, v90
v_sub_f32 v38, v38, v90
v_sub_f32 v39, v39, v90
v_sub_f32 v40, v40, v90
v_sub_f32 v41, v41, v90
v_sub_f32 v42, v42, v90
v_sub_f32 v43, v43, v90
v_sub_f32 v44, v44, v90
v_sub_f32 v45, v45, v90
v_sub_f32 v46, v46, v90
v_sub_f32 v47, v47, v90
v_mul_f32 v91, v8, v8
v_fmac_f32 v91, v9, v9
v_fmac_f32 v91, v10, v10
v_fmac_f32 v91, v11, v11
v_fmac_f32 v91, v12, v12
v_fmac_f32 v91, v13, v13
v_fmac_f32 v91, v14, v14
v_fmac_f32 v91, v15, v15
v_fmac_f32 v91, v16, v16
v_fmac_f32 v91, v17, v17
v_fmac_f32 v91, v18, v18
v_fmac_f32 v91, v19, v19
v_fmac_f32 v91, v20, v20
v_fmac_f32 v91, v21, v21
v_fmac_f32 v91, v22, v22
v_fmac_f32 v91, v23, v23
v_fmac_f32 v91, v24, v24
v_fmac_f32 v91, v25, v25
v_fmac_f32 v91, v26, v26
v_fmac_f32 v91, v27, v27
v_fmac_f32 v91, v28, v28
v_fmac_f32 v91, v29, v29
v_fmac_f32 v91, v30, v30
v_fmac_f32 v91, v31, v31
v_fmac_f32 v91, v32, v32
v_fmac_f32 v91, v33, v33
v_fmac_f32 v91, v34, v34
v_fmac_f32 v91, v35, v35
v_fmac_f32 v91, v36, v36
v_fmac_f32 v91, v37, v37
v_fmac_f32 v91, v38, v38
v_fmac_f32 v91, v39, v39
v_fmac_f32 v91, v40, v40
v_fmac_f32 v91, v41, v41
v_fmac_f32 v91, v42, v42
v_fmac_f32 v91, v43, v43
v_fmac_f32 v91, v44, v44
v_fmac_f32 v91, v45, v45
v_fmac_f32 v91, v46, v46
v_fmac_f32 v91, v47, v47
s_nop 1
v_add_f32_dpp v91, v91, v91 row_ror:8 row_mask:0xf bank_mask:0xf
s_nop 1
v_add_f32_dpp v91, v91, v91 row_ror:4 row_mask:0xf bank_mask:0xf
s_nop 1
v_add_f32_dpp v91, v91, v91 row_ror:2 row_mask:0xf bank_mask:0xf
s_nop 1
v_add_f32_dpp v91, v91, v91 row_ror:1 row_mask:0xf bank_mask:0xf
v_mov_b32 v90, 925353388
v_fmac_f32 v90, 986500301, v91
v_rsq_f32 v90, v90
s_nop 0
v_mul_f32 v8, v8, v90
v_mul_f32 v9, v9, v90
v_mul_f32 v10, v10, v90
v_mul_f32 v11, v11, v90
v_mul_f32 v12, v12, v90
v_mul_f32 v13, v13, v90
v_mul_f32 v14, v14, v90
v_mul_f32 v15, v15, v90
v_mul_f32 v16, v16, v90
v_mul_f32 v17, v17, v90
v_mul_f32 v18, v18, v90
v_mul_f32 v19, v19, v90
v_mul_f32 v20, v20, v90
v_mul_f32 v21, v21, v90
v_mul_f32 v22, v22, v90
v_mul_f32 v23, v23, v90
v_mul_f32 v24, v24, v90
v_mul_f32 v25, v25, v90
v_mul_f32 v26, v26, v90
v_mul_f32 v27, v27, v90
v_mul_f32 v28, v28, v90
v_mul_f32 v29, v29, v90
v_mul_f32 v30, v30, v90
v_mul_f32 v31, v31, v90
v_mul_f32 v32, v32, v90
v_mul_f32 v33, v33, v90
v_mul_f32 v34, v34, v90
v_mul_f32 v35, v35, v90
v_mul_f32 v36, v36, v90
v_mul_f32 v37, v37, v90
v_mul_f32 v38, v38, v90
v_mul_f32 v39, v39, v90
v_mul_f32 v40, v40, v90
v_mul_f32 v41, v41, v90
v_mul_f32 v42, v42, v90
v_mul_f32 v43, v43, v90
v_mul_f32 v44, v44, v90
v_mul_f32 v45, v45, v90
v_mul_f32 v46, v46, v90
v_mul_f32 v47, v47, v90
s_cmp_lg_u32 s26, 1
s_cbranch_scc1 L_pmw_s
v_min_u32 v92, 39, v0
v_lshlrev_b32 v92, 2, v92
s_mov_b32 s37, 8192
L_pmod_s:
buffer_load_dword v93, v92, s[4:7], s37 offen offset:0 sc1
s_add_u32 s27, s27, 1
s_cmp_gt_u32 s27, 262144
s_cbranch_scc1 L_fail_s
s_waitcnt vmcnt(0)
v_cmp_gt_u32 vcc, 1, v93
s_cbranch_vccz L_pmod_sok
s_sleep 2
s_branch L_pmod_s
L_pmod_sok:
v_lshlrev_b32 v92, 4, v0
s_mov_b32 s37, 32768
s_mov_b32 m0, 12288
s_nop 0
buffer_load_dwordx4 v92, s[4:7], s37 offen offset:0 sc1 lds
buffer_load_dwordx4 v92, s[4:7], s37 offen offset:1024 sc1 lds
buffer_load_dwordx4 v92, s[4:7], s37 offen offset:2048 sc1 lds
s_waitcnt vmcnt(0)
L_pmw_s:
v_lshlrev_b32 v5, 4, v2
s_barrier
ds_read_b128 v[48:51], v5 offset:12288
ds_read_b128 v[68:71], v5 offset:13568
ds_read_b128 v[52:55], v5 offset:12544
ds_read_b128 v[72:75], v5 offset:13824
ds_read_b128 v[56:59], v5 offset:12800
ds_read_b128 v[76:79], v5 offset:14080
ds_read_b128 v[60:63], v5 offset:13056
ds_read_b128 v[80:83], v5 offset:14336
ds_read_b128 v[64:67], v5 offset:13312
ds_read_b128 v[84:87], v5 offset:14592
v_xor_b32 v6, v7, v2
v_lshlrev_b32 v5, 8, v2
v_lshl_add_u32 v5, v6, 4, v5
s_waitcnt lgkmcnt(9)
v_lshlrev_b32 v90, 16, v48
v_and_b32 v91, 0xffff0000, v48
s_waitcnt lgkmcnt(8)
v_lshlrev_b32 v92, 16, v68
v_and_b32 v93, 0xffff0000, v68
v_fmac_f32 v90, v8, v92
v_fmac_f32 v91, v9, v93
v_cvt_pk_bf16_f32 v48, v90, v91
v_lshlrev_b32 v90, 16, v49
v_and_b32 v91, 0xffff0000, v49
v_lshlrev_b32 v92, 16, v69
v_and_b32 v93, 0xffff0000, v69
v_fmac_f32 v90, v10, v92
v_fmac_f32 v91, v11, v93
v_cvt_pk_bf16_f32 v49, v90, v91
v_lshlrev_b32 v90, 16, v50
v_and_b32 v91, 0xffff0000, v50
v_lshlrev_b32 v92, 16, v70
v_and_b32 v93, 0xffff0000, v70
v_fmac_f32 v90, v12, v92
v_fmac_f32 v91, v13, v93
v_cvt_pk_bf16_f32 v50, v90, v91
v_lshlrev_b32 v90, 16, v51
v_and_b32 v91, 0xffff0000, v51
v_lshlrev_b32 v92, 16, v71
v_and_b32 v93, 0xffff0000, v71
v_fmac_f32 v90, v14, v92
v_fmac_f32 v91, v15, v93
v_cvt_pk_bf16_f32 v51, v90, v91
ds_write_b128 v5, v[48:51] offset:16384
s_waitcnt lgkmcnt(8)
v_lshlrev_b32 v90, 16, v52
v_and_b32 v91, 0xffff0000, v52
s_waitcnt lgkmcnt(7)
v_lshlrev_b32 v92, 16, v72
v_and_b32 v93, 0xffff0000, v72
v_fmac_f32 v90, v16, v92
v_fmac_f32 v91, v17, v93
v_cvt_pk_bf16_f32 v52, v90, v91
v_lshlrev_b32 v90, 16, v53
v_and_b32 v91, 0xffff0000, v53
v_lshlrev_b32 v92, 16, v73
v_and_b32 v93, 0xffff0000, v73
v_fmac_f32 v90, v18, v92
v_fmac_f32 v91, v19, v93
v_cvt_pk_bf16_f32 v53, v90, v91
v_lshlrev_b32 v90, 16, v54
v_and_b32 v91, 0xffff0000, v54
v_lshlrev_b32 v92, 16, v74
v_and_b32 v93, 0xffff0000, v74
v_fmac_f32 v90, v20, v92
v_fmac_f32 v91, v21, v93
v_cvt_pk_bf16_f32 v54, v90, v91
v_lshlrev_b32 v90, 16, v55
v_and_b32 v91, 0xffff0000, v55
v_lshlrev_b32 v92, 16, v75
v_and_b32 v93, 0xffff0000, v75
v_fmac_f32 v90, v22, v92
v_fmac_f32 v91, v23, v93
v_cvt_pk_bf16_f32 v55, v90, v91
ds_write_b128 v5, v[52:55] offset:20480
s_waitcnt lgkmcnt(7)
v_lshlrev_b32 v90, 16, v56
v_and_b32 v91, 0xffff0000, v56
s_waitcnt lgkmcnt(6)
v_lshlrev_b32 v92, 16, v76
v_and_b32 v93, 0xffff0000, v76
v_fmac_f32 v90, v24, v92
v_fmac_f32 v91, v25, v93
v_cvt_pk_bf16_f32 v56, v90, v91
v_lshlrev_b32 v90, 16, v57
v_and_b32 v91, 0xffff0000, v57
v_lshlrev_b32 v92, 16, v77
v_and_b32 v93, 0xffff0000, v77
v_fmac_f32 v90, v26, v92
v_fmac_f32 v91, v27, v93
v_cvt_pk_bf16_f32 v57, v90, v91
v_lshlrev_b32 v90, 16, v58
v_and_b32 v91, 0xffff0000, v58
v_lshlrev_b32 v92, 16, v78
v_and_b32 v93, 0xffff0000, v78
v_fmac_f32 v90, v28, v92
v_fmac_f32 v91, v29, v93
v_cvt_pk_bf16_f32 v58, v90, v91
v_lshlrev_b32 v90, 16, v59
v_and_b32 v91, 0xffff0000, v59
v_lshlrev_b32 v92, 16, v79
v_and_b32 v93, 0xffff0000, v79
v_fmac_f32 v90, v30, v92
v_fmac_f32 v91, v31, v93
v_cvt_pk_bf16_f32 v59, v90, v91
ds_write_b128 v5, v[56:59] offset:24576
s_waitcnt lgkmcnt(6)
v_lshlrev_b32 v90, 16, v60
v_and_b32 v91, 0xffff0000, v60
s_waitcnt lgkmcnt(5)
v_lshlrev_b32 v92, 16, v80
v_and_b32 v93, 0xffff0000, v80
v_fmac_f32 v90, v32, v92
v_fmac_f32 v91, v33, v93
v_cvt_pk_bf16_f32 v60, v90, v91
v_lshlrev_b32 v90, 16, v61
v_and_b32 v91, 0xffff0000, v61
v_lshlrev_b32 v92, 16, v81
v_and_b32 v93, 0xffff0000, v81
v_fmac_f32 v90, v34, v92
v_fmac_f32 v91, v35, v93
v_cvt_pk_bf16_f32 v61, v90, v91
v_lshlrev_b32 v90, 16, v62
v_and_b32 v91, 0xffff0000, v62
v_lshlrev_b32 v92, 16, v82
v_and_b32 v93, 0xffff0000, v82
v_fmac_f32 v90, v36, v92
v_fmac_f32 v91, v37, v93
v_cvt_pk_bf16_f32 v62, v90, v91
v_lshlrev_b32 v90, 16, v63
v_and_b32 v91, 0xffff0000, v63
v_lshlrev_b32 v92, 16, v83
v_and_b32 v93, 0xffff0000, v83
v_fmac_f32 v90, v38, v92
v_fmac_f32 v91, v39, v93
v_cvt_pk_bf16_f32 v63, v90, v91
ds_write_b128 v5, v[60:63] offset:28672
s_waitcnt lgkmcnt(5)
v_lshlrev_b32 v90, 16, v64
v_and_b32 v91, 0xffff0000, v64
s_waitcnt lgkmcnt(4)
v_lshlrev_b32 v92, 16, v84
v_and_b32 v93, 0xffff0000, v84
v_fmac_f32 v90, v40, v92
v_fmac_f32 v91, v41, v93
v_cvt_pk_bf16_f32 v64, v90, v91
v_lshlrev_b32 v90, 16, v65
v_and_b32 v91, 0xffff0000, v65
v_lshlrev_b32 v92, 16, v85
v_and_b32 v93, 0xffff0000, v85
v_fmac_f32 v90, v42, v92
v_fmac_f32 v91, v43, v93
v_cvt_pk_bf16_f32 v65, v90, v91
v_lshlrev_b32 v90, 16, v66
v_and_b32 v91, 0xffff0000, v66
v_lshlrev_b32 v92, 16, v86
v_and_b32 v93, 0xffff0000, v86
v_fmac_f32 v90, v44, v92
v_fmac_f32 v91, v45, v93
v_cvt_pk_bf16_f32 v66, v90, v91
v_lshlrev_b32 v90, 16, v67
v_and_b32 v91, 0xffff0000, v67
v_lshlrev_b32 v92, 16, v87
v_and_b32 v93, 0xffff0000, v87
v_fmac_f32 v90, v46, v92
v_fmac_f32 v91, v47, v93
v_cvt_pk_bf16_f32 v67, v90, v91
ds_write_b128 v5, v[64:67] offset:32768
s_mul_i32 s3, s26, 5120
v_lshlrev_b32 v5, 4, v0
v_add_u32 v5, s3, v5
s_mul_i32 s30, s32, 20480
s_add_u32 s30, s30, 6291456
v_add_u32 v30, 0, v5
v_lshrrev_b32 v6, 4, v30
v_and_b32 v6, 0xf0, v6
v_xor_b32 v30, v30, v6
v_add_u32 v31, 1024, v5
v_lshrrev_b32 v6, 4, v31
v_and_b32 v6, 0xf0, v6
v_xor_b32 v31, v31, v6
v_add_u32 v32, 2048, v5
v_lshrrev_b32 v6, 4, v32
v_and_b32 v6, 0xf0, v6
v_xor_b32 v32, v32, v6
v_add_u32 v33, 3072, v5
v_lshrrev_b32 v6, 4, v33
v_and_b32 v6, 0xf0, v6
v_xor_b32 v33, v33, v6
v_add_u32 v34, 4096, v5
v_lshrrev_b32 v6, 4, v34
v_and_b32 v6, 0xf0, v6
v_xor_b32 v34, v34, v6
s_waitcnt lgkmcnt(0)
s_barrier
ds_read_b128 v[8:11], v30 offset:16384
ds_read_b128 v[12:15], v31 offset:16384
ds_read_b128 v[16:19], v32 offset:16384
ds_read_b128 v[20:23], v33 offset:16384
ds_read_b128 v[24:27], v34 offset:16384
s_add_u32 s3, s30, 0
s_waitcnt lgkmcnt(4)
buffer_store_dwordx4 v[8:11], v5, s[4:7], s3 offen sc1
s_add_u32 s3, s30, 1024
s_waitcnt lgkmcnt(3)
buffer_store_dwordx4 v[12:15], v5, s[4:7], s3 offen sc1
s_add_u32 s3, s30, 2048
s_waitcnt lgkmcnt(2)
buffer_store_dwordx4 v[16:19], v5, s[4:7], s3 offen sc1
s_add_u32 s3, s30, 3072
s_waitcnt lgkmcnt(1)
buffer_store_dwordx4 v[20:23], v5, s[4:7], s3 offen sc1
s_add_u32 s3, s30, 4096
s_waitcnt lgkmcnt(0)
buffer_store_dwordx4 v[24:27], v5, s[4:7], s3 offen sc1
s_waitcnt vmcnt(0)
s_barrier
v_mov_b32 v9, 1
s_cmp_lg_u32 s26, 0
s_cbranch_scc1 L_ph_s
buffer_store_dword v9, off, s[4:7], s34 sc1
L_ph_s:
s_waitcnt vmcnt(0) lgkmcnt(0)
s_mov_b32 s8, s74
s_mov_b32 s9, s75
s_mov_b32 s10, 5242880
s_mov_b32 s11, 0x20000
s_mov_b32 s12, s84
s_mov_b32 s13, s85
s_mov_b32 s14, 2211840
s_mov_b32 s15, 0x20000
s_mov_b32 s16, s80
s_mov_b32 s17, s81
s_mov_b32 s18, 2211840
s_mov_b32 s19, 0x20000
s_cmp_lt_u32 s26, 2
s_cbranch_scc1 L_pgate_s
s_mov_b32 s16, s82
s_mov_b32 s17, s83
L_pgate_s:
s_lshl_b32 s53, s26, 10
v_lshrrev_b32 v8, 4, v0
v_and_b32 v9, 15, v0
v_mul_u32_u24 v1, 1280, v8
v_lshl_add_u32 v1, v9, 4, v1
v_lshrrev_b32 v10, 3, v0
v_and_b32 v11, 7, v0
v_mul_u32_u24 v2, 3456, v10
v_lshl_add_u32 v2, v11, 4, v2
v_bfe_u32 v10, v0, 1, 1
v_and_b32 v11, 1, v0
v_lshlrev_b32 v12, 4, v11
v_lshl_add_u32 v12, v10, 3, v12
v_lshrrev_b32 v10, 5, v0
v_bfe_u32 v8, v0, 2, 2
v_lshl_add_u32 v8, v10, 3, v8
v_bfe_u32 v11, v0, 4, 1
v_lshl_add_u32 v3, v8, 8, v12
v_lshl_add_u32 v3, v11, 5, v3
s_lshl_b32 s3, s26, 6
v_add_u32 v3, s3, v3
v_lshl_add_u32 v4, v8, 7, v12
v_lshl_add_u32 v4, v11, 11, v4
s_lshl_b32 s3, s26, 5
v_add_u32 v4, s3, v4
s_mul_i32 s31, s26, 5120
s_mul_i32 s3, s25, 163840
s_add_u32 s34, s3, s31
s_mul_i32 s3, s25, 81920
s_add_u32 s36, s3, s31
s_lshl_b32 s3, s25, 7
s_and_b32 s37, s26, 1
s_mul_i32 s37, s37, 27648
s_add_u32 s37, s37, s3
s_cmp_lt_u32 s25, 27
s_cselect_b32 s37, s37, 0x40000000
s_cmp_lt_u32 s24, 6
s_cselect_b64 vcc, -1, 0
s_add_u32 m0, s53, 0
s_add_u32 s3, s34, 0
buffer_load_dwordx4 v1, s[8:11], s3 offen lds
s_add_u32 m0, s53, 4096
s_add_u32 s3, s34, 20480
buffer_load_dwordx4 v1, s[8:11], s3 offen lds
s_cbranch_vccnz L_pth1_s
s_waitcnt vmcnt(1)
L_pth1_s:
s_add_u32 m0, s53, 8192
s_add_u32 s3, s34, 40960
buffer_load_dwordx4 v1, s[8:11], s3 offen lds
s_add_u32 m0, s53, 12288
s_add_u32 s3, s34, 61440
buffer_load_dwordx4 v1, s[8:11], s3 offen lds
s_cbranch_vccnz L_pth3_s
s_waitcnt vmcnt(1)
L_pth3_s:
s_add_u32 m0, s53, 16384
s_add_u32 s3, s34, 81920
buffer_load_dwordx4 v1, s[8:11], s3 offen lds
s_add_u32 m0, s53, 20480
s_add_u32 s3, s34, 102400
buffer_load_dwordx4 v1, s[8:11], s3 offen lds
s_cbranch_vccnz L_pth5_s
s_waitcnt vmcnt(1)
L_pth5_s:
s_add_u32 m0, s53, 24576
s_add_u32 s3, s34, 122880
buffer_load_dwordx4 v1, s[8:11], s3 offen lds
s_add_u32 m0, s53, 28672
s_add_u32 s3, s34, 143360
buffer_load_dwordx4 v1, s[8:11], s3 offen lds
s_cbranch_vccnz L_pth7_s
s_waitcnt vmcnt(1)
L_pth7_s:
s_add_u32 m0, s53, 32768
s_add_u32 s3, s34, 256
buffer_load_dwordx4 v1, s[8:11], s3 offen lds
s_add_u32 m0, s53, 36864
s_add_u32 s3, s34, 20736
buffer_load_dwordx4 v1, s[8:11], s3 offen lds
s_cbranch_vccnz L_pth9_s
s_waitcnt vmcnt(1)
L_pth9_s:
s_add_u32 m0, s53, 40960
s_add_u32 s3, s34, 41216
buffer_load_dwordx4 v1, s[8:11], s3 offen lds
s_add_u32 m0, s53, 45056
s_add_u32 s3, s34, 61696
buffer_load_dwordx4 v1, s[8:11], s3 offen lds
s_cbranch_vccnz L_pth11_s
s_waitcnt vmcnt(1)
L_pth11_s:
s_add_u32 m0, s53, 49152
s_add_u32 s3, s34, 82176
buffer_load_dwordx4 v1, s[8:11], s3 offen lds
s_add_u32 m0, s53, 53248
s_add_u32 s3, s34, 102656
buffer_load_dwordx4 v1, s[8:11], s3 offen lds
s_cbranch_vccnz L_pth13_s
s_waitcnt vmcnt(1)
L_pth13_s:
s_add_u32 m0, s53, 57344
s_add_u32 s3, s34, 123136
buffer_load_dwordx4 v1, s[8:11], s3 offen lds
s_add_u32 m0, s53, 61440
s_add_u32 s3, s34, 143616
buffer_load_dwordx4 v1, s[8:11], s3 offen lds
s_cbranch_vccnz L_pth15_s
s_waitcnt vmcnt(1)
L_pth15_s:
v_add_u32 v5, 0, v3
s_waitcnt vmcnt(12)
s_barrier
ds_read_b64_tr_b16 v[112:113], v5 offset:0
ds_read_b64_tr_b16 v[114:115], v5 offset:1024
ds_read_b64_tr_b16 v[116:117], v5 offset:4096
ds_read_b64_tr_b16 v[118:119], v5 offset:5120
ds_read_b64_tr_b16 v[120:121], v5 offset:8192
ds_read_b64_tr_b16 v[122:123], v5 offset:9216
ds_read_b64_tr_b16 v[124:125], v5 offset:12288
ds_read_b64_tr_b16 v[126:127], v5 offset:13312
s_add_u32 m0, s53, 65536
s_add_u32 s3, s34, 512
buffer_load_dwordx4 v1, s[8:11], s3 offen lds
s_add_u32 m0, s53, 69632
s_add_u32 s3, s34, 20992
buffer_load_dwordx4 v1, s[8:11], s3 offen lds
s_cbranch_vccnz L_pth17_s
s_waitcnt vmcnt(1)
L_pth17_s:
s_add_u32 m0, s53, 73728
s_add_u32 s3, s34, 41472
buffer_load_dwordx4 v1, s[8:11], s3 offen lds
s_add_u32 m0, s53, 77824
s_add_u32 s3, s34, 61952
buffer_load_dwordx4 v1, s[8:11], s3 offen lds
s_cbranch_vccnz L_pth19_s
s_waitcnt vmcnt(1)
L_pth19_s:
v_add_u32 v5, 16384, v3
s_waitcnt vmcnt(12)
s_waitcnt lgkmcnt(0)
s_barrier
ds_read_b64_tr_b16 v[128:129], v5 offset:0
ds_read_b64_tr_b16 v[130:131], v5 offset:1024
ds_read_b64_tr_b16 v[132:133], v5 offset:4096
ds_read_b64_tr_b16 v[134:135], v5 offset:5120
ds_read_b64_tr_b16 v[136:137], v5 offset:8192
ds_read_b64_tr_b16 v[138:139], v5 offset:9216
ds_read_b64_tr_b16 v[140:141], v5 offset:12288
ds_read_b64_tr_b16 v[142:143], v5 offset:13312
s_add_u32 m0, s53, 81920
s_add_u32 s3, s34, 82432
buffer_load_dwordx4 v1, s[8:11], s3 offen lds
s_add_u32 m0, s53, 86016
s_add_u32 s3, s34, 102912
buffer_load_dwordx4 v1, s[8:11], s3 offen lds
s_cbranch_vccnz L_pth21_s
s_waitcnt vmcnt(1)
L_pth21_s:
s_add_u32 m0, s53, 90112
s_add_u32 s3, s34, 123392
buffer_load_dwordx4 v1, s[8:11], s3 offen lds
s_add_u32 m0, s53, 94208
s_add_u32 s3, s34, 143872
buffer_load_dwordx4 v1, s[8:11], s3 offen lds
s_cbranch_vccnz L_pth23_s
s_waitcnt vmcnt(1)
L_pth23_s:
v_add_u32 v5, 32768, v3
s_waitcnt vmcnt(12)
s_waitcnt lgkmcnt(0)
s_barrier
ds_read_b64_tr_b16 v[144:145], v5 offset:0
ds_read_b64_tr_b16 v[146:147], v5 offset:1024
ds_read_b64_tr_b16 v[148:149], v5 offset:4096
ds_read_b64_tr_b16 v[150:151], v5 offset:5120
ds_read_b64_tr_b16 v[152:153], v5 offset:8192
ds_read_b64_tr_b16 v[154:155], v5 offset:9216
ds_read_b64_tr_b16 v[156:157], v5 offset:12288
ds_read_b64_tr_b16 v[158:159], v5 offset:13312
s_add_u32 m0, s53, 98304
s_add_u32 s3, s34, 768
buffer_load_dwordx4 v1, s[8:11], s3 offen lds
s_add_u32 m0, s53, 102400
s_add_u32 s3, s34, 21248
buffer_load_dwordx4 v1, s[8:11], s3 offen lds
s_cbranch_vccnz L_pth25_s
s_waitcnt vmcnt(1)
L_pth25_s:
s_add_u32 m0, s53, 106496
s_add_u32 s3, s34, 41728
buffer_load_dwordx4 v1, s[8:11], s3 offen lds
s_add_u32 m0, s53, 110592
s_add_u32 s3, s34, 62208
buffer_load_dwordx4 v1, s[8:11], s3 offen lds
s_cbranch_vccnz L_pth27_s
s_waitcnt vmcnt(1)
L_pth27_s:
v_add_u32 v5, 49152, v3
s_waitcnt vmcnt(12)
s_waitcnt lgkmcnt(0)
s_barrier
ds_read_b64_tr_b16 v[160:161], v5 offset:0
ds_read_b64_tr_b16 v[162:163], v5 offset:1024
ds_read_b64_tr_b16 v[164:165], v5 offset:4096
ds_read_b64_tr_b16 v[166:167], v5 offset:5120
ds_read_b64_tr_b16 v[168:169], v5 offset:8192
ds_read_b64_tr_b16 v[170:171], v5 offset:9216
ds_read_b64_tr_b16 v[172:173], v5 offset:12288
ds_read_b64_tr_b16 v[174:175], v5 offset:13312
s_add_u32 m0, s53, 114688
s_add_u32 s3, s34, 82688
buffer_load_dwordx4 v1, s[8:11], s3 offen lds
s_add_u32 m0, s53, 118784
s_add_u32 s3, s34, 103168
buffer_load_dwordx4 v1, s[8:11], s3 offen lds
s_cbranch_vccnz L_pth29_s
s_waitcnt vmcnt(1)
L_pth29_s:
s_add_u32 m0, s53, 122880
s_add_u32 s3, s34, 123648
buffer_load_dwordx4 v1, s[8:11], s3 offen lds
s_add_u32 m0, s53, 126976
s_add_u32 s3, s34, 144128
buffer_load_dwordx4 v1, s[8:11], s3 offen lds
s_cbranch_vccnz L_pth31_s
s_waitcnt vmcnt(1)
L_pth31_s:
v_add_u32 v5, 65536, v3
s_waitcnt vmcnt(12)
s_waitcnt lgkmcnt(0)
s_barrier
ds_read_b64_tr_b16 v[176:177], v5 offset:0
ds_read_b64_tr_b16 v[178:179], v5 offset:1024
ds_read_b64_tr_b16 v[180:181], v5 offset:4096
ds_read_b64_tr_b16 v[182:183], v5 offset:5120
ds_read_b64_tr_b16 v[184:185], v5 offset:8192
ds_read_b64_tr_b16 v[186:187], v5 offset:9216
ds_read_b64_tr_b16 v[188:189], v5 offset:12288
ds_read_b64_tr_b16 v[190:191], v5 offset:13312
s_add_u32 m0, s53, 131072
s_add_u32 s3, s34, 1024
buffer_load_dwordx4 v1, s[8:11], s3 offen lds
s_add_u32 m0, s53, 135168
s_add_u32 s3, s34, 21504
buffer_load_dwordx4 v1, s[8:11], s3 offen lds
s_cbranch_vccnz L_pth33_s
s_waitcnt vmcnt(1)
L_pth33_s:
s_add_u32 m0, s53, 139264
s_add_u32 s3, s34, 41984
buffer_load_dwordx4 v1, s[8:11], s3 offen lds
s_add_u32 m0, s53, 143360
s_add_u32 s3, s34, 62464
buffer_load_dwordx4 v1, s[8:11], s3 offen lds
s_cbranch_vccnz L_pth35_s
s_waitcnt vmcnt(1)
L_pth35_s:
v_add_u32 v5, 81920, v3
s_waitcnt vmcnt(12)
s_waitcnt lgkmcnt(0)
s_barrier
ds_read_b64_tr_b16 v[192:193], v5 offset:0
ds_read_b64_tr_b16 v[194:195], v5 offset:1024
ds_read_b64_tr_b16 v[196:197], v5 offset:4096
ds_read_b64_tr_b16 v[198:199], v5 offset:5120
ds_read_b64_tr_b16 v[200:201], v5 offset:8192
ds_read_b64_tr_b16 v[202:203], v5 offset:9216
ds_read_b64_tr_b16 v[204:205], v5 offset:12288
ds_read_b64_tr_b16 v[206:207], v5 offset:13312
s_add_u32 m0, s53, 147456
s_add_u32 s3, s34, 82944
buffer_load_dwordx4 v1, s[8:11], s3 offen lds
s_add_u32 m0, s53, 151552
s_add_u32 s3, s34, 103424
buffer_load_dwordx4 v1, s[8:11], s3 offen lds
s_cbranch_vccnz L_pth37_s
s_waitcnt vmcnt(1)
L_pth37_s:
s_add_u32 m0, s53, 155648
s_add_u32 s3, s34, 123904
buffer_load_dwordx4 v1, s[8:11], s3 offen lds
s_add_u32 m0, s53, 159744
s_add_u32 s3, s34, 144384
buffer_load_dwordx4 v1, s[8:11], s3 offen lds
s_cbranch_vccnz L_pth39_s
s_waitcnt vmcnt(1)
L_pth39_s:
v_add_u32 v5, 98304, v3
s_waitcnt vmcnt(12)
s_waitcnt lgkmcnt(0)
s_barrier
ds_read_b64_tr_b16 v[208:209], v5 offset:0
ds_read_b64_tr_b16 v[210:211], v5 offset:1024
ds_read_b64_tr_b16 v[212:213], v5 offset:4096
ds_read_b64_tr_b16 v[214:215], v5 offset:5120
ds_read_b64_tr_b16 v[216:217], v5 offset:8192
ds_read_b64_tr_b16 v[218:219], v5 offset:9216
ds_read_b64_tr_b16 v[220:221], v5 offset:12288
ds_read_b64_tr_b16 v[222:223], v5 offset:13312
s_add_u32 m0, s53, 0
s_add_u32 s3, s37, 0
buffer_load_dwordx4 v2, s[16:19], s3 offen lds
s_add_u32 m0, s53, 4096
s_add_u32 s3, s37, 55296
buffer_load_dwordx4 v2, s[16:19], s3 offen lds
s_cbranch_vccnz L_pth41_s
s_waitcnt vmcnt(1)
L_pth41_s:
s_add_u32 m0, s53, 8192
s_add_u32 s3, s37, 110592
buffer_load_dwordx4 v2, s[16:19], s3 offen lds
s_add_u32 m0, s53, 12288
s_add_u32 s3, s37, 165888
buffer_load_dwordx4 v2, s[16:19], s3 offen lds
s_cbranch_vccnz L_pth43_s
s_waitcnt vmcnt(1)
L_pth43_s:
v_add_u32 v5, 114688, v3
s_waitcnt vmcnt(12)
s_waitcnt lgkmcnt(0)
s_barrier
ds_read_b64_tr_b16 v[224:225], v5 offset:0
ds_read_b64_tr_b16 v[226:227], v5 offset:1024
ds_read_b64_tr_b16 v[228:229], v5 offset:4096
ds_read_b64_tr_b16 v[230:231], v5 offset:5120
ds_read_b64_tr_b16 v[232:233], v5 offset:8192
ds_read_b64_tr_b16 v[234:235], v5 offset:9216
ds_read_b64_tr_b16 v[236:237], v5 offset:12288
ds_read_b64_tr_b16 v[238:239], v5 offset:13312
s_add_u32 m0, s53, 16384
s_add_u32 s3, s37, 221184
buffer_load_dwordx4 v2, s[16:19], s3 offen lds
s_add_u32 m0, s53, 20480
s_add_u32 s3, s37, 276480
buffer_load_dwordx4 v2, s[16:19], s3 offen lds
s_cbranch_vccnz L_pth45_s
s_waitcnt vmcnt(1)
L_pth45_s:
s_add_u32 m0, s53, 24576
s_add_u32 s3, s37, 331776
buffer_load_dwordx4 v2, s[16:19], s3 offen lds
s_add_u32 m0, s53, 28672
s_add_u32 s3, s37, 387072
buffer_load_dwordx4 v2, s[16:19], s3 offen lds
s_cbranch_vccnz L_pth47_s
s_waitcnt vmcnt(1)
L_pth47_s:
v_add_u32 v5, 131072, v3
s_waitcnt vmcnt(12)
s_waitcnt lgkmcnt(0)
s_barrier
ds_read_b64_tr_b16 v[240:241], v5 offset:0
ds_read_b64_tr_b16 v[242:243], v5 offset:1024
ds_read_b64_tr_b16 v[244:245], v5 offset:4096
ds_read_b64_tr_b16 v[246:247], v5 offset:5120
ds_read_b64_tr_b16 v[248:249], v5 offset:8192
ds_read_b64_tr_b16 v[250:251], v5 offset:9216
ds_read_b64_tr_b16 v[252:253], v5 offset:12288
ds_read_b64_tr_b16 v[254:255], v5 offset:13312
s_add_u32 m0, s53, 32768
s_add_u32 s3, s37, 442368
buffer_load_dwordx4 v2, s[16:19], s3 offen lds
s_add_u32 m0, s53, 36864
s_add_u32 s3, s37, 497664
buffer_load_dwordx4 v2, s[16:19], s3 offen lds
s_cbranch_vccnz L_pth49_s
s_waitcnt vmcnt(1)
L_pth49_s:
s_add_u32 m0, s53, 40960
s_add_u32 s3, s37, 552960
buffer_load_dwordx4 v2, s[16:19], s3 offen lds
s_add_u32 m0, s53, 45056
s_add_u32 s3, s37, 608256
buffer_load_dwordx4 v2, s[16:19], s3 offen lds
s_cbranch_vccnz L_pth51_s
s_waitcnt vmcnt(1)
L_pth51_s:
v_add_u32 v5, 147456, v3
s_waitcnt vmcnt(12)
s_waitcnt lgkmcnt(0)
s_barrier
ds_read_b64_tr_b16 a[0:1], v5 offset:0
ds_read_b64_tr_b16 a[2:3], v5 offset:1024
ds_read_b64_tr_b16 a[4:5], v5 offset:4096
ds_read_b64_tr_b16 a[6:7], v5 offset:5120
ds_read_b64_tr_b16 a[8:9], v5 offset:8192
ds_read_b64_tr_b16 a[10:11], v5 offset:9216
ds_read_b64_tr_b16 a[12:13], v5 offset:12288
ds_read_b64_tr_b16 a[14:15], v5 offset:13312
s_add_u32 m0, s53, 49152
s_add_u32 s3, s37, 663552
buffer_load_dwordx4 v2, s[16:19], s3 offen lds
s_add_u32 m0, s53, 53248
s_add_u32 s3, s37, 718848
buffer_load_dwordx4 v2, s[16:19], s3 offen lds
s_cbranch_vccnz L_pth53_s
s_waitcnt vmcnt(1)
L_pth53_s:
s_add_u32 m0, s53, 57344
s_add_u32 s3, s37, 774144
buffer_load_dwordx4 v2, s[16:19], s3 offen lds
s_add_u32 m0, s53, 61440
s_add_u32 s3, s37, 829440
buffer_load_dwordx4 v2, s[16:19], s3 offen lds
s_cbranch_vccnz L_pth55_s
s_waitcnt vmcnt(1)
L_pth55_s:
v_add_u32 v5, 0, v4
s_waitcnt vmcnt(12)
s_waitcnt lgkmcnt(0)
s_barrier
ds_read_b64_tr_b16 a[16:17], v5 offset:0
ds_read_b64_tr_b16 a[18:19], v5 offset:512
ds_read_b64_tr_b16 a[20:21], v5 offset:4096
ds_read_b64_tr_b16 a[22:23], v5 offset:4608
ds_read_b64_tr_b16 a[24:25], v5 offset:8192
ds_read_b64_tr_b16 a[26:27], v5 offset:8704
ds_read_b64_tr_b16 a[28:29], v5 offset:12288
ds_read_b64_tr_b16 a[30:31], v5 offset:12800
s_add_u32 m0, s53, 65536
s_add_u32 s3, s37, 884736
buffer_load_dwordx4 v2, s[16:19], s3 offen lds
s_add_u32 m0, s53, 69632
s_add_u32 s3, s37, 940032
buffer_load_dwordx4 v2, s[16:19], s3 offen lds
s_cbranch_vccnz L_pth57_s
s_waitcnt vmcnt(1)
L_pth57_s:
s_add_u32 m0, s53, 73728
s_add_u32 s3, s37, 995328
buffer_load_dwordx4 v2, s[16:19], s3 offen lds
s_add_u32 m0, s53, 77824
s_add_u32 s3, s37, 1050624
buffer_load_dwordx4 v2, s[16:19], s3 offen lds
s_cbranch_vccnz L_pth59_s
s_waitcnt vmcnt(1)
L_pth59_s:
v_add_u32 v5, 16384, v4
s_waitcnt vmcnt(12)
s_waitcnt lgkmcnt(0)
s_barrier
ds_read_b64_tr_b16 a[32:33], v5 offset:0
ds_read_b64_tr_b16 a[34:35], v5 offset:512
ds_read_b64_tr_b16 a[36:37], v5 offset:4096
ds_read_b64_tr_b16 a[38:39], v5 offset:4608
ds_read_b64_tr_b16 a[40:41], v5 offset:8192
ds_read_b64_tr_b16 a[42:43], v5 offset:8704
ds_read_b64_tr_b16 a[44:45], v5 offset:12288
ds_read_b64_tr_b16 a[46:47], v5 offset:12800
s_add_u32 m0, s53, 81920
s_add_u32 s3, s37, 1105920
buffer_load_dwordx4 v2, s[16:19], s3 offen lds
s_add_u32 m0, s53, 86016
s_add_u32 s3, s37, 1161216
buffer_load_dwordx4 v2, s[16:19], s3 offen lds
s_cbranch_vccnz L_pth61_s
s_waitcnt vmcnt(1)
L_pth61_s:
s_add_u32 m0, s53, 90112
s_add_u32 s3, s37, 1216512
buffer_load_dwordx4 v2, s[16:19], s3 offen lds
s_add_u32 m0, s53, 94208
s_add_u32 s3, s37, 1271808
buffer_load_dwordx4 v2, s[16:19], s3 offen lds
s_cbranch_vccnz L_pth63_s
s_waitcnt vmcnt(1)
L_pth63_s:
v_add_u32 v5, 32768, v4
s_waitcnt vmcnt(12)
s_waitcnt lgkmcnt(0)
s_barrier
ds_read_b64_tr_b16 a[48:49], v5 offset:0
ds_read_b64_tr_b16 a[50:51], v5 offset:512
ds_read_b64_tr_b16 a[52:53], v5 offset:4096
ds_read_b64_tr_b16 a[54:55], v5 offset:4608
ds_read_b64_tr_b16 a[56:57], v5 offset:8192
ds_read_b64_tr_b16 a[58:59], v5 offset:8704
ds_read_b64_tr_b16 a[60:61], v5 offset:12288
ds_read_b64_tr_b16 a[62:63], v5 offset:12800
s_add_u32 m0, s53, 98304
s_add_u32 s3, s37, 1327104
buffer_load_dwordx4 v2, s[16:19], s3 offen lds
s_add_u32 m0, s53, 102400
s_add_u32 s3, s37, 1382400
buffer_load_dwordx4 v2, s[16:19], s3 offen lds
s_cbranch_vccnz L_pth65_s
s_waitcnt vmcnt(1)
L_pth65_s:
s_add_u32 m0, s53, 106496
s_add_u32 s3, s37, 1437696
buffer_load_dwordx4 v2, s[16:19], s3 offen lds
s_add_u32 m0, s53, 110592
s_add_u32 s3, s37, 1492992
buffer_load_dwordx4 v2, s[16:19], s3 offen lds
s_cbranch_vccnz L_pth67_s
s_waitcnt vmcnt(1)
L_pth67_s:
v_add_u32 v5, 49152, v4
s_waitcnt vmcnt(12)
s_waitcnt lgkmcnt(0)
s_barrier
ds_read_b64_tr_b16 a[64:65], v5 offset:0
ds_read_b64_tr_b16 a[66:67], v5 offset:512
ds_read_b64_tr_b16 a[68:69], v5 offset:4096
ds_read_b64_tr_b16 a[70:71], v5 offset:4608
ds_read_b64_tr_b16 a[72:73], v5 offset:8192
ds_read_b64_tr_b16 a[74:75], v5 offset:8704
ds_read_b64_tr_b16 a[76:77], v5 offset:12288
ds_read_b64_tr_b16 a[78:79], v5 offset:12800
s_add_u32 m0, s53, 114688
s_add_u32 s3, s37, 1548288
buffer_load_dwordx4 v2, s[16:19], s3 offen lds
s_add_u32 m0, s53, 118784
s_add_u32 s3, s37, 1603584
buffer_load_dwordx4 v2, s[16:19], s3 offen lds
s_cbranch_vccnz L_pth69_s
s_waitcnt vmcnt(1)
L_pth69_s:
s_add_u32 m0, s53, 122880
s_add_u32 s3, s37, 1658880
buffer_load_dwordx4 v2, s[16:19], s3 offen lds
s_add_u32 m0, s53, 126976
s_add_u32 s3, s37, 1714176
buffer_load_dwordx4 v2, s[16:19], s3 offen lds
s_cbranch_vccnz L_pth71_s
s_waitcnt vmcnt(1)
L_pth71_s:
v_add_u32 v5, 65536, v4
s_waitcnt vmcnt(12)
s_waitcnt lgkmcnt(0)
s_barrier
ds_read_b64_tr_b16 a[80:81], v5 offset:0
ds_read_b64_tr_b16 a[82:83], v5 offset:512
ds_read_b64_tr_b16 a[84:85], v5 offset:4096
ds_read_b64_tr_b16 a[86:87], v5 offset:4608
ds_read_b64_tr_b16 a[88:89], v5 offset:8192
ds_read_b64_tr_b16 a[90:91], v5 offset:8704
ds_read_b64_tr_b16 a[92:93], v5 offset:12288
ds_read_b64_tr_b16 a[94:95], v5 offset:12800
s_add_u32 m0, s53, 131072
s_add_u32 s3, s37, 1769472
buffer_load_dwordx4 v2, s[16:19], s3 offen lds
s_add_u32 m0, s53, 135168
s_add_u32 s3, s37, 1824768
buffer_load_dwordx4 v2, s[16:19], s3 offen lds
s_cbranch_vccnz L_pth73_s
s_waitcnt vmcnt(1)
L_pth73_s:
s_add_u32 m0, s53, 139264
s_add_u32 s3, s37, 1880064
buffer_load_dwordx4 v2, s[16:19], s3 offen lds
s_add_u32 m0, s53, 143360
s_add_u32 s3, s37, 1935360
buffer_load_dwordx4 v2, s[16:19], s3 offen lds
s_cbranch_vccnz L_pth75_s
s_waitcnt vmcnt(1)
L_pth75_s:
v_add_u32 v5, 81920, v4
s_waitcnt vmcnt(12)
s_waitcnt lgkmcnt(0)
s_barrier
ds_read_b64_tr_b16 a[96:97], v5 offset:0
ds_read_b64_tr_b16 a[98:99], v5 offset:512
ds_read_b64_tr_b16 a[100:101], v5 offset:4096
ds_read_b64_tr_b16 a[102:103], v5 offset:4608
ds_read_b64_tr_b16 a[104:105], v5 offset:8192
ds_read_b64_tr_b16 a[106:107], v5 offset:8704
ds_read_b64_tr_b16 a[108:109], v5 offset:12288
ds_read_b64_tr_b16 a[110:111], v5 offset:12800
s_add_u32 m0, s53, 147456
s_add_u32 s3, s37, 1990656
buffer_load_dwordx4 v2, s[16:19], s3 offen lds
s_add_u32 m0, s53, 151552
s_add_u32 s3, s37, 2045952
buffer_load_dwordx4 v2, s[16:19], s3 offen lds
s_cbranch_vccnz L_pth77_s
s_waitcnt vmcnt(1)
L_pth77_s:
s_add_u32 m0, s53, 155648
s_add_u32 s3, s37, 2101248
buffer_load_dwordx4 v2, s[16:19], s3 offen lds
s_add_u32 m0, s53, 159744
s_add_u32 s3, s37, 2156544
buffer_load_dwordx4 v2, s[16:19], s3 offen lds
s_cbranch_vccnz L_pth79_s
s_waitcnt vmcnt(1)
L_pth79_s:
v_add_u32 v5, 98304, v4
s_waitcnt vmcnt(12)
s_waitcnt lgkmcnt(0)
s_barrier
ds_read_b64_tr_b16 a[112:113], v5 offset:0
ds_read_b64_tr_b16 a[114:115], v5 offset:512
ds_read_b64_tr_b16 a[116:117], v5 offset:4096
ds_read_b64_tr_b16 a[118:119], v5 offset:4608
ds_read_b64_tr_b16 a[120:121], v5 offset:8192
ds_read_b64_tr_b16 a[122:123], v5 offset:8704
ds_read_b64_tr_b16 a[124:125], v5 offset:12288
ds_read_b64_tr_b16 a[126:127], v5 offset:12800
s_add_u32 m0, s53, 0
s_add_u32 s3, s36, 0
buffer_load_dwordx4 v1, s[12:15], s3 offen lds
s_add_u32 m0, s53, 4096
s_add_u32 s3, s36, 20480
buffer_load_dwordx4 v1, s[12:15], s3 offen lds
s_cbranch_vccnz L_pth81_s
s_waitcnt vmcnt(1)
L_pth81_s:
s_add_u32 m0, s53, 8192
s_add_u32 s3, s36, 40960
buffer_load_dwordx4 v1, s[12:15], s3 offen lds
s_add_u32 m0, s53, 12288
s_add_u32 s3, s36, 61440
buffer_load_dwordx4 v1, s[12:15], s3 offen lds
s_cbranch_vccnz L_pth83_s
s_waitcnt vmcnt(1)
L_pth83_s:
v_add_u32 v5, 114688, v4
s_waitcnt vmcnt(12)
s_waitcnt lgkmcnt(0)
s_barrier
ds_read_b64_tr_b16 a[128:129], v5 offset:0
ds_read_b64_tr_b16 a[130:131], v5 offset:512
ds_read_b64_tr_b16 a[132:133], v5 offset:4096
ds_read_b64_tr_b16 a[134:135], v5 offset:4608
ds_read_b64_tr_b16 a[136:137], v5 offset:8192
ds_read_b64_tr_b16 a[138:139], v5 offset:8704
ds_read_b64_tr_b16 a[140:141], v5 offset:12288
ds_read_b64_tr_b16 a[142:143], v5 offset:12800
s_add_u32 m0, s53, 16384
s_add_u32 s3, s36, 256
buffer_load_dwordx4 v1, s[12:15], s3 offen lds
s_add_u32 m0, s53, 20480
s_add_u32 s3, s36, 20736
buffer_load_dwordx4 v1, s[12:15], s3 offen lds
s_cbranch_vccnz L_pth85_s
s_waitcnt vmcnt(1)
L_pth85_s:
s_add_u32 m0, s53, 24576
s_add_u32 s3, s36, 41216
buffer_load_dwordx4 v1, s[12:15], s3 offen lds
s_add_u32 m0, s53, 28672
s_add_u32 s3, s36, 61696
buffer_load_dwordx4 v1, s[12:15], s3 offen lds
s_cbranch_vccnz L_pth87_s
s_waitcnt vmcnt(1)
L_pth87_s:
v_add_u32 v5, 131072, v4
s_waitcnt vmcnt(12)
s_waitcnt lgkmcnt(0)
s_barrier
ds_read_b64_tr_b16 a[144:145], v5 offset:0
ds_read_b64_tr_b16 a[146:147], v5 offset:512
ds_read_b64_tr_b16 a[148:149], v5 offset:4096
ds_read_b64_tr_b16 a[150:151], v5 offset:4608
ds_read_b64_tr_b16 a[152:153], v5 offset:8192
ds_read_b64_tr_b16 a[154:155], v5 offset:8704
ds_read_b64_tr_b16 a[156:157], v5 offset:12288
ds_read_b64_tr_b16 a[158:159], v5 offset:12800
s_add_u32 m0, s53, 32768
s_add_u32 s3, s36, 512
buffer_load_dwordx4 v1, s[12:15], s3 offen lds
s_add_u32 m0, s53, 36864
s_add_u32 s3, s36, 20992
buffer_load_dwordx4 v1, s[12:15], s3 offen lds
s_cbranch_vccnz L_pth89_s
s_waitcnt vmcnt(1)
L_pth89_s:
s_add_u32 m0, s53, 40960
s_add_u32 s3, s36, 41472
buffer_load_dwordx4 v1, s[12:15], s3 offen lds
s_add_u32 m0, s53, 45056
s_add_u32 s3, s36, 61952
buffer_load_dwordx4 v1, s[12:15], s3 offen lds
s_cbranch_vccnz L_pth91_s
s_waitcnt vmcnt(1)
L_pth91_s:
v_add_u32 v5, 147456, v4
s_waitcnt vmcnt(12)
s_waitcnt lgkmcnt(0)
s_barrier
ds_read_b64_tr_b16 a[160:161], v5 offset:0
ds_read_b64_tr_b16 a[162:163], v5 offset:512
ds_read_b64_tr_b16 a[164:165], v5 offset:4096
ds_read_b64_tr_b16 a[166:167], v5 offset:4608
ds_read_b64_tr_b16 a[168:169], v5 offset:8192
ds_read_b64_tr_b16 a[170:171], v5 offset:8704
ds_read_b64_tr_b16 a[172:173], v5 offset:12288
ds_read_b64_tr_b16 a[174:175], v5 offset:12800
s_add_u32 m0, s53, 49152
s_add_u32 s3, s36, 768
buffer_load_dwordx4 v1, s[12:15], s3 offen lds
s_add_u32 m0, s53, 53248
s_add_u32 s3, s36, 21248
buffer_load_dwordx4 v1, s[12:15], s3 offen lds
s_cbranch_vccnz L_pth93_s
s_waitcnt vmcnt(1)
L_pth93_s:
s_add_u32 m0, s53, 57344
s_add_u32 s3, s36, 41728
buffer_load_dwordx4 v1, s[12:15], s3 offen lds
s_add_u32 m0, s53, 61440
s_add_u32 s3, s36, 62208
buffer_load_dwordx4 v1, s[12:15], s3 offen lds
s_cbranch_vccnz L_pth95_s
s_waitcnt vmcnt(1)
L_pth95_s:
v_add_u32 v5, 0, v3
s_waitcnt vmcnt(12)
s_waitcnt lgkmcnt(0)
s_barrier
ds_read_b64_tr_b16 a[176:177], v5 offset:0
ds_read_b64_tr_b16 a[178:179], v5 offset:1024
ds_read_b64_tr_b16 a[180:181], v5 offset:4096
ds_read_b64_tr_b16 a[182:183], v5 offset:5120
ds_read_b64_tr_b16 a[184:185], v5 offset:8192
ds_read_b64_tr_b16 a[186:187], v5 offset:9216
ds_read_b64_tr_b16 a[188:189], v5 offset:12288
ds_read_b64_tr_b16 a[190:191], v5 offset:13312
s_add_u32 m0, s53, 65536
s_add_u32 s3, s36, 1024
buffer_load_dwordx4 v1, s[12:15], s3 offen lds
s_add_u32 m0, s53, 69632
s_add_u32 s3, s36, 21504
buffer_load_dwordx4 v1, s[12:15], s3 offen lds
s_cbranch_vccnz L_pth97_s
s_waitcnt vmcnt(1)
L_pth97_s:
s_add_u32 m0, s53, 73728
s_add_u32 s3, s36, 41984
buffer_load_dwordx4 v1, s[12:15], s3 offen lds
s_add_u32 m0, s53, 77824
s_add_u32 s3, s36, 62464
buffer_load_dwordx4 v1, s[12:15], s3 offen lds
s_cbranch_vccnz L_pth99_s
s_waitcnt vmcnt(1)
L_pth99_s:
v_add_u32 v5, 16384, v3
s_waitcnt vmcnt(12)
s_waitcnt lgkmcnt(0)
s_barrier
ds_read_b64_tr_b16 a[192:193], v5 offset:0
ds_read_b64_tr_b16 a[194:195], v5 offset:1024
ds_read_b64_tr_b16 a[196:197], v5 offset:4096
ds_read_b64_tr_b16 a[198:199], v5 offset:5120
ds_read_b64_tr_b16 a[200:201], v5 offset:8192
ds_read_b64_tr_b16 a[202:203], v5 offset:9216
ds_read_b64_tr_b16 a[204:205], v5 offset:12288
ds_read_b64_tr_b16 a[206:207], v5 offset:13312
v_add_u32 v5, 32768, v3
s_waitcnt vmcnt(8)
s_waitcnt lgkmcnt(0)
s_barrier
ds_read_b64_tr_b16 a[208:209], v5 offset:0
ds_read_b64_tr_b16 a[210:211], v5 offset:1024
ds_read_b64_tr_b16 a[212:213], v5 offset:4096
ds_read_b64_tr_b16 a[214:215], v5 offset:5120
ds_read_b64_tr_b16 a[216:217], v5 offset:8192
ds_read_b64_tr_b16 a[218:219], v5 offset:9216
ds_read_b64_tr_b16 a[220:221], v5 offset:12288
ds_read_b64_tr_b16 a[222:223], v5 offset:13312
v_add_u32 v5, 49152, v3
s_waitcnt vmcnt(4)
s_waitcnt lgkmcnt(0)
s_barrier
ds_read_b64_tr_b16 a[224:225], v5 offset:0
ds_read_b64_tr_b16 a[226:227], v5 offset:1024
ds_read_b64_tr_b16 a[228:229], v5 offset:4096
ds_read_b64_tr_b16 a[230:231], v5 offset:5120
ds_read_b64_tr_b16 a[232:233], v5 offset:8192
ds_read_b64_tr_b16 a[234:235], v5 offset:9216
ds_read_b64_tr_b16 a[236:237], v5 offset:12288
ds_read_b64_tr_b16 a[238:239], v5 offset:13312
v_add_u32 v5, 65536, v3
s_waitcnt vmcnt(0)
s_waitcnt lgkmcnt(0)
s_barrier
ds_read_b64_tr_b16 a[240:241], v5 offset:0
ds_read_b64_tr_b16 a[242:243], v5 offset:1024
ds_read_b64_tr_b16 a[244:245], v5 offset:4096
ds_read_b64_tr_b16 a[246:247], v5 offset:5120
ds_read_b64_tr_b16 a[248:249], v5 offset:8192
ds_read_b64_tr_b16 a[250:251], v5 offset:9216
ds_read_b64_tr_b16 a[252:253], v5 offset:12288
ds_read_b64_tr_b16 a[254:255], v5 offset:13312
s_waitcnt lgkmcnt(0)
s_barrier
s_mov_b32 s8, s64
s_mov_b32 s9, s65
s_mov_b32 s10, 2621440
s_mov_b32 s11, 0x20000
s_mov_b32 s12, s90
s_mov_b32 s13, s91
s_mov_b32 s14, 2621440
s_mov_b32 s15, 0x20000
v_mbcnt_lo_u32_b32 v40, -1, 0
v_mbcnt_hi_u32_b32 v40, -1, v40
s_mov_b32 s58, s77
v_lshrrev_b32 v41, 4, v40
v_and_b32 v42, 15, v40
v_lshrrev_b32 v43, 5, v40
v_and_b32 v44, 31, v40
v_bfe_u32 v45, v40, 4, 1
v_lshlrev_b32 v0, 4, v40
v_add_u32 v19, 0x10000, v0
s_and_b32 s30, s26, 1
s_lshr_b32 s31, s26, 1
s_lshl_b32 s54, s30, 12
s_lshl_b32 s55, s31, 12
s_lshl_b32 s3, s30, 8
s_add_u32 s3, s3, s55
s_add_u32 s3, s3, 30720
v_lshlrev_b32 v46, 4, v42
v_lshl_add_u32 v47, v45, 3, v46
v_lshl_add_u32 v1, v43, 9, v47
v_add_u32 v1, s3, v1
v_lshl_add_u32 v12, v43, 8, v47
v_mov_b32 v48, 2147483632
v_cmp_eq_u32 vcc, 0, v43
s_nop 1
v_cndmask_b32 v13, v48, v12, vcc
s_and_b32 s3, s25, 15
s_lshl_b32 s3, s3, 4
v_xor_b32 v14, s3, v12
v_cndmask_b32 v15, v48, v14, vcc
v_lshlrev_b32 v49, 6, v43
v_lshlrev_b32 v50, 3, v42
v_xor_b32 v49, v49, v50
v_lshl_add_u32 v2, v41, 7, v49
s_lshl_b32 s3, s31, 10
s_add_u32 s3, s3, 28672
v_add_u32 v2, s3, v2
s_mul_i32 s3, s26, 2560
s_add_u32 s3, s3, 38912
v_mul_u32_u24 v3, 80, v44
v_lshl_add_u32 v3, v43, 4, v3
v_add_u32 v3, s3, v3
v_lshrrev_b32 v49, 2, v40
v_and_b32 v50, 3, v40
v_mul_u32_u24 v5, 80, v49
v_lshl_add_u32 v5, v50, 4, v5
v_add_u32 v5, s3, v5
v_mul_u32_u24 v7, 41216, v49
v_lshl_add_u32 v7, v50, 4, v7
s_lshl_b32 s3, s26, 6
v_add_u32 v7, s3, v7
v_mul_u32_u24 v8, 1280, v41
v_add_u32 v8, v8, v46
v_add_u32 v9, 5120, v8
s_lshl_b32 s3, s26, 3
v_add_u32 v49, s3, v41
v_cmp_gt_u32 vcc, 27, v49
s_nop 1
v_cndmask_b32 v10, v48, v8, vcc
s_mov_b64 s[16:17], vcc
v_cmp_gt_u32 vcc, 23, v49
s_nop 1
v_cndmask_b32 v11, v48, v9, vcc
s_mov_b64 s[18:19], vcc
s_mov_b32 s61, 0x10001
v_xor_b32 v49, v43, v42
v_lshlrev_b32 v16, 8, v44
v_lshl_add_u32 v16, v49, 4, v16
v_add_u32 v16, 65536, v16
s_lshl_b32 s3, s26, 7
v_lshlrev_b32 v17, 2, v44
v_add_u32 v17, s3, v17
v_lshlrev_b32 v18, 2, v44
v_and_b32 v49, 16, v0
v_mov_b32 v50, 0x3f80
v_lshlrev_b32 v49, v49, v50
v_lshrrev_b32 v50, 1, v42
v_cmp_eq_u32 vcc, 0, v50
s_nop 1
v_cndmask_b32 v20, 0, v49, vcc
v_cmp_eq_u32 vcc, 1, v50
s_nop 1
v_cndmask_b32 v21, 0, v49, vcc
v_cmp_eq_u32 vcc, 2, v50
s_nop 1
v_cndmask_b32 v22, 0, v49, vcc
v_cmp_eq_u32 vcc, 3, v50
s_nop 1
v_cndmask_b32 v23, 0, v49, vcc
v_cmp_eq_u32 vcc, 4, v50
s_nop 1
v_cndmask_b32 v24, 0, v49, vcc
v_cmp_eq_u32 vcc, 5, v50
s_nop 1
v_cndmask_b32 v25, 0, v49, vcc
v_cmp_eq_u32 vcc, 6, v50
s_nop 1
v_cndmask_b32 v26, 0, v49, vcc
v_cmp_eq_u32 vcc, 7, v50
s_nop 1
v_cndmask_b32 v27, 0, v49, vcc
v_lshl_add_u32 v49, v41, 2, 0
v_cmp_gt_u32 vcc, v49, v42
s_cmp_eq_u32 s30, 0
s_cselect_b64 s[64:65], vcc, 0
s_cselect_b64 s[72:73], -1, vcc
v_lshl_add_u32 v49, v41, 2, 1
v_cmp_gt_u32 vcc, v49, v42
s_cmp_eq_u32 s30, 0
s_cselect_b64 s[66:67], vcc, 0
s_cselect_b64 s[74:75], -1, vcc
v_lshl_add_u32 v49, v41, 2, 2
v_cmp_gt_u32 vcc, v49, v42
s_cmp_eq_u32 s30, 0
s_cselect_b64 s[68:69], vcc, 0
s_cselect_b64 s[76:77], -1, vcc
v_lshl_add_u32 v49, v41, 2, 3
v_cmp_gt_u32 vcc, v49, v42
s_cmp_eq_u32 s30, 0
s_cselect_b64 s[70:71], vcc, 0
s_cselect_b64 s[78:79], -1, vcc
s_sub_u32 s33, s24, 4
s_mul_i32 s3, s33, 1572864
s_add_u32 s3, s3, 9437184
s_mul_i32 s30, s25, 1280
s_add_u32 s42, s3, s30
s_add_u32 s44, s42, 0
s_add_u32 s43, s42, 659456
s_add_u32 s45, s44, 659456
s_add_u32 s48, s42, 1376256
s_mul_i32 s53, s26, 10240
s_add_u32 s49, s3, s53
s_mul_i32 s31, s25, 41216
s_add_u32 s46, s49, s31
s_add_u32 s47, s46, 0
s_add_u32 s49, s49, 1376256
s_mul_i32 s50, s33, 40960
s_add_u32 s50, s50, s30
s_lshl_b32 s51, s26, 11
s_mul_i32 s36, s25, 2097152
s_mul_i32 s3, s33, 32768
s_add_u32 s36, s36, s3
s_add_u32 s36, s36, s51
s_add_u32 s36, s36, 50331648
s_min_u32 s52, s26, 2
s_lshl_b32 s52, s52, 11
s_mul_i32 s37, s25, 1048576
s_mul_i32 s3, s33, 16384
s_add_u32 s37, s37, s3
s_add_u32 s37, s37, s52
s_add_u32 s37, s37, 16777216
s_lshl_b32 s3, s25, 7
s_add_u32 s38, s3, 0
s_add_u32 s39, s3, 524288
s_mov_b32 s34, 1
s_mov_b32 s56, 4048155338
s_mul_i32 s57, s26, 3072
s_lshl_b32 s59, s26, 11
v_add_u32 v4, s54, v0
v_add_u32 v6, s55, v0
v_lshlrev_b32 v60, 2, v40
L_pcls_s:
global_load_dword v61, v60, s[28:29] sc1
s_add_u32 s27, s27, 1
s_cmp_gt_u32 s27, 262144
s_cbranch_scc1 L_fail_s
s_lshl_b32 s3, s58, 4
s_add_u32 s3, s3, 15
s_waitcnt vmcnt(0)
v_readlane_b32 s3, v61, s3
s_cmp_lt_u32 s3, 64
s_cbranch_scc1 L_pcls_s
s_lshl_b32 s3, s58, 4
s_add_u32 s3, s3, 14
v_readlane_b32 s3, v61, s3
s_cmp_lt_u32 s3, 0x400000
s_cbranch_scc1 L_pcls_s
s_and_b32 s31, s3, 0xff
s_cmp_ge_u32 s31, 32
s_cselect_b32 s30, 8192, 0
s_bfe_u32 s31, s3, 0x80008
s_cmp_ge_u32 s31, 32
s_cselect_b32 s31, 0, 16384
s_add_u32 s30, s30, s31
s_add_u32 s39, s39, s30
s_lshr_b32 s3, s36, 8
s_xor_b32 s3, s3, s30
s_and_b32 s3, s3, 8192
s_add_u32 s36, s36, s3
s_lshr_b32 s3, s37, 8
s_xor_b32 s3, s3, s30
s_and_b32 s3, s3, 8192
s_add_u32 s37, s37, s3
v_lshlrev_b32 v40, 3, v40
s_mov_b32 s3, 8192
L_pmod2_s:
buffer_load_dwordx2 v[42:43], v40, s[4:7], s3 offen sc1
s_add_u32 s27, s27, 1
s_cmp_gt_u32 s27, 262144
s_cbranch_scc1 L_fail_s
s_waitcnt vmcnt(0)
v_and_b32 v42, v42, v43
v_cmp_ne_u32 vcc, 1, v42
s_cbranch_vccnz L_pmod2_s
s_lshl_b32 s3, s26, 2
s_lshr_b32 s3, 0x5342, s3
s_and_b32 s3, s3, 15
s_mul_i32 s3, s3, 1280
s_add_u32 s3, s3, 32768
buffer_load_dwordx2 v[40:41], v12, s[4:7], s3 offen offset:0 sc1
buffer_load_dwordx2 v[42:43], v12, s[4:7], s3 offen offset:512 sc1
buffer_load_dwordx2 v[44:45], v13, s[4:7], s3 offen offset:1024 sc1
v_add_u32 v60, s57, v19
s_waitcnt vmcnt(2)
v_lshlrev_b32 v48, 16, v40
v_and_b32 v49, 0xffff0000, v40
v_lshlrev_b32 v50, 16, v41
v_and_b32 v51, 0xffff0000, v41
ds_write_b128 v60, v[48:51] offset:40960
s_waitcnt vmcnt(1)
v_lshlrev_b32 v52, 16, v42
v_and_b32 v53, 0xffff0000, v42
v_lshlrev_b32 v54, 16, v43
v_and_b32 v55, 0xffff0000, v43
ds_write_b128 v60, v[52:55] offset:41984
s_waitcnt vmcnt(0)
v_lshlrev_b32 v56, 16, v44
v_and_b32 v57, 0xffff0000, v44
v_lshlrev_b32 v58, 16, v45
v_and_b32 v59, 0xffff0000, v45
ds_write_b128 v60, v[56:59] offset:43008
s_waitcnt lgkmcnt(0)
s_add_u32 s35, s33, 1
s_mov_b32 s58, 0
v_bfe_u32 v40, v0, 2, 5
L_pkv0_s:
buffer_load_dword v41, v40, s[4:7], s38 offen offset:0 sc1
s_add_u32 s27, s27, 1
s_cmp_gt_u32 s27, 262144
s_cbranch_scc1 L_fail_s
s_waitcnt vmcnt(0)
v_cmp_gt_u32 vcc, s35, v41
s_cbranch_vccz L_pkv0_sok
s_sleep 8
s_branch L_pkv0_s
L_pkv0_sok:
s_add_u32 m0, s51, 0
s_xor_b32 s3, s36, 0
buffer_load_dwordx4 v0, s[4:7], s3 offen offset:0 sc1 lds
buffer_load_dwordx4 v0, s[4:7], s3 offen offset:1024 sc1 lds
s_add_u32 m0, s51, 8192
s_xor_b32 s3, s36, 16384
buffer_load_dwordx4 v0, s[4:7], s3 offen offset:0 sc1 lds
buffer_load_dwordx4 v0, s[4:7], s3 offen offset:1024 sc1 lds
s_add_u32 m0, s51, 16384
s_xor_b32 s3, s36, 8192
buffer_load_dwordx4 v0, s[4:7], s3 offen offset:0 sc1 lds
buffer_load_dwordx4 v0, s[4:7], s3 offen offset:1024 sc1 lds
s_add_u32 s36, s36, 131072
s_waitcnt vmcnt(0) lgkmcnt(0)
s_barrier
L_unit_s:
buffer_load_dwordx2 v[34:35], v12, s[8:11], s50 offen offset:0
buffer_load_dwordx2 v[36:37], v12, s[8:11], s50 offen offset:512
buffer_load_dwordx2 v[38:39], v13, s[8:11], s50 offen offset:1024
s_cmp_lg_u32 s58, 0
s_cbranch_scc1 L_pwo_s
v_bfe_u32 v104, v0, 2, 3
buffer_load_dword v105, v104, s[4:7], s39 offen sc1
ds_read_b128 v[40:43], v4 offset:16384
ds_read_b128 v[72:75], v0 offset:0
ds_read_b128 v[44:47], v4 offset:17408
ds_read_b128 v[76:79], v0 offset:1024
ds_read_b128 v[48:51], v4 offset:18432
ds_read_b128 v[80:83], v0 offset:2048
ds_read_b128 v[52:55], v4 offset:19456
ds_read_b128 v[84:87], v0 offset:3072
ds_read_b128 v[56:59], v0 offset:4096
ds_read_b128 v[60:63], v0 offset:5120
ds_read_b128 v[64:67], v0 offset:6144
ds_read_b128 v[68:71], v0 offset:7168
s_waitcnt lgkmcnt(10)
v_mfma_f32_16x16x32_bf16 v[92:95], v[72:75], v[40:43], 0
ds_read_b128 v[72:75], v6 offset:8192
s_waitcnt lgkmcnt(9)
v_mfma_f32_16x16x32_bf16 v[92:95], v[76:79], v[44:47], v[92:95]
ds_read_b128 v[76:79], v6 offset:9216
s_waitcnt lgkmcnt(8)
v_mfma_f32_16x16x32_bf16 v[92:95], v[80:83], v[48:51], v[92:95]
ds_read_b128 v[80:83], v6 offset:10240
s_waitcnt lgkmcnt(7)
v_mfma_f32_16x16x32_bf16 v[92:95], v[84:87], v[52:55], v[92:95]
ds_read_b128 v[84:87], v6 offset:11264
s_waitcnt lgkmcnt(7)
v_mfma_f32_16x16x32_bf16 v[96:99], v[56:59], v[40:43], 0
s_waitcnt lgkmcnt(6)
v_mfma_f32_16x16x32_bf16 v[96:99], v[60:63], v[44:47], v[96:99]
s_waitcnt lgkmcnt(5)
v_mfma_f32_16x16x32_bf16 v[96:99], v[64:67], v[48:51], v[96:99]
s_waitcnt lgkmcnt(4)
v_mfma_f32_16x16x32_bf16 v[96:99], v[68:71], v[52:55], v[96:99]
s_waitcnt vmcnt(0)
v_cmp_gt_u32 vcc, s35, v105
s_cbranch_vccz L_proka_s
L_pra_s:
buffer_load_dword v105, v104, s[4:7], s39 offen offset:0 sc1
s_add_u32 s27, s27, 1
s_cmp_gt_u32 s27, 262144
s_cbranch_scc1 L_fail_s
s_waitcnt vmcnt(0)
v_cmp_gt_u32 vcc, s35, v105
s_cbranch_vccz L_pra_sok
s_sleep 1
s_branch L_pra_s
L_pra_sok:
L_proka_s:
s_add_u32 m0, s52, 24576
s_nop 0
buffer_load_dwordx4 v0, s[4:7], s37 offen offset:0 sc1 lds
buffer_load_dwordx4 v0, s[4:7], s37 offen offset:1024 sc1 lds
v_mov_b32 v110, s56
v_mov_b32 v107, 0
v_mov_b32 v108, 0
s_add_u32 s37, s37, 65536
v_cndmask_b32 v92, v92, v110, s[64:65]
v_cndmask_b32 v93, v93, v110, s[66:67]
v_cndmask_b32 v94, v94, v110, s[68:69]
v_cndmask_b32 v95, v95, v110, s[70:71]
v_cndmask_b32 v96, v96, v110, s[72:73]
v_cndmask_b32 v97, v97, v110, s[74:75]
v_cndmask_b32 v98, v98, v110, s[76:77]
v_cndmask_b32 v99, v99, v110, s[78:79]
v_max3_f32 v110, v92, v93, v94
v_max3_f32 v110, v110, v95, v96
v_max3_f32 v110, v110, v97, v98
v_max_f32 v110, v110, v99
s_waitcnt vmcnt(0)
s_barrier
ds_read_b128 v[56:59], v0 offset:24576
ds_read_b128 v[60:63], v0 offset:25600
ds_read_b128 v[64:67], v0 offset:26624
ds_read_b128 v[68:71], v0 offset:27648
ds_read_b64 v[100:101], v2 offset:0
ds_read_b64 v[102:103], v2 offset:512
s_waitcnt lgkmcnt(5)
v_mfma_f32_16x16x32_bf16 v[88:91], v[56:59], v[40:43], 0
s_waitcnt lgkmcnt(4)
v_mfma_f32_16x16x32_bf16 v[88:91], v[60:63], v[44:47], v[88:91]
s_waitcnt lgkmcnt(3)
v_mfma_f32_16x16x32_bf16 v[88:91], v[64:67], v[48:51], v[88:91]
s_waitcnt lgkmcnt(2)
v_mfma_f32_16x16x32_bf16 v[88:91], v[68:71], v[52:55], v[88:91]
s_nop 7
v_max3_f32 v88, v90, v91, v110
v_mov_b32 v89, v88
s_nop 1
v_permlane16_swap_b32 v88, v89
v_max_f32 v88, v88, v89
v_mov_b32 v89, v88
s_nop 1
v_permlane32_swap_b32 v88, v89
v_max_f32 v88, v88, v89
v_sub_f32 v90, v90, v88
v_sub_f32 v91, v91, v88
v_sub_f32 v92, v92, v88
v_sub_f32 v93, v93, v88
v_sub_f32 v94, v94, v88
v_sub_f32 v95, v95, v88
v_sub_f32 v96, v96, v88
v_sub_f32 v97, v97, v88
v_sub_f32 v98, v98, v88
v_sub_f32 v99, v99, v88
v_exp_f32 v90, v90
v_exp_f32 v91, v91
v_exp_f32 v92, v92
v_exp_f32 v93, v93
v_exp_f32 v94, v94
v_exp_f32 v95, v95
v_exp_f32 v96, v96
v_exp_f32 v97, v97
v_exp_f32 v98, v98
v_exp_f32 v99, v99
v_cvt_pk_bf16_f32 v106, v90, v91
v_cvt_pk_bf16_f32 v109, v90, v91
v_cvt_pk_bf16_f32 v56, v92, v93
v_cvt_pk_bf16_f32 v57, v94, v95
v_cvt_pk_bf16_f32 v58, v96, v97
v_cvt_pk_bf16_f32 v59, v98, v99
s_nop 1
v_mfma_f32_16x16x32_bf16 v[40:43], v[72:75], v[56:59], 0
v_add_f32 v88, v90, v91
v_add_f32 v88, v88, v92
v_mfma_f32_16x16x32_bf16 v[44:47], v[76:79], v[56:59], 0
v_add_f32 v88, v88, v93
v_add_f32 v88, v88, v94
v_mfma_f32_16x16x32_bf16 v[48:51], v[80:83], v[56:59], 0
v_add_f32 v88, v88, v95
v_add_f32 v88, v88, v96
v_mfma_f32_16x16x32_bf16 v[52:55], v[84:87], v[56:59], 0
v_add_f32 v88, v88, v97
v_add_f32 v88, v88, v98
v_add_f32 v88, v88, v99
s_waitcnt lgkmcnt(1)
v_mfma_f32_16x16x16_bf16 v[40:43], v[100:101], v[106:107], v[40:43]
v_mov_b32 v89, v88
v_mfma_f32_16x16x16_bf16 v[44:47], v[100:101], v[108:109], v[44:47]
s_nop 0
v_permlane16_swap_b32 v88, v89
v_add_f32 v88, v88, v89
s_waitcnt lgkmcnt(0)
v_mfma_f32_16x16x16_bf16 v[48:51], v[102:103], v[106:107], v[48:51]
v_mov_b32 v89, v88
v_mfma_f32_16x16x16_bf16 v[52:55], v[102:103], v[108:109], v[52:55]
s_nop 0
v_permlane32_swap_b32 v88, v89
v_add_f32 v88, v88, v89
v_rcp_f32 v88, v88
s_nop 0
v_mov_b32 v89, v88
v_pk_mul_f32 v[40:41], v[40:41], v[88:89]
v_pk_mul_f32 v[42:43], v[42:43], v[88:89]
v_cvt_pk_bf16_f32 v40, v40, v41
v_cvt_pk_bf16_f32 v41, v42, v43
ds_write_b64 v1, v[40:41] offset:0
v_pk_mul_f32 v[44:45], v[44:45], v[88:89]
v_pk_mul_f32 v[46:47], v[46:47], v[88:89]
v_cvt_pk_bf16_f32 v44, v44, v45
v_cvt_pk_bf16_f32 v45, v46, v47
ds_write_b64 v1, v[44:45] offset:1024
v_pk_mul_f32 v[48:49], v[48:49], v[88:89]
v_pk_mul_f32 v[50:51], v[50:51], v[88:89]
v_cvt_pk_bf16_f32 v48, v48, v49
v_cvt_pk_bf16_f32 v49, v50, v51
ds_write_b64 v1, v[48:49] offset:2048
v_pk_mul_f32 v[52:53], v[52:53], v[88:89]
v_pk_mul_f32 v[54:55], v[54:55], v[88:89]
v_cvt_pk_bf16_f32 v52, v52, v53
v_cvt_pk_bf16_f32 v53, v54, v55
ds_write_b64 v1, v[52:53] offset:3072
s_waitcnt lgkmcnt(0)
s_barrier
L_pwo_s:
ds_read_b128 v[40:43], v0 offset:30720
ds_read_b128 v[44:47], v0 offset:31744
ds_read_b128 v[48:51], v0 offset:32768
ds_read_b128 v[52:55], v0 offset:33792
ds_read_b128 v[56:59], v0 offset:34816
ds_read_b128 v[60:63], v0 offset:35840
ds_read_b128 v[64:67], v0 offset:36864
ds_read_b128 v[68:71], v0 offset:37888
s_and_b32 s62, s34, 1
s_lshl_b32 s62, s62, 16
s_or_b32 s62, s62, 0
v_mov_b32 v29, s62
s_waitcnt lgkmcnt(7)
v_mfma_f32_32x32x16_bf16 v[72:87], v[112:115], v[40:43], 0
s_waitcnt lgkmcnt(6)
v_mfma_f32_32x32x16_bf16 v[72:87], v[116:119], v[44:47], v[72:87]
s_waitcnt lgkmcnt(5)
v_mfma_f32_32x32x16_bf16 v[72:87], v[120:123], v[48:51], v[72:87]
s_waitcnt lgkmcnt(4)
v_mfma_f32_32x32x16_bf16 v[72:87], v[124:127], v[52:55], v[72:87]
s_waitcnt lgkmcnt(3)
v_mfma_f32_32x32x16_bf16 v[72:87], v[128:131], v[56:59], v[72:87]
buffer_load_dword v28, v18, s[4:7], s41 offen offset:640 sc1
s_sub_u32 s30, s34, 1
s_waitcnt lgkmcnt(2)
v_mfma_f32_32x32x16_bf16 v[72:87], v[132:135], v[60:63], v[72:87]
s_waitcnt lgkmcnt(1)
v_mfma_f32_32x32x16_bf16 v[72:87], v[136:139], v[64:67], v[72:87]
s_waitcnt lgkmcnt(0)
v_mfma_f32_32x32x16_bf16 v[72:87], v[140:143], v[68:71], v[72:87]
v_mfma_f32_32x32x16_bf16 v[88:103], v[144:147], v[40:43], 0
s_nop 3
s_nop 2
v_mfma_f32_32x32x16_bf16 v[88:103], v[148:151], v[44:47], v[88:103]
s_nop 2
v_cvt_pk_bf16_f32 v72, v72, v73
v_cvt_pk_bf16_f32 v73, v74, v75
v_cvt_pk_bf16_f32 v74, v76, v77
v_cvt_pk_bf16_f32 v75, v78, v79
v_mfma_f32_32x32x16_bf16 v[88:103], v[152:155], v[48:51], v[88:103]
v_bfi_b32 v72, s61, v29, v72
ds_write_b128 v3, v[72:75] offset:0
v_cvt_pk_bf16_f32 v76, v80, v81
v_cvt_pk_bf16_f32 v77, v82, v83
v_cvt_pk_bf16_f32 v78, v84, v85
v_mfma_f32_32x32x16_bf16 v[88:103], v[156:159], v[52:55], v[88:103]
v_cvt_pk_bf16_f32 v79, v86, v87
v_bfi_b32 v76, s61, v29, v76
ds_write_b128 v3, v[76:79] offset:32
ds_read_b128 v[104:107], v5 offset:0
ds_read_b128 v[108:111], v5 offset:1280
v_mfma_f32_32x32x16_bf16 v[88:103], v[160:163], v[56:59], v[88:103]
v_mfma_f32_32x32x16_bf16 v[88:103], v[164:167], v[60:63], v[88:103]
s_waitcnt vmcnt(0)
v_cmp_gt_u32 vcc, s30, v28
s_cbranch_vccz L_p4ok_s
L_p4_s:
buffer_load_dword v28, v18, s[4:7], s41 offen offset:640 sc1
s_add_u32 s27, s27, 1
s_cmp_gt_u32 s27, 262144
s_cbranch_scc1 L_fail_s
s_waitcnt vmcnt(0)
v_cmp_gt_u32 vcc, s30, v28
s_cbranch_vccnz L_p4_s
L_p4ok_s:
v_mfma_f32_32x32x16_bf16 v[88:103], v[168:171], v[64:67], v[88:103]
s_waitcnt lgkmcnt(1)
buffer_store_dwordx4 v[104:107], v7, s[4:7], s42 offen offset:0 sc1
v_mfma_f32_32x32x16_bf16 v[88:103], v[172:175], v[68:71], v[88:103]
s_waitcnt lgkmcnt(0)
buffer_store_dwordx4 v[108:111], v7, s[4:7], s43 offen offset:0 sc1
v_mfma_f32_32x32x16_bf16 v[72:87], v[176:179], v[40:43], 0
s_nop 3
s_nop 2
v_mfma_f32_32x32x16_bf16 v[72:87], v[180:183], v[44:47], v[72:87]
s_nop 0
v_cvt_pk_bf16_f32 v88, v88, v89
v_cvt_pk_bf16_f32 v89, v90, v91
v_cvt_pk_bf16_f32 v90, v92, v93
v_cvt_pk_bf16_f32 v91, v94, v95
v_mfma_f32_32x32x16_bf16 v[72:87], v[184:187], v[48:51], v[72:87]
v_bfi_b32 v88, s61, v29, v88
ds_write_b128 v3, v[88:91] offset:0
v_cvt_pk_bf16_f32 v92, v96, v97
v_cvt_pk_bf16_f32 v93, v98, v99
v_cvt_pk_bf16_f32 v94, v100, v101
v_mfma_f32_32x32x16_bf16 v[72:87], v[188:191], v[52:55], v[72:87]
v_cvt_pk_bf16_f32 v95, v102, v103
v_bfi_b32 v92, s61, v29, v92
ds_write_b128 v3, v[92:95] offset:32
ds_read_b128 v[104:107], v5 offset:0
ds_read_b128 v[108:111], v5 offset:1280
v_mfma_f32_32x32x16_bf16 v[72:87], v[192:195], v[56:59], v[72:87]
v_mfma_f32_32x32x16_bf16 v[72:87], v[196:199], v[60:63], v[72:87]
v_mfma_f32_32x32x16_bf16 v[72:87], v[200:203], v[64:67], v[72:87]
s_waitcnt lgkmcnt(1)
buffer_store_dwordx4 v[104:107], v7, s[4:7], s42 offen offset:256 sc1
v_mfma_f32_32x32x16_bf16 v[72:87], v[204:207], v[68:71], v[72:87]
s_waitcnt lgkmcnt(0)
buffer_store_dwordx4 v[108:111], v7, s[4:7], s43 offen offset:256 sc1
v_mfma_f32_32x32x16_bf16 v[88:103], v[208:211], v[40:43], 0
s_nop 3
s_nop 2
v_mfma_f32_32x32x16_bf16 v[88:103], v[212:215], v[44:47], v[88:103]
s_nop 0
v_cvt_pk_bf16_f32 v72, v72, v73
v_cvt_pk_bf16_f32 v73, v74, v75
v_cvt_pk_bf16_f32 v74, v76, v77
v_cvt_pk_bf16_f32 v75, v78, v79
v_mfma_f32_32x32x16_bf16 v[88:103], v[216:219], v[48:51], v[88:103]
v_bfi_b32 v72, s61, v29, v72
ds_write_b128 v3, v[72:75] offset:0
v_cvt_pk_bf16_f32 v76, v80, v81
v_cvt_pk_bf16_f32 v77, v82, v83
v_cvt_pk_bf16_f32 v78, v84, v85
v_mfma_f32_32x32x16_bf16 v[88:103], v[220:223], v[52:55], v[88:103]
v_cvt_pk_bf16_f32 v79, v86, v87
v_bfi_b32 v76, s61, v29, v76
ds_write_b128 v3, v[76:79] offset:32
ds_read_b128 v[104:107], v5 offset:0
ds_read_b128 v[108:111], v5 offset:1280
v_mfma_f32_32x32x16_bf16 v[88:103], v[224:227], v[56:59], v[88:103]
v_mfma_f32_32x32x16_bf16 v[88:103], v[228:231], v[60:63], v[88:103]
v_mfma_f32_32x32x16_bf16 v[88:103], v[232:235], v[64:67], v[88:103]
s_waitcnt lgkmcnt(1)
buffer_store_dwordx4 v[104:107], v7, s[4:7], s42 offen offset:512 sc1
v_mfma_f32_32x32x16_bf16 v[88:103], v[236:239], v[68:71], v[88:103]
s_waitcnt lgkmcnt(0)
buffer_store_dwordx4 v[108:111], v7, s[4:7], s43 offen offset:512 sc1
v_mfma_f32_32x32x16_bf16 v[72:87], v[240:243], v[40:43], 0
s_nop 3
s_nop 2
v_mfma_f32_32x32x16_bf16 v[72:87], v[244:247], v[44:47], v[72:87]
s_nop 0
v_cvt_pk_bf16_f32 v88, v88, v89
v_cvt_pk_bf16_f32 v89, v90, v91
v_cvt_pk_bf16_f32 v90, v92, v93
v_cvt_pk_bf16_f32 v91, v94, v95
v_mfma_f32_32x32x16_bf16 v[72:87], v[248:251], v[48:51], v[72:87]
v_bfi_b32 v88, s61, v29, v88
ds_write_b128 v3, v[88:91] offset:0
v_cvt_pk_bf16_f32 v92, v96, v97
v_cvt_pk_bf16_f32 v93, v98, v99
v_cvt_pk_bf16_f32 v94, v100, v101
v_mfma_f32_32x32x16_bf16 v[72:87], v[252:255], v[52:55], v[72:87]
v_cvt_pk_bf16_f32 v95, v102, v103
v_bfi_b32 v92, s61, v29, v92
ds_write_b128 v3, v[92:95] offset:32
ds_read_b128 v[104:107], v5 offset:0
ds_read_b128 v[108:111], v5 offset:1280
v_mfma_f32_32x32x16_bf16 v[72:87], a[0:3], v[56:59], v[72:87]
v_mfma_f32_32x32x16_bf16 v[72:87], a[4:7], v[60:63], v[72:87]
v_mfma_f32_32x32x16_bf16 v[72:87], a[8:11], v[64:67], v[72:87]
s_waitcnt lgkmcnt(1)
buffer_store_dwordx4 v[104:107], v7, s[4:7], s42 offen offset:768 sc1
v_mfma_f32_32x32x16_bf16 v[72:87], a[12:15], v[68:71], v[72:87]
s_waitcnt lgkmcnt(0)
buffer_store_dwordx4 v[108:111], v7, s[4:7], s43 offen offset:768 sc1
s_nop 9
v_cvt_pk_bf16_f32 v72, v72, v73
v_cvt_pk_bf16_f32 v73, v74, v75
v_cvt_pk_bf16_f32 v74, v76, v77
v_cvt_pk_bf16_f32 v75, v78, v79
v_bfi_b32 v72, s61, v29, v72
ds_write_b128 v3, v[72:75] offset:0
v_cvt_pk_bf16_f32 v76, v80, v81
v_cvt_pk_bf16_f32 v77, v82, v83
v_cvt_pk_bf16_f32 v78, v84, v85
v_cvt_pk_bf16_f32 v79, v86, v87
v_bfi_b32 v76, s61, v29, v76
ds_write_b128 v3, v[76:79] offset:32
ds_read_b128 v[104:107], v5 offset:0
ds_read_b128 v[108:111], v5 offset:1280
s_waitcnt lgkmcnt(1)
buffer_store_dwordx4 v[104:107], v7, s[4:7], s42 offen offset:1024 sc1
s_waitcnt lgkmcnt(0)
buffer_store_dwordx4 v[108:111], v7, s[4:7], s43 offen offset:1024 sc1
v_mov_b32 v40, s34
s_cmp_lg_u32 s34, 1
s_cbranch_scc1 L_pf_s
s_waitcnt vmcnt(0)
L_pf_s:
buffer_store_dword v40, off, s[4:7], s40 offset:0 sc1
v_lshlrev_b32 v28, 16, v34
v_and_b32 v29, 0xffff0000, v34
v_lshlrev_b32 v30, 16, v35
v_and_b32 v31, 0xffff0000, v35
v_lshlrev_b32 v32, 16, v36
v_and_b32 v33, 0xffff0000, v36
v_lshlrev_b32 v34, 16, v37
v_and_b32 v35, 0xffff0000, v37
v_lshlrev_b32 v36, 16, v38
v_and_b32 v37, 0xffff0000, v38
v_lshlrev_b32 v38, 16, v39
v_and_b32 v39, 0xffff0000, v39
s_add_u32 s35, s35, 4
L_p1_s:
buffer_load_dword v40, v17, s[4:7], s41 offen offset:0 sc1
s_add_u32 s27, s27, 1
s_cmp_gt_u32 s27, 262144
s_cbranch_scc1 L_fail_s
s_waitcnt vmcnt(0)
v_cmp_gt_u32 vcc, s34, v40
s_cbranch_vccnz L_p1_s
L_rr1_s:
buffer_load_dwordx4 v[40:43], v8, s[4:7], s46 offen offset:0 sc1
buffer_load_dwordx4 v[44:47], v9, s[4:7], s46 offen offset:0 sc1
buffer_load_dwordx4 v[48:51], v8, s[4:7], s46 offen offset:256 sc1
buffer_load_dwordx4 v[52:55], v9, s[4:7], s46 offen offset:256 sc1
buffer_load_dwordx4 v[56:59], v8, s[4:7], s46 offen offset:512 sc1
buffer_load_dwordx4 v[60:63], v9, s[4:7], s46 offen offset:512 sc1
buffer_load_dwordx4 v[64:67], v8, s[4:7], s46 offen offset:768 sc1
buffer_load_dwordx4 v[68:71], v9, s[4:7], s46 offen offset:768 sc1
buffer_load_dwordx4 v[72:75], v8, s[4:7], s46 offen offset:1024 sc1
buffer_load_dwordx4 v[76:79], v9, s[4:7], s46 offen offset:1024 sc1
v_add_u32 v92, s57, v0
ds_read_b128 v[96:99], v19 offset:40960
ds_read_b128 v[100:103], v19 offset:41984
ds_read_b128 v[104:107], v19 offset:43008
s_add_u32 s27, s27, 1
s_cmp_gt_u32 s27, 262144
s_cbranch_scc1 L_fail_s
s_waitcnt vmcnt(9)
v_mfma_f32_16x16x32_bf16 v[80:83], v[20:23], v[40:43], 0
v_xor_b32 v94, s62, v40
s_waitcnt vmcnt(8)
v_mfma_f32_16x16x32_bf16 v[80:83], v[20:23], v[44:47], v[80:83]
v_xor_b32 v95, s62, v44
s_waitcnt vmcnt(7)
v_mfma_f32_16x16x32_bf16 v[80:83], v[24:27], v[48:51], v[80:83]
v_bitop3_b32 v94, v94, v48, s62 bitop3:0xf6
s_waitcnt vmcnt(6)
v_mfma_f32_16x16x32_bf16 v[80:83], v[24:27], v[52:55], v[80:83]
v_bitop3_b32 v95, v95, v52, s62 bitop3:0xf6
s_waitcnt vmcnt(5)
v_mfma_f32_16x16x32_bf16 v[84:87], v[20:23], v[56:59], 0
v_bitop3_b32 v94, v94, v56, s62 bitop3:0xf6
s_waitcnt vmcnt(4)
v_mfma_f32_16x16x32_bf16 v[84:87], v[20:23], v[60:63], v[84:87]
v_bitop3_b32 v95, v95, v60, s62 bitop3:0xf6
s_nop 0
ds_write_b128 v92, v[80:83] offset:49152
s_waitcnt vmcnt(3)
v_mfma_f32_16x16x32_bf16 v[84:87], v[24:27], v[64:67], v[84:87]
v_bitop3_b32 v94, v94, v64, s62 bitop3:0xf6
s_waitcnt vmcnt(2)
v_mfma_f32_16x16x32_bf16 v[84:87], v[24:27], v[68:71], v[84:87]
v_bitop3_b32 v95, v95, v68, s62 bitop3:0xf6
s_waitcnt vmcnt(1)
v_mfma_f32_16x16x32_bf16 v[88:91], v[20:23], v[72:75], 0
v_bitop3_b32 v94, v94, v72, s62 bitop3:0xf6
s_waitcnt vmcnt(0)
v_mfma_f32_16x16x32_bf16 v[88:91], v[20:23], v[76:79], v[88:91]
v_bitop3_b32 v95, v95, v76, s62 bitop3:0xf6
s_nop 0
ds_write_b128 v92, v[84:87] offset:50176
v_bitop3_b32 v94, v94, v95, s61 bitop3:0xa8
v_cmp_ne_u32 vcc, 0, v94
s_nop 2
ds_write_b128 v92, v[88:91] offset:51200
s_cbranch_vccnz L_rr1_s
s_waitcnt lgkmcnt(0)
s_barrier
s_cmp_eq_u32 s26, 0
s_cbranch_scc1 L_pw0_s
s_cmp_lg_u32 s26, 1
s_cbranch_scc1 L_pln_s
v_bfe_u32 v40, v0, 2, 3
buffer_load_dword v41, v40, s[4:7], s39 offen sc1
v_bfe_u32 v42, v0, 2, 5
s_min_u32 s30, s35, 64
L_pkv_s:
buffer_load_dword v43, v42, s[4:7], s38 offen offset:0 sc1
s_add_u32 s27, s27, 1
s_cmp_gt_u32 s27, 262144
s_cbranch_scc1 L_fail_s
s_waitcnt vmcnt(0)
v_cmp_gt_u32 vcc, s30, v43
s_cbranch_vccz L_pkv_sok
s_sleep 8
s_branch L_pkv_s
L_pkv_sok:
v_cmp_gt_u32 vcc, s35, v41
s_cmp_eq_u64 vcc, 0
s_cselect_b32 s3, 1, 0
v_mov_b32 v40, s3
ds_write_b32 v19, v40 offset:53248
s_waitcnt lgkmcnt(0)
s_branch L_pln_s
L_pw0_s:
ds_read_b128 v[40:43], v0 offset:52224
ds_read_b128 v[52:55], v0 offset:55296
ds_read_b128 v[64:67], v0 offset:58368
ds_read_b128 v[44:47], v0 offset:53248
ds_read_b128 v[56:59], v0 offset:56320
ds_read_b128 v[68:71], v0 offset:59392
ds_read_b128 v[48:51], v0 offset:54272
ds_read_b128 v[60:63], v0 offset:57344
ds_read_b128 v[72:75], v0 offset:60416
s_waitcnt lgkmcnt(8)
v_pk_add_f32 v[80:81], v[80:81], v[40:41]
s_waitcnt lgkmcnt(6)
v_pk_add_f32 v[52:53], v[52:53], v[64:65]
v_pk_add_f32 v[80:81], v[80:81], v[52:53]
v_pk_fma_f32 v[28:29], v[96:97], v[80:81], v[28:29]
v_pk_add_f32 v[82:83], v[82:83], v[42:43]
v_pk_add_f32 v[54:55], v[54:55], v[66:67]
v_pk_add_f32 v[82:83], v[82:83], v[54:55]
v_pk_fma_f32 v[30:31], v[98:99], v[82:83], v[30:31]
s_waitcnt lgkmcnt(5)
v_pk_add_f32 v[84:85], v[84:85], v[44:45]
s_waitcnt lgkmcnt(3)
v_pk_add_f32 v[56:57], v[56:57], v[68:69]
v_pk_add_f32 v[84:85], v[84:85], v[56:57]
v_pk_fma_f32 v[32:33], v[100:101], v[84:85], v[32:33]
v_pk_add_f32 v[86:87], v[86:87], v[46:47]
v_pk_add_f32 v[58:59], v[58:59], v[70:71]
v_pk_add_f32 v[86:87], v[86:87], v[58:59]
v_pk_fma_f32 v[34:35], v[102:103], v[86:87], v[34:35]
s_waitcnt lgkmcnt(2)
v_pk_add_f32 v[88:89], v[88:89], v[48:49]
s_waitcnt lgkmcnt(0)
v_pk_add_f32 v[60:61], v[60:61], v[72:73]
v_pk_add_f32 v[88:89], v[88:89], v[60:61]
v_pk_fma_f32 v[36:37], v[104:105], v[88:89], v[36:37]
v_pk_add_f32 v[90:91], v[90:91], v[50:51]
v_pk_add_f32 v[62:63], v[62:63], v[74:75]
v_pk_add_f32 v[90:91], v[90:91], v[62:63]
v_pk_fma_f32 v[38:39], v[106:107], v[90:91], v[38:39]
ds_read_b128 v[52:55], v19 offset:44032
ds_read_b128 v[56:59], v19 offset:45056
ds_read_b128 v[60:63], v19 offset:46080
ds_read_b128 v[64:67], v19 offset:47104
ds_read_b128 v[68:71], v19 offset:48128
ds_read_b128 v[72:75], v19 offset:49152
v_pk_add_f32 v[92:93], v[28:29], v[30:31]
v_pk_add_f32 v[94:95], v[32:33], v[34:35]
v_pk_add_f32 v[92:93], v[92:93], v[36:37]
v_pk_add_f32 v[94:95], v[94:95], v[38:39]
v_pk_add_f32 v[92:93], v[92:93], v[94:95]
v_add_f32 v92, v92, v93
s_nop 1
v_add_f32_dpp v92, v92, v92 row_ror:8 row_mask:0xf bank_mask:0xf
s_nop 1
v_add_f32_dpp v92, v92, v92 row_ror:4 row_mask:0xf bank_mask:0xf
s_nop 1
v_add_f32_dpp v92, v92, v92 row_ror:2 row_mask:0xf bank_mask:0xf
s_nop 1
v_add_f32_dpp v92, v92, v92 row_ror:1 row_mask:0xf bank_mask:0xf
v_mov_b32 v94, v92
s_nop 1
v_permlane16_swap_b32 v92, v94
v_add_f32 v92, v92, v94
v_mov_b32 v94, v92
s_nop 1
v_permlane32_swap_b32 v92, v94
v_add_f32 v92, v92, v94
v_mul_f32 v92, 3133983949, v92
s_mov_b32 s30, -1
s_mov_b32 s31, 0
v_mov_b32 v93, v92
v_cndmask_b32 v94, 0, v92, s[30:31]
v_cndmask_b32 v95, 0, v92, s[30:31]
v_pk_add_f32 v[80:81], v[28:29], v[92:93]
v_pk_add_f32 v[82:83], v[30:31], v[92:93]
v_pk_add_f32 v[84:85], v[32:33], v[92:93]
v_pk_add_f32 v[86:87], v[34:35], v[92:93]
v_pk_add_f32 v[88:89], v[36:37], v[94:95]
v_pk_add_f32 v[90:91], v[38:39], v[94:95]
v_pk_mul_f32 v[92:93], v[80:81], v[80:81]
v_pk_fma_f32 v[92:93], v[82:83], v[82:83], v[92:93]
v_pk_fma_f32 v[92:93], v[84:85], v[84:85], v[92:93]
v_pk_fma_f32 v[92:93], v[86:87], v[86:87], v[92:93]
v_pk_fma_f32 v[92:93], v[88:89], v[88:89], v[92:93]
v_pk_fma_f32 v[92:93], v[90:91], v[90:91], v[92:93]
v_add_f32 v92, v92, v93
s_waitcnt lgkmcnt(5)
v_pk_mul_f32 v[80:81], v[80:81], v[52:53]
v_pk_mul_f32 v[82:83], v[82:83], v[54:55]
v_add_f32_dpp v92, v92, v92 row_ror:8 row_mask:0xf bank_mask:0xf
s_waitcnt lgkmcnt(4)
v_pk_mul_f32 v[84:85], v[84:85], v[56:57]
v_pk_mul_f32 v[86:87], v[86:87], v[58:59]
v_add_f32_dpp v92, v92, v92 row_ror:4 row_mask:0xf bank_mask:0xf
s_waitcnt lgkmcnt(3)
v_pk_mul_f32 v[88:89], v[88:89], v[60:61]
v_pk_mul_f32 v[90:91], v[90:91], v[62:63]
v_add_f32_dpp v92, v92, v92 row_ror:2 row_mask:0xf bank_mask:0xf
s_nop 1
v_add_f32_dpp v92, v92, v92 row_ror:1 row_mask:0xf bank_mask:0xf
v_mov_b32 v94, v92
s_nop 1
v_permlane16_swap_b32 v92, v94
v_add_f32 v92, v92, v94
v_mov_b32 v94, v92
s_nop 1
v_permlane32_swap_b32 v92, v94
v_add_f32 v92, v92, v94
v_mov_b32 v94, 925353388
v_fmac_f32 v94, 986500301, v92
v_rsq_f32 v94, v94
s_nop 0
v_mov_b32 v95, v94
s_waitcnt lgkmcnt(2)
v_pk_fma_f32 v[64:65], v[80:81], v[94:95], v[64:65]
v_pk_fma_f32 v[66:67], v[82:83], v[94:95], v[66:67]
v_cvt_pk_bf16_f32 v40, v64, v65
v_cvt_pk_bf16_f32 v41, v66, v67
buffer_store_dwordx2 v[40:41], v14, s[4:7], s48 offen offset:0 sc1
s_waitcnt lgkmcnt(1)
v_pk_fma_f32 v[68:69], v[84:85], v[94:95], v[68:69]
v_pk_fma_f32 v[70:71], v[86:87], v[94:95], v[70:71]
v_cvt_pk_bf16_f32 v42, v68, v69
v_cvt_pk_bf16_f32 v43, v70, v71
buffer_store_dwordx2 v[42:43], v14, s[4:7], s48 offen offset:512 sc1
s_waitcnt lgkmcnt(0)
v_pk_fma_f32 v[72:73], v[88:89], v[94:95], v[72:73]
v_pk_fma_f32 v[74:75], v[90:91], v[94:95], v[74:75]
v_cvt_pk_bf16_f32 v44, v72, v73
v_cvt_pk_bf16_f32 v45, v74, v75
buffer_store_dwordx2 v[44:45], v15, s[4:7], s48 offen offset:1024 sc1
v_mov_b32 v48, s34
s_waitcnt vmcnt(0)
buffer_store_dword v48, off, s[4:7], s60 offset:512 sc1
L_p2_s:
buffer_load_dword v40, v18, s[4:7], s41 offen offset:512 sc1
s_add_u32 s27, s27, 1
s_cmp_gt_u32 s27, 262144
s_cbranch_scc1 L_fail_s
s_waitcnt vmcnt(0)
v_cmp_gt_u32 vcc, s34, v40
s_cbranch_vccnz L_p2_s
L_pln_s:
s_barrier
ds_read_b32 v81, v19 offset:53248
s_and_b32 s62, s34, 1
s_lshl_b32 s62, s62, 16
s_or_b32 s62, s62, 1
s_cmp_eq_u32 s34, 16
s_cselect_b32 s36, 0x40000000, s36
s_cmp_ge_u32 s25, 27
s_cbranch_scc1 L_pskip_s
s_add_u32 m0, s59, 65536
s_nop 0
buffer_load_dwordx4 v8, s[4:7], s49 offen offset:0 sc1 lds
s_add_u32 m0, s59, 66560
s_nop 0
buffer_load_dwordx4 v9, s[4:7], s49 offen offset:0 sc1 lds
s_nop 7
s_add_u32 m0, s59, 73472
s_nop 0
buffer_load_dwordx4 v8, s[4:7], s49 offen offset:256 sc1 lds
s_add_u32 m0, s59, 74496
s_nop 0
buffer_load_dwordx4 v9, s[4:7], s49 offen offset:256 sc1 lds
s_add_u32 m0, s59, 81408
s_nop 0
buffer_load_dwordx4 v8, s[4:7], s49 offen offset:512 sc1 lds
s_add_u32 m0, s59, 82432
s_nop 0
buffer_load_dwordx4 v9, s[4:7], s49 offen offset:512 sc1 lds
v_xor_b32 v40, 0, v16
v_xor_b32 v41, 32, v16
v_xor_b32 v42, 64, v16
v_xor_b32 v43, 96, v16
v_xor_b32 v44, 128, v16
v_xor_b32 v45, 160, v16
v_xor_b32 v46, 192, v16
v_xor_b32 v47, 224, v16
s_lshl_b32 s3, s26, 10
v_add_u32 v80, s3, v0
s_waitcnt vmcnt(4)
s_barrier
ds_read_b128 v[48:51], v40 offset:0
ds_read_b128 v[52:55], v41 offset:0
ds_read_b128 v[56:59], v42 offset:0
ds_read_b128 v[60:63], v43 offset:0
s_waitcnt lgkmcnt(3)
v_mfma_f32_32x32x16_bf16 v[64:79], a[16:19], v[48:51], 0
ds_read_b128 v[48:51], v44 offset:0
s_add_u32 m0, s59, 89344
s_nop 0
buffer_load_dwordx4 v8, s[4:7], s49 offen offset:768 sc1 lds
s_waitcnt lgkmcnt(3)
v_mfma_f32_32x32x16_bf16 v[64:79], a[20:23], v[52:55], v[64:79]
ds_read_b128 v[52:55], v45 offset:0
s_add_u32 m0, s59, 90368
s_nop 0
buffer_load_dwordx4 v9, s[4:7], s49 offen offset:768 sc1 lds
s_waitcnt lgkmcnt(3)
v_mfma_f32_32x32x16_bf16 v[64:79], a[24:27], v[56:59], v[64:79]
ds_read_b128 v[56:59], v46 offset:0
s_add_u32 m0, s59, 97280
s_nop 0
buffer_load_dwordx4 v8, s[4:7], s49 offen offset:1024 sc1 lds
s_waitcnt lgkmcnt(3)
v_mfma_f32_32x32x16_bf16 v[64:79], a[28:31], v[60:63], v[64:79]
ds_read_b128 v[60:63], v47 offset:0
s_add_u32 m0, s59, 98304
s_nop 0
buffer_load_dwordx4 v9, s[4:7], s49 offen offset:1024 sc1 lds
s_waitcnt lgkmcnt(3)
v_mfma_f32_32x32x16_bf16 v[64:79], a[32:35], v[48:51], v[64:79]
s_waitcnt vmcnt(6)
s_barrier
ds_read_b128 v[48:51], v40 offset:8192
s_waitcnt lgkmcnt(3)
v_mfma_f32_32x32x16_bf16 v[64:79], a[36:39], v[52:55], v[64:79]
ds_read_b128 v[52:55], v41 offset:8192
s_waitcnt lgkmcnt(3)
v_mfma_f32_32x32x16_bf16 v[64:79], a[40:43], v[56:59], v[64:79]
ds_read_b128 v[56:59], v42 offset:8192
v_readfirstlane_b32 s58, v81
s_cmp_lg_u32 s58, 0
s_cselect_b32 s31, s37, 0x40000000
s_waitcnt lgkmcnt(3)
v_mfma_f32_32x32x16_bf16 v[64:79], a[44:47], v[60:63], v[64:79]
ds_read_b128 v[60:63], v43 offset:8192
s_waitcnt lgkmcnt(3)
v_mfma_f32_32x32x16_bf16 v[64:79], a[48:51], v[48:51], v[64:79]
ds_read_b128 v[48:51], v44 offset:8192
s_waitcnt lgkmcnt(3)
v_mfma_f32_32x32x16_bf16 v[64:79], a[52:55], v[52:55], v[64:79]
ds_read_b128 v[52:55], v45 offset:8192
s_add_u32 m0, s51, 0
s_xor_b32 s3, s36, 0
buffer_load_dwordx4 v0, s[4:7], s3 offen offset:0 sc1 lds
s_waitcnt lgkmcnt(3)
v_mfma_f32_32x32x16_bf16 v[64:79], a[56:59], v[56:59], v[64:79]
ds_read_b128 v[56:59], v46 offset:8192
s_waitcnt lgkmcnt(3)
v_mfma_f32_32x32x16_bf16 v[64:79], a[60:63], v[60:63], v[64:79]
ds_read_b128 v[60:63], v47 offset:8192
buffer_load_dwordx4 v0, s[4:7], s3 offen offset:1024 sc1 lds
s_waitcnt lgkmcnt(3)
v_mfma_f32_32x32x16_bf16 v[64:79], a[64:67], v[48:51], v[64:79]
s_waitcnt vmcnt(6)
s_barrier
ds_read_b128 v[48:51], v40 offset:16384
s_waitcnt lgkmcnt(3)
v_mfma_f32_32x32x16_bf16 v[64:79], a[68:71], v[52:55], v[64:79]
ds_read_b128 v[52:55], v41 offset:16384
s_add_u32 m0, s51, 8192
s_xor_b32 s3, s36, 16384
buffer_load_dwordx4 v0, s[4:7], s3 offen offset:0 sc1 lds
s_waitcnt lgkmcnt(3)
v_mfma_f32_32x32x16_bf16 v[64:79], a[72:75], v[56:59], v[64:79]
ds_read_b128 v[56:59], v42 offset:16384
s_waitcnt lgkmcnt(3)
v_mfma_f32_32x32x16_bf16 v[64:79], a[76:79], v[60:63], v[64:79]
ds_read_b128 v[60:63], v43 offset:16384
buffer_load_dwordx4 v0, s[4:7], s3 offen offset:1024 sc1 lds
s_waitcnt lgkmcnt(3)
v_mfma_f32_32x32x16_bf16 v[64:79], a[80:83], v[48:51], v[64:79]
ds_read_b128 v[48:51], v44 offset:16384
s_waitcnt lgkmcnt(3)
v_mfma_f32_32x32x16_bf16 v[64:79], a[84:87], v[52:55], v[64:79]
ds_read_b128 v[52:55], v45 offset:16384
s_add_u32 m0, s51, 16384
s_xor_b32 s3, s36, 8192
buffer_load_dwordx4 v0, s[4:7], s3 offen offset:0 sc1 lds
s_waitcnt lgkmcnt(3)
v_mfma_f32_32x32x16_bf16 v[64:79], a[88:91], v[56:59], v[64:79]
ds_read_b128 v[56:59], v46 offset:16384
s_waitcnt lgkmcnt(3)
v_mfma_f32_32x32x16_bf16 v[64:79], a[92:95], v[60:63], v[64:79]
ds_read_b128 v[60:63], v47 offset:16384
buffer_load_dwordx4 v0, s[4:7], s3 offen offset:1024 sc1 lds
s_add_u32 s36, s36, 131072
s_waitcnt lgkmcnt(3)
v_mfma_f32_32x32x16_bf16 v[64:79], a[96:99], v[48:51], v[64:79]
s_waitcnt vmcnt(6)
s_barrier
ds_read_b128 v[48:51], v40 offset:24576
s_waitcnt lgkmcnt(3)
v_mfma_f32_32x32x16_bf16 v[64:79], a[100:103], v[52:55], v[64:79]
ds_read_b128 v[52:55], v41 offset:24576
s_waitcnt lgkmcnt(3)
v_mfma_f32_32x32x16_bf16 v[64:79], a[104:107], v[56:59], v[64:79]
ds_read_b128 v[56:59], v42 offset:24576
s_add_u32 m0, s52, 24576
s_nop 0
buffer_load_dwordx4 v0, s[4:7], s31 offen offset:0 sc1 lds
buffer_load_dwordx4 v0, s[4:7], s31 offen offset:1024 sc1 lds
s_waitcnt lgkmcnt(3)
v_mfma_f32_32x32x16_bf16 v[64:79], a[108:111], v[60:63], v[64:79]
ds_read_b128 v[60:63], v43 offset:24576
s_waitcnt lgkmcnt(3)
v_mfma_f32_32x32x16_bf16 v[64:79], a[112:115], v[48:51], v[64:79]
ds_read_b128 v[48:51], v44 offset:24576
s_waitcnt lgkmcnt(3)
v_mfma_f32_32x32x16_bf16 v[64:79], a[116:119], v[52:55], v[64:79]
ds_read_b128 v[52:55], v45 offset:24576
s_waitcnt lgkmcnt(3)
v_mfma_f32_32x32x16_bf16 v[64:79], a[120:123], v[56:59], v[64:79]
ds_read_b128 v[56:59], v46 offset:24576
s_waitcnt lgkmcnt(3)
v_mfma_f32_32x32x16_bf16 v[64:79], a[124:127], v[60:63], v[64:79]
ds_read_b128 v[60:63], v47 offset:24576
s_waitcnt lgkmcnt(3)
v_mfma_f32_32x32x16_bf16 v[64:79], a[128:131], v[48:51], v[64:79]
ds_read_b128 v[48:51], v40 offset:32768
s_waitcnt lgkmcnt(3)
v_mfma_f32_32x32x16_bf16 v[64:79], a[132:135], v[52:55], v[64:79]
ds_read_b128 v[52:55], v41 offset:32768
s_waitcnt lgkmcnt(3)
v_mfma_f32_32x32x16_bf16 v[64:79], a[136:139], v[56:59], v[64:79]
ds_read_b128 v[56:59], v42 offset:32768
s_waitcnt lgkmcnt(3)
v_mfma_f32_32x32x16_bf16 v[64:79], a[140:143], v[60:63], v[64:79]
ds_read_b128 v[60:63], v43 offset:32768
s_waitcnt lgkmcnt(3)
v_mfma_f32_32x32x16_bf16 v[64:79], a[144:147], v[48:51], v[64:79]
ds_read_b128 v[48:51], v44 offset:32768
s_waitcnt lgkmcnt(3)
v_mfma_f32_32x32x16_bf16 v[64:79], a[148:151], v[52:55], v[64:79]
ds_read_b128 v[52:55], v45 offset:32768
s_waitcnt lgkmcnt(3)
v_mfma_f32_32x32x16_bf16 v[64:79], a[152:155], v[56:59], v[64:79]
ds_read_b128 v[56:59], v46 offset:32768
s_waitcnt lgkmcnt(3)
v_mfma_f32_32x32x16_bf16 v[64:79], a[156:159], v[60:63], v[64:79]
ds_read_b128 v[60:63], v47 offset:32768
s_waitcnt lgkmcnt(3)
v_mfma_f32_32x32x16_bf16 v[64:79], a[160:163], v[48:51], v[64:79]
s_waitcnt lgkmcnt(2)
v_mfma_f32_32x32x16_bf16 v[64:79], a[164:167], v[52:55], v[64:79]
s_waitcnt lgkmcnt(1)
v_mfma_f32_32x32x16_bf16 v[64:79], a[168:171], v[56:59], v[64:79]
s_waitcnt lgkmcnt(0)
v_mfma_f32_32x32x16_bf16 v[64:79], a[172:175], v[60:63], v[64:79]
s_nop 11
v_max_f32 v64, 0, v64
v_max_f32 v65, 0, v65
v_max_f32 v66, 0, v66
v_max_f32 v67, 0, v67
v_max_f32 v68, 0, v68
v_max_f32 v69, 0, v69
v_max_f32 v70, 0, v70
v_max_f32 v71, 0, v71
v_pk_mul_f32 v[64:65], v[64:65], v[72:73]
v_pk_mul_f32 v[66:67], v[66:67], v[74:75]
v_pk_mul_f32 v[68:69], v[68:69], v[76:77]
v_pk_mul_f32 v[70:71], v[70:71], v[78:79]
v_cvt_pk_bf16_f32 v64, v64, v65
v_cvt_pk_bf16_f32 v65, v66, v67
v_cvt_pk_bf16_f32 v66, v68, v69
v_cvt_pk_bf16_f32 v67, v70, v71
ds_write_b128 v80, v[64:67] offset:61440
s_waitcnt lgkmcnt(0)
s_barrier
ds_read_b128 v[40:43], v0 offset:61440
ds_read_b128 v[44:47], v0 offset:62464
ds_read_b128 v[48:51], v0 offset:63488
ds_read_b128 v[52:55], v0 offset:64512
v_mov_b32 v56, s62
s_waitcnt lgkmcnt(3)
v_mfma_f32_32x32x16_bf16 v[72:87], a[176:179], v[40:43], 0
s_waitcnt lgkmcnt(2)
v_mfma_f32_32x32x16_bf16 v[72:87], a[180:183], v[44:47], v[72:87]
s_waitcnt lgkmcnt(1)
v_mfma_f32_32x32x16_bf16 v[72:87], a[184:187], v[48:51], v[72:87]
s_waitcnt lgkmcnt(0)
v_mfma_f32_32x32x16_bf16 v[72:87], a[188:191], v[52:55], v[72:87]
v_mfma_f32_32x32x16_bf16 v[88:103], a[192:195], v[40:43], 0
s_nop 3
s_nop 2
v_mfma_f32_32x32x16_bf16 v[88:103], a[196:199], v[44:47], v[88:103]
s_nop 2
v_cvt_pk_bf16_f32 v72, v72, v73
v_cvt_pk_bf16_f32 v73, v74, v75
v_cvt_pk_bf16_f32 v74, v76, v77
v_cvt_pk_bf16_f32 v75, v78, v79
v_mfma_f32_32x32x16_bf16 v[88:103], a[200:203], v[48:51], v[88:103]
v_bfi_b32 v72, s61, v56, v72
ds_write_b128 v3, v[72:75] offset:0
v_cvt_pk_bf16_f32 v76, v80, v81
v_cvt_pk_bf16_f32 v77, v82, v83
v_cvt_pk_bf16_f32 v78, v84, v85
v_mfma_f32_32x32x16_bf16 v[88:103], a[204:207], v[52:55], v[88:103]
v_cvt_pk_bf16_f32 v79, v86, v87
v_bfi_b32 v76, s61, v56, v76
ds_write_b128 v3, v[76:79] offset:32
ds_read_b128 v[104:107], v5 offset:0
ds_read_b128 v[108:111], v5 offset:1280
v_mfma_f32_32x32x16_bf16 v[72:87], a[208:211], v[40:43], 0
s_waitcnt lgkmcnt(1)
buffer_store_dwordx4 v[104:107], v7, s[4:7], s44 offen offset:0 sc1
s_waitcnt lgkmcnt(0)
buffer_store_dwordx4 v[108:111], v7, s[4:7], s45 offen offset:0 sc1
s_nop 3
v_mfma_f32_32x32x16_bf16 v[72:87], a[212:215], v[44:47], v[72:87]
v_cvt_pk_bf16_f32 v88, v88, v89
v_cvt_pk_bf16_f32 v89, v90, v91
v_cvt_pk_bf16_f32 v90, v92, v93
v_cvt_pk_bf16_f32 v91, v94, v95
v_mfma_f32_32x32x16_bf16 v[72:87], a[216:219], v[48:51], v[72:87]
v_bfi_b32 v88, s61, v56, v88
ds_write_b128 v3, v[88:91] offset:0
v_cvt_pk_bf16_f32 v92, v96, v97
v_cvt_pk_bf16_f32 v93, v98, v99
v_cvt_pk_bf16_f32 v94, v100, v101
v_mfma_f32_32x32x16_bf16 v[72:87], a[220:223], v[52:55], v[72:87]
v_cvt_pk_bf16_f32 v95, v102, v103
v_bfi_b32 v92, s61, v56, v92
ds_write_b128 v3, v[92:95] offset:32
ds_read_b128 v[104:107], v5 offset:0
ds_read_b128 v[108:111], v5 offset:1280
v_mfma_f32_32x32x16_bf16 v[88:103], a[224:227], v[40:43], 0
s_waitcnt lgkmcnt(1)
buffer_store_dwordx4 v[104:107], v7, s[4:7], s44 offen offset:256 sc1
s_waitcnt lgkmcnt(0)
buffer_store_dwordx4 v[108:111], v7, s[4:7], s45 offen offset:256 sc1
s_nop 3
v_mfma_f32_32x32x16_bf16 v[88:103], a[228:231], v[44:47], v[88:103]
v_cvt_pk_bf16_f32 v72, v72, v73
v_cvt_pk_bf16_f32 v73, v74, v75
v_cvt_pk_bf16_f32 v74, v76, v77
v_cvt_pk_bf16_f32 v75, v78, v79
v_mfma_f32_32x32x16_bf16 v[88:103], a[232:235], v[48:51], v[88:103]
v_bfi_b32 v72, s61, v56, v72
ds_write_b128 v3, v[72:75] offset:0
v_cvt_pk_bf16_f32 v76, v80, v81
v_cvt_pk_bf16_f32 v77, v82, v83
v_cvt_pk_bf16_f32 v78, v84, v85
v_mfma_f32_32x32x16_bf16 v[88:103], a[236:239], v[52:55], v[88:103]
v_cvt_pk_bf16_f32 v79, v86, v87
v_bfi_b32 v76, s61, v56, v76
ds_write_b128 v3, v[76:79] offset:32
ds_read_b128 v[104:107], v5 offset:0
ds_read_b128 v[108:111], v5 offset:1280
v_mfma_f32_32x32x16_bf16 v[72:87], a[240:243], v[40:43], 0
s_waitcnt lgkmcnt(1)
buffer_store_dwordx4 v[104:107], v7, s[4:7], s44 offen offset:512 sc1
s_waitcnt lgkmcnt(0)
buffer_store_dwordx4 v[108:111], v7, s[4:7], s45 offen offset:512 sc1
s_nop 3
v_mfma_f32_32x32x16_bf16 v[72:87], a[244:247], v[44:47], v[72:87]
v_cvt_pk_bf16_f32 v88, v88, v89
v_cvt_pk_bf16_f32 v89, v90, v91
v_cvt_pk_bf16_f32 v90, v92, v93
v_cvt_pk_bf16_f32 v91, v94, v95
v_mfma_f32_32x32x16_bf16 v[72:87], a[248:251], v[48:51], v[72:87]
v_bfi_b32 v88, s61, v56, v88
ds_write_b128 v3, v[88:91] offset:0
v_cvt_pk_bf16_f32 v92, v96, v97
v_cvt_pk_bf16_f32 v93, v98, v99
v_cvt_pk_bf16_f32 v94, v100, v101
v_mfma_f32_32x32x16_bf16 v[72:87], a[252:255], v[52:55], v[72:87]
v_cvt_pk_bf16_f32 v95, v102, v103
v_bfi_b32 v92, s61, v56, v92
ds_write_b128 v3, v[92:95] offset:32
ds_read_b128 v[104:107], v5 offset:0
ds_read_b128 v[108:111], v5 offset:1280
s_waitcnt lgkmcnt(1)
buffer_store_dwordx4 v[104:107], v7, s[4:7], s44 offen offset:768 sc1
s_waitcnt lgkmcnt(0)
buffer_store_dwordx4 v[108:111], v7, s[4:7], s45 offen offset:768 sc1
s_nop 2
v_cvt_pk_bf16_f32 v72, v72, v73
v_cvt_pk_bf16_f32 v73, v74, v75
v_cvt_pk_bf16_f32 v74, v76, v77
v_cvt_pk_bf16_f32 v75, v78, v79
v_bfi_b32 v72, s61, v56, v72
ds_write_b128 v3, v[72:75] offset:0
v_cvt_pk_bf16_f32 v76, v80, v81
v_cvt_pk_bf16_f32 v77, v82, v83
v_cvt_pk_bf16_f32 v78, v84, v85
v_cvt_pk_bf16_f32 v79, v86, v87
v_bfi_b32 v76, s61, v56, v76
ds_write_b128 v3, v[76:79] offset:32
ds_read_b128 v[104:107], v5 offset:0
ds_read_b128 v[108:111], v5 offset:1280
s_waitcnt lgkmcnt(1)
buffer_store_dwordx4 v[104:107], v7, s[4:7], s44 offen offset:1024 sc1
s_waitcnt lgkmcnt(0)
buffer_store_dwordx4 v[108:111], v7, s[4:7], s45 offen offset:1024 sc1
s_branch L_pffn_s
L_pskip_s:
s_waitcnt lgkmcnt(0)
v_readfirstlane_b32 s58, v81
s_cmp_lg_u32 s58, 0
s_cselect_b32 s31, s37, 0x40000000
s_add_u32 m0, s51, 0
s_xor_b32 s3, s36, 0
buffer_load_dwordx4 v0, s[4:7], s3 offen offset:0 sc1 lds
buffer_load_dwordx4 v0, s[4:7], s3 offen offset:1024 sc1 lds
s_add_u32 m0, s51, 8192
s_xor_b32 s3, s36, 16384
buffer_load_dwordx4 v0, s[4:7], s3 offen offset:0 sc1 lds
buffer_load_dwordx4 v0, s[4:7], s3 offen offset:1024 sc1 lds
s_add_u32 m0, s51, 16384
s_xor_b32 s3, s36, 8192
buffer_load_dwordx4 v0, s[4:7], s3 offen offset:0 sc1 lds
buffer_load_dwordx4 v0, s[4:7], s3 offen offset:1024 sc1 lds
s_add_u32 s36, s36, 131072
s_add_u32 m0, s52, 24576
s_nop 0
buffer_load_dwordx4 v0, s[4:7], s31 offen offset:0 sc1 lds
buffer_load_dwordx4 v0, s[4:7], s31 offen offset:1024 sc1 lds
s_waitcnt vmcnt(0)
L_pffn_s:
v_mov_b32 v40, s34
buffer_store_dword v40, off, s[4:7], s40 offset:1024 sc1
s_cmp_eq_u32 s58, 0
s_cbranch_scc1 L_pnat_s
s_waitcnt vmcnt(11)
s_barrier
ds_read_b128 v[40:43], v4 offset:16384
ds_read_b128 v[72:75], v0 offset:0
ds_read_b128 v[44:47], v4 offset:17408
ds_read_b128 v[76:79], v0 offset:1024
ds_read_b128 v[48:51], v4 offset:18432
ds_read_b128 v[80:83], v0 offset:2048
ds_read_b128 v[52:55], v4 offset:19456
ds_read_b128 v[84:87], v0 offset:3072
ds_read_b128 v[56:59], v0 offset:4096
ds_read_b128 v[60:63], v0 offset:5120
ds_read_b128 v[64:67], v0 offset:6144
ds_read_b128 v[68:71], v0 offset:7168
s_waitcnt lgkmcnt(10)
v_mfma_f32_16x16x32_bf16 v[92:95], v[72:75], v[40:43], 0
ds_read_b128 v[72:75], v6 offset:8192
s_waitcnt lgkmcnt(9)
v_mfma_f32_16x16x32_bf16 v[92:95], v[76:79], v[44:47], v[92:95]
ds_read_b128 v[76:79], v6 offset:9216
s_waitcnt lgkmcnt(8)
v_mfma_f32_16x16x32_bf16 v[92:95], v[80:83], v[48:51], v[92:95]
ds_read_b128 v[80:83], v6 offset:10240
s_waitcnt lgkmcnt(7)
v_mfma_f32_16x16x32_bf16 v[92:95], v[84:87], v[52:55], v[92:95]
ds_read_b128 v[84:87], v6 offset:11264
s_waitcnt lgkmcnt(7)
v_mfma_f32_16x16x32_bf16 v[96:99], v[56:59], v[40:43], 0
ds_read_b128 v[56:59], v0 offset:24576
s_waitcnt lgkmcnt(7)
v_mfma_f32_16x16x32_bf16 v[96:99], v[60:63], v[44:47], v[96:99]
ds_read_b128 v[60:63], v0 offset:25600
s_waitcnt lgkmcnt(7)
v_mfma_f32_16x16x32_bf16 v[96:99], v[64:67], v[48:51], v[96:99]
ds_read_b128 v[64:67], v0 offset:26624
s_waitcnt lgkmcnt(7)
v_mfma_f32_16x16x32_bf16 v[96:99], v[68:71], v[52:55], v[96:99]
ds_read_b128 v[68:71], v0 offset:27648
v_mov_b32 v110, s56
v_mov_b32 v107, 0
v_mov_b32 v108, 0
s_add_u32 s37, s37, 65536
ds_read_b64 v[100:101], v2 offset:0
ds_read_b64 v[102:103], v2 offset:512
s_waitcnt lgkmcnt(5)
v_mfma_f32_16x16x32_bf16 v[88:91], v[56:59], v[40:43], 0
s_waitcnt lgkmcnt(4)
v_mfma_f32_16x16x32_bf16 v[88:91], v[60:63], v[44:47], v[88:91]
s_waitcnt lgkmcnt(3)
v_mfma_f32_16x16x32_bf16 v[88:91], v[64:67], v[48:51], v[88:91]
s_waitcnt lgkmcnt(2)
v_mfma_f32_16x16x32_bf16 v[88:91], v[68:71], v[52:55], v[88:91]
v_cndmask_b32 v92, v92, v110, s[64:65]
v_cndmask_b32 v93, v93, v110, s[66:67]
v_cndmask_b32 v94, v94, v110, s[68:69]
v_cndmask_b32 v95, v95, v110, s[70:71]
v_cndmask_b32 v96, v96, v110, s[72:73]
v_cndmask_b32 v97, v97, v110, s[74:75]
v_cndmask_b32 v98, v98, v110, s[76:77]
v_cndmask_b32 v99, v99, v110, s[78:79]
v_max3_f32 v110, v92, v93, v94
v_max3_f32 v110, v110, v95, v96
v_max3_f32 v110, v110, v97, v98
v_max_f32 v110, v110, v99
v_max3_f32 v88, v90, v91, v110
v_mov_b32 v89, v88
s_nop 1
v_permlane16_swap_b32 v88, v89
v_max_f32 v88, v88, v89
v_mov_b32 v89, v88
s_nop 1
v_permlane32_swap_b32 v88, v89
v_max_f32 v88, v88, v89
v_sub_f32 v90, v90, v88
v_sub_f32 v91, v91, v88
v_sub_f32 v92, v92, v88
v_sub_f32 v93, v93, v88
v_sub_f32 v94, v94, v88
v_sub_f32 v95, v95, v88
v_sub_f32 v96, v96, v88
v_sub_f32 v97, v97, v88
v_sub_f32 v98, v98, v88
v_sub_f32 v99, v99, v88
v_exp_f32 v90, v90
v_exp_f32 v91, v91
v_exp_f32 v92, v92
v_exp_f32 v93, v93
v_exp_f32 v94, v94
v_exp_f32 v95, v95
v_exp_f32 v96, v96
v_exp_f32 v97, v97
v_exp_f32 v98, v98
v_exp_f32 v99, v99
v_cvt_pk_bf16_f32 v106, v90, v91
v_cvt_pk_bf16_f32 v109, v90, v91
v_cvt_pk_bf16_f32 v56, v92, v93
v_cvt_pk_bf16_f32 v57, v94, v95
v_cvt_pk_bf16_f32 v58, v96, v97
v_cvt_pk_bf16_f32 v59, v98, v99
s_nop 1
v_mfma_f32_16x16x32_bf16 v[40:43], v[72:75], v[56:59], 0
v_add_f32 v88, v90, v91
v_add_f32 v88, v88, v92
v_mfma_f32_16x16x32_bf16 v[44:47], v[76:79], v[56:59], 0
v_add_f32 v88, v88, v93
v_add_f32 v88, v88, v94
v_mfma_f32_16x16x32_bf16 v[48:51], v[80:83], v[56:59], 0
v_add_f32 v88, v88, v95
v_add_f32 v88, v88, v96
v_mfma_f32_16x16x32_bf16 v[52:55], v[84:87], v[56:59], 0
v_add_f32 v88, v88, v97
v_add_f32 v88, v88, v98
v_add_f32 v88, v88, v99
s_waitcnt lgkmcnt(1)
v_mfma_f32_16x16x16_bf16 v[40:43], v[100:101], v[106:107], v[40:43]
v_mov_b32 v89, v88
v_mfma_f32_16x16x16_bf16 v[44:47], v[100:101], v[108:109], v[44:47]
s_nop 0
v_permlane16_swap_b32 v88, v89
v_add_f32 v88, v88, v89
s_waitcnt lgkmcnt(0)
v_mfma_f32_16x16x16_bf16 v[48:51], v[102:103], v[106:107], v[48:51]
v_mov_b32 v89, v88
v_mfma_f32_16x16x16_bf16 v[52:55], v[102:103], v[108:109], v[52:55]
s_nop 0
v_permlane32_swap_b32 v88, v89
v_add_f32 v88, v88, v89
v_rcp_f32 v88, v88
s_nop 0
v_mov_b32 v89, v88
v_pk_mul_f32 v[40:41], v[40:41], v[88:89]
v_pk_mul_f32 v[42:43], v[42:43], v[88:89]
v_cvt_pk_bf16_f32 v40, v40, v41
v_cvt_pk_bf16_f32 v41, v42, v43
ds_write_b64 v1, v[40:41] offset:0
v_pk_mul_f32 v[44:45], v[44:45], v[88:89]
v_pk_mul_f32 v[46:47], v[46:47], v[88:89]
v_cvt_pk_bf16_f32 v44, v44, v45
v_cvt_pk_bf16_f32 v45, v46, v47
ds_write_b64 v1, v[44:45] offset:1024
v_pk_mul_f32 v[48:49], v[48:49], v[88:89]
v_pk_mul_f32 v[50:51], v[50:51], v[88:89]
v_cvt_pk_bf16_f32 v48, v48, v49
v_cvt_pk_bf16_f32 v49, v50, v51
ds_write_b64 v1, v[48:49] offset:2048
v_pk_mul_f32 v[52:53], v[52:53], v[88:89]
v_pk_mul_f32 v[54:55], v[54:55], v[88:89]
v_cvt_pk_bf16_f32 v52, v52, v53
v_cvt_pk_bf16_f32 v53, v54, v55
ds_write_b64 v1, v[52:53] offset:3072
s_waitcnt lgkmcnt(0)
L_pnat_s:
L_p3_s:
buffer_load_dword v40, v17, s[4:7], s41 offen offset:1024 sc1
s_add_u32 s27, s27, 1
s_cmp_gt_u32 s27, 262144
s_cbranch_scc1 L_fail_s
s_waitcnt vmcnt(0)
v_cmp_gt_u32 vcc, s34, v40
s_cbranch_vccnz L_p3_s
L_rr2_s:
buffer_load_dwordx4 v[40:43], v10, s[4:7], s47 offen offset:0 sc1
buffer_load_dwordx4 v[44:47], v11, s[4:7], s47 offen offset:0 sc1
buffer_load_dwordx4 v[48:51], v10, s[4:7], s47 offen offset:256 sc1
buffer_load_dwordx4 v[52:55], v11, s[4:7], s47 offen offset:256 sc1
buffer_load_dwordx4 v[56:59], v10, s[4:7], s47 offen offset:512 sc1
buffer_load_dwordx4 v[60:63], v11, s[4:7], s47 offen offset:512 sc1
buffer_load_dwordx4 v[64:67], v10, s[4:7], s47 offen offset:768 sc1
buffer_load_dwordx4 v[68:71], v11, s[4:7], s47 offen offset:768 sc1
buffer_load_dwordx4 v[72:75], v10, s[4:7], s47 offen offset:1024 sc1
buffer_load_dwordx4 v[76:79], v11, s[4:7], s47 offen offset:1024 sc1
v_add_u32 v92, s57, v0
ds_read_b128 v[96:99], v19 offset:50176
ds_read_b128 v[100:103], v19 offset:51200
ds_read_b128 v[104:107], v19 offset:52224
s_add_u32 s27, s27, 1
s_cmp_gt_u32 s27, 262144
s_cbranch_scc1 L_fail_s
s_waitcnt vmcnt(9)
v_mfma_f32_16x16x32_bf16 v[80:83], v[20:23], v[40:43], 0
v_xor_b32 v94, s62, v40
s_waitcnt vmcnt(8)
v_mfma_f32_16x16x32_bf16 v[80:83], v[20:23], v[44:47], v[80:83]
v_xor_b32 v95, s62, v44
s_waitcnt vmcnt(7)
v_mfma_f32_16x16x32_bf16 v[80:83], v[24:27], v[48:51], v[80:83]
v_bitop3_b32 v94, v94, v48, s62 bitop3:0xf6
s_waitcnt vmcnt(6)
v_mfma_f32_16x16x32_bf16 v[80:83], v[24:27], v[52:55], v[80:83]
v_bitop3_b32 v95, v95, v52, s62 bitop3:0xf6
s_waitcnt vmcnt(5)
v_mfma_f32_16x16x32_bf16 v[84:87], v[20:23], v[56:59], 0
v_bitop3_b32 v94, v94, v56, s62 bitop3:0xf6
s_waitcnt vmcnt(4)
v_mfma_f32_16x16x32_bf16 v[84:87], v[20:23], v[60:63], v[84:87]
v_bitop3_b32 v95, v95, v60, s62 bitop3:0xf6
s_nop 0
ds_write_b128 v92, v[80:83] offset:49152
s_waitcnt vmcnt(3)
v_mfma_f32_16x16x32_bf16 v[84:87], v[24:27], v[64:67], v[84:87]
v_bitop3_b32 v94, v94, v64, s62 bitop3:0xf6
s_waitcnt vmcnt(2)
v_mfma_f32_16x16x32_bf16 v[84:87], v[24:27], v[68:71], v[84:87]
v_bitop3_b32 v95, v95, v68, s62 bitop3:0xf6
s_waitcnt vmcnt(1)
v_mfma_f32_16x16x32_bf16 v[88:91], v[20:23], v[72:75], 0
v_bitop3_b32 v94, v94, v72, s62 bitop3:0xf6
s_waitcnt vmcnt(0)
v_mfma_f32_16x16x32_bf16 v[88:91], v[20:23], v[76:79], v[88:91]
v_bitop3_b32 v95, v95, v76, s62 bitop3:0xf6
s_nop 0
ds_write_b128 v92, v[84:87] offset:50176
v_cndmask_b32 v94, 0, v94, s[16:17]
v_cndmask_b32 v95, 0, v95, s[18:19]
v_bitop3_b32 v94, v94, v95, s61 bitop3:0xa8
v_cmp_ne_u32 vcc, 0, v94
s_nop 0
ds_write_b128 v92, v[88:91] offset:51200
s_cbranch_vccnz L_rr2_s
s_waitcnt lgkmcnt(0)
s_barrier
s_cmp_lg_u32 s26, 0
s_cbranch_scc1 L_pout_s
v_mov_b32 v93, s34
buffer_store_dword v93, off, s[4:7], s60 offset:640 sc1
ds_read_b128 v[40:43], v0 offset:52224
ds_read_b128 v[52:55], v0 offset:55296
ds_read_b128 v[64:67], v0 offset:58368
ds_read_b128 v[44:47], v0 offset:53248
ds_read_b128 v[56:59], v0 offset:56320
ds_read_b128 v[68:71], v0 offset:59392
ds_read_b128 v[48:51], v0 offset:54272
ds_read_b128 v[60:63], v0 offset:57344
ds_read_b128 v[72:75], v0 offset:60416
s_waitcnt lgkmcnt(8)
v_pk_add_f32 v[80:81], v[80:81], v[40:41]
s_waitcnt lgkmcnt(6)
v_pk_add_f32 v[52:53], v[52:53], v[64:65]
v_pk_add_f32 v[80:81], v[80:81], v[52:53]
v_pk_fma_f32 v[28:29], v[96:97], v[80:81], v[28:29]
v_pk_add_f32 v[82:83], v[82:83], v[42:43]
v_pk_add_f32 v[54:55], v[54:55], v[66:67]
v_pk_add_f32 v[82:83], v[82:83], v[54:55]
v_pk_fma_f32 v[30:31], v[98:99], v[82:83], v[30:31]
s_waitcnt lgkmcnt(5)
v_pk_add_f32 v[84:85], v[84:85], v[44:45]
s_waitcnt lgkmcnt(3)
v_pk_add_f32 v[56:57], v[56:57], v[68:69]
v_pk_add_f32 v[84:85], v[84:85], v[56:57]
v_pk_fma_f32 v[32:33], v[100:101], v[84:85], v[32:33]
v_pk_add_f32 v[86:87], v[86:87], v[46:47]
v_pk_add_f32 v[58:59], v[58:59], v[70:71]
v_pk_add_f32 v[86:87], v[86:87], v[58:59]
v_pk_fma_f32 v[34:35], v[102:103], v[86:87], v[34:35]
s_waitcnt lgkmcnt(2)
v_pk_add_f32 v[88:89], v[88:89], v[48:49]
s_waitcnt lgkmcnt(0)
v_pk_add_f32 v[60:61], v[60:61], v[72:73]
v_pk_add_f32 v[88:89], v[88:89], v[60:61]
v_pk_fma_f32 v[36:37], v[104:105], v[88:89], v[36:37]
v_pk_add_f32 v[90:91], v[90:91], v[50:51]
v_pk_add_f32 v[62:63], v[62:63], v[74:75]
v_pk_add_f32 v[90:91], v[90:91], v[62:63]
v_pk_fma_f32 v[38:39], v[106:107], v[90:91], v[38:39]
v_cvt_pk_bf16_f32 v52, v28, v29
v_cvt_pk_bf16_f32 v53, v30, v31
buffer_store_dwordx2 v[52:53], v12, s[12:15], s50 offen offset:0
v_cvt_pk_bf16_f32 v54, v32, v33
v_cvt_pk_bf16_f32 v55, v34, v35
buffer_store_dwordx2 v[54:55], v12, s[12:15], s50 offen offset:512
v_cvt_pk_bf16_f32 v56, v36, v37
v_cvt_pk_bf16_f32 v57, v38, v39
buffer_store_dwordx2 v[56:57], v13, s[12:15], s50 offen offset:1024
L_pout_s:
s_add_u32 s33, s33, 4
s_add_u32 s34, s34, 1
s_add_u32 s50, s50, 163840
s_cmp_lt_u32 s33, 64
s_cbranch_scc1 L_unit_s
s_endpgm
L_role_k_s:
s_cmp_eq_u32 s24, 3
s_cbranch_scc1 L_role_v_s
s_mov_b32 s8, s70
s_mov_b32 s9, s71
s_mov_b32 s10, 5242880
s_mov_b32 s11, 0x20000
s_mov_b32 s12, s68
s_mov_b32 s13, s69
s_mov_b32 s14, 5242880
s_mov_b32 s15, 0x20000
v_mbcnt_lo_u32_b32 v0, -1, 0
v_mbcnt_hi_u32_b32 v0, -1, v0
s_lshl_b32 s37, s25, 7
s_lshl_b32 s3, s26, 2
s_add_u32 s37, s37, s3
s_add_u32 s37, s37, 0
s_cmp_lg_u32 s26, 0
s_cbranch_scc1 L_arrk_s
s_mul_i32 s3, s24, 66
s_and_b32 s3, s3, 0xc8
s_add_u32 s3, s3, s76
v_mov_b32 v10, s3
s_lshl_b32 s3, 1, s25
v_mov_b32 v8, s3
s_add_u32 s3, s78, 0x10000
v_mov_b32 v9, s3
s_mov_b64 exec, 1
global_atomic_add_x2 v10, v[8:9], s[28:29] sc1
s_mov_b64 exec, -1
L_arrk_s:
s_lshl_b32 s30, s26, 15
s_lshl_b32 s31, s25, 8
s_add_u32 s31, s31, s30
s_lshl_b32 s38, s26, 10
v_lshrrev_b32 v8, 4, v0
v_and_b32 v9, 15, v0
v_lshlrev_b32 v5, 13, v8
v_lshl_add_u32 v5, v9, 4, v5
v_add_u32 v5, s31, v5
v_bfe_u32 v10, v0, 2, 2
v_and_b32 v9, 3, v0
v_lshlrev_b32 v6, 11, v8
v_lshl_add_u32 v6, v10, 8, v6
v_lshl_add_u32 v6, v9, 3, v6
s_lshl_b32 s30, s26, 6
v_add_u32 v6, s30, v6
v_lshlrev_b32 v1, 4, v0
v_add_u32 v3, 4096, v1
s_add_u32 m0, s38, 0
s_mov_b32 s3, 0
buffer_load_dwordx4 v5, s[8:11], s3 offen lds
s_add_u32 m0, s38, 4096
s_mov_b32 s3, 131072
buffer_load_dwordx4 v5, s[8:11], s3 offen lds
s_add_u32 m0, s38, 8192
s_mov_b32 s3, 262144
buffer_load_dwordx4 v5, s[8:11], s3 offen lds
s_add_u32 m0, s38, 12288
s_mov_b32 s3, 393216
buffer_load_dwordx4 v5, s[8:11], s3 offen lds
s_add_u32 m0, s38, 16384
s_mov_b32 s3, 524288
buffer_load_dwordx4 v5, s[8:11], s3 offen lds
s_add_u32 m0, s38, 20480
s_mov_b32 s3, 655360
buffer_load_dwordx4 v5, s[8:11], s3 offen lds
s_add_u32 m0, s38, 24576
s_mov_b32 s3, 786432
buffer_load_dwordx4 v5, s[8:11], s3 offen lds
s_add_u32 m0, s38, 28672
s_mov_b32 s3, 917504
buffer_load_dwordx4 v5, s[8:11], s3 offen lds
s_add_u32 m0, s38, 32768
s_mov_b32 s3, 1048576
buffer_load_dwordx4 v5, s[8:11], s3 offen lds
s_add_u32 m0, s38, 36864
s_mov_b32 s3, 1179648
buffer_load_dwordx4 v5, s[8:11], s3 offen lds
s_add_u32 m0, s38, 40960
s_mov_b32 s3, 1310720
buffer_load_dwordx4 v5, s[8:11], s3 offen lds
s_add_u32 m0, s38, 45056
s_mov_b32 s3, 1441792
buffer_load_dwordx4 v5, s[8:11], s3 offen lds
s_add_u32 m0, s38, 49152
s_mov_b32 s3, 1572864
buffer_load_dwordx4 v5, s[8:11], s3 offen lds
s_add_u32 m0, s38, 53248
s_mov_b32 s3, 1703936
buffer_load_dwordx4 v5, s[8:11], s3 offen lds
s_add_u32 m0, s38, 57344
s_mov_b32 s3, 1835008
buffer_load_dwordx4 v5, s[8:11], s3 offen lds
s_add_u32 m0, s38, 61440
s_mov_b32 s3, 1966080
buffer_load_dwordx4 v5, s[8:11], s3 offen lds
v_add_u32 v8, 0, v6
s_waitcnt vmcnt(12)
s_barrier
ds_read_b64_tr_b16 v[192:193], v8 offset:0
ds_read_b64_tr_b16 v[194:195], v8 offset:1024
ds_read_b64_tr_b16 v[196:197], v8 offset:32
ds_read_b64_tr_b16 v[198:199], v8 offset:1056
ds_read_b64_tr_b16 v[200:201], v8 offset:8192
ds_read_b64_tr_b16 v[202:203], v8 offset:9216
ds_read_b64_tr_b16 v[204:205], v8 offset:8224
ds_read_b64_tr_b16 v[206:207], v8 offset:9248
s_add_u32 m0, s38, 65536
s_mov_b32 s3, 2097152
buffer_load_dwordx4 v5, s[8:11], s3 offen lds
s_add_u32 m0, s38, 69632
s_mov_b32 s3, 2228224
buffer_load_dwordx4 v5, s[8:11], s3 offen lds
s_add_u32 m0, s38, 73728
s_mov_b32 s3, 2359296
buffer_load_dwordx4 v5, s[8:11], s3 offen lds
s_add_u32 m0, s38, 77824
s_mov_b32 s3, 2490368
buffer_load_dwordx4 v5, s[8:11], s3 offen lds
v_add_u32 v8, 16384, v6
s_waitcnt vmcnt(12)
s_waitcnt lgkmcnt(0)
s_barrier
ds_read_b64_tr_b16 v[208:209], v8 offset:0
ds_read_b64_tr_b16 v[210:211], v8 offset:1024
ds_read_b64_tr_b16 v[212:213], v8 offset:32
ds_read_b64_tr_b16 v[214:215], v8 offset:1056
ds_read_b64_tr_b16 v[216:217], v8 offset:8192
ds_read_b64_tr_b16 v[218:219], v8 offset:9216
ds_read_b64_tr_b16 v[220:221], v8 offset:8224
ds_read_b64_tr_b16 v[222:223], v8 offset:9248
s_add_u32 m0, s38, 81920
s_mov_b32 s3, 2621440
buffer_load_dwordx4 v5, s[8:11], s3 offen lds
s_add_u32 m0, s38, 86016
s_mov_b32 s3, 2752512
buffer_load_dwordx4 v5, s[8:11], s3 offen lds
s_add_u32 m0, s38, 90112
s_mov_b32 s3, 2883584
buffer_load_dwordx4 v5, s[8:11], s3 offen lds
s_add_u32 m0, s38, 94208
s_mov_b32 s3, 3014656
buffer_load_dwordx4 v5, s[8:11], s3 offen lds
v_add_u32 v8, 32768, v6
s_waitcnt vmcnt(12)
s_waitcnt lgkmcnt(0)
s_barrier
ds_read_b64_tr_b16 v[224:225], v8 offset:0
ds_read_b64_tr_b16 v[226:227], v8 offset:1024
ds_read_b64_tr_b16 v[228:229], v8 offset:32
ds_read_b64_tr_b16 v[230:231], v8 offset:1056
ds_read_b64_tr_b16 v[232:233], v8 offset:8192
ds_read_b64_tr_b16 v[234:235], v8 offset:9216
ds_read_b64_tr_b16 v[236:237], v8 offset:8224
ds_read_b64_tr_b16 v[238:239], v8 offset:9248
s_add_u32 m0, s38, 98304
s_mov_b32 s3, 3145728
buffer_load_dwordx4 v5, s[8:11], s3 offen lds
s_add_u32 m0, s38, 102400
s_mov_b32 s3, 3276800
buffer_load_dwordx4 v5, s[8:11], s3 offen lds
s_add_u32 m0, s38, 106496
s_mov_b32 s3, 3407872
buffer_load_dwordx4 v5, s[8:11], s3 offen lds
s_add_u32 m0, s38, 110592
s_mov_b32 s3, 3538944
buffer_load_dwordx4 v5, s[8:11], s3 offen lds
v_add_u32 v8, 49152, v6
s_waitcnt vmcnt(12)
s_waitcnt lgkmcnt(0)
s_barrier
ds_read_b64_tr_b16 v[240:241], v8 offset:0
ds_read_b64_tr_b16 v[242:243], v8 offset:1024
ds_read_b64_tr_b16 v[244:245], v8 offset:32
ds_read_b64_tr_b16 v[246:247], v8 offset:1056
ds_read_b64_tr_b16 v[248:249], v8 offset:8192
ds_read_b64_tr_b16 v[250:251], v8 offset:9216
ds_read_b64_tr_b16 v[252:253], v8 offset:8224
ds_read_b64_tr_b16 v[254:255], v8 offset:9248
s_add_u32 m0, s38, 114688
s_mov_b32 s3, 3670016
buffer_load_dwordx4 v5, s[8:11], s3 offen lds
s_add_u32 m0, s38, 118784
s_mov_b32 s3, 3801088
buffer_load_dwordx4 v5, s[8:11], s3 offen lds
s_add_u32 m0, s38, 122880
s_mov_b32 s3, 3932160
buffer_load_dwordx4 v5, s[8:11], s3 offen lds
s_add_u32 m0, s38, 126976
s_mov_b32 s3, 4063232
buffer_load_dwordx4 v5, s[8:11], s3 offen lds
v_add_u32 v8, 65536, v6
s_waitcnt vmcnt(12)
s_waitcnt lgkmcnt(0)
s_barrier
ds_read_b64_tr_b16 a[0:1], v8 offset:0
ds_read_b64_tr_b16 a[2:3], v8 offset:1024
ds_read_b64_tr_b16 a[4:5], v8 offset:32
ds_read_b64_tr_b16 a[6:7], v8 offset:1056
ds_read_b64_tr_b16 a[8:9], v8 offset:8192
ds_read_b64_tr_b16 a[10:11], v8 offset:9216
ds_read_b64_tr_b16 a[12:13], v8 offset:8224
ds_read_b64_tr_b16 a[14:15], v8 offset:9248
s_add_u32 m0, s38, 131072
s_mov_b32 s3, 4194304
buffer_load_dwordx4 v5, s[8:11], s3 offen lds
s_add_u32 m0, s38, 135168
s_mov_b32 s3, 4325376
buffer_load_dwordx4 v5, s[8:11], s3 offen lds
s_add_u32 m0, s38, 139264
s_mov_b32 s3, 4456448
buffer_load_dwordx4 v5, s[8:11], s3 offen lds
s_add_u32 m0, s38, 143360
s_mov_b32 s3, 4587520
buffer_load_dwordx4 v5, s[8:11], s3 offen lds
v_add_u32 v8, 81920, v6
s_waitcnt vmcnt(12)
s_waitcnt lgkmcnt(0)
s_barrier
ds_read_b64_tr_b16 a[16:17], v8 offset:0
ds_read_b64_tr_b16 a[18:19], v8 offset:1024
ds_read_b64_tr_b16 a[20:21], v8 offset:32
ds_read_b64_tr_b16 a[22:23], v8 offset:1056
ds_read_b64_tr_b16 a[24:25], v8 offset:8192
ds_read_b64_tr_b16 a[26:27], v8 offset:9216
ds_read_b64_tr_b16 a[28:29], v8 offset:8224
ds_read_b64_tr_b16 a[30:31], v8 offset:9248
s_add_u32 m0, s38, 147456
s_mov_b32 s3, 4718592
buffer_load_dwordx4 v5, s[8:11], s3 offen lds
s_add_u32 m0, s38, 151552
s_mov_b32 s3, 4849664
buffer_load_dwordx4 v5, s[8:11], s3 offen lds
s_add_u32 m0, s38, 155648
s_mov_b32 s3, 4980736
buffer_load_dwordx4 v5, s[8:11], s3 offen lds
s_add_u32 m0, s38, 159744
s_mov_b32 s3, 5111808
buffer_load_dwordx4 v5, s[8:11], s3 offen lds
v_add_u32 v8, 98304, v6
s_waitcnt vmcnt(12)
s_waitcnt lgkmcnt(0)
s_barrier
ds_read_b64_tr_b16 a[32:33], v8 offset:0
ds_read_b64_tr_b16 a[34:35], v8 offset:1024
ds_read_b64_tr_b16 a[36:37], v8 offset:32
ds_read_b64_tr_b16 a[38:39], v8 offset:1056
ds_read_b64_tr_b16 a[40:41], v8 offset:8192
ds_read_b64_tr_b16 a[42:43], v8 offset:9216
ds_read_b64_tr_b16 a[44:45], v8 offset:8224
ds_read_b64_tr_b16 a[46:47], v8 offset:9248
s_add_u32 m0, s38, 0
s_mov_b32 s3, 0
buffer_load_dwordx4 v5, s[12:15], s3 offen lds
s_add_u32 m0, s38, 4096
s_mov_b32 s3, 131072
buffer_load_dwordx4 v5, s[12:15], s3 offen lds
s_add_u32 m0, s38, 8192
s_mov_b32 s3, 262144
buffer_load_dwordx4 v5, s[12:15], s3 offen lds
s_add_u32 m0, s38, 12288
s_mov_b32 s3, 393216
buffer_load_dwordx4 v5, s[12:15], s3 offen lds
v_add_u32 v8, 114688, v6
s_waitcnt vmcnt(12)
s_waitcnt lgkmcnt(0)
s_barrier
ds_read_b64_tr_b16 a[48:49], v8 offset:0
ds_read_b64_tr_b16 a[50:51], v8 offset:1024
ds_read_b64_tr_b16 a[52:53], v8 offset:32
ds_read_b64_tr_b16 a[54:55], v8 offset:1056
ds_read_b64_tr_b16 a[56:57], v8 offset:8192
ds_read_b64_tr_b16 a[58:59], v8 offset:9216
ds_read_b64_tr_b16 a[60:61], v8 offset:8224
ds_read_b64_tr_b16 a[62:63], v8 offset:9248
s_add_u32 m0, s38, 16384
s_mov_b32 s3, 524288
buffer_load_dwordx4 v5, s[12:15], s3 offen lds
s_add_u32 m0, s38, 20480
s_mov_b32 s3, 655360
buffer_load_dwordx4 v5, s[12:15], s3 offen lds
s_add_u32 m0, s38, 24576
s_mov_b32 s3, 786432
buffer_load_dwordx4 v5, s[12:15], s3 offen lds
s_add_u32 m0, s38, 28672
s_mov_b32 s3, 917504
buffer_load_dwordx4 v5, s[12:15], s3 offen lds
v_add_u32 v8, 131072, v6
s_waitcnt vmcnt(12)
s_waitcnt lgkmcnt(0)
s_barrier
ds_read_b64_tr_b16 a[64:65], v8 offset:0
ds_read_b64_tr_b16 a[66:67], v8 offset:1024
ds_read_b64_tr_b16 a[68:69], v8 offset:32
ds_read_b64_tr_b16 a[70:71], v8 offset:1056
ds_read_b64_tr_b16 a[72:73], v8 offset:8192
ds_read_b64_tr_b16 a[74:75], v8 offset:9216
ds_read_b64_tr_b16 a[76:77], v8 offset:8224
ds_read_b64_tr_b16 a[78:79], v8 offset:9248
s_add_u32 m0, s38, 32768
s_mov_b32 s3, 1048576
buffer_load_dwordx4 v5, s[12:15], s3 offen lds
s_add_u32 m0, s38, 36864
s_mov_b32 s3, 1179648
buffer_load_dwordx4 v5, s[12:15], s3 offen lds
s_add_u32 m0, s38, 40960
s_mov_b32 s3, 1310720
buffer_load_dwordx4 v5, s[12:15], s3 offen lds
s_add_u32 m0, s38, 45056
s_mov_b32 s3, 1441792
buffer_load_dwordx4 v5, s[12:15], s3 offen lds
v_add_u32 v8, 147456, v6
s_waitcnt vmcnt(12)
s_waitcnt lgkmcnt(0)
s_barrier
ds_read_b64_tr_b16 a[80:81], v8 offset:0
ds_read_b64_tr_b16 a[82:83], v8 offset:1024
ds_read_b64_tr_b16 a[84:85], v8 offset:32
ds_read_b64_tr_b16 a[86:87], v8 offset:1056
ds_read_b64_tr_b16 a[88:89], v8 offset:8192
ds_read_b64_tr_b16 a[90:91], v8 offset:9216
ds_read_b64_tr_b16 a[92:93], v8 offset:8224
ds_read_b64_tr_b16 a[94:95], v8 offset:9248
s_add_u32 m0, s38, 49152
s_mov_b32 s3, 1572864
buffer_load_dwordx4 v5, s[12:15], s3 offen lds
s_add_u32 m0, s38, 53248
s_mov_b32 s3, 1703936
buffer_load_dwordx4 v5, s[12:15], s3 offen lds
s_add_u32 m0, s38, 57344
s_mov_b32 s3, 1835008
buffer_load_dwordx4 v5, s[12:15], s3 offen lds
s_add_u32 m0, s38, 61440
s_mov_b32 s3, 1966080
buffer_load_dwordx4 v5, s[12:15], s3 offen lds
v_add_u32 v8, 0, v6
s_waitcnt vmcnt(12)
s_waitcnt lgkmcnt(0)
s_barrier
ds_read_b64_tr_b16 a[96:97], v8 offset:0
ds_read_b64_tr_b16 a[98:99], v8 offset:1024
ds_read_b64_tr_b16 a[100:101], v8 offset:32
ds_read_b64_tr_b16 a[102:103], v8 offset:1056
ds_read_b64_tr_b16 a[104:105], v8 offset:8192
ds_read_b64_tr_b16 a[106:107], v8 offset:9216
ds_read_b64_tr_b16 a[108:109], v8 offset:8224
ds_read_b64_tr_b16 a[110:111], v8 offset:9248
s_add_u32 m0, s38, 65536
s_mov_b32 s3, 2097152
buffer_load_dwordx4 v5, s[12:15], s3 offen lds
s_add_u32 m0, s38, 69632
s_mov_b32 s3, 2228224
buffer_load_dwordx4 v5, s[12:15], s3 offen lds
s_add_u32 m0, s38, 73728
s_mov_b32 s3, 2359296
buffer_load_dwordx4 v5, s[12:15], s3 offen lds
s_add_u32 m0, s38, 77824
s_mov_b32 s3, 2490368
buffer_load_dwordx4 v5, s[12:15], s3 offen lds
v_add_u32 v8, 16384, v6
s_waitcnt vmcnt(12)
s_waitcnt lgkmcnt(0)
s_barrier
ds_read_b64_tr_b16 a[112:113], v8 offset:0
ds_read_b64_tr_b16 a[114:115], v8 offset:1024
ds_read_b64_tr_b16 a[116:117], v8 offset:32
ds_read_b64_tr_b16 a[118:119], v8 offset:1056
ds_read_b64_tr_b16 a[120:121], v8 offset:8192
ds_read_b64_tr_b16 a[122:123], v8 offset:9216
ds_read_b64_tr_b16 a[124:125], v8 offset:8224
ds_read_b64_tr_b16 a[126:127], v8 offset:9248
s_add_u32 m0, s38, 81920
s_mov_b32 s3, 2621440
buffer_load_dwordx4 v5, s[12:15], s3 offen lds
s_add_u32 m0, s38, 86016
s_mov_b32 s3, 2752512
buffer_load_dwordx4 v5, s[12:15], s3 offen lds
s_add_u32 m0, s38, 90112
s_mov_b32 s3, 2883584
buffer_load_dwordx4 v5, s[12:15], s3 offen lds
s_add_u32 m0, s38, 94208
s_mov_b32 s3, 3014656
buffer_load_dwordx4 v5, s[12:15], s3 offen lds
v_add_u32 v8, 32768, v6
s_waitcnt vmcnt(12)
s_waitcnt lgkmcnt(0)
s_barrier
ds_read_b64_tr_b16 a[128:129], v8 offset:0
ds_read_b64_tr_b16 a[130:131], v8 offset:1024
ds_read_b64_tr_b16 a[132:133], v8 offset:32
ds_read_b64_tr_b16 a[134:135], v8 offset:1056
ds_read_b64_tr_b16 a[136:137], v8 offset:8192
ds_read_b64_tr_b16 a[138:139], v8 offset:9216
ds_read_b64_tr_b16 a[140:141], v8 offset:8224
ds_read_b64_tr_b16 a[142:143], v8 offset:9248
s_add_u32 m0, s38, 98304
s_mov_b32 s3, 3145728
buffer_load_dwordx4 v5, s[12:15], s3 offen lds
s_add_u32 m0, s38, 102400
s_mov_b32 s3, 3276800
buffer_load_dwordx4 v5, s[12:15], s3 offen lds
s_add_u32 m0, s38, 106496
s_mov_b32 s3, 3407872
buffer_load_dwordx4 v5, s[12:15], s3 offen lds
s_add_u32 m0, s38, 110592
s_mov_b32 s3, 3538944
buffer_load_dwordx4 v5, s[12:15], s3 offen lds
v_add_u32 v8, 49152, v6
s_waitcnt vmcnt(12)
s_waitcnt lgkmcnt(0)
s_barrier
ds_read_b64_tr_b16 a[144:145], v8 offset:0
ds_read_b64_tr_b16 a[146:147], v8 offset:1024
ds_read_b64_tr_b16 a[148:149], v8 offset:32
ds_read_b64_tr_b16 a[150:151], v8 offset:1056
ds_read_b64_tr_b16 a[152:153], v8 offset:8192
ds_read_b64_tr_b16 a[154:155], v8 offset:9216
ds_read_b64_tr_b16 a[156:157], v8 offset:8224
ds_read_b64_tr_b16 a[158:159], v8 offset:9248
s_add_u32 m0, s38, 114688
s_mov_b32 s3, 3670016
buffer_load_dwordx4 v5, s[12:15], s3 offen lds
s_add_u32 m0, s38, 118784
s_mov_b32 s3, 3801088
buffer_load_dwordx4 v5, s[12:15], s3 offen lds
s_add_u32 m0, s38, 122880
s_mov_b32 s3, 3932160
buffer_load_dwordx4 v5, s[12:15], s3 offen lds
s_add_u32 m0, s38, 126976
s_mov_b32 s3, 4063232
buffer_load_dwordx4 v5, s[12:15], s3 offen lds
v_add_u32 v8, 65536, v6
s_waitcnt vmcnt(12)
s_waitcnt lgkmcnt(0)
s_barrier
ds_read_b64_tr_b16 a[160:161], v8 offset:0
ds_read_b64_tr_b16 a[162:163], v8 offset:1024
ds_read_b64_tr_b16 a[164:165], v8 offset:32
ds_read_b64_tr_b16 a[166:167], v8 offset:1056
ds_read_b64_tr_b16 a[168:169], v8 offset:8192
ds_read_b64_tr_b16 a[170:171], v8 offset:9216
ds_read_b64_tr_b16 a[172:173], v8 offset:8224
ds_read_b64_tr_b16 a[174:175], v8 offset:9248
s_add_u32 m0, s38, 131072
s_mov_b32 s3, 4194304
buffer_load_dwordx4 v5, s[12:15], s3 offen lds
s_add_u32 m0, s38, 135168
s_mov_b32 s3, 4325376
buffer_load_dwordx4 v5, s[12:15], s3 offen lds
s_add_u32 m0, s38, 139264
s_mov_b32 s3, 4456448
buffer_load_dwordx4 v5, s[12:15], s3 offen lds
s_add_u32 m0, s38, 143360
s_mov_b32 s3, 4587520
buffer_load_dwordx4 v5, s[12:15], s3 offen lds
v_add_u32 v8, 81920, v6
s_waitcnt vmcnt(12)
s_waitcnt lgkmcnt(0)
s_barrier
ds_read_b64_tr_b16 a[176:177], v8 offset:0
ds_read_b64_tr_b16 a[178:179], v8 offset:1024
ds_read_b64_tr_b16 a[180:181], v8 offset:32
ds_read_b64_tr_b16 a[182:183], v8 offset:1056
ds_read_b64_tr_b16 a[184:185], v8 offset:8192
ds_read_b64_tr_b16 a[186:187], v8 offset:9216
ds_read_b64_tr_b16 a[188:189], v8 offset:8224
ds_read_b64_tr_b16 a[190:191], v8 offset:9248
s_add_u32 m0, s38, 147456
s_mov_b32 s3, 4718592
buffer_load_dwordx4 v5, s[12:15], s3 offen lds
s_add_u32 m0, s38, 151552
s_mov_b32 s3, 4849664
buffer_load_dwordx4 v5, s[12:15], s3 offen lds
s_add_u32 m0, s38, 155648
s_mov_b32 s3, 4980736
buffer_load_dwordx4 v5, s[12:15], s3 offen lds
s_add_u32 m0, s38, 159744
s_mov_b32 s3, 5111808
buffer_load_dwordx4 v5, s[12:15], s3 offen lds
v_lshlrev_b32 v82, 2, v0
global_load_dword v83, v82, s[28:29] sc1
v_add_u32 v8, 98304, v6
s_waitcnt vmcnt(13)
s_waitcnt lgkmcnt(0)
s_barrier
ds_read_b64_tr_b16 a[192:193], v8 offset:0
ds_read_b64_tr_b16 a[194:195], v8 offset:1024
ds_read_b64_tr_b16 a[196:197], v8 offset:32
ds_read_b64_tr_b16 a[198:199], v8 offset:1056
ds_read_b64_tr_b16 a[200:201], v8 offset:8192
ds_read_b64_tr_b16 a[202:203], v8 offset:9216
ds_read_b64_tr_b16 a[204:205], v8 offset:8224
ds_read_b64_tr_b16 a[206:207], v8 offset:9248
v_add_u32 v8, 114688, v6
s_waitcnt vmcnt(9)
s_waitcnt lgkmcnt(0)
s_barrier
ds_read_b64_tr_b16 a[208:209], v8 offset:0
ds_read_b64_tr_b16 a[210:211], v8 offset:1024
ds_read_b64_tr_b16 a[212:213], v8 offset:32
ds_read_b64_tr_b16 a[214:215], v8 offset:1056
ds_read_b64_tr_b16 a[216:217], v8 offset:8192
ds_read_b64_tr_b16 a[218:219], v8 offset:9216
ds_read_b64_tr_b16 a[220:221], v8 offset:8224
ds_read_b64_tr_b16 a[222:223], v8 offset:9248
v_add_u32 v8, 131072, v6
s_waitcnt vmcnt(5)
s_waitcnt lgkmcnt(0)
s_barrier
ds_read_b64_tr_b16 a[224:225], v8 offset:0
ds_read_b64_tr_b16 a[226:227], v8 offset:1024
ds_read_b64_tr_b16 a[228:229], v8 offset:32
ds_read_b64_tr_b16 a[230:231], v8 offset:1056
ds_read_b64_tr_b16 a[232:233], v8 offset:8192
ds_read_b64_tr_b16 a[234:235], v8 offset:9216
ds_read_b64_tr_b16 a[236:237], v8 offset:8224
ds_read_b64_tr_b16 a[238:239], v8 offset:9248
v_add_u32 v8, 147456, v6
s_waitcnt vmcnt(1)
s_waitcnt lgkmcnt(0)
s_barrier
ds_read_b64_tr_b16 a[240:241], v8 offset:0
ds_read_b64_tr_b16 a[242:243], v8 offset:1024
ds_read_b64_tr_b16 a[244:245], v8 offset:32
ds_read_b64_tr_b16 a[246:247], v8 offset:1056
ds_read_b64_tr_b16 a[248:249], v8 offset:8192
ds_read_b64_tr_b16 a[250:251], v8 offset:9216
ds_read_b64_tr_b16 a[252:253], v8 offset:8224
ds_read_b64_tr_b16 a[254:255], v8 offset:9248
s_waitcnt lgkmcnt(0)
s_barrier
s_branch L_kc1k_s
L_kc0k_s:
global_load_dword v83, v82, s[28:29] sc1
s_add_u32 s27, s27, 1
s_cmp_gt_u32 s27, 262144
s_cbranch_scc1 L_fail_s
L_kc1k_s:
s_lshl_b32 s3, s77, 4
s_add_u32 s3, s3, 14
s_waitcnt vmcnt(0)
v_readlane_b32 s3, v83, s3
s_cmp_lt_u32 s3, 0x400000
s_cbranch_scc1 L_kc0k_s
s_and_b32 s31, s3, 0xff
s_cmp_ge_u32 s31, 32
s_cselect_b32 s30, 8192, 0
s_bfe_u32 s31, s3, 0x80008
s_cmp_ge_u32 s31, 32
s_cselect_b32 s31, 0, 16384
s_add_u32 s30, s30, s31
s_mul_i32 s35, s25, 2097152
s_add_u32 s35, s35, 50331648
s_lshr_b32 s3, s35, 8
s_xor_b32 s3, s3, s30
s_and_b32 s3, s3, 8192
s_add_u32 s35, s35, s3
s_lshl_b32 s3, s26, 10
s_xor_b32 s36, s35, 8192
s_add_u32 s36, s36, s3
s_lshl_b32 s3, s26, 10
s_add_u32 s35, s35, s3
s_add_u32 s35, s35, 0
s_mul_i32 s38, s26, 10240
s_add_u32 s33, s38, 6291456
s_mov_b32 s34, s38
s_mov_b32 s40, 0
s_mov_b32 s32, 0
s_mov_b32 s39, 1040356334
v_mov_b32 v11, 0
s_cmp_lg_u32 s26, 0
s_cbranch_scc1 L_cenwk_s
v_mbcnt_lo_u32_b32 v10, -1, 0
v_mbcnt_hi_u32_b32 v10, -1, v10
v_and_b32 v10, 7, v10
v_mul_u32_u24 v10, 66, v10
v_and_b32 v10, 0xc8, v10
v_add_u32 v10, s76, v10
L_cenk_s:
global_load_dwordx2 v[8:9], v10, s[28:29] sc1
s_add_u32 s27, s27, 1
s_cmp_gt_u32 s27, 262144
s_cbranch_scc1 L_fail_s
s_waitcnt vmcnt(0)
v_cmp_eq_u32 s[30:31], -1, v8
v_cmp_eq_u32 vcc, 0x200000, v9
s_and_b64 s[30:31], s[30:31], vcc
v_lshrrev_b32 v9, 16, v9
s_nop 1
v_add_u32_dpp v9, v9, v9 row_ror:4 row_mask:0xf bank_mask:0xf
s_nop 1
v_add_u32_dpp v9, v9, v9 row_ror:2 row_mask:0xf bank_mask:0xf
s_nop 1
v_add_u32_dpp v9, v9, v9 row_ror:1 row_mask:0xf bank_mask:0xf
v_cmp_lt_u32 vcc, 255, v9
s_cbranch_vccnz L_cendk_s
s_sleep 12
s_branch L_cenk_s
L_cendk_s:
v_mov_b32 v8, s30
ds_write_b32 v11, v8
s_waitcnt lgkmcnt(0)
L_cenwk_s:
s_barrier
ds_read_b32 v8, v11
s_waitcnt lgkmcnt(0)
v_cmp_ne_u32 vcc, -1, v8
s_cbranch_vccnz L_fail_s
s_cmp_lg_u32 s26, 0
s_cbranch_scc1 L_khwk_s
v_min_u32 v80, 11, v0
v_lshlrev_b32 v80, 2, v80
s_mov_b32 s3, 9216
L_kh0k_s:
buffer_load_dword v81, v80, s[4:7], s3 offen sc1
s_add_u32 s27, s27, 1
s_cmp_gt_u32 s27, 262144
s_cbranch_scc1 L_fail_s
s_waitcnt vmcnt(0)
v_cmp_ne_u32 vcc, 1, v81
s_cbranch_vccz L_khok0k_s
s_sleep 2
s_branch L_kh0k_s
L_khok0k_s:
L_khwk_s:
s_barrier
s_add_u32 m0, s34, 0
s_add_u32 s3, s33, 0
buffer_load_dwordx4 v1, s[4:7], s3 offen offset:0 sc1 lds
buffer_load_dwordx4 v1, s[4:7], s3 offen offset:1024 sc1 lds
buffer_load_dwordx4 v1, s[4:7], s3 offen offset:2048 sc1 lds
buffer_load_dwordx4 v1, s[4:7], s3 offen offset:3072 sc1 lds
s_add_u32 m0, s34, 4096
s_add_u32 s3, s33, 4096
buffer_load_dwordx4 v1, s[4:7], s3 offen offset:0 sc1 lds
buffer_load_dwordx4 v1, s[4:7], s3 offen offset:1024 sc1 lds
buffer_load_dwordx4 v1, s[4:7], s3 offen offset:2048 sc1 lds
buffer_load_dwordx4 v1, s[4:7], s3 offen offset:3072 sc1 lds
s_add_u32 m0, s34, 8192
s_add_u32 s3, s33, 8192
buffer_load_dwordx4 v1, s[4:7], s3 offen offset:0 sc1 lds
buffer_load_dwordx4 v1, s[4:7], s3 offen offset:1024 sc1 lds
s_add_u32 s33, s33, 40960
s_add_u32 s34, s34, 40960
s_cmp_ge_u32 s34, 163840
s_cselect_b32 s3, 163840, 0
s_sub_u32 s34, s34, s3
s_add_u32 m0, s34, 0
s_add_u32 s3, s33, 0
buffer_load_dwordx4 v1, s[4:7], s3 offen offset:0 sc1 lds
buffer_load_dwordx4 v1, s[4:7], s3 offen offset:1024 sc1 lds
buffer_load_dwordx4 v1, s[4:7], s3 offen offset:2048 sc1 lds
buffer_load_dwordx4 v1, s[4:7], s3 offen offset:3072 sc1 lds
s_add_u32 m0, s34, 4096
s_add_u32 s3, s33, 4096
buffer_load_dwordx4 v1, s[4:7], s3 offen offset:0 sc1 lds
buffer_load_dwordx4 v1, s[4:7], s3 offen offset:1024 sc1 lds
buffer_load_dwordx4 v1, s[4:7], s3 offen offset:2048 sc1 lds
buffer_load_dwordx4 v1, s[4:7], s3 offen offset:3072 sc1 lds
s_add_u32 m0, s34, 8192
s_add_u32 s3, s33, 8192
buffer_load_dwordx4 v1, s[4:7], s3 offen offset:0 sc1 lds
buffer_load_dwordx4 v1, s[4:7], s3 offen offset:1024 sc1 lds
s_add_u32 s33, s33, 40960
s_add_u32 s34, s34, 40960
s_cmp_ge_u32 s34, 163840
s_cselect_b32 s3, 163840, 0
s_sub_u32 s34, s34, s3
L_ksegk_s:
s_cmp_lg_u32 s32, 4
s_cbranch_scc1 L_kno1k_s
v_min_u32 v80, 63, v0
v_lshlrev_b32 v80, 2, v80
s_mov_b32 s3, 9216
L_kh1k_s:
buffer_load_dword v81, v80, s[4:7], s3 offen sc1
s_add_u32 s27, s27, 1
s_cmp_gt_u32 s27, 262144
s_cbranch_scc1 L_fail_s
s_waitcnt vmcnt(0)
v_cmp_ne_u32 vcc, 1, v81
s_cbranch_vccz L_khok1k_s
s_sleep 2
s_branch L_kh1k_s
L_khok1k_s:
L_kno1k_s:
s_cmp_lg_u32 s32, 30
s_cbranch_scc1 L_kno2k_s
v_min_u32 v80, 63, v0
v_lshlrev_b32 v80, 2, v80
s_mov_b32 s3, 9472
L_kh2k_s:
buffer_load_dword v81, v80, s[4:7], s3 offen sc1
s_add_u32 s27, s27, 1
s_cmp_gt_u32 s27, 262144
s_cbranch_scc1 L_fail_s
s_waitcnt vmcnt(0)
v_cmp_ne_u32 vcc, 1, v81
s_cbranch_vccz L_khok2k_s
s_sleep 2
s_branch L_kh2k_s
L_khok2k_s:
L_kno2k_s:
s_waitcnt vmcnt(10)
s_barrier
v_add_u32 v2, s40, v1
ds_read_b128 v[8:11], v2 offset:0
ds_read_b128 v[12:15], v2 offset:20480
ds_read_b128 v[16:19], v2 offset:1024
ds_read_b128 v[20:23], v2 offset:21504
ds_read_b128 v[24:27], v2 offset:2048
ds_read_b128 v[28:31], v2 offset:22528
s_add_u32 s40, s40, 40960
s_cmp_ge_u32 s40, 163840
s_cselect_b32 s40, 0, s40
v_mov_b32 v5, s32
s_waitcnt lgkmcnt(5)
v_mfma_f32_16x16x32_bf16 v[32:35], v[192:195], v[8:11], 0
s_add_u32 m0, s34, 0
s_add_u32 s3, s33, 0
buffer_load_dwordx4 v1, s[4:7], s3 offen offset:0 sc1 lds
v_mfma_f32_16x16x32_bf16 v[36:39], v[196:199], v[8:11], 0
v_mfma_f32_16x16x32_bf16 v[48:51], a[96:99], v[8:11], 0
v_mfma_f32_16x16x32_bf16 v[52:55], a[100:103], v[8:11], 0
ds_read_b128 v[8:11], v2 offset:3072
s_waitcnt lgkmcnt(5)
v_mfma_f32_16x16x32_bf16 v[40:43], v[192:195], v[12:15], 0
v_mfma_f32_16x16x32_bf16 v[44:47], v[196:199], v[12:15], 0
v_mfma_f32_16x16x32_bf16 v[56:59], a[96:99], v[12:15], 0
v_mfma_f32_16x16x32_bf16 v[60:63], a[100:103], v[12:15], 0
ds_read_b128 v[12:15], v2 offset:23552
s_waitcnt lgkmcnt(5)
v_mfma_f32_16x16x32_bf16 v[32:35], v[200:203], v[16:19], v[32:35]
v_mfma_f32_16x16x32_bf16 v[36:39], v[204:207], v[16:19], v[36:39]
v_mfma_f32_16x16x32_bf16 v[48:51], a[104:107], v[16:19], v[48:51]
v_mfma_f32_16x16x32_bf16 v[52:55], a[108:111], v[16:19], v[52:55]
ds_read_b128 v[16:19], v2 offset:4096
s_waitcnt lgkmcnt(5)
v_mfma_f32_16x16x32_bf16 v[40:43], v[200:203], v[20:23], v[40:43]
buffer_load_dwordx4 v1, s[4:7], s3 offen offset:1024 sc1 lds
v_mfma_f32_16x16x32_bf16 v[44:47], v[204:207], v[20:23], v[44:47]
v_mfma_f32_16x16x32_bf16 v[56:59], a[104:107], v[20:23], v[56:59]
v_mfma_f32_16x16x32_bf16 v[60:63], a[108:111], v[20:23], v[60:63]
ds_read_b128 v[20:23], v2 offset:24576
s_waitcnt lgkmcnt(5)
v_mfma_f32_16x16x32_bf16 v[32:35], v[208:211], v[24:27], v[32:35]
v_mfma_f32_16x16x32_bf16 v[36:39], v[212:215], v[24:27], v[36:39]
v_mfma_f32_16x16x32_bf16 v[48:51], a[112:115], v[24:27], v[48:51]
v_mfma_f32_16x16x32_bf16 v[52:55], a[116:119], v[24:27], v[52:55]
ds_read_b128 v[24:27], v2 offset:5120
s_waitcnt lgkmcnt(5)
v_mfma_f32_16x16x32_bf16 v[40:43], v[208:211], v[28:31], v[40:43]
v_mfma_f32_16x16x32_bf16 v[44:47], v[212:215], v[28:31], v[44:47]
v_mfma_f32_16x16x32_bf16 v[56:59], a[112:115], v[28:31], v[56:59]
v_mfma_f32_16x16x32_bf16 v[60:63], a[116:119], v[28:31], v[60:63]
ds_read_b128 v[28:31], v2 offset:25600
s_waitcnt lgkmcnt(5)
v_mfma_f32_16x16x32_bf16 v[32:35], v[216:219], v[8:11], v[32:35]
buffer_load_dwordx4 v1, s[4:7], s3 offen offset:2048 sc1 lds
v_mfma_f32_16x16x32_bf16 v[36:39], v[220:223], v[8:11], v[36:39]
v_mfma_f32_16x16x32_bf16 v[48:51], a[120:123], v[8:11], v[48:51]
v_mfma_f32_16x16x32_bf16 v[52:55], a[124:127], v[8:11], v[52:55]
ds_read_b128 v[8:11], v2 offset:6144
s_waitcnt lgkmcnt(5)
v_mfma_f32_16x16x32_bf16 v[40:43], v[216:219], v[12:15], v[40:43]
v_mfma_f32_16x16x32_bf16 v[44:47], v[220:223], v[12:15], v[44:47]
v_mfma_f32_16x16x32_bf16 v[56:59], a[120:123], v[12:15], v[56:59]
v_mfma_f32_16x16x32_bf16 v[60:63], a[124:127], v[12:15], v[60:63]
ds_read_b128 v[12:15], v2 offset:26624
s_waitcnt lgkmcnt(5)
v_mfma_f32_16x16x32_bf16 v[32:35], v[224:227], v[16:19], v[32:35]
v_mfma_f32_16x16x32_bf16 v[36:39], v[228:231], v[16:19], v[36:39]
v_mfma_f32_16x16x32_bf16 v[48:51], a[128:131], v[16:19], v[48:51]
v_mfma_f32_16x16x32_bf16 v[52:55], a[132:135], v[16:19], v[52:55]
ds_read_b128 v[16:19], v2 offset:7168
s_waitcnt lgkmcnt(5)
v_mfma_f32_16x16x32_bf16 v[40:43], v[224:227], v[20:23], v[40:43]
buffer_load_dwordx4 v1, s[4:7], s3 offen offset:3072 sc1 lds
v_mfma_f32_16x16x32_bf16 v[44:47], v[228:231], v[20:23], v[44:47]
v_mfma_f32_16x16x32_bf16 v[56:59], a[128:131], v[20:23], v[56:59]
v_mfma_f32_16x16x32_bf16 v[60:63], a[132:135], v[20:23], v[60:63]
ds_read_b128 v[20:23], v2 offset:27648
s_waitcnt lgkmcnt(5)
v_mfma_f32_16x16x32_bf16 v[32:35], v[232:235], v[24:27], v[32:35]
v_mfma_f32_16x16x32_bf16 v[36:39], v[236:239], v[24:27], v[36:39]
v_mfma_f32_16x16x32_bf16 v[48:51], a[136:139], v[24:27], v[48:51]
v_mfma_f32_16x16x32_bf16 v[52:55], a[140:143], v[24:27], v[52:55]
ds_read_b128 v[24:27], v2 offset:8192
s_waitcnt lgkmcnt(5)
v_mfma_f32_16x16x32_bf16 v[40:43], v[232:235], v[28:31], v[40:43]
v_mfma_f32_16x16x32_bf16 v[44:47], v[236:239], v[28:31], v[44:47]
v_mfma_f32_16x16x32_bf16 v[56:59], a[136:139], v[28:31], v[56:59]
v_mfma_f32_16x16x32_bf16 v[60:63], a[140:143], v[28:31], v[60:63]
ds_read_b128 v[28:31], v2 offset:28672
s_waitcnt lgkmcnt(5)
v_mfma_f32_16x16x32_bf16 v[32:35], v[240:243], v[8:11], v[32:35]
s_add_u32 m0, s34, 4096
s_add_u32 s3, s33, 4096
buffer_load_dwordx4 v1, s[4:7], s3 offen offset:0 sc1 lds
v_mfma_f32_16x16x32_bf16 v[36:39], v[244:247], v[8:11], v[36:39]
v_mfma_f32_16x16x32_bf16 v[48:51], a[144:147], v[8:11], v[48:51]
v_mfma_f32_16x16x32_bf16 v[52:55], a[148:151], v[8:11], v[52:55]
ds_read_b128 v[8:11], v2 offset:9216
s_waitcnt lgkmcnt(5)
v_mfma_f32_16x16x32_bf16 v[40:43], v[240:243], v[12:15], v[40:43]
v_mfma_f32_16x16x32_bf16 v[44:47], v[244:247], v[12:15], v[44:47]
v_mfma_f32_16x16x32_bf16 v[56:59], a[144:147], v[12:15], v[56:59]
v_mfma_f32_16x16x32_bf16 v[60:63], a[148:151], v[12:15], v[60:63]
ds_read_b128 v[12:15], v2 offset:29696
s_waitcnt lgkmcnt(5)
v_mfma_f32_16x16x32_bf16 v[32:35], v[248:251], v[16:19], v[32:35]
v_mfma_f32_16x16x32_bf16 v[36:39], v[252:255], v[16:19], v[36:39]
v_mfma_f32_16x16x32_bf16 v[48:51], a[152:155], v[16:19], v[48:51]
v_mfma_f32_16x16x32_bf16 v[52:55], a[156:159], v[16:19], v[52:55]
ds_read_b128 v[16:19], v2 offset:10240
s_waitcnt lgkmcnt(5)
v_mfma_f32_16x16x32_bf16 v[40:43], v[248:251], v[20:23], v[40:43]
buffer_load_dwordx4 v1, s[4:7], s3 offen offset:1024 sc1 lds
v_mfma_f32_16x16x32_bf16 v[44:47], v[252:255], v[20:23], v[44:47]
v_mfma_f32_16x16x32_bf16 v[56:59], a[152:155], v[20:23], v[56:59]
v_mfma_f32_16x16x32_bf16 v[60:63], a[156:159], v[20:23], v[60:63]
ds_read_b128 v[20:23], v2 offset:30720
s_waitcnt lgkmcnt(5)
v_mfma_f32_16x16x32_bf16 v[32:35], a[0:3], v[24:27], v[32:35]
v_mfma_f32_16x16x32_bf16 v[36:39], a[4:7], v[24:27], v[36:39]
v_mfma_f32_16x16x32_bf16 v[48:51], a[160:163], v[24:27], v[48:51]
v_mfma_f32_16x16x32_bf16 v[52:55], a[164:167], v[24:27], v[52:55]
ds_read_b128 v[24:27], v2 offset:11264
s_waitcnt lgkmcnt(5)
v_mfma_f32_16x16x32_bf16 v[40:43], a[0:3], v[28:31], v[40:43]
v_mfma_f32_16x16x32_bf16 v[44:47], a[4:7], v[28:31], v[44:47]
v_mfma_f32_16x16x32_bf16 v[56:59], a[160:163], v[28:31], v[56:59]
v_mfma_f32_16x16x32_bf16 v[60:63], a[164:167], v[28:31], v[60:63]
ds_read_b128 v[28:31], v2 offset:31744
s_waitcnt vmcnt(6)
buffer_store_dword v5, off, s[4:7], s37 sc1
s_waitcnt lgkmcnt(5)
v_mfma_f32_16x16x32_bf16 v[32:35], a[8:11], v[8:11], v[32:35]
buffer_load_dwordx4 v1, s[4:7], s3 offen offset:2048 sc1 lds
v_mfma_f32_16x16x32_bf16 v[36:39], a[12:15], v[8:11], v[36:39]
v_mfma_f32_16x16x32_bf16 v[48:51], a[168:171], v[8:11], v[48:51]
v_mfma_f32_16x16x32_bf16 v[52:55], a[172:175], v[8:11], v[52:55]
ds_read_b128 v[8:11], v2 offset:12288
s_waitcnt lgkmcnt(5)
v_mfma_f32_16x16x32_bf16 v[40:43], a[8:11], v[12:15], v[40:43]
v_mfma_f32_16x16x32_bf16 v[44:47], a[12:15], v[12:15], v[44:47]
v_mfma_f32_16x16x32_bf16 v[56:59], a[168:171], v[12:15], v[56:59]
v_mfma_f32_16x16x32_bf16 v[60:63], a[172:175], v[12:15], v[60:63]
ds_read_b128 v[12:15], v2 offset:32768
s_waitcnt lgkmcnt(5)
v_mfma_f32_16x16x32_bf16 v[32:35], a[16:19], v[16:19], v[32:35]
v_mfma_f32_16x16x32_bf16 v[36:39], a[20:23], v[16:19], v[36:39]
v_mfma_f32_16x16x32_bf16 v[48:51], a[176:179], v[16:19], v[48:51]
v_mfma_f32_16x16x32_bf16 v[52:55], a[180:183], v[16:19], v[52:55]
ds_read_b128 v[16:19], v2 offset:13312
s_waitcnt lgkmcnt(5)
v_mfma_f32_16x16x32_bf16 v[40:43], a[16:19], v[20:23], v[40:43]
buffer_load_dwordx4 v1, s[4:7], s3 offen offset:3072 sc1 lds
v_mfma_f32_16x16x32_bf16 v[44:47], a[20:23], v[20:23], v[44:47]
v_mfma_f32_16x16x32_bf16 v[56:59], a[176:179], v[20:23], v[56:59]
v_mfma_f32_16x16x32_bf16 v[60:63], a[180:183], v[20:23], v[60:63]
ds_read_b128 v[20:23], v2 offset:33792
s_waitcnt lgkmcnt(5)
v_mfma_f32_16x16x32_bf16 v[32:35], a[24:27], v[24:27], v[32:35]
v_mfma_f32_16x16x32_bf16 v[36:39], a[28:31], v[24:27], v[36:39]
v_mfma_f32_16x16x32_bf16 v[48:51], a[184:187], v[24:27], v[48:51]
v_mfma_f32_16x16x32_bf16 v[52:55], a[188:191], v[24:27], v[52:55]
ds_read_b128 v[24:27], v2 offset:14336
s_waitcnt lgkmcnt(5)
v_mfma_f32_16x16x32_bf16 v[40:43], a[24:27], v[28:31], v[40:43]
v_mfma_f32_16x16x32_bf16 v[44:47], a[28:31], v[28:31], v[44:47]
v_mfma_f32_16x16x32_bf16 v[56:59], a[184:187], v[28:31], v[56:59]
v_mfma_f32_16x16x32_bf16 v[60:63], a[188:191], v[28:31], v[60:63]
ds_read_b128 v[28:31], v2 offset:34816
s_waitcnt lgkmcnt(5)
v_mfma_f32_16x16x32_bf16 v[32:35], a[32:35], v[8:11], v[32:35]
s_add_u32 m0, s34, 8192
s_add_u32 s3, s33, 8192
buffer_load_dwordx4 v1, s[4:7], s3 offen offset:0 sc1 lds
v_mfma_f32_16x16x32_bf16 v[36:39], a[36:39], v[8:11], v[36:39]
v_mfma_f32_16x16x32_bf16 v[48:51], a[192:195], v[8:11], v[48:51]
v_mfma_f32_16x16x32_bf16 v[52:55], a[196:199], v[8:11], v[52:55]
ds_read_b128 v[8:11], v2 offset:15360
s_waitcnt lgkmcnt(5)
v_mfma_f32_16x16x32_bf16 v[40:43], a[32:35], v[12:15], v[40:43]
v_mfma_f32_16x16x32_bf16 v[44:47], a[36:39], v[12:15], v[44:47]
v_mfma_f32_16x16x32_bf16 v[56:59], a[192:195], v[12:15], v[56:59]
v_mfma_f32_16x16x32_bf16 v[60:63], a[196:199], v[12:15], v[60:63]
ds_read_b128 v[12:15], v2 offset:35840
s_waitcnt lgkmcnt(5)
v_mfma_f32_16x16x32_bf16 v[32:35], a[40:43], v[16:19], v[32:35]
v_mfma_f32_16x16x32_bf16 v[36:39], a[44:47], v[16:19], v[36:39]
v_mfma_f32_16x16x32_bf16 v[48:51], a[200:203], v[16:19], v[48:51]
v_mfma_f32_16x16x32_bf16 v[52:55], a[204:207], v[16:19], v[52:55]
ds_read_b128 v[16:19], v2 offset:16384
s_waitcnt lgkmcnt(5)
v_mfma_f32_16x16x32_bf16 v[40:43], a[40:43], v[20:23], v[40:43]
buffer_load_dwordx4 v1, s[4:7], s3 offen offset:1024 sc1 lds
s_add_u32 s33, s33, 40960
s_add_u32 s34, s34, 40960
s_cmp_ge_u32 s34, 163840
s_cselect_b32 s3, 163840, 0
s_sub_u32 s34, s34, s3
v_mfma_f32_16x16x32_bf16 v[44:47], a[44:47], v[20:23], v[44:47]
v_mfma_f32_16x16x32_bf16 v[56:59], a[200:203], v[20:23], v[56:59]
v_mfma_f32_16x16x32_bf16 v[60:63], a[204:207], v[20:23], v[60:63]
ds_read_b128 v[20:23], v2 offset:36864
s_waitcnt lgkmcnt(5)
v_mfma_f32_16x16x32_bf16 v[32:35], a[48:51], v[24:27], v[32:35]
v_mfma_f32_16x16x32_bf16 v[36:39], a[52:55], v[24:27], v[36:39]
v_mfma_f32_16x16x32_bf16 v[48:51], a[208:211], v[24:27], v[48:51]
v_mfma_f32_16x16x32_bf16 v[52:55], a[212:215], v[24:27], v[52:55]
ds_read_b128 v[24:27], v2 offset:17408
s_waitcnt lgkmcnt(5)
v_mfma_f32_16x16x32_bf16 v[40:43], a[48:51], v[28:31], v[40:43]
v_mfma_f32_16x16x32_bf16 v[44:47], a[52:55], v[28:31], v[44:47]
v_mfma_f32_16x16x32_bf16 v[56:59], a[208:211], v[28:31], v[56:59]
v_mfma_f32_16x16x32_bf16 v[60:63], a[212:215], v[28:31], v[60:63]
ds_read_b128 v[28:31], v2 offset:37888
s_waitcnt lgkmcnt(5)
v_mfma_f32_16x16x32_bf16 v[32:35], a[56:59], v[8:11], v[32:35]
v_mfma_f32_16x16x32_bf16 v[36:39], a[60:63], v[8:11], v[36:39]
v_mfma_f32_16x16x32_bf16 v[48:51], a[216:219], v[8:11], v[48:51]
v_mfma_f32_16x16x32_bf16 v[52:55], a[220:223], v[8:11], v[52:55]
ds_read_b128 v[8:11], v2 offset:18432
s_waitcnt lgkmcnt(5)
v_mfma_f32_16x16x32_bf16 v[40:43], a[56:59], v[12:15], v[40:43]
v_mfma_f32_16x16x32_bf16 v[44:47], a[60:63], v[12:15], v[44:47]
v_mfma_f32_16x16x32_bf16 v[56:59], a[216:219], v[12:15], v[56:59]
v_mfma_f32_16x16x32_bf16 v[60:63], a[220:223], v[12:15], v[60:63]
ds_read_b128 v[12:15], v2 offset:38912
s_waitcnt lgkmcnt(5)
v_mfma_f32_16x16x32_bf16 v[32:35], a[64:67], v[16:19], v[32:35]
v_mfma_f32_16x16x32_bf16 v[36:39], a[68:71], v[16:19], v[36:39]
v_mfma_f32_16x16x32_bf16 v[48:51], a[224:227], v[16:19], v[48:51]
v_mfma_f32_16x16x32_bf16 v[52:55], a[228:231], v[16:19], v[52:55]
ds_read_b128 v[16:19], v2 offset:19456
s_waitcnt lgkmcnt(5)
v_mfma_f32_16x16x32_bf16 v[40:43], a[64:67], v[20:23], v[40:43]
v_mfma_f32_16x16x32_bf16 v[44:47], a[68:71], v[20:23], v[44:47]
v_mfma_f32_16x16x32_bf16 v[56:59], a[224:227], v[20:23], v[56:59]
v_mfma_f32_16x16x32_bf16 v[60:63], a[228:231], v[20:23], v[60:63]
ds_read_b128 v[20:23], v2 offset:39936
s_waitcnt lgkmcnt(5)
v_mfma_f32_16x16x32_bf16 v[32:35], a[72:75], v[24:27], v[32:35]
v_mfma_f32_16x16x32_bf16 v[36:39], a[76:79], v[24:27], v[36:39]
v_mfma_f32_16x16x32_bf16 v[48:51], a[232:235], v[24:27], v[48:51]
v_mfma_f32_16x16x32_bf16 v[52:55], a[236:239], v[24:27], v[52:55]
s_waitcnt lgkmcnt(4)
v_mfma_f32_16x16x32_bf16 v[40:43], a[72:75], v[28:31], v[40:43]
v_mfma_f32_16x16x32_bf16 v[44:47], a[76:79], v[28:31], v[44:47]
v_mfma_f32_16x16x32_bf16 v[56:59], a[232:235], v[28:31], v[56:59]
v_mfma_f32_16x16x32_bf16 v[60:63], a[236:239], v[28:31], v[60:63]
s_waitcnt lgkmcnt(3)
v_mfma_f32_16x16x32_bf16 v[32:35], a[80:83], v[8:11], v[32:35]
v_mfma_f32_16x16x32_bf16 v[36:39], a[84:87], v[8:11], v[36:39]
v_mfma_f32_16x16x32_bf16 v[48:51], a[240:243], v[8:11], v[48:51]
v_mfma_f32_16x16x32_bf16 v[52:55], a[244:247], v[8:11], v[52:55]
s_waitcnt lgkmcnt(2)
v_mfma_f32_16x16x32_bf16 v[40:43], a[80:83], v[12:15], v[40:43]
v_mfma_f32_16x16x32_bf16 v[44:47], a[84:87], v[12:15], v[44:47]
v_mfma_f32_16x16x32_bf16 v[56:59], a[240:243], v[12:15], v[56:59]
v_mfma_f32_16x16x32_bf16 v[60:63], a[244:247], v[12:15], v[60:63]
s_waitcnt lgkmcnt(1)
v_mfma_f32_16x16x32_bf16 v[32:35], a[88:91], v[16:19], v[32:35]
v_mfma_f32_16x16x32_bf16 v[36:39], a[92:95], v[16:19], v[36:39]
v_mfma_f32_16x16x32_bf16 v[48:51], a[248:251], v[16:19], v[48:51]
v_mfma_f32_16x16x32_bf16 v[52:55], a[252:255], v[16:19], v[52:55]
s_waitcnt lgkmcnt(0)
v_mfma_f32_16x16x32_bf16 v[40:43], a[88:91], v[20:23], v[40:43]
v_mfma_f32_16x16x32_bf16 v[44:47], a[92:95], v[20:23], v[44:47]
v_mfma_f32_16x16x32_bf16 v[56:59], a[248:251], v[20:23], v[56:59]
v_mfma_f32_16x16x32_bf16 v[60:63], a[252:255], v[20:23], v[60:63]
v_mul_f32 v32, s39, v32
v_mul_f32 v33, s39, v33
v_mul_f32 v34, s39, v34
v_mul_f32 v35, s39, v35
v_mul_f32 v36, s39, v36
v_mul_f32 v37, s39, v37
v_mul_f32 v38, s39, v38
v_mul_f32 v39, s39, v39
v_cvt_pk_bf16_f32 v64, v32, v33
v_cvt_pk_bf16_f32 v65, v34, v35
v_cvt_pk_bf16_f32 v66, v36, v37
v_cvt_pk_bf16_f32 v67, v38, v39
buffer_store_dwordx4 v[64:67], v1, s[4:7], s35 offen offset:0 sc1
v_mul_f32 v40, s39, v40
v_mul_f32 v41, s39, v41
v_mul_f32 v42, s39, v42
v_mul_f32 v43, s39, v43
v_mul_f32 v44, s39, v44
v_mul_f32 v45, s39, v45
v_mul_f32 v46, s39, v46
v_mul_f32 v47, s39, v47
v_cvt_pk_bf16_f32 v68, v40, v41
v_cvt_pk_bf16_f32 v69, v42, v43
v_cvt_pk_bf16_f32 v70, v44, v45
v_cvt_pk_bf16_f32 v71, v46, v47
buffer_store_dwordx4 v[68:71], v3, s[4:7], s35 offen offset:0 sc1
v_cvt_pk_bf16_f32 v72, v48, v49
v_cvt_pk_bf16_f32 v73, v50, v51
v_cvt_pk_bf16_f32 v74, v52, v53
v_cvt_pk_bf16_f32 v75, v54, v55
buffer_store_dwordx4 v[72:75], v1, s[4:7], s36 offen offset:0 sc1
v_cvt_pk_bf16_f32 v76, v56, v57
v_cvt_pk_bf16_f32 v77, v58, v59
v_cvt_pk_bf16_f32 v78, v60, v61
v_cvt_pk_bf16_f32 v79, v62, v63
buffer_store_dwordx4 v[76:79], v3, s[4:7], s36 offen offset:0 sc1
s_add_u32 s35, s35, 32768
s_add_u32 s36, s36, 32768
s_add_u32 s32, s32, 1
s_barrier
v_add_u32 v2, s40, v1
ds_read_b128 v[8:11], v2 offset:0
ds_read_b128 v[12:15], v2 offset:20480
ds_read_b128 v[16:19], v2 offset:1024
ds_read_b128 v[20:23], v2 offset:21504
ds_read_b128 v[24:27], v2 offset:2048
ds_read_b128 v[28:31], v2 offset:22528
s_add_u32 s40, s40, 40960
s_cmp_ge_u32 s40, 163840
s_cselect_b32 s40, 0, s40
v_mov_b32 v5, s32
s_waitcnt lgkmcnt(5)
v_mfma_f32_16x16x32_bf16 v[32:35], v[192:195], v[8:11], 0
s_add_u32 m0, s34, 0
s_add_u32 s3, s33, 0
buffer_load_dwordx4 v1, s[4:7], s3 offen offset:0 sc1 lds
v_mfma_f32_16x16x32_bf16 v[36:39], v[196:199], v[8:11], 0
ds_read_b128 v[8:11], v2 offset:3072
s_waitcnt lgkmcnt(5)
v_mfma_f32_16x16x32_bf16 v[40:43], v[192:195], v[12:15], 0
v_mfma_f32_16x16x32_bf16 v[44:47], v[196:199], v[12:15], 0
ds_read_b128 v[12:15], v2 offset:23552
s_waitcnt lgkmcnt(5)
v_mfma_f32_16x16x32_bf16 v[32:35], v[200:203], v[16:19], v[32:35]
v_mfma_f32_16x16x32_bf16 v[36:39], v[204:207], v[16:19], v[36:39]
ds_read_b128 v[16:19], v2 offset:4096
s_waitcnt lgkmcnt(5)
v_mfma_f32_16x16x32_bf16 v[40:43], v[200:203], v[20:23], v[40:43]
buffer_load_dwordx4 v1, s[4:7], s3 offen offset:1024 sc1 lds
v_mfma_f32_16x16x32_bf16 v[44:47], v[204:207], v[20:23], v[44:47]
ds_read_b128 v[20:23], v2 offset:24576
s_waitcnt lgkmcnt(5)
v_mfma_f32_16x16x32_bf16 v[32:35], v[208:211], v[24:27], v[32:35]
v_mfma_f32_16x16x32_bf16 v[36:39], v[212:215], v[24:27], v[36:39]
ds_read_b128 v[24:27], v2 offset:5120
s_waitcnt lgkmcnt(5)
v_mfma_f32_16x16x32_bf16 v[40:43], v[208:211], v[28:31], v[40:43]
v_mfma_f32_16x16x32_bf16 v[44:47], v[212:215], v[28:31], v[44:47]
ds_read_b128 v[28:31], v2 offset:25600
s_waitcnt lgkmcnt(5)
v_mfma_f32_16x16x32_bf16 v[32:35], v[216:219], v[8:11], v[32:35]
buffer_load_dwordx4 v1, s[4:7], s3 offen offset:2048 sc1 lds
v_mfma_f32_16x16x32_bf16 v[36:39], v[220:223], v[8:11], v[36:39]
ds_read_b128 v[8:11], v2 offset:6144
s_waitcnt lgkmcnt(5)
v_mfma_f32_16x16x32_bf16 v[40:43], v[216:219], v[12:15], v[40:43]
v_mfma_f32_16x16x32_bf16 v[44:47], v[220:223], v[12:15], v[44:47]
ds_read_b128 v[12:15], v2 offset:26624
s_waitcnt lgkmcnt(5)
v_mfma_f32_16x16x32_bf16 v[32:35], v[224:227], v[16:19], v[32:35]
v_mfma_f32_16x16x32_bf16 v[36:39], v[228:231], v[16:19], v[36:39]
ds_read_b128 v[16:19], v2 offset:7168
s_waitcnt lgkmcnt(5)
v_mfma_f32_16x16x32_bf16 v[40:43], v[224:227], v[20:23], v[40:43]
buffer_load_dwordx4 v1, s[4:7], s3 offen offset:3072 sc1 lds
v_mfma_f32_16x16x32_bf16 v[44:47], v[228:231], v[20:23], v[44:47]
ds_read_b128 v[20:23], v2 offset:27648
s_waitcnt lgkmcnt(5)
v_mfma_f32_16x16x32_bf16 v[32:35], v[232:235], v[24:27], v[32:35]
v_mfma_f32_16x16x32_bf16 v[36:39], v[236:239], v[24:27], v[36:39]
ds_read_b128 v[24:27], v2 offset:8192
s_waitcnt lgkmcnt(5)
v_mfma_f32_16x16x32_bf16 v[40:43], v[232:235], v[28:31], v[40:43]
v_mfma_f32_16x16x32_bf16 v[44:47], v[236:239], v[28:31], v[44:47]
ds_read_b128 v[28:31], v2 offset:28672
s_waitcnt lgkmcnt(5)
v_mfma_f32_16x16x32_bf16 v[32:35], v[240:243], v[8:11], v[32:35]
s_add_u32 m0, s34, 4096
s_add_u32 s3, s33, 4096
buffer_load_dwordx4 v1, s[4:7], s3 offen offset:0 sc1 lds
v_mfma_f32_16x16x32_bf16 v[36:39], v[244:247], v[8:11], v[36:39]
ds_read_b128 v[8:11], v2 offset:9216
s_waitcnt lgkmcnt(5)
v_mfma_f32_16x16x32_bf16 v[40:43], v[240:243], v[12:15], v[40:43]
v_mfma_f32_16x16x32_bf16 v[44:47], v[244:247], v[12:15], v[44:47]
ds_read_b128 v[12:15], v2 offset:29696
s_waitcnt lgkmcnt(5)
v_mfma_f32_16x16x32_bf16 v[32:35], v[248:251], v[16:19], v[32:35]
v_mfma_f32_16x16x32_bf16 v[36:39], v[252:255], v[16:19], v[36:39]
ds_read_b128 v[16:19], v2 offset:10240
s_waitcnt lgkmcnt(5)
v_mfma_f32_16x16x32_bf16 v[40:43], v[248:251], v[20:23], v[40:43]
buffer_load_dwordx4 v1, s[4:7], s3 offen offset:1024 sc1 lds
v_mfma_f32_16x16x32_bf16 v[44:47], v[252:255], v[20:23], v[44:47]
ds_read_b128 v[20:23], v2 offset:30720
s_waitcnt lgkmcnt(5)
v_mfma_f32_16x16x32_bf16 v[32:35], a[0:3], v[24:27], v[32:35]
v_mfma_f32_16x16x32_bf16 v[36:39], a[4:7], v[24:27], v[36:39]
ds_read_b128 v[24:27], v2 offset:11264
s_waitcnt lgkmcnt(5)
v_mfma_f32_16x16x32_bf16 v[40:43], a[0:3], v[28:31], v[40:43]
v_mfma_f32_16x16x32_bf16 v[44:47], a[4:7], v[28:31], v[44:47]
ds_read_b128 v[28:31], v2 offset:31744
s_waitcnt lgkmcnt(5)
v_mfma_f32_16x16x32_bf16 v[32:35], a[8:11], v[8:11], v[32:35]
buffer_load_dwordx4 v1, s[4:7], s3 offen offset:2048 sc1 lds
v_mfma_f32_16x16x32_bf16 v[36:39], a[12:15], v[8:11], v[36:39]
ds_read_b128 v[8:11], v2 offset:12288
s_waitcnt lgkmcnt(5)
v_mfma_f32_16x16x32_bf16 v[40:43], a[8:11], v[12:15], v[40:43]
v_mfma_f32_16x16x32_bf16 v[44:47], a[12:15], v[12:15], v[44:47]
ds_read_b128 v[12:15], v2 offset:32768
s_waitcnt lgkmcnt(5)
v_mfma_f32_16x16x32_bf16 v[32:35], a[16:19], v[16:19], v[32:35]
v_mfma_f32_16x16x32_bf16 v[36:39], a[20:23], v[16:19], v[36:39]
ds_read_b128 v[16:19], v2 offset:13312
s_waitcnt lgkmcnt(5)
v_mfma_f32_16x16x32_bf16 v[40:43], a[16:19], v[20:23], v[40:43]
buffer_load_dwordx4 v1, s[4:7], s3 offen offset:3072 sc1 lds
v_mfma_f32_16x16x32_bf16 v[44:47], a[20:23], v[20:23], v[44:47]
ds_read_b128 v[20:23], v2 offset:33792
s_waitcnt lgkmcnt(5)
v_mfma_f32_16x16x32_bf16 v[32:35], a[24:27], v[24:27], v[32:35]
v_mfma_f32_16x16x32_bf16 v[36:39], a[28:31], v[24:27], v[36:39]
ds_read_b128 v[24:27], v2 offset:14336
s_waitcnt lgkmcnt(5)
v_mfma_f32_16x16x32_bf16 v[40:43], a[24:27], v[28:31], v[40:43]
v_mfma_f32_16x16x32_bf16 v[44:47], a[28:31], v[28:31], v[44:47]
ds_read_b128 v[28:31], v2 offset:34816
s_waitcnt lgkmcnt(5)
v_mfma_f32_16x16x32_bf16 v[32:35], a[32:35], v[8:11], v[32:35]
s_add_u32 m0, s34, 8192
s_add_u32 s3, s33, 8192
buffer_load_dwordx4 v1, s[4:7], s3 offen offset:0 sc1 lds
v_mfma_f32_16x16x32_bf16 v[36:39], a[36:39], v[8:11], v[36:39]
ds_read_b128 v[8:11], v2 offset:15360
s_waitcnt lgkmcnt(5)
v_mfma_f32_16x16x32_bf16 v[40:43], a[32:35], v[12:15], v[40:43]
v_mfma_f32_16x16x32_bf16 v[44:47], a[36:39], v[12:15], v[44:47]
ds_read_b128 v[12:15], v2 offset:35840
s_waitcnt lgkmcnt(5)
v_mfma_f32_16x16x32_bf16 v[32:35], a[40:43], v[16:19], v[32:35]
v_mfma_f32_16x16x32_bf16 v[36:39], a[44:47], v[16:19], v[36:39]
ds_read_b128 v[16:19], v2 offset:16384
s_waitcnt lgkmcnt(5)
v_mfma_f32_16x16x32_bf16 v[40:43], a[40:43], v[20:23], v[40:43]
buffer_load_dwordx4 v1, s[4:7], s3 offen offset:1024 sc1 lds
s_add_u32 s33, s33, 40960
s_add_u32 s34, s34, 40960
s_cmp_ge_u32 s34, 163840
s_cselect_b32 s3, 163840, 0
s_sub_u32 s34, s34, s3
v_mfma_f32_16x16x32_bf16 v[44:47], a[44:47], v[20:23], v[44:47]
ds_read_b128 v[20:23], v2 offset:36864
s_waitcnt lgkmcnt(5)
v_mfma_f32_16x16x32_bf16 v[32:35], a[48:51], v[24:27], v[32:35]
v_mfma_f32_16x16x32_bf16 v[36:39], a[52:55], v[24:27], v[36:39]
ds_read_b128 v[24:27], v2 offset:17408
s_waitcnt lgkmcnt(5)
v_mfma_f32_16x16x32_bf16 v[40:43], a[48:51], v[28:31], v[40:43]
v_mfma_f32_16x16x32_bf16 v[44:47], a[52:55], v[28:31], v[44:47]
ds_read_b128 v[28:31], v2 offset:37888
s_waitcnt lgkmcnt(5)
v_mfma_f32_16x16x32_bf16 v[32:35], a[56:59], v[8:11], v[32:35]
v_mfma_f32_16x16x32_bf16 v[36:39], a[60:63], v[8:11], v[36:39]
ds_read_b128 v[8:11], v2 offset:18432
s_waitcnt lgkmcnt(5)
v_mfma_f32_16x16x32_bf16 v[40:43], a[56:59], v[12:15], v[40:43]
v_mfma_f32_16x16x32_bf16 v[44:47], a[60:63], v[12:15], v[44:47]
ds_read_b128 v[12:15], v2 offset:38912
s_waitcnt vmcnt(10)
buffer_store_dword v5, off, s[4:7], s37 sc1
s_waitcnt lgkmcnt(5)
v_mfma_f32_16x16x32_bf16 v[32:35], a[64:67], v[16:19], v[32:35]
v_mfma_f32_16x16x32_bf16 v[36:39], a[68:71], v[16:19], v[36:39]
ds_read_b128 v[16:19], v2 offset:19456
s_waitcnt lgkmcnt(5)
v_mfma_f32_16x16x32_bf16 v[40:43], a[64:67], v[20:23], v[40:43]
v_mfma_f32_16x16x32_bf16 v[44:47], a[68:71], v[20:23], v[44:47]
ds_read_b128 v[20:23], v2 offset:39936
s_waitcnt lgkmcnt(5)
v_mfma_f32_16x16x32_bf16 v[32:35], a[72:75], v[24:27], v[32:35]
v_mfma_f32_16x16x32_bf16 v[36:39], a[76:79], v[24:27], v[36:39]
s_waitcnt lgkmcnt(4)
v_mfma_f32_16x16x32_bf16 v[40:43], a[72:75], v[28:31], v[40:43]
v_mfma_f32_16x16x32_bf16 v[44:47], a[76:79], v[28:31], v[44:47]
s_waitcnt lgkmcnt(3)
v_mfma_f32_16x16x32_bf16 v[32:35], a[80:83], v[8:11], v[32:35]
v_mfma_f32_16x16x32_bf16 v[36:39], a[84:87], v[8:11], v[36:39]
s_waitcnt lgkmcnt(2)
v_mfma_f32_16x16x32_bf16 v[40:43], a[80:83], v[12:15], v[40:43]
v_mfma_f32_16x16x32_bf16 v[44:47], a[84:87], v[12:15], v[44:47]
s_waitcnt lgkmcnt(1)
v_mfma_f32_16x16x32_bf16 v[32:35], a[88:91], v[16:19], v[32:35]
v_mfma_f32_16x16x32_bf16 v[36:39], a[92:95], v[16:19], v[36:39]
s_waitcnt lgkmcnt(0)
v_mfma_f32_16x16x32_bf16 v[40:43], a[88:91], v[20:23], v[40:43]
v_mfma_f32_16x16x32_bf16 v[44:47], a[92:95], v[20:23], v[44:47]
s_nop 3
v_mul_f32 v32, s39, v32
v_mul_f32 v33, s39, v33
v_mul_f32 v34, s39, v34
v_mul_f32 v35, s39, v35
v_mul_f32 v36, s39, v36
v_mul_f32 v37, s39, v37
v_mul_f32 v38, s39, v38
v_mul_f32 v39, s39, v39
v_cvt_pk_bf16_f32 v64, v32, v33
v_cvt_pk_bf16_f32 v65, v34, v35
v_cvt_pk_bf16_f32 v66, v36, v37
v_cvt_pk_bf16_f32 v67, v38, v39
buffer_store_dwordx4 v[64:67], v1, s[4:7], s35 offen offset:0 sc1
v_mul_f32 v40, s39, v40
v_mul_f32 v41, s39, v41
v_mul_f32 v42, s39, v42
v_mul_f32 v43, s39, v43
v_mul_f32 v44, s39, v44
v_mul_f32 v45, s39, v45
v_mul_f32 v46, s39, v46
v_mul_f32 v47, s39, v47
v_cvt_pk_bf16_f32 v68, v40, v41
v_cvt_pk_bf16_f32 v69, v42, v43
v_cvt_pk_bf16_f32 v70, v44, v45
v_cvt_pk_bf16_f32 v71, v46, v47
buffer_store_dwordx4 v[68:71], v3, s[4:7], s35 offen offset:0 sc1
s_add_u32 s35, s35, 32768
s_add_u32 s36, s36, 32768
s_add_u32 s32, s32, 1
s_cmp_lt_u32 s32, 64
s_cbranch_scc1 L_ksegk_s
v_mov_b32 v5, 64
s_waitcnt vmcnt(0)
buffer_store_dword v5, off, s[4:7], s37 sc1
s_endpgm
L_role_v_s:
s_mov_b32 s8, s72
s_mov_b32 s9, s73
s_mov_b32 s10, 5242880
s_mov_b32 s11, 0x20000
s_mov_b32 s12, s68
s_mov_b32 s13, s69
s_mov_b32 s14, 5242880
s_mov_b32 s15, 0x20000
v_mbcnt_lo_u32_b32 v0, -1, 0
v_mbcnt_hi_u32_b32 v0, -1, v0
s_lshl_b32 s37, s25, 7
s_lshl_b32 s3, s26, 2
s_add_u32 s37, s37, s3
s_add_u32 s37, s37, 16
s_cmp_lg_u32 s26, 0
s_cbranch_scc1 L_arrv_s
s_mul_i32 s3, s24, 66
s_and_b32 s3, s3, 0xc8
s_add_u32 s3, s3, s76
v_mov_b32 v10, s3
s_lshl_b32 s3, 1, s25
v_mov_b32 v8, s3
s_add_u32 s3, s78, 0x10000
v_mov_b32 v9, s3
s_mov_b64 exec, 1
global_atomic_add_x2 v10, v[8:9], s[28:29] sc1
s_mov_b64 exec, -1
L_arrv_s:
s_lshl_b32 s30, s26, 15
s_lshl_b32 s31, s25, 8
s_add_u32 s31, s31, s30
s_lshl_b32 s38, s26, 10
v_lshrrev_b32 v8, 4, v0
v_and_b32 v9, 15, v0
v_lshlrev_b32 v5, 13, v8
v_lshl_add_u32 v5, v9, 4, v5
v_add_u32 v5, s31, v5
v_bfe_u32 v10, v0, 2, 2
v_and_b32 v9, 3, v0
v_lshlrev_b32 v6, 11, v8
v_lshl_add_u32 v6, v10, 8, v6
v_lshl_add_u32 v6, v9, 3, v6
s_lshl_b32 s30, s26, 6
v_add_u32 v6, s30, v6
v_lshlrev_b32 v1, 4, v0
v_add_u32 v3, 4096, v1
s_add_u32 m0, s38, 0
s_mov_b32 s3, 0
buffer_load_dwordx4 v5, s[8:11], s3 offen lds
s_add_u32 m0, s38, 4096
s_mov_b32 s3, 131072
buffer_load_dwordx4 v5, s[8:11], s3 offen lds
s_add_u32 m0, s38, 8192
s_mov_b32 s3, 262144
buffer_load_dwordx4 v5, s[8:11], s3 offen lds
s_add_u32 m0, s38, 12288
s_mov_b32 s3, 393216
buffer_load_dwordx4 v5, s[8:11], s3 offen lds
s_add_u32 m0, s38, 16384
s_mov_b32 s3, 524288
buffer_load_dwordx4 v5, s[8:11], s3 offen lds
s_add_u32 m0, s38, 20480
s_mov_b32 s3, 655360
buffer_load_dwordx4 v5, s[8:11], s3 offen lds
s_add_u32 m0, s38, 24576
s_mov_b32 s3, 786432
buffer_load_dwordx4 v5, s[8:11], s3 offen lds
s_add_u32 m0, s38, 28672
s_mov_b32 s3, 917504
buffer_load_dwordx4 v5, s[8:11], s3 offen lds
s_add_u32 m0, s38, 32768
s_mov_b32 s3, 1048576
buffer_load_dwordx4 v5, s[8:11], s3 offen lds
s_add_u32 m0, s38, 36864
s_mov_b32 s3, 1179648
buffer_load_dwordx4 v5, s[8:11], s3 offen lds
s_add_u32 m0, s38, 40960
s_mov_b32 s3, 1310720
buffer_load_dwordx4 v5, s[8:11], s3 offen lds
s_add_u32 m0, s38, 45056
s_mov_b32 s3, 1441792
buffer_load_dwordx4 v5, s[8:11], s3 offen lds
s_add_u32 m0, s38, 49152
s_mov_b32 s3, 1572864
buffer_load_dwordx4 v5, s[8:11], s3 offen lds
s_add_u32 m0, s38, 53248
s_mov_b32 s3, 1703936
buffer_load_dwordx4 v5, s[8:11], s3 offen lds
s_add_u32 m0, s38, 57344
s_mov_b32 s3, 1835008
buffer_load_dwordx4 v5, s[8:11], s3 offen lds
s_add_u32 m0, s38, 61440
s_mov_b32 s3, 1966080
buffer_load_dwordx4 v5, s[8:11], s3 offen lds
v_add_u32 v8, 0, v6
s_waitcnt vmcnt(12)
s_barrier
ds_read_b64_tr_b16 v[192:193], v8 offset:0
ds_read_b64_tr_b16 v[194:195], v8 offset:1024
ds_read_b64_tr_b16 v[196:197], v8 offset:32
ds_read_b64_tr_b16 v[198:199], v8 offset:1056
ds_read_b64_tr_b16 v[200:201], v8 offset:8192
ds_read_b64_tr_b16 v[202:203], v8 offset:9216
ds_read_b64_tr_b16 v[204:205], v8 offset:8224
ds_read_b64_tr_b16 v[206:207], v8 offset:9248
s_add_u32 m0, s38, 65536
s_mov_b32 s3, 2097152
buffer_load_dwordx4 v5, s[8:11], s3 offen lds
s_add_u32 m0, s38, 69632
s_mov_b32 s3, 2228224
buffer_load_dwordx4 v5, s[8:11], s3 offen lds
s_add_u32 m0, s38, 73728
s_mov_b32 s3, 2359296
buffer_load_dwordx4 v5, s[8:11], s3 offen lds
s_add_u32 m0, s38, 77824
s_mov_b32 s3, 2490368
buffer_load_dwordx4 v5, s[8:11], s3 offen lds
v_add_u32 v8, 16384, v6
s_waitcnt vmcnt(12)
s_waitcnt lgkmcnt(0)
s_barrier
ds_read_b64_tr_b16 v[208:209], v8 offset:0
ds_read_b64_tr_b16 v[210:211], v8 offset:1024
ds_read_b64_tr_b16 v[212:213], v8 offset:32
ds_read_b64_tr_b16 v[214:215], v8 offset:1056
ds_read_b64_tr_b16 v[216:217], v8 offset:8192
ds_read_b64_tr_b16 v[218:219], v8 offset:9216
ds_read_b64_tr_b16 v[220:221], v8 offset:8224
ds_read_b64_tr_b16 v[222:223], v8 offset:9248
s_add_u32 m0, s38, 81920
s_mov_b32 s3, 2621440
buffer_load_dwordx4 v5, s[8:11], s3 offen lds
s_add_u32 m0, s38, 86016
s_mov_b32 s3, 2752512
buffer_load_dwordx4 v5, s[8:11], s3 offen lds
s_add_u32 m0, s38, 90112
s_mov_b32 s3, 2883584
buffer_load_dwordx4 v5, s[8:11], s3 offen lds
s_add_u32 m0, s38, 94208
s_mov_b32 s3, 3014656
buffer_load_dwordx4 v5, s[8:11], s3 offen lds
v_add_u32 v8, 32768, v6
s_waitcnt vmcnt(12)
s_waitcnt lgkmcnt(0)
s_barrier
ds_read_b64_tr_b16 v[224:225], v8 offset:0
ds_read_b64_tr_b16 v[226:227], v8 offset:1024
ds_read_b64_tr_b16 v[228:229], v8 offset:32
ds_read_b64_tr_b16 v[230:231], v8 offset:1056
ds_read_b64_tr_b16 v[232:233], v8 offset:8192
ds_read_b64_tr_b16 v[234:235], v8 offset:9216
ds_read_b64_tr_b16 v[236:237], v8 offset:8224
ds_read_b64_tr_b16 v[238:239], v8 offset:9248
s_add_u32 m0, s38, 98304
s_mov_b32 s3, 3145728
buffer_load_dwordx4 v5, s[8:11], s3 offen lds
s_add_u32 m0, s38, 102400
s_mov_b32 s3, 3276800
buffer_load_dwordx4 v5, s[8:11], s3 offen lds
s_add_u32 m0, s38, 106496
s_mov_b32 s3, 3407872
buffer_load_dwordx4 v5, s[8:11], s3 offen lds
s_add_u32 m0, s38, 110592
s_mov_b32 s3, 3538944
buffer_load_dwordx4 v5, s[8:11], s3 offen lds
v_add_u32 v8, 49152, v6
s_waitcnt vmcnt(12)
s_waitcnt lgkmcnt(0)
s_barrier
ds_read_b64_tr_b16 v[240:241], v8 offset:0
ds_read_b64_tr_b16 v[242:243], v8 offset:1024
ds_read_b64_tr_b16 v[244:245], v8 offset:32
ds_read_b64_tr_b16 v[246:247], v8 offset:1056
ds_read_b64_tr_b16 v[248:249], v8 offset:8192
ds_read_b64_tr_b16 v[250:251], v8 offset:9216
ds_read_b64_tr_b16 v[252:253], v8 offset:8224
ds_read_b64_tr_b16 v[254:255], v8 offset:9248
s_add_u32 m0, s38, 114688
s_mov_b32 s3, 3670016
buffer_load_dwordx4 v5, s[8:11], s3 offen lds
s_add_u32 m0, s38, 118784
s_mov_b32 s3, 3801088
buffer_load_dwordx4 v5, s[8:11], s3 offen lds
s_add_u32 m0, s38, 122880
s_mov_b32 s3, 3932160
buffer_load_dwordx4 v5, s[8:11], s3 offen lds
s_add_u32 m0, s38, 126976
s_mov_b32 s3, 4063232
buffer_load_dwordx4 v5, s[8:11], s3 offen lds
v_add_u32 v8, 65536, v6
s_waitcnt vmcnt(12)
s_waitcnt lgkmcnt(0)
s_barrier
ds_read_b64_tr_b16 a[0:1], v8 offset:0
ds_read_b64_tr_b16 a[2:3], v8 offset:1024
ds_read_b64_tr_b16 a[4:5], v8 offset:32
ds_read_b64_tr_b16 a[6:7], v8 offset:1056
ds_read_b64_tr_b16 a[8:9], v8 offset:8192
ds_read_b64_tr_b16 a[10:11], v8 offset:9216
ds_read_b64_tr_b16 a[12:13], v8 offset:8224
ds_read_b64_tr_b16 a[14:15], v8 offset:9248
s_add_u32 m0, s38, 131072
s_mov_b32 s3, 4194304
buffer_load_dwordx4 v5, s[8:11], s3 offen lds
s_add_u32 m0, s38, 135168
s_mov_b32 s3, 4325376
buffer_load_dwordx4 v5, s[8:11], s3 offen lds
s_add_u32 m0, s38, 139264
s_mov_b32 s3, 4456448
buffer_load_dwordx4 v5, s[8:11], s3 offen lds
s_add_u32 m0, s38, 143360
s_mov_b32 s3, 4587520
buffer_load_dwordx4 v5, s[8:11], s3 offen lds
v_add_u32 v8, 81920, v6
s_waitcnt vmcnt(12)
s_waitcnt lgkmcnt(0)
s_barrier
ds_read_b64_tr_b16 a[16:17], v8 offset:0
ds_read_b64_tr_b16 a[18:19], v8 offset:1024
ds_read_b64_tr_b16 a[20:21], v8 offset:32
ds_read_b64_tr_b16 a[22:23], v8 offset:1056
ds_read_b64_tr_b16 a[24:25], v8 offset:8192
ds_read_b64_tr_b16 a[26:27], v8 offset:9216
ds_read_b64_tr_b16 a[28:29], v8 offset:8224
ds_read_b64_tr_b16 a[30:31], v8 offset:9248
s_add_u32 m0, s38, 147456
s_mov_b32 s3, 4718592
buffer_load_dwordx4 v5, s[8:11], s3 offen lds
s_add_u32 m0, s38, 151552
s_mov_b32 s3, 4849664
buffer_load_dwordx4 v5, s[8:11], s3 offen lds
s_add_u32 m0, s38, 155648
s_mov_b32 s3, 4980736
buffer_load_dwordx4 v5, s[8:11], s3 offen lds
s_add_u32 m0, s38, 159744
s_mov_b32 s3, 5111808
buffer_load_dwordx4 v5, s[8:11], s3 offen lds
v_add_u32 v8, 98304, v6
s_waitcnt vmcnt(12)
s_waitcnt lgkmcnt(0)
s_barrier
ds_read_b64_tr_b16 a[32:33], v8 offset:0
ds_read_b64_tr_b16 a[34:35], v8 offset:1024
ds_read_b64_tr_b16 a[36:37], v8 offset:32
ds_read_b64_tr_b16 a[38:39], v8 offset:1056
ds_read_b64_tr_b16 a[40:41], v8 offset:8192
ds_read_b64_tr_b16 a[42:43], v8 offset:9216
ds_read_b64_tr_b16 a[44:45], v8 offset:8224
ds_read_b64_tr_b16 a[46:47], v8 offset:9248
s_add_u32 m0, s38, 0
s_mov_b32 s3, 2621440
buffer_load_dwordx4 v5, s[12:15], s3 offen lds
s_add_u32 m0, s38, 4096
s_mov_b32 s3, 2752512
buffer_load_dwordx4 v5, s[12:15], s3 offen lds
s_add_u32 m0, s38, 8192
s_mov_b32 s3, 2883584
buffer_load_dwordx4 v5, s[12:15], s3 offen lds
s_add_u32 m0, s38, 12288
s_mov_b32 s3, 3014656
buffer_load_dwordx4 v5, s[12:15], s3 offen lds
v_add_u32 v8, 114688, v6
s_waitcnt vmcnt(12)
s_waitcnt lgkmcnt(0)
s_barrier
ds_read_b64_tr_b16 a[48:49], v8 offset:0
ds_read_b64_tr_b16 a[50:51], v8 offset:1024
ds_read_b64_tr_b16 a[52:53], v8 offset:32
ds_read_b64_tr_b16 a[54:55], v8 offset:1056
ds_read_b64_tr_b16 a[56:57], v8 offset:8192
ds_read_b64_tr_b16 a[58:59], v8 offset:9216
ds_read_b64_tr_b16 a[60:61], v8 offset:8224
ds_read_b64_tr_b16 a[62:63], v8 offset:9248
s_add_u32 m0, s38, 16384
s_mov_b32 s3, 3145728
buffer_load_dwordx4 v5, s[12:15], s3 offen lds
s_add_u32 m0, s38, 20480
s_mov_b32 s3, 3276800
buffer_load_dwordx4 v5, s[12:15], s3 offen lds
s_add_u32 m0, s38, 24576
s_mov_b32 s3, 3407872
buffer_load_dwordx4 v5, s[12:15], s3 offen lds
s_add_u32 m0, s38, 28672
s_mov_b32 s3, 3538944
buffer_load_dwordx4 v5, s[12:15], s3 offen lds
v_add_u32 v8, 131072, v6
s_waitcnt vmcnt(12)
s_waitcnt lgkmcnt(0)
s_barrier
ds_read_b64_tr_b16 a[64:65], v8 offset:0
ds_read_b64_tr_b16 a[66:67], v8 offset:1024
ds_read_b64_tr_b16 a[68:69], v8 offset:32
ds_read_b64_tr_b16 a[70:71], v8 offset:1056
ds_read_b64_tr_b16 a[72:73], v8 offset:8192
ds_read_b64_tr_b16 a[74:75], v8 offset:9216
ds_read_b64_tr_b16 a[76:77], v8 offset:8224
ds_read_b64_tr_b16 a[78:79], v8 offset:9248
s_add_u32 m0, s38, 32768
s_mov_b32 s3, 3670016
buffer_load_dwordx4 v5, s[12:15], s3 offen lds
s_add_u32 m0, s38, 36864
s_mov_b32 s3, 3801088
buffer_load_dwordx4 v5, s[12:15], s3 offen lds
s_add_u32 m0, s38, 40960
s_mov_b32 s3, 3932160
buffer_load_dwordx4 v5, s[12:15], s3 offen lds
s_add_u32 m0, s38, 45056
s_mov_b32 s3, 4063232
buffer_load_dwordx4 v5, s[12:15], s3 offen lds
v_add_u32 v8, 147456, v6
s_waitcnt vmcnt(12)
s_waitcnt lgkmcnt(0)
s_barrier
ds_read_b64_tr_b16 a[80:81], v8 offset:0
ds_read_b64_tr_b16 a[82:83], v8 offset:1024
ds_read_b64_tr_b16 a[84:85], v8 offset:32
ds_read_b64_tr_b16 a[86:87], v8 offset:1056
ds_read_b64_tr_b16 a[88:89], v8 offset:8192
ds_read_b64_tr_b16 a[90:91], v8 offset:9216
ds_read_b64_tr_b16 a[92:93], v8 offset:8224
ds_read_b64_tr_b16 a[94:95], v8 offset:9248
s_add_u32 m0, s38, 49152
s_mov_b32 s3, 4194304
buffer_load_dwordx4 v5, s[12:15], s3 offen lds
s_add_u32 m0, s38, 53248
s_mov_b32 s3, 4325376
buffer_load_dwordx4 v5, s[12:15], s3 offen lds
s_add_u32 m0, s38, 57344
s_mov_b32 s3, 4456448
buffer_load_dwordx4 v5, s[12:15], s3 offen lds
s_add_u32 m0, s38, 61440
s_mov_b32 s3, 4587520
buffer_load_dwordx4 v5, s[12:15], s3 offen lds
v_add_u32 v8, 0, v6
s_waitcnt vmcnt(12)
s_waitcnt lgkmcnt(0)
s_barrier
ds_read_b64_tr_b16 a[176:177], v8 offset:0
ds_read_b64_tr_b16 a[178:179], v8 offset:1024
ds_read_b64_tr_b16 a[180:181], v8 offset:32
ds_read_b64_tr_b16 a[182:183], v8 offset:1056
ds_read_b64_tr_b16 a[184:185], v8 offset:8192
ds_read_b64_tr_b16 a[186:187], v8 offset:9216
ds_read_b64_tr_b16 a[188:189], v8 offset:8224
ds_read_b64_tr_b16 a[190:191], v8 offset:9248
s_add_u32 m0, s38, 65536
s_mov_b32 s3, 4718592
buffer_load_dwordx4 v5, s[12:15], s3 offen lds
s_add_u32 m0, s38, 69632
s_mov_b32 s3, 4849664
buffer_load_dwordx4 v5, s[12:15], s3 offen lds
s_add_u32 m0, s38, 73728
s_mov_b32 s3, 4980736
buffer_load_dwordx4 v5, s[12:15], s3 offen lds
s_add_u32 m0, s38, 77824
s_mov_b32 s3, 5111808
buffer_load_dwordx4 v5, s[12:15], s3 offen lds
v_add_u32 v8, 16384, v6
s_waitcnt vmcnt(12)
s_waitcnt lgkmcnt(0)
s_barrier
ds_read_b64_tr_b16 a[192:193], v8 offset:0
ds_read_b64_tr_b16 a[194:195], v8 offset:1024
ds_read_b64_tr_b16 a[196:197], v8 offset:32
ds_read_b64_tr_b16 a[198:199], v8 offset:1056
ds_read_b64_tr_b16 a[200:201], v8 offset:8192
ds_read_b64_tr_b16 a[202:203], v8 offset:9216
ds_read_b64_tr_b16 a[204:205], v8 offset:8224
ds_read_b64_tr_b16 a[206:207], v8 offset:9248
s_add_u32 m0, s38, 81920
s_mov_b32 s3, 0
buffer_load_dwordx4 v5, s[12:15], s3 offen lds
s_add_u32 m0, s38, 86016
s_mov_b32 s3, 131072
buffer_load_dwordx4 v5, s[12:15], s3 offen lds
s_add_u32 m0, s38, 90112
s_mov_b32 s3, 262144
buffer_load_dwordx4 v5, s[12:15], s3 offen lds
s_add_u32 m0, s38, 94208
s_mov_b32 s3, 393216
buffer_load_dwordx4 v5, s[12:15], s3 offen lds
v_add_u32 v8, 32768, v6
s_waitcnt vmcnt(12)
s_waitcnt lgkmcnt(0)
s_barrier
ds_read_b64_tr_b16 a[208:209], v8 offset:0
ds_read_b64_tr_b16 a[210:211], v8 offset:1024
ds_read_b64_tr_b16 a[212:213], v8 offset:32
ds_read_b64_tr_b16 a[214:215], v8 offset:1056
ds_read_b64_tr_b16 a[216:217], v8 offset:8192
ds_read_b64_tr_b16 a[218:219], v8 offset:9216
ds_read_b64_tr_b16 a[220:221], v8 offset:8224
ds_read_b64_tr_b16 a[222:223], v8 offset:9248
s_add_u32 m0, s38, 98304
s_mov_b32 s3, 524288
buffer_load_dwordx4 v5, s[12:15], s3 offen lds
s_add_u32 m0, s38, 102400
s_mov_b32 s3, 655360
buffer_load_dwordx4 v5, s[12:15], s3 offen lds
s_add_u32 m0, s38, 106496
s_mov_b32 s3, 786432
buffer_load_dwordx4 v5, s[12:15], s3 offen lds
s_add_u32 m0, s38, 110592
s_mov_b32 s3, 917504
buffer_load_dwordx4 v5, s[12:15], s3 offen lds
v_add_u32 v8, 49152, v6
s_waitcnt vmcnt(12)
s_waitcnt lgkmcnt(0)
s_barrier
ds_read_b64_tr_b16 a[224:225], v8 offset:0
ds_read_b64_tr_b16 a[226:227], v8 offset:1024
ds_read_b64_tr_b16 a[228:229], v8 offset:32
ds_read_b64_tr_b16 a[230:231], v8 offset:1056
ds_read_b64_tr_b16 a[232:233], v8 offset:8192
ds_read_b64_tr_b16 a[234:235], v8 offset:9216
ds_read_b64_tr_b16 a[236:237], v8 offset:8224
ds_read_b64_tr_b16 a[238:239], v8 offset:9248
s_add_u32 m0, s38, 114688
s_mov_b32 s3, 1048576
buffer_load_dwordx4 v5, s[12:15], s3 offen lds
s_add_u32 m0, s38, 118784
s_mov_b32 s3, 1179648
buffer_load_dwordx4 v5, s[12:15], s3 offen lds
s_add_u32 m0, s38, 122880
s_mov_b32 s3, 1310720
buffer_load_dwordx4 v5, s[12:15], s3 offen lds
s_add_u32 m0, s38, 126976
s_mov_b32 s3, 1441792
buffer_load_dwordx4 v5, s[12:15], s3 offen lds
v_add_u32 v8, 65536, v6
s_waitcnt vmcnt(12)
s_waitcnt lgkmcnt(0)
s_barrier
ds_read_b64_tr_b16 a[240:241], v8 offset:0
ds_read_b64_tr_b16 a[242:243], v8 offset:1024
ds_read_b64_tr_b16 a[244:245], v8 offset:32
ds_read_b64_tr_b16 a[246:247], v8 offset:1056
ds_read_b64_tr_b16 a[248:249], v8 offset:8192
ds_read_b64_tr_b16 a[250:251], v8 offset:9216
ds_read_b64_tr_b16 a[252:253], v8 offset:8224
ds_read_b64_tr_b16 a[254:255], v8 offset:9248
s_add_u32 m0, s38, 131072
s_mov_b32 s3, 1572864
buffer_load_dwordx4 v5, s[12:15], s3 offen lds
s_add_u32 m0, s38, 135168
s_mov_b32 s3, 1703936
buffer_load_dwordx4 v5, s[12:15], s3 offen lds
s_add_u32 m0, s38, 139264
s_mov_b32 s3, 1835008
buffer_load_dwordx4 v5, s[12:15], s3 offen lds
s_add_u32 m0, s38, 143360
s_mov_b32 s3, 1966080
buffer_load_dwordx4 v5, s[12:15], s3 offen lds
v_add_u32 v8, 81920, v6
s_waitcnt vmcnt(12)
s_waitcnt lgkmcnt(0)
s_barrier
ds_read_b64_tr_b16 a[96:97], v8 offset:0
ds_read_b64_tr_b16 a[98:99], v8 offset:1024
ds_read_b64_tr_b16 a[100:101], v8 offset:32
ds_read_b64_tr_b16 a[102:103], v8 offset:1056
ds_read_b64_tr_b16 a[104:105], v8 offset:8192
ds_read_b64_tr_b16 a[106:107], v8 offset:9216
ds_read_b64_tr_b16 a[108:109], v8 offset:8224
ds_read_b64_tr_b16 a[110:111], v8 offset:9248
s_add_u32 m0, s38, 147456
s_mov_b32 s3, 2097152
buffer_load_dwordx4 v5, s[12:15], s3 offen lds
s_add_u32 m0, s38, 151552
s_mov_b32 s3, 2228224
buffer_load_dwordx4 v5, s[12:15], s3 offen lds
s_add_u32 m0, s38, 155648
s_mov_b32 s3, 2359296
buffer_load_dwordx4 v5, s[12:15], s3 offen lds
s_add_u32 m0, s38, 159744
s_mov_b32 s3, 2490368
buffer_load_dwordx4 v5, s[12:15], s3 offen lds
v_lshlrev_b32 v82, 2, v0
global_load_dword v83, v82, s[28:29] sc1
v_add_u32 v8, 98304, v6
s_waitcnt vmcnt(13)
s_waitcnt lgkmcnt(0)
s_barrier
ds_read_b64_tr_b16 a[112:113], v8 offset:0
ds_read_b64_tr_b16 a[114:115], v8 offset:1024
ds_read_b64_tr_b16 a[116:117], v8 offset:32
ds_read_b64_tr_b16 a[118:119], v8 offset:1056
ds_read_b64_tr_b16 a[120:121], v8 offset:8192
ds_read_b64_tr_b16 a[122:123], v8 offset:9216
ds_read_b64_tr_b16 a[124:125], v8 offset:8224
ds_read_b64_tr_b16 a[126:127], v8 offset:9248
v_add_u32 v8, 114688, v6
s_waitcnt vmcnt(9)
s_waitcnt lgkmcnt(0)
s_barrier
ds_read_b64_tr_b16 a[128:129], v8 offset:0
ds_read_b64_tr_b16 a[130:131], v8 offset:1024
ds_read_b64_tr_b16 a[132:133], v8 offset:32
ds_read_b64_tr_b16 a[134:135], v8 offset:1056
ds_read_b64_tr_b16 a[136:137], v8 offset:8192
ds_read_b64_tr_b16 a[138:139], v8 offset:9216
ds_read_b64_tr_b16 a[140:141], v8 offset:8224
ds_read_b64_tr_b16 a[142:143], v8 offset:9248
v_add_u32 v8, 131072, v6
s_waitcnt vmcnt(5)
s_waitcnt lgkmcnt(0)
s_barrier
ds_read_b64_tr_b16 a[144:145], v8 offset:0
ds_read_b64_tr_b16 a[146:147], v8 offset:1024
ds_read_b64_tr_b16 a[148:149], v8 offset:32
ds_read_b64_tr_b16 a[150:151], v8 offset:1056
ds_read_b64_tr_b16 a[152:153], v8 offset:8192
ds_read_b64_tr_b16 a[154:155], v8 offset:9216
ds_read_b64_tr_b16 a[156:157], v8 offset:8224
ds_read_b64_tr_b16 a[158:159], v8 offset:9248
v_add_u32 v8, 147456, v6
s_waitcnt vmcnt(1)
s_waitcnt lgkmcnt(0)
s_barrier
ds_read_b64_tr_b16 a[160:161], v8 offset:0
ds_read_b64_tr_b16 a[162:163], v8 offset:1024
ds_read_b64_tr_b16 a[164:165], v8 offset:32
ds_read_b64_tr_b16 a[166:167], v8 offset:1056
ds_read_b64_tr_b16 a[168:169], v8 offset:8192
ds_read_b64_tr_b16 a[170:171], v8 offset:9216
ds_read_b64_tr_b16 a[172:173], v8 offset:8224
ds_read_b64_tr_b16 a[174:175], v8 offset:9248
s_waitcnt lgkmcnt(0)
s_barrier
s_branch L_kc1v_s
L_kc0v_s:
global_load_dword v83, v82, s[28:29] sc1
s_add_u32 s27, s27, 1
s_cmp_gt_u32 s27, 262144
s_cbranch_scc1 L_fail_s
L_kc1v_s:
s_lshl_b32 s3, s77, 4
s_add_u32 s3, s3, 14
s_waitcnt vmcnt(0)
v_readlane_b32 s3, v83, s3
s_cmp_lt_u32 s3, 0x400000
s_cbranch_scc1 L_kc0v_s
s_and_b32 s31, s3, 0xff
s_cmp_ge_u32 s31, 32
s_cselect_b32 s30, 8192, 0
s_bfe_u32 s31, s3, 0x80008
s_cmp_ge_u32 s31, 32
s_cselect_b32 s31, 0, 16384
s_add_u32 s30, s30, s31
s_mul_i32 s35, s25, 2097152
s_add_u32 s35, s35, 50331648
s_lshr_b32 s3, s35, 8
s_xor_b32 s3, s3, s30
s_and_b32 s3, s3, 8192
s_add_u32 s35, s35, s3
s_lshl_b32 s3, s26, 10
s_xor_b32 s36, s35, 8192
s_add_u32 s36, s36, s3
s_lshl_b32 s3, s26, 11
s_add_u32 s35, s35, s3
s_add_u32 s35, s35, 16384
s_mul_i32 s38, s26, 10240
s_add_u32 s33, s38, 6291456
s_mov_b32 s34, s38
s_mov_b32 s40, 0
s_mov_b32 s32, 0
s_mov_b32 s39, 1040356334
v_mov_b32 v11, 0
s_cmp_lg_u32 s26, 0
s_cbranch_scc1 L_cenwv_s
v_mbcnt_lo_u32_b32 v10, -1, 0
v_mbcnt_hi_u32_b32 v10, -1, v10
v_and_b32 v10, 7, v10
v_mul_u32_u24 v10, 66, v10
v_and_b32 v10, 0xc8, v10
v_add_u32 v10, s76, v10
L_cenv_s:
global_load_dwordx2 v[8:9], v10, s[28:29] sc1
s_add_u32 s27, s27, 1
s_cmp_gt_u32 s27, 262144
s_cbranch_scc1 L_fail_s
s_waitcnt vmcnt(0)
v_cmp_eq_u32 s[30:31], -1, v8
v_cmp_eq_u32 vcc, 0x200000, v9
s_and_b64 s[30:31], s[30:31], vcc
v_lshrrev_b32 v9, 16, v9
s_nop 1
v_add_u32_dpp v9, v9, v9 row_ror:4 row_mask:0xf bank_mask:0xf
s_nop 1
v_add_u32_dpp v9, v9, v9 row_ror:2 row_mask:0xf bank_mask:0xf
s_nop 1
v_add_u32_dpp v9, v9, v9 row_ror:1 row_mask:0xf bank_mask:0xf
v_cmp_lt_u32 vcc, 255, v9
s_cbranch_vccnz L_cendv_s
s_sleep 12
s_branch L_cenv_s
L_cendv_s:
v_mov_b32 v8, s30
ds_write_b32 v11, v8
s_waitcnt lgkmcnt(0)
L_cenwv_s:
s_barrier
ds_read_b32 v8, v11
s_waitcnt lgkmcnt(0)
v_cmp_ne_u32 vcc, -1, v8
s_cbranch_vccnz L_fail_s
s_cmp_lg_u32 s26, 0
s_cbranch_scc1 L_khwv_s
v_min_u32 v80, 11, v0
v_lshlrev_b32 v80, 2, v80
s_mov_b32 s3, 9216
L_kh0v_s:
buffer_load_dword v81, v80, s[4:7], s3 offen sc1
s_add_u32 s27, s27, 1
s_cmp_gt_u32 s27, 262144
s_cbranch_scc1 L_fail_s
s_waitcnt vmcnt(0)
v_cmp_ne_u32 vcc, 1, v81
s_cbranch_vccz L_khok0v_s
s_sleep 2
s_branch L_kh0v_s
L_khok0v_s:
L_khwv_s:
s_barrier
s_add_u32 m0, s34, 0
s_add_u32 s3, s33, 0
buffer_load_dwordx4 v1, s[4:7], s3 offen offset:0 sc1 lds
buffer_load_dwordx4 v1, s[4:7], s3 offen offset:1024 sc1 lds
buffer_load_dwordx4 v1, s[4:7], s3 offen offset:2048 sc1 lds
buffer_load_dwordx4 v1, s[4:7], s3 offen offset:3072 sc1 lds
s_add_u32 m0, s34, 4096
s_add_u32 s3, s33, 4096
buffer_load_dwordx4 v1, s[4:7], s3 offen offset:0 sc1 lds
buffer_load_dwordx4 v1, s[4:7], s3 offen offset:1024 sc1 lds
buffer_load_dwordx4 v1, s[4:7], s3 offen offset:2048 sc1 lds
buffer_load_dwordx4 v1, s[4:7], s3 offen offset:3072 sc1 lds
s_add_u32 m0, s34, 8192
s_add_u32 s3, s33, 8192
buffer_load_dwordx4 v1, s[4:7], s3 offen offset:0 sc1 lds
buffer_load_dwordx4 v1, s[4:7], s3 offen offset:1024 sc1 lds
s_add_u32 s33, s33, 40960
s_add_u32 s34, s34, 40960
s_cmp_ge_u32 s34, 163840
s_cselect_b32 s3, 163840, 0
s_sub_u32 s34, s34, s3
s_add_u32 m0, s34, 0
s_add_u32 s3, s33, 0
buffer_load_dwordx4 v1, s[4:7], s3 offen offset:0 sc1 lds
buffer_load_dwordx4 v1, s[4:7], s3 offen offset:1024 sc1 lds
buffer_load_dwordx4 v1, s[4:7], s3 offen offset:2048 sc1 lds
buffer_load_dwordx4 v1, s[4:7], s3 offen offset:3072 sc1 lds
s_add_u32 m0, s34, 4096
s_add_u32 s3, s33, 4096
buffer_load_dwordx4 v1, s[4:7], s3 offen offset:0 sc1 lds
buffer_load_dwordx4 v1, s[4:7], s3 offen offset:1024 sc1 lds
buffer_load_dwordx4 v1, s[4:7], s3 offen offset:2048 sc1 lds
buffer_load_dwordx4 v1, s[4:7], s3 offen offset:3072 sc1 lds
s_add_u32 m0, s34, 8192
s_add_u32 s3, s33, 8192
buffer_load_dwordx4 v1, s[4:7], s3 offen offset:0 sc1 lds
buffer_load_dwordx4 v1, s[4:7], s3 offen offset:1024 sc1 lds
s_add_u32 s33, s33, 40960
s_add_u32 s34, s34, 40960
s_cmp_ge_u32 s34, 163840
s_cselect_b32 s3, 163840, 0
s_sub_u32 s34, s34, s3
L_ksegv_s:
s_cmp_lg_u32 s32, 4
s_cbranch_scc1 L_kno1v_s
v_min_u32 v80, 63, v0
v_lshlrev_b32 v80, 2, v80
s_mov_b32 s3, 9216
L_kh1v_s:
buffer_load_dword v81, v80, s[4:7], s3 offen sc1
s_add_u32 s27, s27, 1
s_cmp_gt_u32 s27, 262144
s_cbranch_scc1 L_fail_s
s_waitcnt vmcnt(0)
v_cmp_ne_u32 vcc, 1, v81
s_cbranch_vccz L_khok1v_s
s_sleep 2
s_branch L_kh1v_s
L_khok1v_s:
L_kno1v_s:
s_cmp_lg_u32 s32, 30
s_cbranch_scc1 L_kno2v_s
v_min_u32 v80, 63, v0
v_lshlrev_b32 v80, 2, v80
s_mov_b32 s3, 9472
L_kh2v_s:
buffer_load_dword v81, v80, s[4:7], s3 offen sc1
s_add_u32 s27, s27, 1
s_cmp_gt_u32 s27, 262144
s_cbranch_scc1 L_fail_s
s_waitcnt vmcnt(0)
v_cmp_ne_u32 vcc, 1, v81
s_cbranch_vccz L_khok2v_s
s_sleep 2
s_branch L_kh2v_s
L_khok2v_s:
L_kno2v_s:
s_waitcnt vmcnt(10)
s_barrier
v_add_u32 v2, s40, v1
ds_read_b128 v[8:11], v2 offset:0
ds_read_b128 v[12:15], v2 offset:20480
ds_read_b128 v[16:19], v2 offset:1024
ds_read_b128 v[20:23], v2 offset:21504
ds_read_b128 v[24:27], v2 offset:2048
ds_read_b128 v[28:31], v2 offset:22528
s_add_u32 s40, s40, 40960
s_cmp_ge_u32 s40, 163840
s_cselect_b32 s40, 0, s40
v_mov_b32 v5, s32
s_waitcnt lgkmcnt(5)
v_mfma_f32_16x16x32_bf16 v[32:35], v[8:11], v[192:195], 0
s_add_u32 m0, s34, 0
s_add_u32 s3, s33, 0
buffer_load_dwordx4 v1, s[4:7], s3 offen offset:0 sc1 lds
v_mfma_f32_16x16x32_bf16 v[40:43], v[8:11], v[196:199], 0
ds_read_b128 v[8:11], v2 offset:3072
s_waitcnt lgkmcnt(5)
v_mfma_f32_16x16x32_bf16 v[36:39], v[12:15], v[192:195], 0
v_mfma_f32_16x16x32_bf16 v[44:47], v[12:15], v[196:199], 0
ds_read_b128 v[12:15], v2 offset:23552
s_waitcnt lgkmcnt(5)
v_mfma_f32_16x16x32_bf16 v[32:35], v[16:19], v[200:203], v[32:35]
v_mfma_f32_16x16x32_bf16 v[40:43], v[16:19], v[204:207], v[40:43]
ds_read_b128 v[16:19], v2 offset:4096
s_waitcnt lgkmcnt(5)
v_mfma_f32_16x16x32_bf16 v[36:39], v[20:23], v[200:203], v[36:39]
buffer_load_dwordx4 v1, s[4:7], s3 offen offset:1024 sc1 lds
v_mfma_f32_16x16x32_bf16 v[44:47], v[20:23], v[204:207], v[44:47]
ds_read_b128 v[20:23], v2 offset:24576
s_waitcnt lgkmcnt(5)
v_mfma_f32_16x16x32_bf16 v[32:35], v[24:27], v[208:211], v[32:35]
v_mfma_f32_16x16x32_bf16 v[40:43], v[24:27], v[212:215], v[40:43]
ds_read_b128 v[24:27], v2 offset:5120
s_waitcnt lgkmcnt(5)
v_mfma_f32_16x16x32_bf16 v[36:39], v[28:31], v[208:211], v[36:39]
v_mfma_f32_16x16x32_bf16 v[44:47], v[28:31], v[212:215], v[44:47]
ds_read_b128 v[28:31], v2 offset:25600
s_waitcnt lgkmcnt(5)
v_mfma_f32_16x16x32_bf16 v[32:35], v[8:11], v[216:219], v[32:35]
buffer_load_dwordx4 v1, s[4:7], s3 offen offset:2048 sc1 lds
v_mfma_f32_16x16x32_bf16 v[40:43], v[8:11], v[220:223], v[40:43]
ds_read_b128 v[8:11], v2 offset:6144
s_waitcnt lgkmcnt(5)
v_mfma_f32_16x16x32_bf16 v[36:39], v[12:15], v[216:219], v[36:39]
v_mfma_f32_16x16x32_bf16 v[44:47], v[12:15], v[220:223], v[44:47]
ds_read_b128 v[12:15], v2 offset:26624
s_waitcnt lgkmcnt(5)
v_mfma_f32_16x16x32_bf16 v[32:35], v[16:19], v[224:227], v[32:35]
v_mfma_f32_16x16x32_bf16 v[40:43], v[16:19], v[228:231], v[40:43]
ds_read_b128 v[16:19], v2 offset:7168
s_waitcnt lgkmcnt(5)
v_mfma_f32_16x16x32_bf16 v[36:39], v[20:23], v[224:227], v[36:39]
buffer_load_dwordx4 v1, s[4:7], s3 offen offset:3072 sc1 lds
v_mfma_f32_16x16x32_bf16 v[44:47], v[20:23], v[228:231], v[44:47]
ds_read_b128 v[20:23], v2 offset:27648
s_waitcnt lgkmcnt(5)
v_mfma_f32_16x16x32_bf16 v[32:35], v[24:27], v[232:235], v[32:35]
v_mfma_f32_16x16x32_bf16 v[40:43], v[24:27], v[236:239], v[40:43]
ds_read_b128 v[24:27], v2 offset:8192
s_waitcnt lgkmcnt(5)
v_mfma_f32_16x16x32_bf16 v[36:39], v[28:31], v[232:235], v[36:39]
v_mfma_f32_16x16x32_bf16 v[44:47], v[28:31], v[236:239], v[44:47]
ds_read_b128 v[28:31], v2 offset:28672
s_waitcnt lgkmcnt(5)
v_mfma_f32_16x16x32_bf16 v[32:35], v[8:11], v[240:243], v[32:35]
s_add_u32 m0, s34, 4096
s_add_u32 s3, s33, 4096
buffer_load_dwordx4 v1, s[4:7], s3 offen offset:0 sc1 lds
v_mfma_f32_16x16x32_bf16 v[40:43], v[8:11], v[244:247], v[40:43]
ds_read_b128 v[8:11], v2 offset:9216
s_waitcnt lgkmcnt(5)
v_mfma_f32_16x16x32_bf16 v[36:39], v[12:15], v[240:243], v[36:39]
v_mfma_f32_16x16x32_bf16 v[44:47], v[12:15], v[244:247], v[44:47]
ds_read_b128 v[12:15], v2 offset:29696
s_waitcnt lgkmcnt(5)
v_mfma_f32_16x16x32_bf16 v[32:35], v[16:19], v[248:251], v[32:35]
v_mfma_f32_16x16x32_bf16 v[40:43], v[16:19], v[252:255], v[40:43]
ds_read_b128 v[16:19], v2 offset:10240
s_waitcnt lgkmcnt(5)
v_mfma_f32_16x16x32_bf16 v[36:39], v[20:23], v[248:251], v[36:39]
buffer_load_dwordx4 v1, s[4:7], s3 offen offset:1024 sc1 lds
v_mfma_f32_16x16x32_bf16 v[44:47], v[20:23], v[252:255], v[44:47]
ds_read_b128 v[20:23], v2 offset:30720
s_waitcnt lgkmcnt(5)
v_mfma_f32_16x16x32_bf16 v[32:35], v[24:27], a[0:3], v[32:35]
v_mfma_f32_16x16x32_bf16 v[40:43], v[24:27], a[4:7], v[40:43]
ds_read_b128 v[24:27], v2 offset:11264
s_waitcnt lgkmcnt(5)
v_mfma_f32_16x16x32_bf16 v[36:39], v[28:31], a[0:3], v[36:39]
v_mfma_f32_16x16x32_bf16 v[44:47], v[28:31], a[4:7], v[44:47]
ds_read_b128 v[28:31], v2 offset:31744
s_waitcnt lgkmcnt(5)
v_mfma_f32_16x16x32_bf16 v[32:35], v[8:11], a[8:11], v[32:35]
buffer_load_dwordx4 v1, s[4:7], s3 offen offset:2048 sc1 lds
v_mfma_f32_16x16x32_bf16 v[40:43], v[8:11], a[12:15], v[40:43]
ds_read_b128 v[8:11], v2 offset:12288
s_waitcnt lgkmcnt(5)
v_mfma_f32_16x16x32_bf16 v[36:39], v[12:15], a[8:11], v[36:39]
v_mfma_f32_16x16x32_bf16 v[44:47], v[12:15], a[12:15], v[44:47]
ds_read_b128 v[12:15], v2 offset:32768
s_waitcnt lgkmcnt(5)
v_mfma_f32_16x16x32_bf16 v[32:35], v[16:19], a[16:19], v[32:35]
v_mfma_f32_16x16x32_bf16 v[40:43], v[16:19], a[20:23], v[40:43]
ds_read_b128 v[16:19], v2 offset:13312
s_waitcnt lgkmcnt(5)
v_mfma_f32_16x16x32_bf16 v[36:39], v[20:23], a[16:19], v[36:39]
buffer_load_dwordx4 v1, s[4:7], s3 offen offset:3072 sc1 lds
v_mfma_f32_16x16x32_bf16 v[44:47], v[20:23], a[20:23], v[44:47]
ds_read_b128 v[20:23], v2 offset:33792
s_waitcnt lgkmcnt(5)
v_mfma_f32_16x16x32_bf16 v[32:35], v[24:27], a[24:27], v[32:35]
v_mfma_f32_16x16x32_bf16 v[40:43], v[24:27], a[28:31], v[40:43]
ds_read_b128 v[24:27], v2 offset:14336
s_waitcnt lgkmcnt(5)
v_mfma_f32_16x16x32_bf16 v[36:39], v[28:31], a[24:27], v[36:39]
v_mfma_f32_16x16x32_bf16 v[44:47], v[28:31], a[28:31], v[44:47]
ds_read_b128 v[28:31], v2 offset:34816
s_waitcnt lgkmcnt(5)
v_mfma_f32_16x16x32_bf16 v[32:35], v[8:11], a[32:35], v[32:35]
s_add_u32 m0, s34, 8192
s_add_u32 s3, s33, 8192
buffer_load_dwordx4 v1, s[4:7], s3 offen offset:0 sc1 lds
v_mfma_f32_16x16x32_bf16 v[40:43], v[8:11], a[36:39], v[40:43]
ds_read_b128 v[8:11], v2 offset:15360
s_waitcnt lgkmcnt(5)
v_mfma_f32_16x16x32_bf16 v[36:39], v[12:15], a[32:35], v[36:39]
v_mfma_f32_16x16x32_bf16 v[44:47], v[12:15], a[36:39], v[44:47]
ds_read_b128 v[12:15], v2 offset:35840
s_waitcnt lgkmcnt(5)
v_mfma_f32_16x16x32_bf16 v[32:35], v[16:19], a[40:43], v[32:35]
v_mfma_f32_16x16x32_bf16 v[40:43], v[16:19], a[44:47], v[40:43]
ds_read_b128 v[16:19], v2 offset:16384
s_waitcnt lgkmcnt(5)
v_mfma_f32_16x16x32_bf16 v[36:39], v[20:23], a[40:43], v[36:39]
buffer_load_dwordx4 v1, s[4:7], s3 offen offset:1024 sc1 lds
s_add_u32 s33, s33, 40960
s_add_u32 s34, s34, 40960
s_cmp_ge_u32 s34, 163840
s_cselect_b32 s3, 163840, 0
s_sub_u32 s34, s34, s3
v_mfma_f32_16x16x32_bf16 v[44:47], v[20:23], a[44:47], v[44:47]
ds_read_b128 v[20:23], v2 offset:36864
s_waitcnt lgkmcnt(5)
v_mfma_f32_16x16x32_bf16 v[32:35], v[24:27], a[48:51], v[32:35]
v_mfma_f32_16x16x32_bf16 v[40:43], v[24:27], a[52:55], v[40:43]
ds_read_b128 v[24:27], v2 offset:17408
s_waitcnt lgkmcnt(5)
v_mfma_f32_16x16x32_bf16 v[36:39], v[28:31], a[48:51], v[36:39]
v_mfma_f32_16x16x32_bf16 v[44:47], v[28:31], a[52:55], v[44:47]
ds_read_b128 v[28:31], v2 offset:37888
s_waitcnt lgkmcnt(5)
v_mfma_f32_16x16x32_bf16 v[32:35], v[8:11], a[56:59], v[32:35]
v_mfma_f32_16x16x32_bf16 v[40:43], v[8:11], a[60:63], v[40:43]
ds_read_b128 v[8:11], v2 offset:18432
s_waitcnt lgkmcnt(5)
v_mfma_f32_16x16x32_bf16 v[36:39], v[12:15], a[56:59], v[36:39]
v_mfma_f32_16x16x32_bf16 v[44:47], v[12:15], a[60:63], v[44:47]
ds_read_b128 v[12:15], v2 offset:38912
s_waitcnt vmcnt(10)
buffer_store_dword v5, off, s[4:7], s37 sc1
s_waitcnt lgkmcnt(5)
v_mfma_f32_16x16x32_bf16 v[32:35], v[16:19], a[64:67], v[32:35]
v_mfma_f32_16x16x32_bf16 v[40:43], v[16:19], a[68:71], v[40:43]
ds_read_b128 v[16:19], v2 offset:19456
s_waitcnt lgkmcnt(5)
v_mfma_f32_16x16x32_bf16 v[36:39], v[20:23], a[64:67], v[36:39]
v_mfma_f32_16x16x32_bf16 v[44:47], v[20:23], a[68:71], v[44:47]
ds_read_b128 v[20:23], v2 offset:39936
s_waitcnt lgkmcnt(5)
v_mfma_f32_16x16x32_bf16 v[32:35], v[24:27], a[72:75], v[32:35]
v_mfma_f32_16x16x32_bf16 v[40:43], v[24:27], a[76:79], v[40:43]
s_waitcnt lgkmcnt(4)
v_mfma_f32_16x16x32_bf16 v[36:39], v[28:31], a[72:75], v[36:39]
v_mfma_f32_16x16x32_bf16 v[44:47], v[28:31], a[76:79], v[44:47]
s_waitcnt lgkmcnt(3)
v_mfma_f32_16x16x32_bf16 v[32:35], v[8:11], a[80:83], v[32:35]
v_mfma_f32_16x16x32_bf16 v[40:43], v[8:11], a[84:87], v[40:43]
s_waitcnt lgkmcnt(2)
v_mfma_f32_16x16x32_bf16 v[36:39], v[12:15], a[80:83], v[36:39]
v_mfma_f32_16x16x32_bf16 v[44:47], v[12:15], a[84:87], v[44:47]
s_waitcnt lgkmcnt(1)
v_mfma_f32_16x16x32_bf16 v[32:35], v[16:19], a[88:91], v[32:35]
v_mfma_f32_16x16x32_bf16 v[40:43], v[16:19], a[92:95], v[40:43]
s_waitcnt lgkmcnt(0)
v_mfma_f32_16x16x32_bf16 v[36:39], v[20:23], a[88:91], v[36:39]
v_mfma_f32_16x16x32_bf16 v[44:47], v[20:23], a[92:95], v[44:47]
s_nop 3
v_cvt_pk_bf16_f32 v64, v32, v33
v_cvt_pk_bf16_f32 v65, v34, v35
s_nop 0
v_cvt_pk_bf16_f32 v66, v36, v37
v_cvt_pk_bf16_f32 v67, v38, v39
buffer_store_dwordx4 v[64:67], v1, s[4:7], s35 offen offset:0 sc1
v_cvt_pk_bf16_f32 v68, v40, v41
v_cvt_pk_bf16_f32 v69, v42, v43
v_cvt_pk_bf16_f32 v70, v44, v45
v_cvt_pk_bf16_f32 v71, v46, v47
buffer_store_dwordx4 v[68:71], v1, s[4:7], s35 offen offset:1024 sc1
s_add_u32 s35, s35, 32768
s_add_u32 s36, s36, 32768
s_add_u32 s32, s32, 1
s_barrier
v_add_u32 v2, s40, v1
ds_read_b128 v[8:11], v2 offset:0
ds_read_b128 v[12:15], v2 offset:20480
ds_read_b128 v[16:19], v2 offset:1024
ds_read_b128 v[20:23], v2 offset:21504
ds_read_b128 v[24:27], v2 offset:2048
ds_read_b128 v[28:31], v2 offset:22528
s_add_u32 s40, s40, 40960
s_cmp_ge_u32 s40, 163840
s_cselect_b32 s40, 0, s40
v_mov_b32 v5, s32
s_waitcnt lgkmcnt(5)
v_mfma_f32_16x16x32_bf16 v[32:35], v[8:11], v[192:195], 0
s_add_u32 m0, s34, 0
s_add_u32 s3, s33, 0
buffer_load_dwordx4 v1, s[4:7], s3 offen offset:0 sc1 lds
v_mfma_f32_16x16x32_bf16 v[40:43], v[8:11], v[196:199], 0
v_mfma_f32_16x16x32_bf16 v[48:51], a[96:99], v[8:11], 0
v_mfma_f32_16x16x32_bf16 v[52:55], a[100:103], v[8:11], 0
ds_read_b128 v[8:11], v2 offset:3072
s_waitcnt lgkmcnt(5)
v_mfma_f32_16x16x32_bf16 v[36:39], v[12:15], v[192:195], 0
v_mfma_f32_16x16x32_bf16 v[44:47], v[12:15], v[196:199], 0
v_mfma_f32_16x16x32_bf16 v[56:59], a[96:99], v[12:15], 0
v_mfma_f32_16x16x32_bf16 v[60:63], a[100:103], v[12:15], 0
ds_read_b128 v[12:15], v2 offset:23552
s_waitcnt lgkmcnt(5)
v_mfma_f32_16x16x32_bf16 v[32:35], v[16:19], v[200:203], v[32:35]
v_mfma_f32_16x16x32_bf16 v[40:43], v[16:19], v[204:207], v[40:43]
v_mfma_f32_16x16x32_bf16 v[48:51], a[104:107], v[16:19], v[48:51]
v_mfma_f32_16x16x32_bf16 v[52:55], a[108:111], v[16:19], v[52:55]
ds_read_b128 v[16:19], v2 offset:4096
s_waitcnt lgkmcnt(5)
v_mfma_f32_16x16x32_bf16 v[36:39], v[20:23], v[200:203], v[36:39]
buffer_load_dwordx4 v1, s[4:7], s3 offen offset:1024 sc1 lds
v_mfma_f32_16x16x32_bf16 v[44:47], v[20:23], v[204:207], v[44:47]
v_mfma_f32_16x16x32_bf16 v[56:59], a[104:107], v[20:23], v[56:59]
v_mfma_f32_16x16x32_bf16 v[60:63], a[108:111], v[20:23], v[60:63]
ds_read_b128 v[20:23], v2 offset:24576
s_waitcnt lgkmcnt(5)
v_mfma_f32_16x16x32_bf16 v[32:35], v[24:27], v[208:211], v[32:35]
v_mfma_f32_16x16x32_bf16 v[40:43], v[24:27], v[212:215], v[40:43]
v_mfma_f32_16x16x32_bf16 v[48:51], a[112:115], v[24:27], v[48:51]
v_mfma_f32_16x16x32_bf16 v[52:55], a[116:119], v[24:27], v[52:55]
ds_read_b128 v[24:27], v2 offset:5120
s_waitcnt lgkmcnt(5)
v_mfma_f32_16x16x32_bf16 v[36:39], v[28:31], v[208:211], v[36:39]
v_mfma_f32_16x16x32_bf16 v[44:47], v[28:31], v[212:215], v[44:47]
v_mfma_f32_16x16x32_bf16 v[56:59], a[112:115], v[28:31], v[56:59]
v_mfma_f32_16x16x32_bf16 v[60:63], a[116:119], v[28:31], v[60:63]
ds_read_b128 v[28:31], v2 offset:25600
s_waitcnt lgkmcnt(5)
v_mfma_f32_16x16x32_bf16 v[32:35], v[8:11], v[216:219], v[32:35]
buffer_load_dwordx4 v1, s[4:7], s3 offen offset:2048 sc1 lds
v_mfma_f32_16x16x32_bf16 v[40:43], v[8:11], v[220:223], v[40:43]
v_mfma_f32_16x16x32_bf16 v[48:51], a[120:123], v[8:11], v[48:51]
v_mfma_f32_16x16x32_bf16 v[52:55], a[124:127], v[8:11], v[52:55]
ds_read_b128 v[8:11], v2 offset:6144
s_waitcnt lgkmcnt(5)
v_mfma_f32_16x16x32_bf16 v[36:39], v[12:15], v[216:219], v[36:39]
v_mfma_f32_16x16x32_bf16 v[44:47], v[12:15], v[220:223], v[44:47]
v_mfma_f32_16x16x32_bf16 v[56:59], a[120:123], v[12:15], v[56:59]
v_mfma_f32_16x16x32_bf16 v[60:63], a[124:127], v[12:15], v[60:63]
ds_read_b128 v[12:15], v2 offset:26624
s_waitcnt lgkmcnt(5)
v_mfma_f32_16x16x32_bf16 v[32:35], v[16:19], v[224:227], v[32:35]
v_mfma_f32_16x16x32_bf16 v[40:43], v[16:19], v[228:231], v[40:43]
v_mfma_f32_16x16x32_bf16 v[48:51], a[128:131], v[16:19], v[48:51]
v_mfma_f32_16x16x32_bf16 v[52:55], a[132:135], v[16:19], v[52:55]
ds_read_b128 v[16:19], v2 offset:7168
s_waitcnt lgkmcnt(5)
v_mfma_f32_16x16x32_bf16 v[36:39], v[20:23], v[224:227], v[36:39]
buffer_load_dwordx4 v1, s[4:7], s3 offen offset:3072 sc1 lds
v_mfma_f32_16x16x32_bf16 v[44:47], v[20:23], v[228:231], v[44:47]
v_mfma_f32_16x16x32_bf16 v[56:59], a[128:131], v[20:23], v[56:59]
v_mfma_f32_16x16x32_bf16 v[60:63], a[132:135], v[20:23], v[60:63]
ds_read_b128 v[20:23], v2 offset:27648
s_waitcnt lgkmcnt(5)
v_mfma_f32_16x16x32_bf16 v[32:35], v[24:27], v[232:235], v[32:35]
v_mfma_f32_16x16x32_bf16 v[40:43], v[24:27], v[236:239], v[40:43]
v_mfma_f32_16x16x32_bf16 v[48:51], a[136:139], v[24:27], v[48:51]
v_mfma_f32_16x16x32_bf16 v[52:55], a[140:143], v[24:27], v[52:55]
ds_read_b128 v[24:27], v2 offset:8192
s_waitcnt lgkmcnt(5)
v_mfma_f32_16x16x32_bf16 v[36:39], v[28:31], v[232:235], v[36:39]
v_mfma_f32_16x16x32_bf16 v[44:47], v[28:31], v[236:239], v[44:47]
v_mfma_f32_16x16x32_bf16 v[56:59], a[136:139], v[28:31], v[56:59]
v_mfma_f32_16x16x32_bf16 v[60:63], a[140:143], v[28:31], v[60:63]
ds_read_b128 v[28:31], v2 offset:28672
s_waitcnt lgkmcnt(5)
v_mfma_f32_16x16x32_bf16 v[32:35], v[8:11], v[240:243], v[32:35]
s_add_u32 m0, s34, 4096
s_add_u32 s3, s33, 4096
buffer_load_dwordx4 v1, s[4:7], s3 offen offset:0 sc1 lds
v_mfma_f32_16x16x32_bf16 v[40:43], v[8:11], v[244:247], v[40:43]
v_mfma_f32_16x16x32_bf16 v[48:51], a[144:147], v[8:11], v[48:51]
v_mfma_f32_16x16x32_bf16 v[52:55], a[148:151], v[8:11], v[52:55]
ds_read_b128 v[8:11], v2 offset:9216
s_waitcnt lgkmcnt(5)
v_mfma_f32_16x16x32_bf16 v[36:39], v[12:15], v[240:243], v[36:39]
v_mfma_f32_16x16x32_bf16 v[44:47], v[12:15], v[244:247], v[44:47]
v_mfma_f32_16x16x32_bf16 v[56:59], a[144:147], v[12:15], v[56:59]
v_mfma_f32_16x16x32_bf16 v[60:63], a[148:151], v[12:15], v[60:63]
ds_read_b128 v[12:15], v2 offset:29696
s_waitcnt lgkmcnt(5)
v_mfma_f32_16x16x32_bf16 v[32:35], v[16:19], v[248:251], v[32:35]
v_mfma_f32_16x16x32_bf16 v[40:43], v[16:19], v[252:255], v[40:43]
v_mfma_f32_16x16x32_bf16 v[48:51], a[152:155], v[16:19], v[48:51]
v_mfma_f32_16x16x32_bf16 v[52:55], a[156:159], v[16:19], v[52:55]
ds_read_b128 v[16:19], v2 offset:10240
s_waitcnt lgkmcnt(5)
v_mfma_f32_16x16x32_bf16 v[36:39], v[20:23], v[248:251], v[36:39]
buffer_load_dwordx4 v1, s[4:7], s3 offen offset:1024 sc1 lds
v_mfma_f32_16x16x32_bf16 v[44:47], v[20:23], v[252:255], v[44:47]
v_mfma_f32_16x16x32_bf16 v[56:59], a[152:155], v[20:23], v[56:59]
v_mfma_f32_16x16x32_bf16 v[60:63], a[156:159], v[20:23], v[60:63]
ds_read_b128 v[20:23], v2 offset:30720
s_waitcnt lgkmcnt(5)
v_mfma_f32_16x16x32_bf16 v[32:35], v[24:27], a[0:3], v[32:35]
v_mfma_f32_16x16x32_bf16 v[40:43], v[24:27], a[4:7], v[40:43]
v_mfma_f32_16x16x32_bf16 v[48:51], a[160:163], v[24:27], v[48:51]
v_mfma_f32_16x16x32_bf16 v[52:55], a[164:167], v[24:27], v[52:55]
ds_read_b128 v[24:27], v2 offset:11264
s_waitcnt lgkmcnt(5)
v_mfma_f32_16x16x32_bf16 v[36:39], v[28:31], a[0:3], v[36:39]
v_mfma_f32_16x16x32_bf16 v[44:47], v[28:31], a[4:7], v[44:47]
v_mfma_f32_16x16x32_bf16 v[56:59], a[160:163], v[28:31], v[56:59]
v_mfma_f32_16x16x32_bf16 v[60:63], a[164:167], v[28:31], v[60:63]
ds_read_b128 v[28:31], v2 offset:31744
s_waitcnt vmcnt(6)
buffer_store_dword v5, off, s[4:7], s37 sc1
s_waitcnt lgkmcnt(5)
v_mfma_f32_16x16x32_bf16 v[32:35], v[8:11], a[8:11], v[32:35]
buffer_load_dwordx4 v1, s[4:7], s3 offen offset:2048 sc1 lds
v_mfma_f32_16x16x32_bf16 v[40:43], v[8:11], a[12:15], v[40:43]
v_mfma_f32_16x16x32_bf16 v[48:51], a[168:171], v[8:11], v[48:51]
v_mfma_f32_16x16x32_bf16 v[52:55], a[172:175], v[8:11], v[52:55]
ds_read_b128 v[8:11], v2 offset:12288
s_waitcnt lgkmcnt(5)
v_mfma_f32_16x16x32_bf16 v[36:39], v[12:15], a[8:11], v[36:39]
v_mfma_f32_16x16x32_bf16 v[44:47], v[12:15], a[12:15], v[44:47]
v_mfma_f32_16x16x32_bf16 v[56:59], a[168:171], v[12:15], v[56:59]
v_mfma_f32_16x16x32_bf16 v[60:63], a[172:175], v[12:15], v[60:63]
ds_read_b128 v[12:15], v2 offset:32768
s_waitcnt lgkmcnt(5)
v_mfma_f32_16x16x32_bf16 v[32:35], v[16:19], a[16:19], v[32:35]
v_mfma_f32_16x16x32_bf16 v[40:43], v[16:19], a[20:23], v[40:43]
v_mfma_f32_16x16x32_bf16 v[48:51], a[176:179], v[16:19], v[48:51]
v_mfma_f32_16x16x32_bf16 v[52:55], a[180:183], v[16:19], v[52:55]
ds_read_b128 v[16:19], v2 offset:13312
s_waitcnt lgkmcnt(5)
v_mfma_f32_16x16x32_bf16 v[36:39], v[20:23], a[16:19], v[36:39]
buffer_load_dwordx4 v1, s[4:7], s3 offen offset:3072 sc1 lds
v_mfma_f32_16x16x32_bf16 v[44:47], v[20:23], a[20:23], v[44:47]
v_mfma_f32_16x16x32_bf16 v[56:59], a[176:179], v[20:23], v[56:59]
v_mfma_f32_16x16x32_bf16 v[60:63], a[180:183], v[20:23], v[60:63]
ds_read_b128 v[20:23], v2 offset:33792
s_waitcnt lgkmcnt(5)
v_mfma_f32_16x16x32_bf16 v[32:35], v[24:27], a[24:27], v[32:35]
v_mfma_f32_16x16x32_bf16 v[40:43], v[24:27], a[28:31], v[40:43]
v_mfma_f32_16x16x32_bf16 v[48:51], a[184:187], v[24:27], v[48:51]
v_mfma_f32_16x16x32_bf16 v[52:55], a[188:191], v[24:27], v[52:55]
ds_read_b128 v[24:27], v2 offset:14336
s_waitcnt lgkmcnt(5)
v_mfma_f32_16x16x32_bf16 v[36:39], v[28:31], a[24:27], v[36:39]
v_mfma_f32_16x16x32_bf16 v[44:47], v[28:31], a[28:31], v[44:47]
v_mfma_f32_16x16x32_bf16 v[56:59], a[184:187], v[28:31], v[56:59]
v_mfma_f32_16x16x32_bf16 v[60:63], a[188:191], v[28:31], v[60:63]
ds_read_b128 v[28:31], v2 offset:34816
s_waitcnt lgkmcnt(5)
v_mfma_f32_16x16x32_bf16 v[32:35], v[8:11], a[32:35], v[32:35]
s_add_u32 m0, s34, 8192
s_add_u32 s3, s33, 8192
buffer_load_dwordx4 v1, s[4:7], s3 offen offset:0 sc1 lds
v_mfma_f32_16x16x32_bf16 v[40:43], v[8:11], a[36:39], v[40:43]
v_mfma_f32_16x16x32_bf16 v[48:51], a[192:195], v[8:11], v[48:51]
v_mfma_f32_16x16x32_bf16 v[52:55], a[196:199], v[8:11], v[52:55]
ds_read_b128 v[8:11], v2 offset:15360
s_waitcnt lgkmcnt(5)
v_mfma_f32_16x16x32_bf16 v[36:39], v[12:15], a[32:35], v[36:39]
v_mfma_f32_16x16x32_bf16 v[44:47], v[12:15], a[36:39], v[44:47]
v_mfma_f32_16x16x32_bf16 v[56:59], a[192:195], v[12:15], v[56:59]
v_mfma_f32_16x16x32_bf16 v[60:63], a[196:199], v[12:15], v[60:63]
ds_read_b128 v[12:15], v2 offset:35840
s_waitcnt lgkmcnt(5)
v_mfma_f32_16x16x32_bf16 v[32:35], v[16:19], a[40:43], v[32:35]
v_mfma_f32_16x16x32_bf16 v[40:43], v[16:19], a[44:47], v[40:43]
v_mfma_f32_16x16x32_bf16 v[48:51], a[200:203], v[16:19], v[48:51]
v_mfma_f32_16x16x32_bf16 v[52:55], a[204:207], v[16:19], v[52:55]
ds_read_b128 v[16:19], v2 offset:16384
s_waitcnt lgkmcnt(5)
v_mfma_f32_16x16x32_bf16 v[36:39], v[20:23], a[40:43], v[36:39]
buffer_load_dwordx4 v1, s[4:7], s3 offen offset:1024 sc1 lds
s_add_u32 s33, s33, 40960
s_add_u32 s34, s34, 40960
s_cmp_ge_u32 s34, 163840
s_cselect_b32 s3, 163840, 0
s_sub_u32 s34, s34, s3
v_mfma_f32_16x16x32_bf16 v[44:47], v[20:23], a[44:47], v[44:47]
v_mfma_f32_16x16x32_bf16 v[56:59], a[200:203], v[20:23], v[56:59]
v_mfma_f32_16x16x32_bf16 v[60:63], a[204:207], v[20:23], v[60:63]
ds_read_b128 v[20:23], v2 offset:36864
s_waitcnt lgkmcnt(5)
v_mfma_f32_16x16x32_bf16 v[32:35], v[24:27], a[48:51], v[32:35]
v_mfma_f32_16x16x32_bf16 v[40:43], v[24:27], a[52:55], v[40:43]
v_mfma_f32_16x16x32_bf16 v[48:51], a[208:211], v[24:27], v[48:51]
v_mfma_f32_16x16x32_bf16 v[52:55], a[212:215], v[24:27], v[52:55]
ds_read_b128 v[24:27], v2 offset:17408
s_waitcnt lgkmcnt(5)
v_mfma_f32_16x16x32_bf16 v[36:39], v[28:31], a[48:51], v[36:39]
v_mfma_f32_16x16x32_bf16 v[44:47], v[28:31], a[52:55], v[44:47]
v_mfma_f32_16x16x32_bf16 v[56:59], a[208:211], v[28:31], v[56:59]
v_mfma_f32_16x16x32_bf16 v[60:63], a[212:215], v[28:31], v[60:63]
ds_read_b128 v[28:31], v2 offset:37888
s_waitcnt lgkmcnt(5)
v_mfma_f32_16x16x32_bf16 v[32:35], v[8:11], a[56:59], v[32:35]
v_mfma_f32_16x16x32_bf16 v[40:43], v[8:11], a[60:63], v[40:43]
v_mfma_f32_16x16x32_bf16 v[48:51], a[216:219], v[8:11], v[48:51]
v_mfma_f32_16x16x32_bf16 v[52:55], a[220:223], v[8:11], v[52:55]
ds_read_b128 v[8:11], v2 offset:18432
s_waitcnt lgkmcnt(5)
v_mfma_f32_16x16x32_bf16 v[36:39], v[12:15], a[56:59], v[36:39]
v_mfma_f32_16x16x32_bf16 v[44:47], v[12:15], a[60:63], v[44:47]
v_mfma_f32_16x16x32_bf16 v[56:59], a[216:219], v[12:15], v[56:59]
v_mfma_f32_16x16x32_bf16 v[60:63], a[220:223], v[12:15], v[60:63]
ds_read_b128 v[12:15], v2 offset:38912
s_waitcnt lgkmcnt(5)
v_mfma_f32_16x16x32_bf16 v[32:35], v[16:19], a[64:67], v[32:35]
v_mfma_f32_16x16x32_bf16 v[40:43], v[16:19], a[68:71], v[40:43]
v_mfma_f32_16x16x32_bf16 v[48:51], a[224:227], v[16:19], v[48:51]
v_mfma_f32_16x16x32_bf16 v[52:55], a[228:231], v[16:19], v[52:55]
ds_read_b128 v[16:19], v2 offset:19456
s_waitcnt lgkmcnt(5)
v_mfma_f32_16x16x32_bf16 v[36:39], v[20:23], a[64:67], v[36:39]
v_mfma_f32_16x16x32_bf16 v[44:47], v[20:23], a[68:71], v[44:47]
v_mfma_f32_16x16x32_bf16 v[56:59], a[224:227], v[20:23], v[56:59]
v_mfma_f32_16x16x32_bf16 v[60:63], a[228:231], v[20:23], v[60:63]
ds_read_b128 v[20:23], v2 offset:39936
s_waitcnt lgkmcnt(5)
v_mfma_f32_16x16x32_bf16 v[32:35], v[24:27], a[72:75], v[32:35]
v_mfma_f32_16x16x32_bf16 v[40:43], v[24:27], a[76:79], v[40:43]
v_mfma_f32_16x16x32_bf16 v[48:51], a[232:235], v[24:27], v[48:51]
v_mfma_f32_16x16x32_bf16 v[52:55], a[236:239], v[24:27], v[52:55]
s_waitcnt lgkmcnt(4)
v_mfma_f32_16x16x32_bf16 v[36:39], v[28:31], a[72:75], v[36:39]
v_mfma_f32_16x16x32_bf16 v[44:47], v[28:31], a[76:79], v[44:47]
v_mfma_f32_16x16x32_bf16 v[56:59], a[232:235], v[28:31], v[56:59]
v_mfma_f32_16x16x32_bf16 v[60:63], a[236:239], v[28:31], v[60:63]
s_waitcnt lgkmcnt(3)
v_mfma_f32_16x16x32_bf16 v[32:35], v[8:11], a[80:83], v[32:35]
v_mfma_f32_16x16x32_bf16 v[40:43], v[8:11], a[84:87], v[40:43]
v_mfma_f32_16x16x32_bf16 v[48:51], a[240:243], v[8:11], v[48:51]
v_mfma_f32_16x16x32_bf16 v[52:55], a[244:247], v[8:11], v[52:55]
s_waitcnt lgkmcnt(2)
v_mfma_f32_16x16x32_bf16 v[36:39], v[12:15], a[80:83], v[36:39]
v_mfma_f32_16x16x32_bf16 v[44:47], v[12:15], a[84:87], v[44:47]
v_mfma_f32_16x16x32_bf16 v[56:59], a[240:243], v[12:15], v[56:59]
v_mfma_f32_16x16x32_bf16 v[60:63], a[244:247], v[12:15], v[60:63]
s_waitcnt lgkmcnt(1)
v_mfma_f32_16x16x32_bf16 v[32:35], v[16:19], a[88:91], v[32:35]
v_mfma_f32_16x16x32_bf16 v[40:43], v[16:19], a[92:95], v[40:43]
v_mfma_f32_16x16x32_bf16 v[48:51], a[248:251], v[16:19], v[48:51]
v_mfma_f32_16x16x32_bf16 v[52:55], a[252:255], v[16:19], v[52:55]
s_waitcnt lgkmcnt(0)
v_mfma_f32_16x16x32_bf16 v[36:39], v[20:23], a[88:91], v[36:39]
v_mfma_f32_16x16x32_bf16 v[44:47], v[20:23], a[92:95], v[44:47]
v_mfma_f32_16x16x32_bf16 v[56:59], a[248:251], v[20:23], v[56:59]
v_mfma_f32_16x16x32_bf16 v[60:63], a[252:255], v[20:23], v[60:63]
v_cvt_pk_bf16_f32 v64, v32, v33
v_cvt_pk_bf16_f32 v65, v34, v35
s_nop 2
v_cvt_pk_bf16_f32 v66, v36, v37
v_cvt_pk_bf16_f32 v67, v38, v39
buffer_store_dwordx4 v[64:67], v1, s[4:7], s35 offen offset:0 sc1
v_cvt_pk_bf16_f32 v68, v40, v41
v_cvt_pk_bf16_f32 v69, v42, v43
v_cvt_pk_bf16_f32 v70, v44, v45
v_cvt_pk_bf16_f32 v71, v46, v47
buffer_store_dwordx4 v[68:71], v1, s[4:7], s35 offen offset:1024 sc1
v_cvt_pk_bf16_f32 v72, v48, v49
v_cvt_pk_bf16_f32 v73, v50, v51
v_cvt_pk_bf16_f32 v74, v52, v53
v_cvt_pk_bf16_f32 v75, v54, v55
buffer_store_dwordx4 v[72:75], v1, s[4:7], s36 offen offset:0 sc1
v_cvt_pk_bf16_f32 v76, v56, v57
v_cvt_pk_bf16_f32 v77, v58, v59
v_cvt_pk_bf16_f32 v78, v60, v61
v_cvt_pk_bf16_f32 v79, v62, v63
buffer_store_dwordx4 v[76:79], v3, s[4:7], s36 offen offset:0 sc1
s_add_u32 s35, s35, 32768
s_add_u32 s36, s36, 32768
s_add_u32 s32, s32, 1
s_cmp_lt_u32 s32, 64
s_cbranch_scc1 L_ksegv_s
v_mov_b32 v5, 64
s_waitcnt vmcnt(0)
buffer_store_dword v5, off, s[4:7], s37 sc1
s_endpgm
L_fail_s:
s_mov_b64 exec, 1
v_mov_b32 v1, 252
v_mov_b32 v2, 1
global_atomic_add v1, v2, s[28:29] sc1
s_endpgm
.section .rodata,"a"
.p2align 6
.amdhsa_kernel adaLN_cond__memory_aug_recurrent_mem_tr__glu_gated_reglu__prompt_kernel
  .amdhsa_next_free_vgpr 512
  .amdhsa_next_free_sgpr 102
  .amdhsa_accum_offset 256
  .amdhsa_group_segment_fixed_size 0
  .amdhsa_kernarg_size 128
  .amdhsa_user_sgpr_count 2
  .amdhsa_user_sgpr_kernarg_segment_ptr 1
  .amdhsa_system_sgpr_workgroup_id_x 1
  .amdhsa_float_denorm_mode_32 3
.end_amdhsa_kernel
```
